```python
import torch

def _softmax(x, axis=-1):
    return torch.softmax(x, dim=axis)

def _gelu(x):
    return torch.nn.functional.gelu(x, approximate='tanh')

def _silu(x):
    return torch.nn.functional.silu(x)

def _sigmoid(x):
    return torch.sigmoid(x)

def _layernorm(x, axis=-1, eps=1e-05):
    m = x.mean(dim=axis, keepdim=True)
    v = x.var(dim=axis, keepdim=True, unbiased=False)
    return (x - m) / torch.sqrt(v + eps)

def _scatter_add(tgt, idx, src, axis=0):
    return tgt.clone().index_add_(axis, idx, src)

def _segment_sum(src, seg, n):
    out = torch.zeros((n,) + src.shape[1:], dtype=src.dtype)
    return out.index_add_(0, seg, src)

def _pad(x, pw):
    flat = tuple((v for pair in reversed(pw) for v in pair))
    return torch.nn.functional.pad(x, flat)
kernel_name = 'sequential_preLN__sliding_block__mixer_gmlp__prompt'

def setup_inputs():

    _w = lambda a: (lambda t: t.to(torch.bfloat16) if t.is_floating_point() else t)(torch.as_tensor(a))

    def _A_setup():
        B, S, D = (1, 2048, 576)
        return {'x': _w((lambda *s: torch.randn(*s, dtype=torch.bfloat16) * 0.05)(B, S, D)), 'wqkv': _w((lambda *s: torch.randn(*s, dtype=torch.bfloat16) * 0.05)(D, 3 * D)), 'wo': _w((lambda *s: torch.randn(*s, dtype=torch.bfloat16) * 0.05)(D, D))}
    _A_in = _A_setup()

    def _B_setup():
        B, S, D, F = (1, 2048, 576, 4608)
        Fh = F // 2
        return {'x': _w((lambda *s: torch.randn(*s, dtype=torch.bfloat16) * 0.05)(B, S, D)), 'w_in': _w((lambda *s: torch.randn(*s, dtype=torch.bfloat16) * 0.8)(D, 2 * Fh)), 'w_sp': _w(0.01 * (lambda *s: torch.randn(*s, dtype=torch.bfloat16) * 0.8)(S, S)), 'b_sp': _w(1.0 + 0.01 * (lambda *s: torch.randn(*s, dtype=torch.bfloat16) * 0.05)(S)), 'w_out': _w((lambda *s: torch.randn(*s, dtype=torch.bfloat16) * 0.05)(Fh, D))}
    _B_in = _B_setup()
    return {'A_x': _A_in['x'], 'A_wqkv': _A_in['wqkv'], 'A_wo': _A_in['wo'], 'B_x': _B_in['x'], 'B_w_in': _B_in['w_in'], 'B_w_sp': _B_in['w_sp'], 'B_b_sp': _B_in['b_sp'], 'B_w_out': _B_in['w_out']}

def reference(A_x, A_wqkv, A_wo, B_x, B_w_in, B_w_sp, B_b_sp, B_w_out):

    def _A_ref(x, wqkv, wo):
        B, S, D = x.shape
        H = 32
        Dh = D // H
        W = 256
        qkv = (lambda x, *d: x.permute(*d))((x @ wqkv).reshape(B, S, 3, H, Dh), 2, 0, 3, 1, 4)
        q, k, v = (qkv[0], qkv[1], qkv[2])
        scores = torch.einsum('bhqd,bhkd->bhqk', q, k) * Dh ** (-0.5)
        idx = torch.arange(S)
        mask = (idx[:, None] - idx[None, :] >= 0) & (idx[:, None] - idx[None, :] < W)
        scores = torch.where(mask[None, None], scores, -1000000000.0)
        p = _softmax(scores, axis=-1)
        o = torch.einsum('bhqk,bhkd->bhqd', p, v)
        return (lambda x, *d: x.permute(*d))(o, 0, 2, 1, 3).reshape(B, S, D) @ wo

    def _B_ref(x, w_in, w_sp, b_sp, w_out):
        B, S, D = x.shape
        F = w_in.shape[-1]
        Fh = F // 2
        z = _gelu(torch.einsum('bsd,df->bsf', x, w_in))
        z1 = z[..., :Fh].clone()
        z2 = _layernorm(z[..., Fh:], axis=-1)
        g = torch.einsum('ts,bsf->btf', w_sp, z2) + b_sp[None, :, None]
        return torch.einsum('bsf,fd->bsd', z1 * g, w_out)
    x = A_x
    h = x + _A_ref(_layernorm(x, axis=-1), A_wqkv, A_wo)
    h2 = h + _B_ref(_layernorm(h, axis=-1), B_w_in, B_w_sp, B_b_sp, B_w_out)
    return h2
```

```asm
; @launch grid=(256,1,1) block=(512,1,1) lds=163840
.amdgcn_target "amdgcn-amd-amdhsa--gfx950"
.text
.globl sequential_preLN__sliding_block__mixer_gmlp__prompt_kernel
.p2align 8
.type sequential_preLN__sliding_block__mixer_gmlp__prompt_kernel,@function
sequential_preLN__sliding_block__mixer_gmlp__prompt_kernel:
 s_load_dwordx16 s[64:79], s[0:1], 0
 s_load_dwordx2 s[4:5], s[0:1], 64
 s_load_dwordx2 s[8:9], s[0:1], 80
 s_cmp_ge_u32 s2, 256
 s_cbranch_scc1 L_fz_end
 v_lshrrev_b32 v1, 6, v0
 v_and_b32 v0, 63, v0
 s_nop 0
 v_readfirstlane_b32 s3, v1
 s_cmp_lg_u32 s3, 7
 s_cbranch_scc1 L_fz_start
 s_getpc_b64 s[56:57]
L_fz_cp1:
 s_add_u32 s56, s56, L_fz_start-L_fz_cp1
 s_addc_u32 s57, s57, 0
 s_lshr_b32 s58, s2, 3
 s_lshl_b32 s58, s58, 10
 v_lshlrev_b32 v2, 4, v0
 s_add_u32 s59, s58, 0
 v_add_u32 v2, s59, v2
 v_min_u32 v2, L_fz_p1pub-L_fz_start-16, v2
 global_load_dwordx4 v[220:223], v2, s[56:57]
L_fz_start:
 s_waitcnt lgkmcnt(0)
 s_add_u32 s8, s8, 0
 s_addc_u32 s9, s9, 0
 s_add_u32 s10, s8, 15466496
 s_addc_u32 s11, s9, 0
 s_load_dword s101, s[10:11], 0
 v_lshlrev_b32 v1, 4, v0
 s_cmp_ge_u32 s2, 224
 s_cbranch_scc1 L_fz_p1cs
 s_and_b32 s35, s2, 7
 s_lshr_b32 s36, s2, 3
 s_and_b32 s33, s35, 3
 s_lshl_b32 s33, s33, 2
 s_and_b32 s37, s36, 3
 s_add_u32 s33, s33, s37
 s_lshr_b32 s34, s35, 2
 s_mul_i32 s34, s34, 7
 s_lshr_b32 s37, s36, 2
 s_add_u32 s34, s34, s37
 s_and_b32 s32, s3, 3
 s_cmp_ge_u32 s3, 4
 s_cbranch_scc0 L_fz_p1cmp
 s_mov_b32 s12, s64
 s_mov_b32 s13, s65
 s_mov_b32 s14, 2359296
 s_mov_b32 s15, 0x20000
 s_add_u32 s16, s8, 15532032
 s_addc_u32 s17, s9, 0
 s_mov_b32 s18, 32768
 s_mov_b32 s19, 0x20000
 s_lshl_b32 s36, s33, 3
 s_add_u32 s36, s36, s34
 s_lshl_b32 s36, s36, 2
 s_add_u32 s36, s36, s32
 s_lshl_b32 s37, s36, 2
 v_lshrrev_b32 v3, 4, v0
 v_and_b32 v4, 15, v0
 v_add_u32 v3, s37, v3
 v_mul_u32_u24 v5, 1152, v3
 v_lshl_add_u32 v5, v4, 3, v5
 s_cmp_lt_u32 s34, 8
 s_cselect_b32 s41, 1, 0
 s_cbranch_scc0 L_fz_p1h0
 buffer_load_dwordx2 v[16:17], v5, s[12:15], 0 offen offset:0
 buffer_load_dwordx2 v[18:19], v5, s[12:15], 0 offen offset:128
 buffer_load_dwordx2 v[20:21], v5, s[12:15], 0 offen offset:256
 buffer_load_dwordx2 v[22:23], v5, s[12:15], 0 offen offset:384
 buffer_load_dwordx2 v[24:25], v5, s[12:15], 0 offen offset:512
 buffer_load_dwordx2 v[26:27], v5, s[12:15], 0 offen offset:640
 buffer_load_dwordx2 v[28:29], v5, s[12:15], 0 offen offset:768
 buffer_load_dwordx2 v[30:31], v5, s[12:15], 0 offen offset:896
 buffer_load_dwordx2 v[32:33], v5, s[12:15], 0 offen offset:1024
L_fz_p1h0:
 s_mov_b32 s24, s66
 s_mov_b32 s25, s67
 s_mov_b32 s26, 1990656
 s_mov_b32 s27, 0x20000
 s_mul_i32 s36, s2, 9216
 s_mul_i32 s37, s32, 2304
 s_add_u32 s36, s36, s37
 s_mul_i32 s38, s2, 8896
 s_mul_i32 s37, s32, 2224
 s_add_u32 s38, s38, s37
 buffer_load_dwordx4 v[220:223], v1, s[24:27], s38 offen
 buffer_load_dwordx4 v[220:223], v1, s[24:27], s38 offen offset:1024
 buffer_load_dword v220, v1, s[24:27], s38 offen offset:2048
 v_cmp_eq_u32 vcc, 0, v4
 v_lshlrev_b32 v6, 4, v3
 v_mov_b32 v7, 0x7fffffff
 v_and_b32 v12, 31, v0
 v_cndmask_b32 v6, v7, v6, vcc
 s_waitcnt lgkmcnt(0)
 s_add_u32 s100, s101, 2654435769
 s_barrier
 s_cmp_eq_u32 s41, 0
 s_cbranch_scc1 L_fz_p1h1
 s_waitcnt vmcnt(3)
 v_lshlrev_b32 v40, 16, v16
 v_and_b32 v41, 0xffff0000, v16
 v_lshlrev_b32 v42, 16, v17
 v_and_b32 v43, 0xffff0000, v17
 v_lshlrev_b32 v44, 16, v18
 v_and_b32 v45, 0xffff0000, v18
 v_lshlrev_b32 v46, 16, v19
 v_and_b32 v47, 0xffff0000, v19
 v_lshlrev_b32 v48, 16, v20
 v_and_b32 v49, 0xffff0000, v20
 v_lshlrev_b32 v50, 16, v21
 v_and_b32 v51, 0xffff0000, v21
 v_lshlrev_b32 v52, 16, v22
 v_and_b32 v53, 0xffff0000, v22
 v_lshlrev_b32 v54, 16, v23
 v_and_b32 v55, 0xffff0000, v23
 v_lshlrev_b32 v56, 16, v24
 v_and_b32 v57, 0xffff0000, v24
 v_lshlrev_b32 v58, 16, v25
 v_and_b32 v59, 0xffff0000, v25
 v_lshlrev_b32 v60, 16, v26
 v_and_b32 v61, 0xffff0000, v26
 v_lshlrev_b32 v62, 16, v27
 v_and_b32 v63, 0xffff0000, v27
 v_lshlrev_b32 v64, 16, v28
 v_and_b32 v65, 0xffff0000, v28
 v_lshlrev_b32 v66, 16, v29
 v_and_b32 v67, 0xffff0000, v29
 v_lshlrev_b32 v68, 16, v30
 v_and_b32 v69, 0xffff0000, v30
 v_lshlrev_b32 v70, 16, v31
 v_and_b32 v71, 0xffff0000, v31
 v_lshlrev_b32 v72, 16, v32
 v_and_b32 v73, 0xffff0000, v32
 v_lshlrev_b32 v74, 16, v33
 v_and_b32 v75, 0xffff0000, v33
 v_add_f32 v8, v40, v41
 v_add_f32 v9, v42, v43
 v_add_f32 v8, v8, v44
 v_add_f32 v9, v9, v45
 v_add_f32 v8, v8, v46
 v_add_f32 v9, v9, v47
 v_add_f32 v8, v8, v48
 v_add_f32 v9, v9, v49
 v_add_f32 v8, v8, v50
 v_add_f32 v9, v9, v51
 v_add_f32 v8, v8, v52
 v_add_f32 v9, v9, v53
 v_add_f32 v8, v8, v54
 v_add_f32 v9, v9, v55
 v_add_f32 v8, v8, v56
 v_add_f32 v9, v9, v57
 v_add_f32 v8, v8, v58
 v_add_f32 v9, v9, v59
 v_add_f32 v8, v8, v60
 v_add_f32 v9, v9, v61
 v_add_f32 v8, v8, v62
 v_add_f32 v9, v9, v63
 v_add_f32 v8, v8, v64
 v_add_f32 v9, v9, v65
 v_add_f32 v8, v8, v66
 v_add_f32 v9, v9, v67
 v_add_f32 v8, v8, v68
 v_add_f32 v9, v9, v69
 v_add_f32 v8, v8, v70
 v_add_f32 v9, v9, v71
 v_add_f32 v8, v8, v72
 v_add_f32 v9, v9, v73
 v_add_f32 v8, v8, v74
 v_add_f32 v9, v9, v75
 v_add_f32 v8, v8, v9
 s_nop 1
 v_add_f32_dpp v8, v8, v8 row_ror:8 row_mask:0xf bank_mask:0xf
 s_nop 1
 v_add_f32_dpp v8, v8, v8 row_ror:4 row_mask:0xf bank_mask:0xf
 s_nop 1
 v_add_f32_dpp v8, v8, v8 row_ror:2 row_mask:0xf bank_mask:0xf
 s_nop 1
 v_add_f32_dpp v8, v8, v8 row_ror:1 row_mask:0xf bank_mask:0xf
 v_mul_f32 v8, 0.001736111111111111, v8
L_fz_p1h1:
 s_barrier
 s_cmp_eq_u32 s41, 0
 s_cbranch_scc1 L_fz_p1h2
 v_sub_f32 v40, v40, v8
 v_sub_f32 v41, v41, v8
 v_sub_f32 v42, v42, v8
 v_sub_f32 v43, v43, v8
 v_sub_f32 v44, v44, v8
 v_sub_f32 v45, v45, v8
 v_sub_f32 v46, v46, v8
 v_sub_f32 v47, v47, v8
 v_sub_f32 v48, v48, v8
 v_sub_f32 v49, v49, v8
 v_sub_f32 v50, v50, v8
 v_sub_f32 v51, v51, v8
 v_sub_f32 v52, v52, v8
 v_sub_f32 v53, v53, v8
 v_sub_f32 v54, v54, v8
 v_sub_f32 v55, v55, v8
 v_sub_f32 v56, v56, v8
 v_sub_f32 v57, v57, v8
 v_sub_f32 v58, v58, v8
 v_sub_f32 v59, v59, v8
 v_sub_f32 v60, v60, v8
 v_sub_f32 v61, v61, v8
 v_sub_f32 v62, v62, v8
 v_sub_f32 v63, v63, v8
 v_sub_f32 v64, v64, v8
 v_sub_f32 v65, v65, v8
 v_sub_f32 v66, v66, v8
 v_sub_f32 v67, v67, v8
 v_sub_f32 v68, v68, v8
 v_sub_f32 v69, v69, v8
 v_sub_f32 v70, v70, v8
 v_sub_f32 v71, v71, v8
 v_sub_f32 v72, v72, v8
 v_sub_f32 v73, v73, v8
 v_sub_f32 v74, v74, v8
 v_sub_f32 v75, v75, v8
 v_mul_f32 v9, v40, v40
 v_mul_f32 v10, v41, v41
 v_fmac_f32 v9, v42, v42
 v_fmac_f32 v10, v43, v43
 v_fmac_f32 v9, v44, v44
 v_fmac_f32 v10, v45, v45
 v_fmac_f32 v9, v46, v46
 v_fmac_f32 v10, v47, v47
 v_fmac_f32 v9, v48, v48
 v_fmac_f32 v10, v49, v49
 v_fmac_f32 v9, v50, v50
 v_fmac_f32 v10, v51, v51
 v_fmac_f32 v9, v52, v52
 v_fmac_f32 v10, v53, v53
 v_fmac_f32 v9, v54, v54
 v_fmac_f32 v10, v55, v55
 v_fmac_f32 v9, v56, v56
 v_fmac_f32 v10, v57, v57
 v_fmac_f32 v9, v58, v58
 v_fmac_f32 v10, v59, v59
 v_fmac_f32 v9, v60, v60
 v_fmac_f32 v10, v61, v61
 v_fmac_f32 v9, v62, v62
 v_fmac_f32 v10, v63, v63
 v_fmac_f32 v9, v64, v64
 v_fmac_f32 v10, v65, v65
 v_fmac_f32 v9, v66, v66
 v_fmac_f32 v10, v67, v67
 v_fmac_f32 v9, v68, v68
 v_fmac_f32 v10, v69, v69
 v_fmac_f32 v9, v70, v70
 v_fmac_f32 v10, v71, v71
 v_fmac_f32 v9, v72, v72
 v_fmac_f32 v10, v73, v73
 v_fmac_f32 v9, v74, v74
 v_fmac_f32 v10, v75, v75
 v_add_f32 v9, v9, v10
 s_nop 1
 v_add_f32_dpp v9, v9, v9 row_ror:8 row_mask:0xf bank_mask:0xf
 s_nop 1
 v_add_f32_dpp v9, v9, v9 row_ror:4 row_mask:0xf bank_mask:0xf
 s_nop 1
 v_add_f32_dpp v9, v9, v9 row_ror:2 row_mask:0xf bank_mask:0xf
 s_nop 1
 v_add_f32_dpp v9, v9, v9 row_ror:1 row_mask:0xf bank_mask:0xf
 v_mov_b32 v10, 0x3727c5ac
 v_fmac_f32 v10, 0.001736111111111111, v9
 v_rsq_f32 v10, v10
 v_mov_b32 v9, s100
 v_mov_b32 v11, s100
 buffer_store_dwordx4 v[8:11], v6, s[16:19], 0 offen sc1
L_fz_p1h2:
 s_lshl_b32 s36, s33, 2
 s_add_u32 s36, s36, s32
 s_lshl_b32 s36, s36, 9
 s_lshl_b32 s37, s32, 7
 s_add_u32 s37, s37, 131072
 v_lshlrev_b32 v13, 4, v12
 v_lshl_add_u32 v21, v12, 2, s37
 s_mov_b32 s38, 40000
 s_barrier
 s_barrier
 s_barrier
 s_barrier
 s_barrier
 s_barrier
 buffer_load_dwordx4 v[24:27], v13, s[16:19], s36 offen sc1
 s_barrier
 s_branch L_fz_p1h4
L_fz_p1h3:
 buffer_load_dwordx4 v[24:27], v13, s[16:19], s36 offen sc1
L_fz_p1h4:
 s_waitcnt vmcnt(0)
 v_xor_b32 v25, s100, v25
 v_xor_b32 v27, s100, v27
 v_or_b32 v25, v25, v27
 v_cmp_ne_u32 vcc, 0, v25
 s_sub_u32 s38, s38, 1
 s_cbranch_vccz L_fz_p1h5
 s_cmp_lg_u32 s38, 0
 s_cbranch_scc1 L_fz_p1h3
L_fz_p1h5:
 ds_write_b32 v21, v24 offset:512
 ds_write_b32 v21, v26
 s_cmp_lg_u32 s3, 7
 s_cbranch_scc1 L_fz_p1cp
 s_getpc_b64 s[56:57]
L_fz_cp2:
 s_add_u32 s56, s56, L_fz_p1pub-L_fz_cp2
 s_addc_u32 s57, s57, 0
 s_lshr_b32 s58, s2, 3
 s_lshl_b32 s58, s58, 10
 v_lshlrev_b32 v14, 4, v0
 s_add_u32 s59, s58, 0
 v_add_u32 v14, s59, v14
 v_min_u32 v14, L_fz_last-L_fz_p1pub-16, v14
 global_load_dwordx4 v[220:223], v14, s[56:57]
 v_lshlrev_b32 v14, 4, v0
 s_add_u32 s59, s58, 32768
 v_add_u32 v14, s59, v14
 v_min_u32 v14, L_fz_last-L_fz_p1pub-16, v14
 global_load_dwordx4 v[220:223], v14, s[56:57]
 v_lshlrev_b32 v14, 4, v0
 s_add_u32 s59, s58, 65536
 v_add_u32 v14, s59, v14
 v_min_u32 v14, L_fz_last-L_fz_p1pub-16, v14
 global_load_dwordx4 v[220:223], v14, s[56:57]
L_fz_p1cp:
 s_cmp_ge_u32 s34, 4
 s_cbranch_scc1 L_fz_p1ns
 s_lshl_b32 s36, s33, 2
 s_add_u32 s36, s36, s34
 s_lshl_b32 s36, s36, 12
 s_lshl_b32 s37, s32, 10
 s_add_u32 s36, s36, s37
 v_mov_b32 v24, -1
 v_mov_b32 v25, -1
 v_mov_b32 v26, -1
 v_mov_b32 v27, -1
 s_add_u32 s20, s8, 15728640
 s_addc_u32 s21, s9, 0
 s_mov_b32 s22, 524288
 s_mov_b32 s23, 0x20000
 buffer_store_dwordx4 v[24:27], v1, s[20:23], s36 offen sc1
L_fz_p1ns:
 s_waitcnt lgkmcnt(0)
 s_barrier
 s_branch L_fz_p1idx
L_fz_p1cmp:
 v_lshrrev_b32 v2, 4, v0
 v_and_b32 v3, 7, v0
 v_xor_b32 v3, v3, v2
 v_lshlrev_b32 v3, 4, v3
 v_lshrrev_b32 v2, 3, v0
 s_lshl_b32 s36, s33, 7
 s_lshl_b32 s37, s32, 5
 s_add_u32 s36, s36, s37
 s_movk_i32 s39, 9216
 v_add_u32 v2, s36, v2
 v_mul_u32_u24 v2, 1152, v2
 v_add_u32 v224, v2, v3
 v_xor_b32 v3, 64, v3
 v_add3_u32 v225, v2, v3, s39
 v_add_u32 v226, 18432, v224
 v_add_u32 v227, 18432, v225
 v_lshrrev_b32 v2, 4, v0
 v_bfe_u32 v3, v0, 2, 2
 v_xor_b32 v3, v3, v2
 v_and_b32 v228, 3, v0
 v_lshlrev_b32 v228, 4, v228
 v_lshl_add_u32 v228, v3, 6, v228
 v_mul_u32_u24 v2, 3456, v2
 s_mul_i32 s37, s32, 55296
 s_lshl_b32 s38, s34, 8
 s_add_u32 s37, s37, s38
 v_add3_u32 v228, v2, v228, s37
 s_lshl_b32 s40, s32, 12
 s_mov_b32 s12, s64
 s_mov_b32 s13, s65
 s_mov_b32 s14, 2359296
 s_mov_b32 s15, 0x20000
 s_mov_b32 s16, s66
 s_mov_b32 s17, s67
 s_mov_b32 s18, 1990656
 s_mov_b32 s19, 0x20000
 s_add_u32 m0, s40, 0
 s_mov_b32 s41, 0
 buffer_load_dwordx4 v224, s[12:15], s41 offen lds
 s_add_u32 m0, s40, 16384
 s_mov_b32 s41, 0
 buffer_load_dwordx4 v228, s[16:19], s41 offen lds
 s_add_u32 m0, s40, 1024
 s_mov_b32 s41, 0
 buffer_load_dwordx4 v225, s[12:15], s41 offen lds
 s_add_u32 m0, s40, 17408
 s_mov_b32 s41, 13824
 buffer_load_dwordx4 v228, s[16:19], s41 offen lds
 s_add_u32 m0, s40, 2048
 s_mov_b32 s41, 0
 buffer_load_dwordx4 v226, s[12:15], s41 offen lds
 s_add_u32 m0, s40, 18432
 s_mov_b32 s41, 27648
 buffer_load_dwordx4 v228, s[16:19], s41 offen lds
 s_add_u32 m0, s40, 3072
 s_mov_b32 s41, 0
 buffer_load_dwordx4 v227, s[12:15], s41 offen lds
 s_add_u32 m0, s40, 19456
 s_mov_b32 s41, 41472
 buffer_load_dwordx4 v228, s[16:19], s41 offen lds
 v_and_b32 v20, 31, v0
 v_lshrrev_b32 v21, 5, v0
 v_bfe_u32 v22, v0, 1, 3
 v_xor_b32 v22, v21, v22
 v_lshlrev_b32 v22, 4, v22
 v_lshl_add_u32 v22, v20, 7, v22
 s_lshl_b32 s36, s32, 12
 v_add_u32 v12, s36, v22
 v_xor_b32 v13, 32, v12
 v_xor_b32 v14, 64, v12
 v_xor_b32 v15, 96, v12
 v_bfe_u32 v5, v0, 2, 2
 v_lshl_add_u32 v4, v21, 3, v5
 v_lshlrev_b32 v4, 8, v4
 v_bfe_u32 v6, v0, 4, 1
 v_lshl_add_u32 v4, v6, 5, v4
 v_and_b32 v6, 3, v0
 v_lshl_add_u32 v4, v6, 3, v4
 v_lshl_add_u32 v8, v5, 6, v4
 v_add_u32 v8, 16384, v8
 v_xor_b32 v9, 64, v8
 v_xor_b32 v10, 128, v8
 v_xor_b32 v11, 192, v8
 v_mov_b32 v216, 0x3f803f80
 v_mov_b32 v217, 0x3f803f80
 v_mov_b32 v218, 0x3f803f80
 v_mov_b32 v219, 0x3f803f80
 s_lshl_b32 s36, s32, 6
 v_xor_b32 v8, s36, v8
 v_xor_b32 v9, s36, v9
 v_xor_b32 v10, s36, v10
 v_xor_b32 v11, s36, v11
 s_lshl_b32 s38, s34, 7
 v_mul_u32_u24 v5, 27648, v21
 v_lshl_add_u32 v5, v20, 4, v5
 s_lshl_b32 s37, s33, 2
 s_add_u32 s37, s37, s32
 s_mul_i32 s37, s37, 110592
 s_mov_b32 s43, 55296
 s_xor_b32 s36, s32, 0
 s_lshl_b32 s36, s36, 5
 s_add_u32 s44, s36, s38
 s_lshl_b32 s36, s44, 4
 s_add_u32 s36, s36, s37
 v_add_u32 v16, s36, v5
 s_xor_b32 s36, s32, 1
 s_lshl_b32 s36, s36, 5
 s_add_u32 s45, s36, s38
 s_lshl_b32 s36, s45, 4
 s_add_u32 s36, s36, s37
 v_add_u32 v17, s36, v5
 s_xor_b32 s36, s32, 2
 s_lshl_b32 s36, s36, 5
 s_add_u32 s46, s36, s38
 s_lshl_b32 s36, s46, 4
 s_add_u32 s36, s36, s37
 v_add_u32 v18, s36, v5
 s_xor_b32 s36, s32, 3
 s_lshl_b32 s36, s36, 5
 s_add_u32 s47, s36, s38
 s_lshl_b32 s36, s47, 4
 s_add_u32 s36, s36, s37
 v_add_u32 v19, s36, v5
 s_mov_b32 s20, s8
 s_mov_b32 s21, s9
 s_mov_b32 s22, 7077888
 s_mov_b32 s23, 0x20000
 s_add_u32 m0, s40, 32768
 s_mov_b32 s41, 128
 buffer_load_dwordx4 v224, s[12:15], s41 offen lds
 s_add_u32 m0, s40, 49152
 s_mov_b32 s41, 221184
 buffer_load_dwordx4 v228, s[16:19], s41 offen lds
 s_waitcnt vmcnt(2) lgkmcnt(0)
 s_barrier
 ds_read_b128 v[176:179], v12 offset:0
 ds_read_b64_tr_b16 v[184:185], v8 offset:0
 ds_read_b64_tr_b16 v[186:187], v8 offset:1024
 ds_read_b64_tr_b16 v[188:189], v9 offset:0
 ds_read_b64_tr_b16 v[190:191], v9 offset:1024
 ds_read_b64_tr_b16 v[192:193], v10 offset:0
 ds_read_b64_tr_b16 v[194:195], v10 offset:1024
 ds_read_b64_tr_b16 v[196:197], v11 offset:0
 ds_read_b64_tr_b16 v[198:199], v11 offset:1024
 s_add_u32 m0, s40, 33792
 s_mov_b32 s41, 128
 buffer_load_dwordx4 v225, s[12:15], s41 offen lds
 s_add_u32 m0, s40, 50176
 s_mov_b32 s41, 235008
 buffer_load_dwordx4 v228, s[16:19], s41 offen lds
 s_add_u32 m0, s40, 34816
 s_mov_b32 s41, 128
 buffer_load_dwordx4 v226, s[12:15], s41 offen lds
 s_add_u32 m0, s40, 51200
 s_mov_b32 s41, 248832
 buffer_load_dwordx4 v228, s[16:19], s41 offen lds
 s_add_u32 m0, s40, 35840
 s_mov_b32 s41, 128
 buffer_load_dwordx4 v227, s[12:15], s41 offen lds
 s_add_u32 m0, s40, 52224
 s_mov_b32 s41, 262656
 buffer_load_dwordx4 v228, s[16:19], s41 offen lds
 s_waitcnt lgkmcnt(6)
 v_mfma_f32_32x32x16_bf16 v[96:111], v[176:179], v[184:187], 0
 ds_read_b128 v[180:183], v13 offset:0
 ds_read_b64_tr_b16 v[200:201], v8 offset:4096
 ds_read_b64_tr_b16 v[202:203], v8 offset:5120
 v_mfma_f32_32x32x16_bf16 v[160:175], v[216:219], v[184:187], 0
 s_add_u32 m0, s40, 65536
 s_mov_b32 s41, 256
 buffer_load_dwordx4 v224, s[12:15], s41 offen lds
 s_add_u32 m0, s40, 81920
 s_mov_b32 s41, 442368
 buffer_load_dwordx4 v228, s[16:19], s41 offen lds
 s_add_u32 m0, s40, 66560
 s_mov_b32 s41, 256
 buffer_load_dwordx4 v225, s[12:15], s41 offen lds
 s_waitcnt lgkmcnt(7)
 v_mfma_f32_32x32x16_bf16 v[112:127], v[176:179], v[188:191], 0
 ds_read_b64_tr_b16 v[204:205], v9 offset:4096
 ds_read_b64_tr_b16 v[206:207], v9 offset:5120
 s_waitcnt lgkmcnt(7)
 v_mfma_f32_32x32x16_bf16 v[128:143], v[176:179], v[192:195], 0
 ds_read_b64_tr_b16 v[208:209], v10 offset:4096
 ds_read_b64_tr_b16 v[210:211], v10 offset:5120
 s_waitcnt lgkmcnt(7)
 v_mfma_f32_32x32x16_bf16 v[144:159], v[176:179], v[196:199], 0
 ds_read_b64_tr_b16 v[212:213], v11 offset:4096
 ds_read_b64_tr_b16 v[214:215], v11 offset:5120
 s_waitcnt lgkmcnt(6)
 v_mfma_f32_32x32x16_bf16 v[96:111], v[180:183], v[200:203], v[96:111]
 ds_read_b128 v[176:179], v14 offset:0
 ds_read_b64_tr_b16 v[184:185], v8 offset:8192
 ds_read_b64_tr_b16 v[186:187], v8 offset:9216
 v_mfma_f32_32x32x16_bf16 v[160:175], v[216:219], v[200:203], v[160:175]
 s_add_u32 m0, s40, 82944
 s_mov_b32 s41, 456192
 buffer_load_dwordx4 v228, s[16:19], s41 offen lds
 s_add_u32 m0, s40, 67584
 s_mov_b32 s41, 256
 buffer_load_dwordx4 v226, s[12:15], s41 offen lds
 s_add_u32 m0, s40, 83968
 s_mov_b32 s41, 470016
 buffer_load_dwordx4 v228, s[16:19], s41 offen lds
 s_waitcnt lgkmcnt(7)
 v_mfma_f32_32x32x16_bf16 v[112:127], v[180:183], v[204:207], v[112:127]
 ds_read_b64_tr_b16 v[188:189], v9 offset:8192
 ds_read_b64_tr_b16 v[190:191], v9 offset:9216
 s_waitcnt lgkmcnt(7)
 v_mfma_f32_32x32x16_bf16 v[128:143], v[180:183], v[208:211], v[128:143]
 ds_read_b64_tr_b16 v[192:193], v10 offset:8192
 ds_read_b64_tr_b16 v[194:195], v10 offset:9216
 s_waitcnt lgkmcnt(7)
 v_mfma_f32_32x32x16_bf16 v[144:159], v[180:183], v[212:215], v[144:159]
 ds_read_b64_tr_b16 v[196:197], v11 offset:8192
 ds_read_b64_tr_b16 v[198:199], v11 offset:9216
 s_waitcnt lgkmcnt(6)
 v_mfma_f32_32x32x16_bf16 v[96:111], v[176:179], v[184:187], v[96:111]
 ds_read_b128 v[180:183], v15 offset:0
 ds_read_b64_tr_b16 v[200:201], v8 offset:12288
 ds_read_b64_tr_b16 v[202:203], v8 offset:13312
 v_mfma_f32_32x32x16_bf16 v[160:175], v[216:219], v[184:187], v[160:175]
 s_add_u32 m0, s40, 68608
 s_mov_b32 s41, 256
 buffer_load_dwordx4 v227, s[12:15], s41 offen lds
 s_add_u32 m0, s40, 84992
 s_mov_b32 s41, 483840
 buffer_load_dwordx4 v228, s[16:19], s41 offen lds
 s_add_u32 m0, s40, 98304
 s_mov_b32 s41, 384
 buffer_load_dwordx4 v224, s[12:15], s41 offen lds
 s_waitcnt lgkmcnt(7)
 v_mfma_f32_32x32x16_bf16 v[112:127], v[176:179], v[188:191], v[112:127]
 ds_read_b64_tr_b16 v[204:205], v9 offset:12288
 ds_read_b64_tr_b16 v[206:207], v9 offset:13312
 s_waitcnt lgkmcnt(7)
 v_mfma_f32_32x32x16_bf16 v[128:143], v[176:179], v[192:195], v[128:143]
 ds_read_b64_tr_b16 v[208:209], v10 offset:12288
 ds_read_b64_tr_b16 v[210:211], v10 offset:13312
 s_waitcnt lgkmcnt(7)
 v_mfma_f32_32x32x16_bf16 v[144:159], v[176:179], v[196:199], v[144:159]
 ds_read_b64_tr_b16 v[212:213], v11 offset:12288
 ds_read_b64_tr_b16 v[214:215], v11 offset:13312
 s_waitcnt lgkmcnt(6)
 v_mfma_f32_32x32x16_bf16 v[96:111], v[180:183], v[200:203], v[96:111]
 v_mfma_f32_32x32x16_bf16 v[160:175], v[216:219], v[200:203], v[160:175]
 s_waitcnt vmcnt(9) lgkmcnt(0)
 s_barrier
 v_mfma_f32_32x32x16_bf16 v[112:127], v[180:183], v[204:207], v[112:127]
 ds_read_b128 v[176:179], v12 offset:32768
 ds_read_b64_tr_b16 v[184:185], v8 offset:32768
 ds_read_b64_tr_b16 v[186:187], v8 offset:33792
 v_mfma_f32_32x32x16_bf16 v[128:143], v[180:183], v[208:211], v[128:143]
 ds_read_b64_tr_b16 v[188:189], v9 offset:32768
 ds_read_b64_tr_b16 v[190:191], v9 offset:33792
 ds_read_b64_tr_b16 v[192:193], v10 offset:32768
 v_mfma_f32_32x32x16_bf16 v[144:159], v[180:183], v[212:215], v[144:159]
 ds_read_b64_tr_b16 v[194:195], v10 offset:33792
 ds_read_b64_tr_b16 v[196:197], v11 offset:32768
 ds_read_b64_tr_b16 v[198:199], v11 offset:33792
 s_add_u32 m0, s40, 114688
 s_mov_b32 s41, 663552
 buffer_load_dwordx4 v228, s[16:19], s41 offen lds
 s_add_u32 m0, s40, 99328
 s_mov_b32 s41, 384
 buffer_load_dwordx4 v225, s[12:15], s41 offen lds
 s_waitcnt lgkmcnt(6)
 v_mfma_f32_32x32x16_bf16 v[96:111], v[176:179], v[184:187], v[96:111]
 ds_read_b128 v[180:183], v13 offset:32768
 ds_read_b64_tr_b16 v[200:201], v8 offset:36864
 ds_read_b64_tr_b16 v[202:203], v8 offset:37888
 v_mfma_f32_32x32x16_bf16 v[160:175], v[216:219], v[184:187], v[160:175]
 s_add_u32 m0, s40, 115712
 s_mov_b32 s41, 677376
 buffer_load_dwordx4 v228, s[16:19], s41 offen lds
 s_add_u32 m0, s40, 100352
 s_mov_b32 s41, 384
 buffer_load_dwordx4 v226, s[12:15], s41 offen lds
 s_add_u32 m0, s40, 116736
 s_mov_b32 s41, 691200
 buffer_load_dwordx4 v228, s[16:19], s41 offen lds
 s_waitcnt lgkmcnt(7)
 v_mfma_f32_32x32x16_bf16 v[112:127], v[176:179], v[188:191], v[112:127]
 ds_read_b64_tr_b16 v[204:205], v9 offset:36864
 ds_read_b64_tr_b16 v[206:207], v9 offset:37888
 s_waitcnt lgkmcnt(7)
 v_mfma_f32_32x32x16_bf16 v[128:143], v[176:179], v[192:195], v[128:143]
 ds_read_b64_tr_b16 v[208:209], v10 offset:36864
 ds_read_b64_tr_b16 v[210:211], v10 offset:37888
 s_waitcnt lgkmcnt(7)
 v_mfma_f32_32x32x16_bf16 v[144:159], v[176:179], v[196:199], v[144:159]
 ds_read_b64_tr_b16 v[212:213], v11 offset:36864
 ds_read_b64_tr_b16 v[214:215], v11 offset:37888
 s_waitcnt lgkmcnt(6)
 v_mfma_f32_32x32x16_bf16 v[96:111], v[180:183], v[200:203], v[96:111]
 ds_read_b128 v[176:179], v14 offset:32768
 ds_read_b64_tr_b16 v[184:185], v8 offset:40960
 ds_read_b64_tr_b16 v[186:187], v8 offset:41984
 v_mfma_f32_32x32x16_bf16 v[160:175], v[216:219], v[200:203], v[160:175]
 s_add_u32 m0, s40, 101376
 s_mov_b32 s41, 384
 buffer_load_dwordx4 v227, s[12:15], s41 offen lds
 s_add_u32 m0, s40, 117760
 s_mov_b32 s41, 705024
 buffer_load_dwordx4 v228, s[16:19], s41 offen lds
 s_add_u32 m0, s40, 0
 s_mov_b32 s41, 512
 buffer_load_dwordx4 v224, s[12:15], s41 offen lds
 s_waitcnt lgkmcnt(7)
 v_mfma_f32_32x32x16_bf16 v[112:127], v[180:183], v[204:207], v[112:127]
 ds_read_b64_tr_b16 v[188:189], v9 offset:40960
 ds_read_b64_tr_b16 v[190:191], v9 offset:41984
 s_waitcnt lgkmcnt(7)
 v_mfma_f32_32x32x16_bf16 v[128:143], v[180:183], v[208:211], v[128:143]
 ds_read_b64_tr_b16 v[192:193], v10 offset:40960
 ds_read_b64_tr_b16 v[194:195], v10 offset:41984
 s_waitcnt lgkmcnt(7)
 v_mfma_f32_32x32x16_bf16 v[144:159], v[180:183], v[212:215], v[144:159]
 ds_read_b64_tr_b16 v[196:197], v11 offset:40960
 ds_read_b64_tr_b16 v[198:199], v11 offset:41984
 s_waitcnt lgkmcnt(6)
 v_mfma_f32_32x32x16_bf16 v[96:111], v[176:179], v[184:187], v[96:111]
 ds_read_b128 v[180:183], v15 offset:32768
 ds_read_b64_tr_b16 v[200:201], v8 offset:45056
 ds_read_b64_tr_b16 v[202:203], v8 offset:46080
 v_mfma_f32_32x32x16_bf16 v[160:175], v[216:219], v[184:187], v[160:175]
 s_add_u32 m0, s40, 16384
 s_mov_b32 s41, 884736
 buffer_load_dwordx4 v228, s[16:19], s41 offen lds
 s_add_u32 m0, s40, 1024
 s_mov_b32 s41, 512
 buffer_load_dwordx4 v225, s[12:15], s41 offen lds
 s_add_u32 m0, s40, 17408
 s_mov_b32 s41, 898560
 buffer_load_dwordx4 v228, s[16:19], s41 offen lds
 s_waitcnt lgkmcnt(7)
 v_mfma_f32_32x32x16_bf16 v[112:127], v[176:179], v[188:191], v[112:127]
 ds_read_b64_tr_b16 v[204:205], v9 offset:45056
 ds_read_b64_tr_b16 v[206:207], v9 offset:46080
 s_waitcnt lgkmcnt(7)
 v_mfma_f32_32x32x16_bf16 v[128:143], v[176:179], v[192:195], v[128:143]
 ds_read_b64_tr_b16 v[208:209], v10 offset:45056
 ds_read_b64_tr_b16 v[210:211], v10 offset:46080
 s_waitcnt lgkmcnt(7)
 v_mfma_f32_32x32x16_bf16 v[144:159], v[176:179], v[196:199], v[144:159]
 ds_read_b64_tr_b16 v[212:213], v11 offset:45056
 ds_read_b64_tr_b16 v[214:215], v11 offset:46080
 s_waitcnt lgkmcnt(6)
 v_mfma_f32_32x32x16_bf16 v[96:111], v[180:183], v[200:203], v[96:111]
 v_mfma_f32_32x32x16_bf16 v[160:175], v[216:219], v[200:203], v[160:175]
 s_waitcnt vmcnt(12) lgkmcnt(0)
 s_barrier
 v_add_u32 v8, 0x10000, v8
 v_add_u32 v9, 0x10000, v9
 v_add_u32 v10, 0x10000, v10
 v_add_u32 v11, 0x10000, v11
 v_add_u32 v12, 0x10000, v12
 v_add_u32 v13, 0x10000, v13
 v_add_u32 v14, 0x10000, v14
 v_add_u32 v15, 0x10000, v15
 v_mfma_f32_32x32x16_bf16 v[112:127], v[180:183], v[204:207], v[112:127]
 ds_read_b128 v[176:179], v12 offset:0
 ds_read_b64_tr_b16 v[184:185], v8 offset:0
 ds_read_b64_tr_b16 v[186:187], v8 offset:1024
 v_mfma_f32_32x32x16_bf16 v[128:143], v[180:183], v[208:211], v[128:143]
 ds_read_b64_tr_b16 v[188:189], v9 offset:0
 ds_read_b64_tr_b16 v[190:191], v9 offset:1024
 ds_read_b64_tr_b16 v[192:193], v10 offset:0
 v_mfma_f32_32x32x16_bf16 v[144:159], v[180:183], v[212:215], v[144:159]
 ds_read_b64_tr_b16 v[194:195], v10 offset:1024
 ds_read_b64_tr_b16 v[196:197], v11 offset:0
 ds_read_b64_tr_b16 v[198:199], v11 offset:1024
 s_add_u32 m0, s40, 2048
 s_mov_b32 s41, 512
 buffer_load_dwordx4 v226, s[12:15], s41 offen lds
 s_add_u32 m0, s40, 18432
 s_mov_b32 s41, 912384
 buffer_load_dwordx4 v228, s[16:19], s41 offen lds
 s_waitcnt lgkmcnt(6)
 v_mfma_f32_32x32x16_bf16 v[96:111], v[176:179], v[184:187], v[96:111]
 ds_read_b128 v[180:183], v13 offset:0
 ds_read_b64_tr_b16 v[200:201], v8 offset:4096
 ds_read_b64_tr_b16 v[202:203], v8 offset:5120
 v_mfma_f32_32x32x16_bf16 v[160:175], v[216:219], v[184:187], v[160:175]
 s_add_u32 m0, s40, 3072
 s_mov_b32 s41, 512
 buffer_load_dwordx4 v227, s[12:15], s41 offen lds
 s_add_u32 m0, s40, 19456
 s_mov_b32 s41, 926208
 buffer_load_dwordx4 v228, s[16:19], s41 offen lds
 s_waitcnt lgkmcnt(7)
 v_mfma_f32_32x32x16_bf16 v[112:127], v[176:179], v[188:191], v[112:127]
 ds_read_b64_tr_b16 v[204:205], v9 offset:4096
 ds_read_b64_tr_b16 v[206:207], v9 offset:5120
 s_waitcnt lgkmcnt(7)
 v_mfma_f32_32x32x16_bf16 v[128:143], v[176:179], v[192:195], v[128:143]
 ds_read_b64_tr_b16 v[208:209], v10 offset:4096
 ds_read_b64_tr_b16 v[210:211], v10 offset:5120
 s_waitcnt lgkmcnt(7)
 v_mfma_f32_32x32x16_bf16 v[144:159], v[176:179], v[196:199], v[144:159]
 ds_read_b64_tr_b16 v[212:213], v11 offset:4096
 ds_read_b64_tr_b16 v[214:215], v11 offset:5120
 s_waitcnt lgkmcnt(6)
 v_mfma_f32_32x32x16_bf16 v[96:111], v[180:183], v[200:203], v[96:111]
 ds_read_b128 v[176:179], v14 offset:0
 ds_read_b64_tr_b16 v[184:185], v8 offset:8192
 ds_read_b64_tr_b16 v[186:187], v8 offset:9216
 v_mfma_f32_32x32x16_bf16 v[160:175], v[216:219], v[200:203], v[160:175]
 s_add_u32 m0, s40, 32768
 s_mov_b32 s41, 640
 buffer_load_dwordx4 v224, s[12:15], s41 offen lds
 s_add_u32 m0, s40, 49152
 s_mov_b32 s41, 1105920
 buffer_load_dwordx4 v228, s[16:19], s41 offen lds
 s_waitcnt lgkmcnt(7)
 v_mfma_f32_32x32x16_bf16 v[112:127], v[180:183], v[204:207], v[112:127]
 ds_read_b64_tr_b16 v[188:189], v9 offset:8192
 ds_read_b64_tr_b16 v[190:191], v9 offset:9216
 s_waitcnt lgkmcnt(7)
 v_mfma_f32_32x32x16_bf16 v[128:143], v[180:183], v[208:211], v[128:143]
 ds_read_b64_tr_b16 v[192:193], v10 offset:8192
 ds_read_b64_tr_b16 v[194:195], v10 offset:9216
 s_waitcnt lgkmcnt(7)
 v_mfma_f32_32x32x16_bf16 v[144:159], v[180:183], v[212:215], v[144:159]
 ds_read_b64_tr_b16 v[196:197], v11 offset:8192
 ds_read_b64_tr_b16 v[198:199], v11 offset:9216
 s_waitcnt lgkmcnt(6)
 v_mfma_f32_32x32x16_bf16 v[96:111], v[176:179], v[184:187], v[96:111]
 ds_read_b128 v[180:183], v15 offset:0
 ds_read_b64_tr_b16 v[200:201], v8 offset:12288
 ds_read_b64_tr_b16 v[202:203], v8 offset:13312
 v_mfma_f32_32x32x16_bf16 v[160:175], v[216:219], v[184:187], v[160:175]
 s_add_u32 m0, s40, 33792
 s_mov_b32 s41, 640
 buffer_load_dwordx4 v225, s[12:15], s41 offen lds
 s_add_u32 m0, s40, 50176
 s_mov_b32 s41, 1119744
 buffer_load_dwordx4 v228, s[16:19], s41 offen lds
 s_waitcnt lgkmcnt(7)
 v_mfma_f32_32x32x16_bf16 v[112:127], v[176:179], v[188:191], v[112:127]
 ds_read_b64_tr_b16 v[204:205], v9 offset:12288
 ds_read_b64_tr_b16 v[206:207], v9 offset:13312
 s_waitcnt lgkmcnt(7)
 v_mfma_f32_32x32x16_bf16 v[128:143], v[176:179], v[192:195], v[128:143]
 ds_read_b64_tr_b16 v[208:209], v10 offset:12288
 ds_read_b64_tr_b16 v[210:211], v10 offset:13312
 s_waitcnt lgkmcnt(7)
 v_mfma_f32_32x32x16_bf16 v[144:159], v[176:179], v[196:199], v[144:159]
 ds_read_b64_tr_b16 v[212:213], v11 offset:12288
 ds_read_b64_tr_b16 v[214:215], v11 offset:13312
 s_waitcnt lgkmcnt(6)
 v_mfma_f32_32x32x16_bf16 v[96:111], v[180:183], v[200:203], v[96:111]
 v_mfma_f32_32x32x16_bf16 v[160:175], v[216:219], v[200:203], v[160:175]
 s_waitcnt vmcnt(12) lgkmcnt(0)
 s_barrier
 v_mfma_f32_32x32x16_bf16 v[112:127], v[180:183], v[204:207], v[112:127]
 ds_read_b128 v[176:179], v12 offset:32768
 ds_read_b64_tr_b16 v[184:185], v8 offset:32768
 ds_read_b64_tr_b16 v[186:187], v8 offset:33792
 v_mfma_f32_32x32x16_bf16 v[128:143], v[180:183], v[208:211], v[128:143]
 ds_read_b64_tr_b16 v[188:189], v9 offset:32768
 ds_read_b64_tr_b16 v[190:191], v9 offset:33792
 ds_read_b64_tr_b16 v[192:193], v10 offset:32768
 v_mfma_f32_32x32x16_bf16 v[144:159], v[180:183], v[212:215], v[144:159]
 ds_read_b64_tr_b16 v[194:195], v10 offset:33792
 ds_read_b64_tr_b16 v[196:197], v11 offset:32768
 ds_read_b64_tr_b16 v[198:199], v11 offset:33792
 s_add_u32 m0, s40, 34816
 s_mov_b32 s41, 640
 buffer_load_dwordx4 v226, s[12:15], s41 offen lds
 s_add_u32 m0, s40, 51200
 s_mov_b32 s41, 1133568
 buffer_load_dwordx4 v228, s[16:19], s41 offen lds
 s_waitcnt lgkmcnt(6)
 v_mfma_f32_32x32x16_bf16 v[96:111], v[176:179], v[184:187], v[96:111]
 ds_read_b128 v[180:183], v13 offset:32768
 ds_read_b64_tr_b16 v[200:201], v8 offset:36864
 ds_read_b64_tr_b16 v[202:203], v8 offset:37888
 v_mfma_f32_32x32x16_bf16 v[160:175], v[216:219], v[184:187], v[160:175]
 s_add_u32 m0, s40, 35840
 s_mov_b32 s41, 640
 buffer_load_dwordx4 v227, s[12:15], s41 offen lds
 s_add_u32 m0, s40, 52224
 s_mov_b32 s41, 1147392
 buffer_load_dwordx4 v228, s[16:19], s41 offen lds
 s_waitcnt lgkmcnt(7)
 v_mfma_f32_32x32x16_bf16 v[112:127], v[176:179], v[188:191], v[112:127]
 ds_read_b64_tr_b16 v[204:205], v9 offset:36864
 ds_read_b64_tr_b16 v[206:207], v9 offset:37888
 s_waitcnt lgkmcnt(7)
 v_mfma_f32_32x32x16_bf16 v[128:143], v[176:179], v[192:195], v[128:143]
 ds_read_b64_tr_b16 v[208:209], v10 offset:36864
 ds_read_b64_tr_b16 v[210:211], v10 offset:37888
 s_waitcnt lgkmcnt(7)
 v_mfma_f32_32x32x16_bf16 v[144:159], v[176:179], v[196:199], v[144:159]
 ds_read_b64_tr_b16 v[212:213], v11 offset:36864
 ds_read_b64_tr_b16 v[214:215], v11 offset:37888
 s_waitcnt lgkmcnt(6)
 v_mfma_f32_32x32x16_bf16 v[96:111], v[180:183], v[200:203], v[96:111]
 ds_read_b128 v[176:179], v14 offset:32768
 ds_read_b64_tr_b16 v[184:185], v8 offset:40960
 ds_read_b64_tr_b16 v[186:187], v8 offset:41984
 v_mfma_f32_32x32x16_bf16 v[160:175], v[216:219], v[200:203], v[160:175]
 s_add_u32 m0, s40, 65536
 s_mov_b32 s41, 768
 buffer_load_dwordx4 v224, s[12:15], s41 offen lds
 s_add_u32 m0, s40, 81920
 s_mov_b32 s41, 1327104
 buffer_load_dwordx4 v228, s[16:19], s41 offen lds
 s_waitcnt lgkmcnt(7)
 v_mfma_f32_32x32x16_bf16 v[112:127], v[180:183], v[204:207], v[112:127]
 ds_read_b64_tr_b16 v[188:189], v9 offset:40960
 ds_read_b64_tr_b16 v[190:191], v9 offset:41984
 s_waitcnt lgkmcnt(7)
 v_mfma_f32_32x32x16_bf16 v[128:143], v[180:183], v[208:211], v[128:143]
 ds_read_b64_tr_b16 v[192:193], v10 offset:40960
 ds_read_b64_tr_b16 v[194:195], v10 offset:41984
 s_waitcnt lgkmcnt(7)
 v_mfma_f32_32x32x16_bf16 v[144:159], v[180:183], v[212:215], v[144:159]
 ds_read_b64_tr_b16 v[196:197], v11 offset:40960
 ds_read_b64_tr_b16 v[198:199], v11 offset:41984
 s_waitcnt lgkmcnt(6)
 v_mfma_f32_32x32x16_bf16 v[96:111], v[176:179], v[184:187], v[96:111]
 ds_read_b128 v[180:183], v15 offset:32768
 ds_read_b64_tr_b16 v[200:201], v8 offset:45056
 ds_read_b64_tr_b16 v[202:203], v8 offset:46080
 v_mfma_f32_32x32x16_bf16 v[160:175], v[216:219], v[184:187], v[160:175]
 s_add_u32 m0, s40, 66560
 s_mov_b32 s41, 768
 buffer_load_dwordx4 v225, s[12:15], s41 offen lds
 s_add_u32 m0, s40, 82944
 s_mov_b32 s41, 1340928
 buffer_load_dwordx4 v228, s[16:19], s41 offen lds
 s_waitcnt lgkmcnt(7)
 v_mfma_f32_32x32x16_bf16 v[112:127], v[176:179], v[188:191], v[112:127]
 ds_read_b64_tr_b16 v[204:205], v9 offset:45056
 ds_read_b64_tr_b16 v[206:207], v9 offset:46080
 s_waitcnt lgkmcnt(7)
 v_mfma_f32_32x32x16_bf16 v[128:143], v[176:179], v[192:195], v[128:143]
 ds_read_b64_tr_b16 v[208:209], v10 offset:45056
 ds_read_b64_tr_b16 v[210:211], v10 offset:46080
 s_waitcnt lgkmcnt(7)
 v_mfma_f32_32x32x16_bf16 v[144:159], v[176:179], v[196:199], v[144:159]
 ds_read_b64_tr_b16 v[212:213], v11 offset:45056
 ds_read_b64_tr_b16 v[214:215], v11 offset:46080
 s_waitcnt lgkmcnt(6)
 v_mfma_f32_32x32x16_bf16 v[96:111], v[180:183], v[200:203], v[96:111]
 v_mfma_f32_32x32x16_bf16 v[160:175], v[216:219], v[200:203], v[160:175]
 s_waitcnt vmcnt(12) lgkmcnt(0)
 s_barrier
 v_add_u32 v8, 0xffff0000, v8
 v_add_u32 v9, 0xffff0000, v9
 v_add_u32 v10, 0xffff0000, v10
 v_add_u32 v11, 0xffff0000, v11
 v_add_u32 v12, 0xffff0000, v12
 v_add_u32 v13, 0xffff0000, v13
 v_add_u32 v14, 0xffff0000, v14
 v_add_u32 v15, 0xffff0000, v15
 v_mfma_f32_32x32x16_bf16 v[112:127], v[180:183], v[204:207], v[112:127]
 ds_read_b128 v[176:179], v12 offset:0
 ds_read_b64_tr_b16 v[184:185], v8 offset:0
 ds_read_b64_tr_b16 v[186:187], v8 offset:1024
 v_mfma_f32_32x32x16_bf16 v[128:143], v[180:183], v[208:211], v[128:143]
 ds_read_b64_tr_b16 v[188:189], v9 offset:0
 ds_read_b64_tr_b16 v[190:191], v9 offset:1024
 ds_read_b64_tr_b16 v[192:193], v10 offset:0
 v_mfma_f32_32x32x16_bf16 v[144:159], v[180:183], v[212:215], v[144:159]
 ds_read_b64_tr_b16 v[194:195], v10 offset:1024
 ds_read_b64_tr_b16 v[196:197], v11 offset:0
 ds_read_b64_tr_b16 v[198:199], v11 offset:1024
 s_add_u32 m0, s40, 67584
 s_mov_b32 s41, 768
 buffer_load_dwordx4 v226, s[12:15], s41 offen lds
 s_add_u32 m0, s40, 83968
 s_mov_b32 s41, 1354752
 buffer_load_dwordx4 v228, s[16:19], s41 offen lds
 s_waitcnt lgkmcnt(6)
 v_mfma_f32_32x32x16_bf16 v[96:111], v[176:179], v[184:187], v[96:111]
 ds_read_b128 v[180:183], v13 offset:0
 ds_read_b64_tr_b16 v[200:201], v8 offset:4096
 ds_read_b64_tr_b16 v[202:203], v8 offset:5120
 v_mfma_f32_32x32x16_bf16 v[160:175], v[216:219], v[184:187], v[160:175]
 s_add_u32 m0, s40, 68608
 s_mov_b32 s41, 768
 buffer_load_dwordx4 v227, s[12:15], s41 offen lds
 s_add_u32 m0, s40, 84992
 s_mov_b32 s41, 1368576
 buffer_load_dwordx4 v228, s[16:19], s41 offen lds
 s_waitcnt lgkmcnt(7)
 v_mfma_f32_32x32x16_bf16 v[112:127], v[176:179], v[188:191], v[112:127]
 ds_read_b64_tr_b16 v[204:205], v9 offset:4096
 ds_read_b64_tr_b16 v[206:207], v9 offset:5120
 s_waitcnt lgkmcnt(7)
 v_mfma_f32_32x32x16_bf16 v[128:143], v[176:179], v[192:195], v[128:143]
 ds_read_b64_tr_b16 v[208:209], v10 offset:4096
 ds_read_b64_tr_b16 v[210:211], v10 offset:5120
 s_waitcnt lgkmcnt(7)
 v_mfma_f32_32x32x16_bf16 v[144:159], v[176:179], v[196:199], v[144:159]
 ds_read_b64_tr_b16 v[212:213], v11 offset:4096
 ds_read_b64_tr_b16 v[214:215], v11 offset:5120
 s_waitcnt lgkmcnt(6)
 v_mfma_f32_32x32x16_bf16 v[96:111], v[180:183], v[200:203], v[96:111]
 ds_read_b128 v[176:179], v14 offset:0
 ds_read_b64_tr_b16 v[184:185], v8 offset:8192
 ds_read_b64_tr_b16 v[186:187], v8 offset:9216
 v_mfma_f32_32x32x16_bf16 v[160:175], v[216:219], v[200:203], v[160:175]
 s_add_u32 m0, s40, 98304
 s_mov_b32 s41, 896
 buffer_load_dwordx4 v224, s[12:15], s41 offen lds
 s_add_u32 m0, s40, 114688
 s_mov_b32 s41, 1548288
 buffer_load_dwordx4 v228, s[16:19], s41 offen lds
 s_waitcnt lgkmcnt(7)
 v_mfma_f32_32x32x16_bf16 v[112:127], v[180:183], v[204:207], v[112:127]
 ds_read_b64_tr_b16 v[188:189], v9 offset:8192
 ds_read_b64_tr_b16 v[190:191], v9 offset:9216
 s_waitcnt lgkmcnt(7)
 v_mfma_f32_32x32x16_bf16 v[128:143], v[180:183], v[208:211], v[128:143]
 ds_read_b64_tr_b16 v[192:193], v10 offset:8192
 ds_read_b64_tr_b16 v[194:195], v10 offset:9216
 s_waitcnt lgkmcnt(7)
 v_mfma_f32_32x32x16_bf16 v[144:159], v[180:183], v[212:215], v[144:159]
 ds_read_b64_tr_b16 v[196:197], v11 offset:8192
 ds_read_b64_tr_b16 v[198:199], v11 offset:9216
 s_waitcnt lgkmcnt(6)
 v_mfma_f32_32x32x16_bf16 v[96:111], v[176:179], v[184:187], v[96:111]
 ds_read_b128 v[180:183], v15 offset:0
 ds_read_b64_tr_b16 v[200:201], v8 offset:12288
 ds_read_b64_tr_b16 v[202:203], v8 offset:13312
 v_mfma_f32_32x32x16_bf16 v[160:175], v[216:219], v[184:187], v[160:175]
 s_add_u32 m0, s40, 99328
 s_mov_b32 s41, 896
 buffer_load_dwordx4 v225, s[12:15], s41 offen lds
 s_add_u32 m0, s40, 115712
 s_mov_b32 s41, 1562112
 buffer_load_dwordx4 v228, s[16:19], s41 offen lds
 s_waitcnt lgkmcnt(7)
 v_mfma_f32_32x32x16_bf16 v[112:127], v[176:179], v[188:191], v[112:127]
 ds_read_b64_tr_b16 v[204:205], v9 offset:12288
 ds_read_b64_tr_b16 v[206:207], v9 offset:13312
 s_waitcnt lgkmcnt(7)
 v_mfma_f32_32x32x16_bf16 v[128:143], v[176:179], v[192:195], v[128:143]
 ds_read_b64_tr_b16 v[208:209], v10 offset:12288
 ds_read_b64_tr_b16 v[210:211], v10 offset:13312
 s_waitcnt lgkmcnt(7)
 v_mfma_f32_32x32x16_bf16 v[144:159], v[176:179], v[196:199], v[144:159]
 ds_read_b64_tr_b16 v[212:213], v11 offset:12288
 ds_read_b64_tr_b16 v[214:215], v11 offset:13312
 s_waitcnt lgkmcnt(6)
 v_mfma_f32_32x32x16_bf16 v[96:111], v[180:183], v[200:203], v[96:111]
 v_mfma_f32_32x32x16_bf16 v[160:175], v[216:219], v[200:203], v[160:175]
 s_waitcnt vmcnt(12) lgkmcnt(0)
 s_barrier
 v_mfma_f32_32x32x16_bf16 v[112:127], v[180:183], v[204:207], v[112:127]
 ds_read_b128 v[176:179], v12 offset:32768
 ds_read_b64_tr_b16 v[184:185], v8 offset:32768
 ds_read_b64_tr_b16 v[186:187], v8 offset:33792
 v_mfma_f32_32x32x16_bf16 v[128:143], v[180:183], v[208:211], v[128:143]
 ds_read_b64_tr_b16 v[188:189], v9 offset:32768
 ds_read_b64_tr_b16 v[190:191], v9 offset:33792
 ds_read_b64_tr_b16 v[192:193], v10 offset:32768
 v_mfma_f32_32x32x16_bf16 v[144:159], v[180:183], v[212:215], v[144:159]
 ds_read_b64_tr_b16 v[194:195], v10 offset:33792
 ds_read_b64_tr_b16 v[196:197], v11 offset:32768
 ds_read_b64_tr_b16 v[198:199], v11 offset:33792
 s_add_u32 m0, s40, 100352
 s_mov_b32 s41, 896
 buffer_load_dwordx4 v226, s[12:15], s41 offen lds
 s_add_u32 m0, s40, 116736
 s_mov_b32 s41, 1575936
 buffer_load_dwordx4 v228, s[16:19], s41 offen lds
 s_waitcnt lgkmcnt(6)
 v_mfma_f32_32x32x16_bf16 v[96:111], v[176:179], v[184:187], v[96:111]
 ds_read_b128 v[180:183], v13 offset:32768
 ds_read_b64_tr_b16 v[200:201], v8 offset:36864
 ds_read_b64_tr_b16 v[202:203], v8 offset:37888
 v_mfma_f32_32x32x16_bf16 v[160:175], v[216:219], v[184:187], v[160:175]
 s_add_u32 m0, s40, 101376
 s_mov_b32 s41, 896
 buffer_load_dwordx4 v227, s[12:15], s41 offen lds
 s_add_u32 m0, s40, 117760
 s_mov_b32 s41, 1589760
 buffer_load_dwordx4 v228, s[16:19], s41 offen lds
 s_waitcnt lgkmcnt(7)
 v_mfma_f32_32x32x16_bf16 v[112:127], v[176:179], v[188:191], v[112:127]
 ds_read_b64_tr_b16 v[204:205], v9 offset:36864
 ds_read_b64_tr_b16 v[206:207], v9 offset:37888
 s_waitcnt lgkmcnt(7)
 v_mfma_f32_32x32x16_bf16 v[128:143], v[176:179], v[192:195], v[128:143]
 ds_read_b64_tr_b16 v[208:209], v10 offset:36864
 ds_read_b64_tr_b16 v[210:211], v10 offset:37888
 s_waitcnt lgkmcnt(7)
 v_mfma_f32_32x32x16_bf16 v[144:159], v[176:179], v[196:199], v[144:159]
 ds_read_b64_tr_b16 v[212:213], v11 offset:36864
 ds_read_b64_tr_b16 v[214:215], v11 offset:37888
 s_waitcnt lgkmcnt(6)
 v_mfma_f32_32x32x16_bf16 v[96:111], v[180:183], v[200:203], v[96:111]
 ds_read_b128 v[176:179], v14 offset:32768
 ds_read_b64_tr_b16 v[184:185], v8 offset:40960
 ds_read_b64_tr_b16 v[186:187], v8 offset:41984
 v_mfma_f32_32x32x16_bf16 v[160:175], v[216:219], v[200:203], v[160:175]
 s_add_u32 m0, s40, 0
 s_mov_b32 s41, 1024
 buffer_load_dwordx4 v224, s[12:15], s41 offen lds
 s_add_u32 m0, s40, 16384
 s_mov_b32 s41, 1769472
 buffer_load_dwordx4 v228, s[16:19], s41 offen lds
 s_waitcnt lgkmcnt(7)
 v_mfma_f32_32x32x16_bf16 v[112:127], v[180:183], v[204:207], v[112:127]
 ds_read_b64_tr_b16 v[188:189], v9 offset:40960
 ds_read_b64_tr_b16 v[190:191], v9 offset:41984
 s_waitcnt lgkmcnt(7)
 v_mfma_f32_32x32x16_bf16 v[128:143], v[180:183], v[208:211], v[128:143]
 ds_read_b64_tr_b16 v[192:193], v10 offset:40960
 ds_read_b64_tr_b16 v[194:195], v10 offset:41984
 s_waitcnt lgkmcnt(7)
 v_mfma_f32_32x32x16_bf16 v[144:159], v[180:183], v[212:215], v[144:159]
 ds_read_b64_tr_b16 v[196:197], v11 offset:40960
 ds_read_b64_tr_b16 v[198:199], v11 offset:41984
 s_waitcnt lgkmcnt(6)
 v_mfma_f32_32x32x16_bf16 v[96:111], v[176:179], v[184:187], v[96:111]
 ds_read_b128 v[180:183], v15 offset:32768
 ds_read_b64_tr_b16 v[200:201], v8 offset:45056
 ds_read_b64_tr_b16 v[202:203], v8 offset:46080
 v_mfma_f32_32x32x16_bf16 v[160:175], v[216:219], v[184:187], v[160:175]
 s_add_u32 m0, s40, 1024
 s_mov_b32 s41, 1024
 buffer_load_dwordx4 v225, s[12:15], s41 offen lds
 s_add_u32 m0, s40, 17408
 s_mov_b32 s41, 1783296
 buffer_load_dwordx4 v228, s[16:19], s41 offen lds
 s_waitcnt lgkmcnt(7)
 v_mfma_f32_32x32x16_bf16 v[112:127], v[176:179], v[188:191], v[112:127]
 ds_read_b64_tr_b16 v[204:205], v9 offset:45056
 ds_read_b64_tr_b16 v[206:207], v9 offset:46080
 s_waitcnt lgkmcnt(7)
 v_mfma_f32_32x32x16_bf16 v[128:143], v[176:179], v[192:195], v[128:143]
 ds_read_b64_tr_b16 v[208:209], v10 offset:45056
 ds_read_b64_tr_b16 v[210:211], v10 offset:46080
 s_waitcnt lgkmcnt(7)
 v_mfma_f32_32x32x16_bf16 v[144:159], v[176:179], v[196:199], v[144:159]
 ds_read_b64_tr_b16 v[212:213], v11 offset:45056
 ds_read_b64_tr_b16 v[214:215], v11 offset:46080
 s_waitcnt lgkmcnt(6)
 v_mfma_f32_32x32x16_bf16 v[96:111], v[180:183], v[200:203], v[96:111]
 v_mfma_f32_32x32x16_bf16 v[160:175], v[216:219], v[200:203], v[160:175]
 s_waitcnt vmcnt(12) lgkmcnt(0)
 s_barrier
 v_add_u32 v8, 0x10000, v8
 v_add_u32 v9, 0x10000, v9
 v_add_u32 v10, 0x10000, v10
 v_add_u32 v11, 0x10000, v11
 v_add_u32 v12, 0x10000, v12
 v_add_u32 v13, 0x10000, v13
 v_add_u32 v14, 0x10000, v14
 v_add_u32 v15, 0x10000, v15
 v_mfma_f32_32x32x16_bf16 v[112:127], v[180:183], v[204:207], v[112:127]
 ds_read_b128 v[176:179], v12 offset:0
 ds_read_b64_tr_b16 v[184:185], v8 offset:0
 ds_read_b64_tr_b16 v[186:187], v8 offset:1024
 v_mfma_f32_32x32x16_bf16 v[128:143], v[180:183], v[208:211], v[128:143]
 ds_read_b64_tr_b16 v[188:189], v9 offset:0
 ds_read_b64_tr_b16 v[190:191], v9 offset:1024
 ds_read_b64_tr_b16 v[192:193], v10 offset:0
 v_mfma_f32_32x32x16_bf16 v[144:159], v[180:183], v[212:215], v[144:159]
 ds_read_b64_tr_b16 v[194:195], v10 offset:1024
 ds_read_b64_tr_b16 v[196:197], v11 offset:0
 ds_read_b64_tr_b16 v[198:199], v11 offset:1024
 s_add_u32 m0, s40, 2048
 s_mov_b32 s41, 1024
 buffer_load_dwordx4 v226, s[12:15], s41 offen lds
 s_add_u32 m0, s40, 18432
 s_mov_b32 s41, 1797120
 buffer_load_dwordx4 v228, s[16:19], s41 offen lds
 s_waitcnt lgkmcnt(6)
 v_mfma_f32_32x32x16_bf16 v[96:111], v[176:179], v[184:187], v[96:111]
 ds_read_b128 v[180:183], v13 offset:0
 ds_read_b64_tr_b16 v[200:201], v8 offset:4096
 ds_read_b64_tr_b16 v[202:203], v8 offset:5120
 v_mfma_f32_32x32x16_bf16 v[160:175], v[216:219], v[184:187], v[160:175]
 s_add_u32 m0, s40, 3072
 s_mov_b32 s41, 1024
 buffer_load_dwordx4 v227, s[12:15], s41 offen lds
 s_add_u32 m0, s40, 19456
 s_mov_b32 s41, 1810944
 buffer_load_dwordx4 v228, s[16:19], s41 offen lds
 s_waitcnt lgkmcnt(7)
 v_mfma_f32_32x32x16_bf16 v[112:127], v[176:179], v[188:191], v[112:127]
 ds_read_b64_tr_b16 v[204:205], v9 offset:4096
 ds_read_b64_tr_b16 v[206:207], v9 offset:5120
 s_waitcnt lgkmcnt(7)
 v_mfma_f32_32x32x16_bf16 v[128:143], v[176:179], v[192:195], v[128:143]
 ds_read_b64_tr_b16 v[208:209], v10 offset:4096
 ds_read_b64_tr_b16 v[210:211], v10 offset:5120
 s_waitcnt lgkmcnt(7)
 v_mfma_f32_32x32x16_bf16 v[144:159], v[176:179], v[196:199], v[144:159]
 ds_read_b64_tr_b16 v[212:213], v11 offset:4096
 ds_read_b64_tr_b16 v[214:215], v11 offset:5120
 s_waitcnt lgkmcnt(6)
 v_mfma_f32_32x32x16_bf16 v[96:111], v[180:183], v[200:203], v[96:111]
 ds_read_b128 v[176:179], v14 offset:0
 ds_read_b64_tr_b16 v[184:185], v8 offset:8192
 ds_read_b64_tr_b16 v[186:187], v8 offset:9216
 v_mfma_f32_32x32x16_bf16 v[160:175], v[216:219], v[200:203], v[160:175]
 s_waitcnt lgkmcnt(7)
 v_mfma_f32_32x32x16_bf16 v[112:127], v[180:183], v[204:207], v[112:127]
 ds_read_b64_tr_b16 v[188:189], v9 offset:8192
 ds_read_b64_tr_b16 v[190:191], v9 offset:9216
 s_waitcnt lgkmcnt(7)
 v_mfma_f32_32x32x16_bf16 v[128:143], v[180:183], v[208:211], v[128:143]
 ds_read_b64_tr_b16 v[192:193], v10 offset:8192
 ds_read_b64_tr_b16 v[194:195], v10 offset:9216
 s_waitcnt lgkmcnt(7)
 v_mfma_f32_32x32x16_bf16 v[144:159], v[180:183], v[212:215], v[144:159]
 ds_read_b64_tr_b16 v[196:197], v11 offset:8192
 ds_read_b64_tr_b16 v[198:199], v11 offset:9216
 s_waitcnt lgkmcnt(6)
 v_mfma_f32_32x32x16_bf16 v[96:111], v[176:179], v[184:187], v[96:111]
 ds_read_b128 v[180:183], v15 offset:0
 ds_read_b64_tr_b16 v[200:201], v8 offset:12288
 ds_read_b64_tr_b16 v[202:203], v8 offset:13312
 v_mfma_f32_32x32x16_bf16 v[160:175], v[216:219], v[184:187], v[160:175]
 s_waitcnt lgkmcnt(7)
 v_mfma_f32_32x32x16_bf16 v[112:127], v[176:179], v[188:191], v[112:127]
 ds_read_b64_tr_b16 v[204:205], v9 offset:12288
 ds_read_b64_tr_b16 v[206:207], v9 offset:13312
 s_waitcnt lgkmcnt(7)
 v_mfma_f32_32x32x16_bf16 v[128:143], v[176:179], v[192:195], v[128:143]
 ds_read_b64_tr_b16 v[208:209], v10 offset:12288
 ds_read_b64_tr_b16 v[210:211], v10 offset:13312
 s_waitcnt lgkmcnt(7)
 v_mfma_f32_32x32x16_bf16 v[144:159], v[176:179], v[196:199], v[144:159]
 ds_read_b64_tr_b16 v[212:213], v11 offset:12288
 ds_read_b64_tr_b16 v[214:215], v11 offset:13312
 s_waitcnt lgkmcnt(6)
 v_mfma_f32_32x32x16_bf16 v[96:111], v[180:183], v[200:203], v[96:111]
 v_mfma_f32_32x32x16_bf16 v[160:175], v[216:219], v[200:203], v[160:175]
 s_waitcnt vmcnt(8) lgkmcnt(0)
 s_barrier
 v_mfma_f32_32x32x16_bf16 v[112:127], v[180:183], v[204:207], v[112:127]
 ds_read_b128 v[176:179], v12 offset:32768
 ds_read_b64_tr_b16 v[184:185], v8 offset:32768
 ds_read_b64_tr_b16 v[186:187], v8 offset:33792
 v_mfma_f32_32x32x16_bf16 v[128:143], v[180:183], v[208:211], v[128:143]
 ds_read_b64_tr_b16 v[188:189], v9 offset:32768
 ds_read_b64_tr_b16 v[190:191], v9 offset:33792
 ds_read_b64_tr_b16 v[192:193], v10 offset:32768
 v_mfma_f32_32x32x16_bf16 v[144:159], v[180:183], v[212:215], v[144:159]
 ds_read_b64_tr_b16 v[194:195], v10 offset:33792
 ds_read_b64_tr_b16 v[196:197], v11 offset:32768
 ds_read_b64_tr_b16 v[198:199], v11 offset:33792
 s_waitcnt lgkmcnt(6)
 v_mfma_f32_32x32x16_bf16 v[96:111], v[176:179], v[184:187], v[96:111]
 ds_read_b128 v[180:183], v13 offset:32768
 ds_read_b64_tr_b16 v[200:201], v8 offset:36864
 ds_read_b64_tr_b16 v[202:203], v8 offset:37888
 v_mfma_f32_32x32x16_bf16 v[160:175], v[216:219], v[184:187], v[160:175]
 s_waitcnt lgkmcnt(7)
 v_mfma_f32_32x32x16_bf16 v[112:127], v[176:179], v[188:191], v[112:127]
 ds_read_b64_tr_b16 v[204:205], v9 offset:36864
 ds_read_b64_tr_b16 v[206:207], v9 offset:37888
 s_waitcnt lgkmcnt(7)
 v_mfma_f32_32x32x16_bf16 v[128:143], v[176:179], v[192:195], v[128:143]
 ds_read_b64_tr_b16 v[208:209], v10 offset:36864
 ds_read_b64_tr_b16 v[210:211], v10 offset:37888
 s_waitcnt lgkmcnt(7)
 v_mfma_f32_32x32x16_bf16 v[144:159], v[176:179], v[196:199], v[144:159]
 ds_read_b64_tr_b16 v[212:213], v11 offset:36864
 ds_read_b64_tr_b16 v[214:215], v11 offset:37888
 s_waitcnt lgkmcnt(6)
 v_mfma_f32_32x32x16_bf16 v[96:111], v[180:183], v[200:203], v[96:111]
 ds_read_b128 v[176:179], v14 offset:32768
 ds_read_b64_tr_b16 v[184:185], v8 offset:40960
 ds_read_b64_tr_b16 v[186:187], v8 offset:41984
 v_mfma_f32_32x32x16_bf16 v[160:175], v[216:219], v[200:203], v[160:175]
 s_waitcnt lgkmcnt(7)
 v_mfma_f32_32x32x16_bf16 v[112:127], v[180:183], v[204:207], v[112:127]
 ds_read_b64_tr_b16 v[188:189], v9 offset:40960
 ds_read_b64_tr_b16 v[190:191], v9 offset:41984
 s_waitcnt lgkmcnt(7)
 v_mfma_f32_32x32x16_bf16 v[128:143], v[180:183], v[208:211], v[128:143]
 ds_read_b64_tr_b16 v[192:193], v10 offset:40960
 ds_read_b64_tr_b16 v[194:195], v10 offset:41984
 s_waitcnt lgkmcnt(7)
 v_mfma_f32_32x32x16_bf16 v[144:159], v[180:183], v[212:215], v[144:159]
 ds_read_b64_tr_b16 v[196:197], v11 offset:40960
 ds_read_b64_tr_b16 v[198:199], v11 offset:41984
 s_waitcnt lgkmcnt(6)
 v_mfma_f32_32x32x16_bf16 v[96:111], v[176:179], v[184:187], v[96:111]
 ds_read_b128 v[180:183], v15 offset:32768
 ds_read_b64_tr_b16 v[200:201], v8 offset:45056
 ds_read_b64_tr_b16 v[202:203], v8 offset:46080
 v_mfma_f32_32x32x16_bf16 v[160:175], v[216:219], v[184:187], v[160:175]
 s_waitcnt lgkmcnt(7)
 v_mfma_f32_32x32x16_bf16 v[112:127], v[176:179], v[188:191], v[112:127]
 ds_read_b64_tr_b16 v[204:205], v9 offset:45056
 ds_read_b64_tr_b16 v[206:207], v9 offset:46080
 s_waitcnt lgkmcnt(7)
 v_mfma_f32_32x32x16_bf16 v[128:143], v[176:179], v[192:195], v[128:143]
 ds_read_b64_tr_b16 v[208:209], v10 offset:45056
 ds_read_b64_tr_b16 v[210:211], v10 offset:46080
 s_waitcnt lgkmcnt(7)
 v_mfma_f32_32x32x16_bf16 v[144:159], v[176:179], v[196:199], v[144:159]
 ds_read_b64_tr_b16 v[212:213], v11 offset:45056
 ds_read_b64_tr_b16 v[214:215], v11 offset:46080
 s_waitcnt lgkmcnt(6)
 v_mfma_f32_32x32x16_bf16 v[96:111], v[180:183], v[200:203], v[96:111]
 v_mfma_f32_32x32x16_bf16 v[160:175], v[216:219], v[200:203], v[160:175]
 s_waitcnt vmcnt(0) lgkmcnt(0)
 s_barrier
 v_add_u32 v8, 0xffff0000, v8
 v_add_u32 v9, 0xffff0000, v9
 v_add_u32 v10, 0xffff0000, v10
 v_add_u32 v11, 0xffff0000, v11
 v_add_u32 v12, 0xffff0000, v12
 v_add_u32 v13, 0xffff0000, v13
 v_add_u32 v14, 0xffff0000, v14
 v_add_u32 v15, 0xffff0000, v15
 v_mfma_f32_32x32x16_bf16 v[112:127], v[180:183], v[204:207], v[112:127]
 ds_read_b128 v[176:179], v12 offset:0
 ds_read_b64_tr_b16 v[184:185], v8 offset:0
 ds_read_b64_tr_b16 v[186:187], v8 offset:1024
 v_mfma_f32_32x32x16_bf16 v[128:143], v[180:183], v[208:211], v[128:143]
 ds_read_b64_tr_b16 v[188:189], v9 offset:0
 ds_read_b64_tr_b16 v[190:191], v9 offset:1024
 ds_read_b64_tr_b16 v[192:193], v10 offset:0
 v_mfma_f32_32x32x16_bf16 v[144:159], v[180:183], v[212:215], v[144:159]
 ds_read_b64_tr_b16 v[194:195], v10 offset:1024
 ds_read_b64_tr_b16 v[196:197], v11 offset:0
 ds_read_b64_tr_b16 v[198:199], v11 offset:1024
 s_waitcnt lgkmcnt(6)
 v_mfma_f32_32x32x16_bf16 v[96:111], v[176:179], v[184:187], v[96:111]
 ds_read_b128 v[180:183], v13 offset:0
 ds_read_b64_tr_b16 v[200:201], v8 offset:4096
 ds_read_b64_tr_b16 v[202:203], v8 offset:5120
 v_mfma_f32_32x32x16_bf16 v[160:175], v[216:219], v[184:187], v[160:175]
 s_waitcnt lgkmcnt(7)
 v_mfma_f32_32x32x16_bf16 v[112:127], v[176:179], v[188:191], v[112:127]
 ds_read_b64_tr_b16 v[204:205], v9 offset:4096
 ds_read_b64_tr_b16 v[206:207], v9 offset:5120
 s_waitcnt lgkmcnt(7)
 v_mfma_f32_32x32x16_bf16 v[128:143], v[176:179], v[192:195], v[128:143]
 ds_read_b64_tr_b16 v[208:209], v10 offset:4096
 ds_read_b64_tr_b16 v[210:211], v10 offset:5120
 s_waitcnt lgkmcnt(7)
 v_mfma_f32_32x32x16_bf16 v[144:159], v[176:179], v[196:199], v[144:159]
 ds_read_b64_tr_b16 v[212:213], v11 offset:4096
 ds_read_b64_tr_b16 v[214:215], v11 offset:5120
 s_waitcnt lgkmcnt(6)
 v_mfma_f32_32x32x16_bf16 v[96:111], v[180:183], v[200:203], v[96:111]
 ds_read_b128 v[176:179], v14 offset:0
 ds_read_b64_tr_b16 v[184:185], v8 offset:8192
 ds_read_b64_tr_b16 v[186:187], v8 offset:9216
 v_mfma_f32_32x32x16_bf16 v[160:175], v[216:219], v[200:203], v[160:175]
 s_waitcnt lgkmcnt(7)
 v_mfma_f32_32x32x16_bf16 v[112:127], v[180:183], v[204:207], v[112:127]
 ds_read_b64_tr_b16 v[188:189], v9 offset:8192
 ds_read_b64_tr_b16 v[190:191], v9 offset:9216
 s_waitcnt lgkmcnt(7)
 v_mfma_f32_32x32x16_bf16 v[128:143], v[180:183], v[208:211], v[128:143]
 ds_read_b64_tr_b16 v[192:193], v10 offset:8192
 ds_read_b64_tr_b16 v[194:195], v10 offset:9216
 s_waitcnt lgkmcnt(7)
 v_mfma_f32_32x32x16_bf16 v[144:159], v[180:183], v[212:215], v[144:159]
 ds_read_b64_tr_b16 v[196:197], v11 offset:8192
 ds_read_b64_tr_b16 v[198:199], v11 offset:9216
 s_waitcnt lgkmcnt(6)
 v_mfma_f32_32x32x16_bf16 v[96:111], v[176:179], v[184:187], v[96:111]
 ds_read_b128 v[180:183], v15 offset:0
 ds_read_b64_tr_b16 v[200:201], v8 offset:12288
 ds_read_b64_tr_b16 v[202:203], v8 offset:13312
 v_mfma_f32_32x32x16_bf16 v[160:175], v[216:219], v[184:187], v[160:175]
 s_waitcnt lgkmcnt(7)
 v_mfma_f32_32x32x16_bf16 v[112:127], v[176:179], v[188:191], v[112:127]
 ds_read_b64_tr_b16 v[204:205], v9 offset:12288
 ds_read_b64_tr_b16 v[206:207], v9 offset:13312
 s_waitcnt lgkmcnt(7)
 v_mfma_f32_32x32x16_bf16 v[128:143], v[176:179], v[192:195], v[128:143]
 ds_read_b64_tr_b16 v[208:209], v10 offset:12288
 ds_read_b64_tr_b16 v[210:211], v10 offset:13312
 s_waitcnt lgkmcnt(7)
 v_mfma_f32_32x32x16_bf16 v[144:159], v[176:179], v[196:199], v[144:159]
 ds_read_b64_tr_b16 v[212:213], v11 offset:12288
 ds_read_b64_tr_b16 v[214:215], v11 offset:13312
 s_waitcnt lgkmcnt(6)
 v_mfma_f32_32x32x16_bf16 v[96:111], v[180:183], v[200:203], v[96:111]
 v_mfma_f32_32x32x16_bf16 v[160:175], v[216:219], v[200:203], v[160:175]
 s_waitcnt lgkmcnt(4)
 v_mfma_f32_32x32x16_bf16 v[112:127], v[180:183], v[204:207], v[112:127]
 s_waitcnt lgkmcnt(2)
 v_mfma_f32_32x32x16_bf16 v[128:143], v[180:183], v[208:211], v[128:143]
 s_waitcnt lgkmcnt(0)
 v_mfma_f32_32x32x16_bf16 v[144:159], v[180:183], v[212:215], v[144:159]
 s_lshl_b32 s36, s32, 7
 s_add_u32 s36, s36, 131072
 v_lshl_add_u32 v4, v20, 2, s36
 v_lshl_add_u32 v5, v21, 4, s36
 v_lshlrev_b32 v6, 2, v20
 v_add_u32 v6, 132096, v6
 s_nop 4
 ds_write_b32 v4, v160 offset:1024
 s_waitcnt lgkmcnt(0)
 s_barrier
 ds_read_b128 v[24:27], v5 offset:0
 ds_read_b128 v[40:43], v5 offset:512
 ds_read_b128 v[28:31], v5 offset:32
 ds_read_b128 v[44:47], v5 offset:544
 ds_read_b128 v[32:35], v5 offset:64
 ds_read_b128 v[48:51], v5 offset:576
 ds_read_b128 v[36:39], v5 offset:96
 ds_read_b128 v[52:55], v5 offset:608
 s_lshl_b32 s36, s32, 7
 v_xor_b32 v6, s36, v6
 v_xor_b32 v7, 0, v6
 ds_read_b32 v56, v7
 v_xor_b32 v7, 128, v6
 ds_read_b32 v58, v7
 v_xor_b32 v7, 256, v6
 ds_read_b32 v60, v7
 v_xor_b32 v7, 384, v6
 ds_read_b32 v62, v7
 v_mov_b32 v64, 0.34004648219892986
 s_waitcnt lgkmcnt(0)
 s_cmp_ge_u32 s44, 1728
 s_cbranch_scc1 L_fz_p1e0
 v_pk_fma_f32 v[96:97], v[40:41], v[56:57], v[96:97] op_sel_hi:[1,0,1] neg_lo:[1,0,0] neg_hi:[1,0,0]
 v_pk_fma_f32 v[98:99], v[42:43], v[56:57], v[98:99] op_sel_hi:[1,0,1] neg_lo:[1,0,0] neg_hi:[1,0,0]
 v_pk_fma_f32 v[100:101], v[44:45], v[56:57], v[100:101] op_sel_hi:[1,0,1] neg_lo:[1,0,0] neg_hi:[1,0,0]
 v_pk_fma_f32 v[102:103], v[46:47], v[56:57], v[102:103] op_sel_hi:[1,0,1] neg_lo:[1,0,0] neg_hi:[1,0,0]
 v_pk_fma_f32 v[104:105], v[48:49], v[56:57], v[104:105] op_sel_hi:[1,0,1] neg_lo:[1,0,0] neg_hi:[1,0,0]
 v_pk_fma_f32 v[106:107], v[50:51], v[56:57], v[106:107] op_sel_hi:[1,0,1] neg_lo:[1,0,0] neg_hi:[1,0,0]
 v_pk_fma_f32 v[108:109], v[52:53], v[56:57], v[108:109] op_sel_hi:[1,0,1] neg_lo:[1,0,0] neg_hi:[1,0,0]
 v_pk_fma_f32 v[110:111], v[54:55], v[56:57], v[110:111] op_sel_hi:[1,0,1] neg_lo:[1,0,0] neg_hi:[1,0,0]
 v_pk_mul_f32 v[96:97], v[96:97], v[24:25]
 v_pk_mul_f32 v[98:99], v[98:99], v[26:27]
 v_pk_mul_f32 v[100:101], v[100:101], v[28:29]
 v_pk_mul_f32 v[102:103], v[102:103], v[30:31]
 v_pk_mul_f32 v[104:105], v[104:105], v[32:33]
 v_pk_mul_f32 v[106:107], v[106:107], v[34:35]
 v_pk_mul_f32 v[108:109], v[108:109], v[36:37]
 v_pk_mul_f32 v[110:111], v[110:111], v[38:39]
 s_cmp_ge_u32 s44, 576
 s_cbranch_scc1 L_fz_p1e0q
 v_pk_mul_f32 v[96:97], v[96:97], v[64:65] op_sel_hi:[1,0]
 v_pk_mul_f32 v[98:99], v[98:99], v[64:65] op_sel_hi:[1,0]
 v_pk_mul_f32 v[100:101], v[100:101], v[64:65] op_sel_hi:[1,0]
 v_pk_mul_f32 v[102:103], v[102:103], v[64:65] op_sel_hi:[1,0]
 v_pk_mul_f32 v[104:105], v[104:105], v[64:65] op_sel_hi:[1,0]
 v_pk_mul_f32 v[106:107], v[106:107], v[64:65] op_sel_hi:[1,0]
 v_pk_mul_f32 v[108:109], v[108:109], v[64:65] op_sel_hi:[1,0]
 v_pk_mul_f32 v[110:111], v[110:111], v[64:65] op_sel_hi:[1,0]
L_fz_p1e0q:
 v_cvt_pk_bf16_f32 v96, v96, v97
 v_cvt_pk_bf16_f32 v97, v98, v99
 v_cvt_pk_bf16_f32 v98, v100, v101
 v_cvt_pk_bf16_f32 v99, v102, v103
 v_cvt_pk_bf16_f32 v100, v104, v105
 v_cvt_pk_bf16_f32 v101, v106, v107
 v_cvt_pk_bf16_f32 v102, v108, v109
 v_cvt_pk_bf16_f32 v103, v110, v111
 buffer_store_dwordx4 v[96:99], v16, s[20:23], 0 offen sc1
 buffer_store_dwordx4 v[100:103], v16, s[20:23], s43 offen sc1
L_fz_p1e0:
 s_cmp_ge_u32 s45, 1728
 s_cbranch_scc1 L_fz_p1e1
 v_pk_fma_f32 v[112:113], v[40:41], v[58:59], v[112:113] op_sel_hi:[1,0,1] neg_lo:[1,0,0] neg_hi:[1,0,0]
 v_pk_fma_f32 v[114:115], v[42:43], v[58:59], v[114:115] op_sel_hi:[1,0,1] neg_lo:[1,0,0] neg_hi:[1,0,0]
 v_pk_fma_f32 v[116:117], v[44:45], v[58:59], v[116:117] op_sel_hi:[1,0,1] neg_lo:[1,0,0] neg_hi:[1,0,0]
 v_pk_fma_f32 v[118:119], v[46:47], v[58:59], v[118:119] op_sel_hi:[1,0,1] neg_lo:[1,0,0] neg_hi:[1,0,0]
 v_pk_fma_f32 v[120:121], v[48:49], v[58:59], v[120:121] op_sel_hi:[1,0,1] neg_lo:[1,0,0] neg_hi:[1,0,0]
 v_pk_fma_f32 v[122:123], v[50:51], v[58:59], v[122:123] op_sel_hi:[1,0,1] neg_lo:[1,0,0] neg_hi:[1,0,0]
 v_pk_fma_f32 v[124:125], v[52:53], v[58:59], v[124:125] op_sel_hi:[1,0,1] neg_lo:[1,0,0] neg_hi:[1,0,0]
 v_pk_fma_f32 v[126:127], v[54:55], v[58:59], v[126:127] op_sel_hi:[1,0,1] neg_lo:[1,0,0] neg_hi:[1,0,0]
 v_pk_mul_f32 v[112:113], v[112:113], v[24:25]
 v_pk_mul_f32 v[114:115], v[114:115], v[26:27]
 v_pk_mul_f32 v[116:117], v[116:117], v[28:29]
 v_pk_mul_f32 v[118:119], v[118:119], v[30:31]
 v_pk_mul_f32 v[120:121], v[120:121], v[32:33]
 v_pk_mul_f32 v[122:123], v[122:123], v[34:35]
 v_pk_mul_f32 v[124:125], v[124:125], v[36:37]
 v_pk_mul_f32 v[126:127], v[126:127], v[38:39]
 s_cmp_ge_u32 s45, 576
 s_cbranch_scc1 L_fz_p1e1q
 v_pk_mul_f32 v[112:113], v[112:113], v[64:65] op_sel_hi:[1,0]
 v_pk_mul_f32 v[114:115], v[114:115], v[64:65] op_sel_hi:[1,0]
 v_pk_mul_f32 v[116:117], v[116:117], v[64:65] op_sel_hi:[1,0]
 v_pk_mul_f32 v[118:119], v[118:119], v[64:65] op_sel_hi:[1,0]
 v_pk_mul_f32 v[120:121], v[120:121], v[64:65] op_sel_hi:[1,0]
 v_pk_mul_f32 v[122:123], v[122:123], v[64:65] op_sel_hi:[1,0]
 v_pk_mul_f32 v[124:125], v[124:125], v[64:65] op_sel_hi:[1,0]
 v_pk_mul_f32 v[126:127], v[126:127], v[64:65] op_sel_hi:[1,0]
L_fz_p1e1q:
 v_cvt_pk_bf16_f32 v112, v112, v113
 v_cvt_pk_bf16_f32 v113, v114, v115
 v_cvt_pk_bf16_f32 v114, v116, v117
 v_cvt_pk_bf16_f32 v115, v118, v119
 v_cvt_pk_bf16_f32 v116, v120, v121
 v_cvt_pk_bf16_f32 v117, v122, v123
 v_cvt_pk_bf16_f32 v118, v124, v125
 v_cvt_pk_bf16_f32 v119, v126, v127
 buffer_store_dwordx4 v[112:115], v17, s[20:23], 0 offen sc1
 buffer_store_dwordx4 v[116:119], v17, s[20:23], s43 offen sc1
L_fz_p1e1:
 s_cmp_ge_u32 s46, 1728
 s_cbranch_scc1 L_fz_p1e2
 v_pk_fma_f32 v[128:129], v[40:41], v[60:61], v[128:129] op_sel_hi:[1,0,1] neg_lo:[1,0,0] neg_hi:[1,0,0]
 v_pk_fma_f32 v[130:131], v[42:43], v[60:61], v[130:131] op_sel_hi:[1,0,1] neg_lo:[1,0,0] neg_hi:[1,0,0]
 v_pk_fma_f32 v[132:133], v[44:45], v[60:61], v[132:133] op_sel_hi:[1,0,1] neg_lo:[1,0,0] neg_hi:[1,0,0]
 v_pk_fma_f32 v[134:135], v[46:47], v[60:61], v[134:135] op_sel_hi:[1,0,1] neg_lo:[1,0,0] neg_hi:[1,0,0]
 v_pk_fma_f32 v[136:137], v[48:49], v[60:61], v[136:137] op_sel_hi:[1,0,1] neg_lo:[1,0,0] neg_hi:[1,0,0]
 v_pk_fma_f32 v[138:139], v[50:51], v[60:61], v[138:139] op_sel_hi:[1,0,1] neg_lo:[1,0,0] neg_hi:[1,0,0]
 v_pk_fma_f32 v[140:141], v[52:53], v[60:61], v[140:141] op_sel_hi:[1,0,1] neg_lo:[1,0,0] neg_hi:[1,0,0]
 v_pk_fma_f32 v[142:143], v[54:55], v[60:61], v[142:143] op_sel_hi:[1,0,1] neg_lo:[1,0,0] neg_hi:[1,0,0]
 v_pk_mul_f32 v[128:129], v[128:129], v[24:25]
 v_pk_mul_f32 v[130:131], v[130:131], v[26:27]
 v_pk_mul_f32 v[132:133], v[132:133], v[28:29]
 v_pk_mul_f32 v[134:135], v[134:135], v[30:31]
 v_pk_mul_f32 v[136:137], v[136:137], v[32:33]
 v_pk_mul_f32 v[138:139], v[138:139], v[34:35]
 v_pk_mul_f32 v[140:141], v[140:141], v[36:37]
 v_pk_mul_f32 v[142:143], v[142:143], v[38:39]
 s_cmp_ge_u32 s46, 576
 s_cbranch_scc1 L_fz_p1e2q
 v_pk_mul_f32 v[128:129], v[128:129], v[64:65] op_sel_hi:[1,0]
 v_pk_mul_f32 v[130:131], v[130:131], v[64:65] op_sel_hi:[1,0]
 v_pk_mul_f32 v[132:133], v[132:133], v[64:65] op_sel_hi:[1,0]
 v_pk_mul_f32 v[134:135], v[134:135], v[64:65] op_sel_hi:[1,0]
 v_pk_mul_f32 v[136:137], v[136:137], v[64:65] op_sel_hi:[1,0]
 v_pk_mul_f32 v[138:139], v[138:139], v[64:65] op_sel_hi:[1,0]
 v_pk_mul_f32 v[140:141], v[140:141], v[64:65] op_sel_hi:[1,0]
 v_pk_mul_f32 v[142:143], v[142:143], v[64:65] op_sel_hi:[1,0]
L_fz_p1e2q:
 v_cvt_pk_bf16_f32 v128, v128, v129
 v_cvt_pk_bf16_f32 v129, v130, v131
 v_cvt_pk_bf16_f32 v130, v132, v133
 v_cvt_pk_bf16_f32 v131, v134, v135
 v_cvt_pk_bf16_f32 v132, v136, v137
 v_cvt_pk_bf16_f32 v133, v138, v139
 v_cvt_pk_bf16_f32 v134, v140, v141
 v_cvt_pk_bf16_f32 v135, v142, v143
 buffer_store_dwordx4 v[128:131], v18, s[20:23], 0 offen sc1
 buffer_store_dwordx4 v[132:135], v18, s[20:23], s43 offen sc1
L_fz_p1e2:
 s_cmp_ge_u32 s47, 1728
 s_cbranch_scc1 L_fz_p1e3
 v_pk_fma_f32 v[144:145], v[40:41], v[62:63], v[144:145] op_sel_hi:[1,0,1] neg_lo:[1,0,0] neg_hi:[1,0,0]
 v_pk_fma_f32 v[146:147], v[42:43], v[62:63], v[146:147] op_sel_hi:[1,0,1] neg_lo:[1,0,0] neg_hi:[1,0,0]
 v_pk_fma_f32 v[148:149], v[44:45], v[62:63], v[148:149] op_sel_hi:[1,0,1] neg_lo:[1,0,0] neg_hi:[1,0,0]
 v_pk_fma_f32 v[150:151], v[46:47], v[62:63], v[150:151] op_sel_hi:[1,0,1] neg_lo:[1,0,0] neg_hi:[1,0,0]
 v_pk_fma_f32 v[152:153], v[48:49], v[62:63], v[152:153] op_sel_hi:[1,0,1] neg_lo:[1,0,0] neg_hi:[1,0,0]
 v_pk_fma_f32 v[154:155], v[50:51], v[62:63], v[154:155] op_sel_hi:[1,0,1] neg_lo:[1,0,0] neg_hi:[1,0,0]
 v_pk_fma_f32 v[156:157], v[52:53], v[62:63], v[156:157] op_sel_hi:[1,0,1] neg_lo:[1,0,0] neg_hi:[1,0,0]
 v_pk_fma_f32 v[158:159], v[54:55], v[62:63], v[158:159] op_sel_hi:[1,0,1] neg_lo:[1,0,0] neg_hi:[1,0,0]
 v_pk_mul_f32 v[144:145], v[144:145], v[24:25]
 v_pk_mul_f32 v[146:147], v[146:147], v[26:27]
 v_pk_mul_f32 v[148:149], v[148:149], v[28:29]
 v_pk_mul_f32 v[150:151], v[150:151], v[30:31]
 v_pk_mul_f32 v[152:153], v[152:153], v[32:33]
 v_pk_mul_f32 v[154:155], v[154:155], v[34:35]
 v_pk_mul_f32 v[156:157], v[156:157], v[36:37]
 v_pk_mul_f32 v[158:159], v[158:159], v[38:39]
 s_cmp_ge_u32 s47, 576
 s_cbranch_scc1 L_fz_p1e3q
 v_pk_mul_f32 v[144:145], v[144:145], v[64:65] op_sel_hi:[1,0]
 v_pk_mul_f32 v[146:147], v[146:147], v[64:65] op_sel_hi:[1,0]
 v_pk_mul_f32 v[148:149], v[148:149], v[64:65] op_sel_hi:[1,0]
 v_pk_mul_f32 v[150:151], v[150:151], v[64:65] op_sel_hi:[1,0]
 v_pk_mul_f32 v[152:153], v[152:153], v[64:65] op_sel_hi:[1,0]
 v_pk_mul_f32 v[154:155], v[154:155], v[64:65] op_sel_hi:[1,0]
 v_pk_mul_f32 v[156:157], v[156:157], v[64:65] op_sel_hi:[1,0]
 v_pk_mul_f32 v[158:159], v[158:159], v[64:65] op_sel_hi:[1,0]
L_fz_p1e3q:
 v_cvt_pk_bf16_f32 v144, v144, v145
 v_cvt_pk_bf16_f32 v145, v146, v147
 v_cvt_pk_bf16_f32 v146, v148, v149
 v_cvt_pk_bf16_f32 v147, v150, v151
 v_cvt_pk_bf16_f32 v148, v152, v153
 v_cvt_pk_bf16_f32 v149, v154, v155
 v_cvt_pk_bf16_f32 v150, v156, v157
 v_cvt_pk_bf16_f32 v151, v158, v159
 buffer_store_dwordx4 v[144:147], v19, s[20:23], 0 offen sc1
 buffer_store_dwordx4 v[148:151], v19, s[20:23], s43 offen sc1
L_fz_p1e3:
L_fz_p1idx:
 s_mul_i32 s55, s33, 14
 s_add_u32 s55, s55, s34
 s_branch L_fz_p1pub
L_fz_p1cs:
 s_sub_u32 s33, s2, 224
 s_lshl_b32 s36, s3, 6
 v_add_u32 v4, s36, v0
 v_mul_u32_u24 v2, 3641, v4
 v_lshrrev_b32 v2, 16, v2
 v_mul_u32_u24 v3, 18, v2
 v_sub_u32 v3, v4, v3
 v_mul_u32_u24 v5, 9216, v2
 v_lshl_add_u32 v5, v3, 4, v5
 s_mul_i32 s34, s33, 288
 v_add_u32 v5, s34, v5
 v_cmp_gt_u32 vcc, 504, v4
 v_mov_b32 v6, 0x7fffffff
 s_mov_b32 s12, s72
 s_mov_b32 s13, s73
 s_mov_b32 s14, 5308416
 s_mov_b32 s15, 0x20000
 v_cndmask_b32 v5, v6, v5, vcc
 s_add_u32 s16, s8, 14942208
 s_addc_u32 s17, s9, 0
 s_mov_b32 s18, 18432
 s_mov_b32 s19, 0x20000
 s_mov_b32 s34, 0
 buffer_load_dwordx4 v[16:19], v5, s[12:15], s34 offen
 s_mov_b32 s34, 258048
 buffer_load_dwordx4 v[20:23], v5, s[12:15], s34 offen
 s_mov_b32 s34, 516096
 buffer_load_dwordx4 v[24:27], v5, s[12:15], s34 offen
 s_mov_b32 s34, 774144
 buffer_load_dwordx4 v[28:31], v5, s[12:15], s34 offen
 s_mov_b32 s34, 1032192
 buffer_load_dwordx4 v[32:35], v5, s[12:15], s34 offen
 s_mov_b32 s34, 1290240
 buffer_load_dwordx4 v[36:39], v5, s[12:15], s34 offen
 s_mov_b32 s34, 1548288
 buffer_load_dwordx4 v[40:43], v5, s[12:15], s34 offen
 s_mov_b32 s34, 1806336
 buffer_load_dwordx4 v[44:47], v5, s[12:15], s34 offen
 s_mov_b32 s34, 2064384
 buffer_load_dwordx4 v[48:51], v5, s[12:15], s34 offen
 s_mov_b32 s34, 2322432
 buffer_load_dwordx4 v[52:55], v5, s[12:15], s34 offen
 s_mov_b32 s34, 2580480
 buffer_load_dwordx4 v[56:59], v5, s[12:15], s34 offen
 s_mov_b32 s34, 2838528
 buffer_load_dwordx4 v[60:63], v5, s[12:15], s34 offen
 s_mov_b32 s34, 3096576
 buffer_load_dwordx4 v[64:67], v5, s[12:15], s34 offen
 s_mov_b32 s34, 3354624
 buffer_load_dwordx4 v[68:71], v5, s[12:15], s34 offen
 s_mov_b32 s34, 3612672
 buffer_load_dwordx4 v[72:75], v5, s[12:15], s34 offen
 s_mov_b32 s34, 3870720
 buffer_load_dwordx4 v[76:79], v5, s[12:15], s34 offen
 s_mov_b32 s34, 4128768
 buffer_load_dwordx4 v[80:83], v5, s[12:15], s34 offen
 s_mov_b32 s34, 4386816
 buffer_load_dwordx4 v[84:87], v5, s[12:15], s34 offen
 s_mov_b32 s34, 4644864
 buffer_load_dwordx4 v[88:91], v5, s[12:15], s34 offen
 s_mov_b32 s34, 4902912
 buffer_load_dwordx4 v[92:95], v5, s[12:15], s34 offen
 s_mov_b32 s34, 5160960
 buffer_load_dwordx4 v[96:99], v5, s[12:15], s34 offen
 v_mov_b32 v8, 0
 v_mov_b32 v9, 0
 v_mov_b32 v10, 0
 v_mov_b32 v11, 0
 v_mov_b32 v12, 0
 v_mov_b32 v13, 0
 v_mov_b32 v14, 0
 v_mov_b32 v15, 0
 s_mov_b32 s20, s68
 s_mov_b32 s21, s69
 s_mov_b32 s22, 663552
 s_mov_b32 s23, 0x20000
 s_lshl_b32 s35, s33, 3
 s_add_u32 s35, s35, s3
 s_mul_i32 s35, s35, 3072
 buffer_load_dwordx4 v[120:123], v1, s[20:23], s35 offen offset:0
 buffer_load_dwordx4 v[120:123], v1, s[20:23], s35 offen offset:1024
 buffer_load_dwordx4 v[120:123], v1, s[20:23], s35 offen offset:2048
 s_mov_b32 s20, s74
 s_mov_b32 s21, s75
 s_mov_b32 s22, 8388608
 s_mov_b32 s23, 0x20000
 s_lshl_b32 s35, s33, 3
 s_add_u32 s35, s35, s3
 s_mul_i32 s35, s35, 0
 s_waitcnt vmcnt(23)
 v_lshlrev_b32 v110, 16, v16
 v_and_b32 v111, 0xffff0000, v16
 v_lshlrev_b32 v112, 16, v17
 v_and_b32 v113, 0xffff0000, v17
 v_lshlrev_b32 v114, 16, v18
 v_and_b32 v115, 0xffff0000, v18
 v_lshlrev_b32 v116, 16, v19
 v_and_b32 v117, 0xffff0000, v19
 v_pk_add_f32 v[8:9], v[8:9], v[110:111]
 v_pk_add_f32 v[10:11], v[10:11], v[112:113]
 v_pk_add_f32 v[12:13], v[12:13], v[114:115]
 v_pk_add_f32 v[14:15], v[14:15], v[116:117]
 s_waitcnt vmcnt(22)
 v_lshlrev_b32 v110, 16, v20
 v_and_b32 v111, 0xffff0000, v20
 v_lshlrev_b32 v112, 16, v21
 v_and_b32 v113, 0xffff0000, v21
 v_lshlrev_b32 v114, 16, v22
 v_and_b32 v115, 0xffff0000, v22
 v_lshlrev_b32 v116, 16, v23
 v_and_b32 v117, 0xffff0000, v23
 v_pk_add_f32 v[8:9], v[8:9], v[110:111]
 v_pk_add_f32 v[10:11], v[10:11], v[112:113]
 v_pk_add_f32 v[12:13], v[12:13], v[114:115]
 v_pk_add_f32 v[14:15], v[14:15], v[116:117]
 s_waitcnt vmcnt(21)
 v_lshlrev_b32 v110, 16, v24
 v_and_b32 v111, 0xffff0000, v24
 v_lshlrev_b32 v112, 16, v25
 v_and_b32 v113, 0xffff0000, v25
 v_lshlrev_b32 v114, 16, v26
 v_and_b32 v115, 0xffff0000, v26
 v_lshlrev_b32 v116, 16, v27
 v_and_b32 v117, 0xffff0000, v27
 v_pk_add_f32 v[8:9], v[8:9], v[110:111]
 v_pk_add_f32 v[10:11], v[10:11], v[112:113]
 v_pk_add_f32 v[12:13], v[12:13], v[114:115]
 v_pk_add_f32 v[14:15], v[14:15], v[116:117]
 s_waitcnt vmcnt(20)
 v_lshlrev_b32 v110, 16, v28
 v_and_b32 v111, 0xffff0000, v28
 v_lshlrev_b32 v112, 16, v29
 v_and_b32 v113, 0xffff0000, v29
 v_lshlrev_b32 v114, 16, v30
 v_and_b32 v115, 0xffff0000, v30
 v_lshlrev_b32 v116, 16, v31
 v_and_b32 v117, 0xffff0000, v31
 v_pk_add_f32 v[8:9], v[8:9], v[110:111]
 v_pk_add_f32 v[10:11], v[10:11], v[112:113]
 v_pk_add_f32 v[12:13], v[12:13], v[114:115]
 v_pk_add_f32 v[14:15], v[14:15], v[116:117]
 s_waitcnt vmcnt(19)
 v_lshlrev_b32 v110, 16, v32
 v_and_b32 v111, 0xffff0000, v32
 v_lshlrev_b32 v112, 16, v33
 v_and_b32 v113, 0xffff0000, v33
 v_lshlrev_b32 v114, 16, v34
 v_and_b32 v115, 0xffff0000, v34
 v_lshlrev_b32 v116, 16, v35
 v_and_b32 v117, 0xffff0000, v35
 v_pk_add_f32 v[8:9], v[8:9], v[110:111]
 v_pk_add_f32 v[10:11], v[10:11], v[112:113]
 v_pk_add_f32 v[12:13], v[12:13], v[114:115]
 v_pk_add_f32 v[14:15], v[14:15], v[116:117]
 s_waitcnt vmcnt(18)
 v_lshlrev_b32 v110, 16, v36
 v_and_b32 v111, 0xffff0000, v36
 v_lshlrev_b32 v112, 16, v37
 v_and_b32 v113, 0xffff0000, v37
 v_lshlrev_b32 v114, 16, v38
 v_and_b32 v115, 0xffff0000, v38
 v_lshlrev_b32 v116, 16, v39
 v_and_b32 v117, 0xffff0000, v39
 v_pk_add_f32 v[8:9], v[8:9], v[110:111]
 v_pk_add_f32 v[10:11], v[10:11], v[112:113]
 v_pk_add_f32 v[12:13], v[12:13], v[114:115]
 v_pk_add_f32 v[14:15], v[14:15], v[116:117]
 s_waitcnt vmcnt(17)
 v_lshlrev_b32 v110, 16, v40
 v_and_b32 v111, 0xffff0000, v40
 v_lshlrev_b32 v112, 16, v41
 v_and_b32 v113, 0xffff0000, v41
 v_lshlrev_b32 v114, 16, v42
 v_and_b32 v115, 0xffff0000, v42
 v_lshlrev_b32 v116, 16, v43
 v_and_b32 v117, 0xffff0000, v43
 v_pk_add_f32 v[8:9], v[8:9], v[110:111]
 v_pk_add_f32 v[10:11], v[10:11], v[112:113]
 v_pk_add_f32 v[12:13], v[12:13], v[114:115]
 v_pk_add_f32 v[14:15], v[14:15], v[116:117]
 s_waitcnt vmcnt(16)
 v_lshlrev_b32 v110, 16, v44
 v_and_b32 v111, 0xffff0000, v44
 v_lshlrev_b32 v112, 16, v45
 v_and_b32 v113, 0xffff0000, v45
 v_lshlrev_b32 v114, 16, v46
 v_and_b32 v115, 0xffff0000, v46
 v_lshlrev_b32 v116, 16, v47
 v_and_b32 v117, 0xffff0000, v47
 v_pk_add_f32 v[8:9], v[8:9], v[110:111]
 v_pk_add_f32 v[10:11], v[10:11], v[112:113]
 v_pk_add_f32 v[12:13], v[12:13], v[114:115]
 v_pk_add_f32 v[14:15], v[14:15], v[116:117]
 s_waitcnt vmcnt(15)
 v_lshlrev_b32 v110, 16, v48
 v_and_b32 v111, 0xffff0000, v48
 v_lshlrev_b32 v112, 16, v49
 v_and_b32 v113, 0xffff0000, v49
 v_lshlrev_b32 v114, 16, v50
 v_and_b32 v115, 0xffff0000, v50
 v_lshlrev_b32 v116, 16, v51
 v_and_b32 v117, 0xffff0000, v51
 v_pk_add_f32 v[8:9], v[8:9], v[110:111]
 v_pk_add_f32 v[10:11], v[10:11], v[112:113]
 v_pk_add_f32 v[12:13], v[12:13], v[114:115]
 v_pk_add_f32 v[14:15], v[14:15], v[116:117]
 s_waitcnt vmcnt(14)
 v_lshlrev_b32 v110, 16, v52
 v_and_b32 v111, 0xffff0000, v52
 v_lshlrev_b32 v112, 16, v53
 v_and_b32 v113, 0xffff0000, v53
 v_lshlrev_b32 v114, 16, v54
 v_and_b32 v115, 0xffff0000, v54
 v_lshlrev_b32 v116, 16, v55
 v_and_b32 v117, 0xffff0000, v55
 v_pk_add_f32 v[8:9], v[8:9], v[110:111]
 v_pk_add_f32 v[10:11], v[10:11], v[112:113]
 v_pk_add_f32 v[12:13], v[12:13], v[114:115]
 v_pk_add_f32 v[14:15], v[14:15], v[116:117]
 s_waitcnt vmcnt(13)
 v_lshlrev_b32 v110, 16, v56
 v_and_b32 v111, 0xffff0000, v56
 v_lshlrev_b32 v112, 16, v57
 v_and_b32 v113, 0xffff0000, v57
 v_lshlrev_b32 v114, 16, v58
 v_and_b32 v115, 0xffff0000, v58
 v_lshlrev_b32 v116, 16, v59
 v_and_b32 v117, 0xffff0000, v59
 v_pk_add_f32 v[8:9], v[8:9], v[110:111]
 v_pk_add_f32 v[10:11], v[10:11], v[112:113]
 v_pk_add_f32 v[12:13], v[12:13], v[114:115]
 v_pk_add_f32 v[14:15], v[14:15], v[116:117]
 s_waitcnt vmcnt(12)
 v_lshlrev_b32 v110, 16, v60
 v_and_b32 v111, 0xffff0000, v60
 v_lshlrev_b32 v112, 16, v61
 v_and_b32 v113, 0xffff0000, v61
 v_lshlrev_b32 v114, 16, v62
 v_and_b32 v115, 0xffff0000, v62
 v_lshlrev_b32 v116, 16, v63
 v_and_b32 v117, 0xffff0000, v63
 v_pk_add_f32 v[8:9], v[8:9], v[110:111]
 v_pk_add_f32 v[10:11], v[10:11], v[112:113]
 v_pk_add_f32 v[12:13], v[12:13], v[114:115]
 v_pk_add_f32 v[14:15], v[14:15], v[116:117]
 s_waitcnt vmcnt(11)
 v_lshlrev_b32 v110, 16, v64
 v_and_b32 v111, 0xffff0000, v64
 v_lshlrev_b32 v112, 16, v65
 v_and_b32 v113, 0xffff0000, v65
 v_lshlrev_b32 v114, 16, v66
 v_and_b32 v115, 0xffff0000, v66
 v_lshlrev_b32 v116, 16, v67
 v_and_b32 v117, 0xffff0000, v67
 v_pk_add_f32 v[8:9], v[8:9], v[110:111]
 v_pk_add_f32 v[10:11], v[10:11], v[112:113]
 v_pk_add_f32 v[12:13], v[12:13], v[114:115]
 v_pk_add_f32 v[14:15], v[14:15], v[116:117]
 s_waitcnt vmcnt(10)
 v_lshlrev_b32 v110, 16, v68
 v_and_b32 v111, 0xffff0000, v68
 v_lshlrev_b32 v112, 16, v69
 v_and_b32 v113, 0xffff0000, v69
 v_lshlrev_b32 v114, 16, v70
 v_and_b32 v115, 0xffff0000, v70
 v_lshlrev_b32 v116, 16, v71
 v_and_b32 v117, 0xffff0000, v71
 v_pk_add_f32 v[8:9], v[8:9], v[110:111]
 v_pk_add_f32 v[10:11], v[10:11], v[112:113]
 v_pk_add_f32 v[12:13], v[12:13], v[114:115]
 v_pk_add_f32 v[14:15], v[14:15], v[116:117]
 s_waitcnt vmcnt(9)
 v_lshlrev_b32 v110, 16, v72
 v_and_b32 v111, 0xffff0000, v72
 v_lshlrev_b32 v112, 16, v73
 v_and_b32 v113, 0xffff0000, v73
 v_lshlrev_b32 v114, 16, v74
 v_and_b32 v115, 0xffff0000, v74
 v_lshlrev_b32 v116, 16, v75
 v_and_b32 v117, 0xffff0000, v75
 v_pk_add_f32 v[8:9], v[8:9], v[110:111]
 v_pk_add_f32 v[10:11], v[10:11], v[112:113]
 v_pk_add_f32 v[12:13], v[12:13], v[114:115]
 v_pk_add_f32 v[14:15], v[14:15], v[116:117]
 s_waitcnt vmcnt(8)
 v_lshlrev_b32 v110, 16, v76
 v_and_b32 v111, 0xffff0000, v76
 v_lshlrev_b32 v112, 16, v77
 v_and_b32 v113, 0xffff0000, v77
 v_lshlrev_b32 v114, 16, v78
 v_and_b32 v115, 0xffff0000, v78
 v_lshlrev_b32 v116, 16, v79
 v_and_b32 v117, 0xffff0000, v79
 v_pk_add_f32 v[8:9], v[8:9], v[110:111]
 v_pk_add_f32 v[10:11], v[10:11], v[112:113]
 v_pk_add_f32 v[12:13], v[12:13], v[114:115]
 v_pk_add_f32 v[14:15], v[14:15], v[116:117]
 s_waitcnt vmcnt(7)
 v_lshlrev_b32 v110, 16, v80
 v_and_b32 v111, 0xffff0000, v80
 v_lshlrev_b32 v112, 16, v81
 v_and_b32 v113, 0xffff0000, v81
 v_lshlrev_b32 v114, 16, v82
 v_and_b32 v115, 0xffff0000, v82
 v_lshlrev_b32 v116, 16, v83
 v_and_b32 v117, 0xffff0000, v83
 v_pk_add_f32 v[8:9], v[8:9], v[110:111]
 v_pk_add_f32 v[10:11], v[10:11], v[112:113]
 v_pk_add_f32 v[12:13], v[12:13], v[114:115]
 v_pk_add_f32 v[14:15], v[14:15], v[116:117]
 s_waitcnt vmcnt(6)
 v_lshlrev_b32 v110, 16, v84
 v_and_b32 v111, 0xffff0000, v84
 v_lshlrev_b32 v112, 16, v85
 v_and_b32 v113, 0xffff0000, v85
 v_lshlrev_b32 v114, 16, v86
 v_and_b32 v115, 0xffff0000, v86
 v_lshlrev_b32 v116, 16, v87
 v_and_b32 v117, 0xffff0000, v87
 v_pk_add_f32 v[8:9], v[8:9], v[110:111]
 v_pk_add_f32 v[10:11], v[10:11], v[112:113]
 v_pk_add_f32 v[12:13], v[12:13], v[114:115]
 v_pk_add_f32 v[14:15], v[14:15], v[116:117]
 s_waitcnt vmcnt(5)
 v_lshlrev_b32 v110, 16, v88
 v_and_b32 v111, 0xffff0000, v88
 v_lshlrev_b32 v112, 16, v89
 v_and_b32 v113, 0xffff0000, v89
 v_lshlrev_b32 v114, 16, v90
 v_and_b32 v115, 0xffff0000, v90
 v_lshlrev_b32 v116, 16, v91
 v_and_b32 v117, 0xffff0000, v91
 v_pk_add_f32 v[8:9], v[8:9], v[110:111]
 v_pk_add_f32 v[10:11], v[10:11], v[112:113]
 v_pk_add_f32 v[12:13], v[12:13], v[114:115]
 v_pk_add_f32 v[14:15], v[14:15], v[116:117]
 s_waitcnt vmcnt(4)
 v_lshlrev_b32 v110, 16, v92
 v_and_b32 v111, 0xffff0000, v92
 v_lshlrev_b32 v112, 16, v93
 v_and_b32 v113, 0xffff0000, v93
 v_lshlrev_b32 v114, 16, v94
 v_and_b32 v115, 0xffff0000, v94
 v_lshlrev_b32 v116, 16, v95
 v_and_b32 v117, 0xffff0000, v95
 v_pk_add_f32 v[8:9], v[8:9], v[110:111]
 v_pk_add_f32 v[10:11], v[10:11], v[112:113]
 v_pk_add_f32 v[12:13], v[12:13], v[114:115]
 v_pk_add_f32 v[14:15], v[14:15], v[116:117]
 s_waitcnt vmcnt(3)
 v_lshlrev_b32 v110, 16, v96
 v_and_b32 v111, 0xffff0000, v96
 v_lshlrev_b32 v112, 16, v97
 v_and_b32 v113, 0xffff0000, v97
 v_lshlrev_b32 v114, 16, v98
 v_and_b32 v115, 0xffff0000, v98
 v_lshlrev_b32 v116, 16, v99
 v_and_b32 v117, 0xffff0000, v99
 v_pk_add_f32 v[8:9], v[8:9], v[110:111]
 v_pk_add_f32 v[10:11], v[10:11], v[112:113]
 v_pk_add_f32 v[12:13], v[12:13], v[114:115]
 v_pk_add_f32 v[14:15], v[14:15], v[116:117]
 v_lshlrev_b32 v6, 5, v4
 v_add_u32 v6, 139264, v6
 ds_write_b128 v6, v[8:11]
 ds_write_b128 v6, v[12:15] offset:16
 v_lshlrev_b32 v6, 2, v4
 v_add_u32 v7, 139264, v6
 s_waitcnt lgkmcnt(0)
 s_barrier
 ds_read_b32 v16, v7 offset:0
 ds_read_b32 v17, v7 offset:576
 ds_read_b32 v18, v7 offset:1152
 ds_read_b32 v19, v7 offset:1728
 ds_read_b32 v20, v7 offset:2304
 ds_read_b32 v21, v7 offset:2880
 ds_read_b32 v22, v7 offset:3456
 ds_read_b32 v23, v7 offset:4032
 ds_read_b32 v24, v7 offset:4608
 ds_read_b32 v25, v7 offset:5184
 ds_read_b32 v26, v7 offset:5760
 ds_read_b32 v27, v7 offset:6336
 ds_read_b32 v28, v7 offset:6912
 ds_read_b32 v29, v7 offset:7488
 s_waitcnt lgkmcnt(0)
 ds_read_b32 v30, v7 offset:8064
 ds_read_b32 v31, v7 offset:8640
 ds_read_b32 v32, v7 offset:9216
 ds_read_b32 v33, v7 offset:9792
 ds_read_b32 v34, v7 offset:10368
 ds_read_b32 v35, v7 offset:10944
 ds_read_b32 v36, v7 offset:11520
 ds_read_b32 v37, v7 offset:12096
 ds_read_b32 v38, v7 offset:12672
 ds_read_b32 v39, v7 offset:13248
 ds_read_b32 v40, v7 offset:13824
 ds_read_b32 v41, v7 offset:14400
 ds_read_b32 v42, v7 offset:14976
 ds_read_b32 v43, v7 offset:15552
 s_waitcnt lgkmcnt(0)
 v_add_f32 v16, v16, v30
 v_add_f32 v17, v17, v31
 v_add_f32 v18, v18, v32
 v_add_f32 v19, v19, v33
 v_add_f32 v20, v20, v34
 v_add_f32 v21, v21, v35
 v_add_f32 v22, v22, v36
 v_add_f32 v23, v23, v37
 v_add_f32 v24, v24, v38
 v_add_f32 v25, v25, v39
 v_add_f32 v26, v26, v40
 v_add_f32 v27, v27, v41
 v_add_f32 v28, v28, v42
 v_add_f32 v29, v29, v43
 v_add_f32 v16, v16, v17
 v_add_f32 v16, v16, v18
 v_add_f32 v16, v16, v19
 v_add_f32 v16, v16, v20
 v_add_f32 v16, v16, v21
 v_add_f32 v16, v16, v22
 v_add_f32 v16, v16, v23
 v_add_f32 v16, v16, v24
 v_add_f32 v16, v16, v25
 v_add_f32 v16, v16, v26
 v_add_f32 v16, v16, v27
 v_add_f32 v16, v16, v28
 v_add_f32 v16, v16, v29
 v_cmp_gt_u32 vcc, 144, v4
 v_mov_b32 v7, 0x7fffffff
 s_mul_i32 s34, s33, 576
 v_cndmask_b32 v6, v7, v6, vcc
 buffer_store_dword v16, v6, s[16:19], s34 offen sc1
 s_mov_b32 s55, s2
L_fz_p1pub:
    s_add_u32 s100, s101, 2654435769
 s_and_b32 s35, s2, 7
 s_lshr_b32 s36, s2, 3
 s_mul_i32 s35, s35, 30
 s_add_u32 s35, s35, s36
 s_cmp_ge_u32 s36, 30
 s_cselect_b32 s35, 255, s35
 s_mul_i32 s62, s35, 7282
 s_lshr_b32 s62, s62, 16
 s_mul_i32 s36, s62, 9
 s_sub_u32 s63, s35, s36
 s_and_b32 s32, s3, 3
 v_bfe_u32 v3, v0, 1, 2
 v_bfe_u32 v4, v0, 4, 2
 v_xor_b32 v3, v3, v4
 v_and_b32 v4, 1, v0
 v_lshlrev_b32 v4, 4, v4
 v_lshl_add_u32 v3, v3, 5, v4
 s_lshl_b32 s36, s63, 7
 v_add_u32 v3, s36, v3
 v_lshrrev_b32 v4, 5, v0
 v_bfe_u32 v5, v0, 3, 2
 v_lshl_add_u32 v6, v4, 2, v5
 s_mul_i32 s36, s32, 36
 v_add_u32 v6, s36, v6
 v_mul_u32_u24 v6, 1152, v6
 v_add_u32 v246, v6, v3
 v_mul_u32_u24 v6, 72, v4
 v_lshrrev_b32 v7, 1, v5
 v_mul_u32_u24 v7, 18, v7
 v_add_u32 v6, v6, v7
 v_and_b32 v7, 1, v5
 v_add_u32 v6, v6, v7
 s_mul_i32 s36, s32, 288
 s_add_u32 s36, s36, 16
 v_add_u32 v6, s36, v6
 v_mul_u32_u24 v6, 1152, v6
 v_add_u32 v247, v6, v3
 s_mul_i32 s54, s32, 21760
 s_lshr_b32 s36, s3, 2
 s_mul_i32 s52, s36, 331776
 s_mul_i32 s37, s36, 41472
 v_add_u32 v247, s37, v247
 s_lshl_b32 s37, s36, 11
 s_add_u32 s53, s54, s37
 s_add_u32 s53, s53, 16384
 s_lshl_b32 s37, s36, 13
 s_add_u32 s54, s54, s37
 s_and_b32 s35, s2, 7
 s_lshr_b32 s36, s2, 3
 s_and_b32 s34, s36, 7
 s_lshr_b32 s33, s36, 3
 s_lshl_b32 s35, s35, 2
 s_add_u32 s33, s33, s35
 s_lshl_b32 s36, s3, 6
 v_add_u32 v2, s36, v0
 v_mul_u32_u24 v3, 3277, v2
 v_lshrrev_b32 v3, 16, v3
 v_mul_u32_u24 v4, 20, v3
 v_sub_u32 v4, v2, v4
 v_min_u32 v4, 17, v4
 v_mul_u32_u24 v3, 27648, v3
 v_lshl_add_u32 v2, v4, 4, v3
 s_mul_i32 s36, s33, 288
 s_mul_i32 s37, s34, 884736
 s_add_u32 s39, s36, s37
 s_max_u32 s37, s34, 1
 s_mul_i32 s37, s37, 884736
 s_add_u32 s37, s37, s36
 s_sub_u32 s37, s37, 875520
 s_lshl_b32 s40, s3, 10
 s_cmp_eq_u32 s34, 0
 s_cselect_b32 s41, 884736, 0
 s_mov_b32 s12, s8
 s_mov_b32 s13, s9
 s_mov_b32 s14, 7077888
 s_mov_b32 s15, 0x20000
 s_mul_i32 s43, s3, 1280
 s_add_u32 s43, s43, 87040
 v_bfe_u32 v3, v0, 4, 1
 v_mul_u32_u24 v3, 640, v3
 v_and_b32 v4, 1, v0
 v_mul_u32_u24 v4, 320, v4
 v_add_u32 v3, v3, v4
 v_bfe_u32 v4, v0, 1, 1
 v_lshl_add_u32 v3, v4, 3, v3
 v_add_u32 v3, s43, v3
 v_lshrrev_b32 v5, 5, v0
 v_bfe_u32 v4, v0, 2, 2
 v_lshl_add_u32 v6, v5, 3, v4
 v_lshl_add_u32 v8, v6, 4, v3
 v_and_b32 v4, 1, v4
 v_lshl_add_u32 v9, v4, 4, v3
 v_add_u32 v9, 256, v9
 v_and_b32 v6, 31, v0
 v_mul_u32_u24 v4, 320, v5
 v_lshl_add_u32 v10, v6, 4, v4
 s_add_u32 s44, s43, 20480
 v_add_u32 v10, s44, v10
 v_min_u32 v11, 35, v0
 v_mul_u32_u24 v11, 320, v11
 s_add_u32 s44, s44, 288
 v_add_u32 v11, s44, v11
 v_lshlrev_b32 v4, 2, v5
 v_sub_u32 v7, v6, v4
 s_sub_u32 s45, 8, s3
 s_cmp_eq_u32 s34, 0
 s_cselect_b32 s45, s45, 0
 v_mov_b32 v12, 0xf149f2ca
 v_cmp_gt_i32 s[16:17], 0, v7
 v_cmp_gt_i32 s[18:19], 1, v7
 v_cmp_gt_i32 s[20:21], 2, v7
 v_cmp_gt_i32 s[22:23], 3, v7
 v_cmp_gt_i32 s[24:25], 8, v7
 v_cmp_gt_i32 s[26:27], 9, v7
 v_cmp_gt_i32 s[28:29], 10, v7
 v_cmp_gt_i32 s[30:31], 11, v7
 v_cndmask_b32 v96, v12, 0, s[16:17]
 v_cndmask_b32 v224, 0, v12, s[16:17]
 v_cndmask_b32 v97, v12, 0, s[18:19]
 v_cndmask_b32 v225, 0, v12, s[18:19]
 v_cndmask_b32 v98, v12, 0, s[20:21]
 v_cndmask_b32 v226, 0, v12, s[20:21]
 v_cndmask_b32 v99, v12, 0, s[22:23]
 v_cndmask_b32 v227, 0, v12, s[22:23]
 v_cndmask_b32 v100, v12, 0, s[24:25]
 v_cndmask_b32 v228, 0, v12, s[24:25]
 v_cndmask_b32 v101, v12, 0, s[26:27]
 v_cndmask_b32 v229, 0, v12, s[26:27]
 v_cndmask_b32 v102, v12, 0, s[28:29]
 v_cndmask_b32 v230, 0, v12, s[28:29]
 v_cndmask_b32 v103, v12, 0, s[30:31]
 v_cndmask_b32 v231, 0, v12, s[30:31]
 v_cmp_gt_i32 s[16:17], 16, v7
 v_cmp_gt_i32 s[18:19], 17, v7
 v_cmp_gt_i32 s[20:21], 18, v7
 v_cmp_gt_i32 s[22:23], 19, v7
 v_cmp_gt_i32 s[24:25], 24, v7
 v_cmp_gt_i32 s[26:27], 25, v7
 v_cmp_gt_i32 s[28:29], 26, v7
 v_cmp_gt_i32 s[30:31], 27, v7
 v_cndmask_b32 v104, v12, 0, s[16:17]
 v_cndmask_b32 v232, 0, v12, s[16:17]
 v_cndmask_b32 v105, v12, 0, s[18:19]
 v_cndmask_b32 v233, 0, v12, s[18:19]
 v_cndmask_b32 v106, v12, 0, s[20:21]
 v_cndmask_b32 v234, 0, v12, s[20:21]
 v_cndmask_b32 v107, v12, 0, s[22:23]
 v_cndmask_b32 v235, 0, v12, s[22:23]
 v_cndmask_b32 v108, v12, 0, s[24:25]
 v_cndmask_b32 v236, 0, v12, s[24:25]
 v_cndmask_b32 v109, v12, 0, s[26:27]
 v_cndmask_b32 v237, 0, v12, s[26:27]
 v_cndmask_b32 v110, v12, 0, s[28:29]
 v_cndmask_b32 v238, 0, v12, s[28:29]
 v_cndmask_b32 v111, v12, 0, s[30:31]
 v_cndmask_b32 v239, 0, v12, s[30:31]
 v_mov_b32 v88, 0xff7fffff
 v_mov_b32 v89, 0xff7fffff
 v_mov_b32 v90, 0xff7fffff
 v_mov_b32 v91, 0xff7fffff
 v_mov_b32 v22, 0
 v_mov_b32 v23, 0
 v_mov_b32 v30, 0
 v_mov_b32 v31, 0
 v_mov_b32 v38, 0
 v_mov_b32 v39, 0
 v_mov_b32 v80, 0x3f803f80
 v_mov_b32 v81, 0
 v_mov_b32 v85, 0
 v_mov_b32 v93, 0
 v_mov_b32 v82, 0
 v_mov_b32 v86, 0
 v_mov_b32 v94, 0
 v_mov_b32 v83, 0
 v_mov_b32 v87, 0
 v_mov_b32 v95, 0
 v_mov_b32 v46, 0
 v_mov_b32 v47, 0
 v_mov_b32 v48, 0x3f803f80
 v_mov_b32 v49, 0x3f803f80
 v_mov_b32 v50, 0x3f803f80
 v_mov_b32 v51, 0x3f803f80
 s_lshl_b32 s44, s34, 4
 s_lshl_b32 s47, s3, 1
 s_add_u32 s44, s44, s47
 s_mul_i32 s44, s44, 18432
 v_lshrrev_b32 v3, 4, v6
 v_mul_u32_u24 v3, 18432, v3
 v_and_b32 v4, 15, v0
 v_lshl_add_u32 v3, v4, 4, v3
 v_add_u32 v3, s44, v3
 s_lshr_b32 s44, s33, 1
 s_lshl_b32 s44, s44, 10
 s_and_b32 s47, s33, 1
 s_lshl_b32 s47, s47, 9
 s_add_u32 s44, s44, s47
 v_lshl_add_u32 v14, v5, 8, v3
 v_add_u32 v14, s44, v14
 s_lshr_b32 s44, s33, 4
 s_add_u32 s44, s44, 16
 s_lshl_b32 s44, s44, 10
 s_bfe_u32 s47, s33, 0x20002
 s_lshl_b32 s47, s47, 8
 s_add_u32 s44, s44, s47
 s_and_b32 s47, s33, 3
 s_lshl_b32 s47, s47, 2
 s_add_u32 s44, s44, s47
 v_add_u32 v15, s44, v3
 s_add_u32 s16, s8, 8388608
 s_addc_u32 s17, s9, 0
 s_mov_b32 s18, 2359296
 s_mov_b32 s19, 0x20000
 s_mov_b32 s20, s74
 s_mov_b32 s21, s75
 s_mov_b32 s22, 8388608
 s_mov_b32 s23, 0x20000
 s_mov_b32 s24, s8
 s_mov_b32 s25, s9
 s_mov_b32 s26, 0
 s_mov_b32 s27, 0x20000
 s_mov_b32 s28, s8
 s_mov_b32 s29, s9
 s_mov_b32 s30, 0
 s_mov_b32 s31, 0x20000
 s_waitcnt vmcnt(0)
 s_barrier
 s_cmp_lg_u32 s3, 7
 s_cbranch_scc1 L_fz_pub1
 s_add_u32 s56, s8, 16285696
 s_addc_u32 s57, s9, 0
 s_mov_b32 s58, 32768
 s_mov_b32 s59, 0x20000
 s_lshl_b32 s60, s55, 7
 v_mov_b32 v254, 0
 v_mov_b32 v255, s100
 s_mov_b64 exec, 1
 buffer_store_dword v255, v254, s[56:59], s60 offen sc1
 s_mov_b64 exec, -1
L_fz_pub1:
 s_cmp_lg_u32 s3, 0
 s_cbranch_scc1 L_fz_p2w
 s_lshl_b32 s46, s34, 1
 s_max_u32 s47, s46, 2
 s_sub_u32 s47, s47, 2
 s_add_u32 s46, s46, 2
 s_sub_u32 s46, s46, s47
 s_mul_i32 s46, s46, 14
 s_mul_i32 s47, s47, 14
 s_add_u32 s56, s8, 16285696
 s_addc_u32 s57, s9, 0
 s_mov_b32 s58, 32768
 s_mov_b32 s59, 0x20000
 s_sub_u32 s60, s46, 1
 v_min_u32 v240, s60, v0
 v_add_lshl_u32 v240, v240, s47, 7
 s_mov_b32 s61, 40000
L_fz_wf1:
 buffer_load_dword v241, v240, s[56:59], 0 offen sc1
 s_waitcnt vmcnt(0)
 v_cmp_ne_u32 vcc, s100, v241
 s_sub_u32 s61, s61, 1
 s_cbranch_vccz L_fz_wd1
 s_cmp_lg_u32 s61, 0
 s_cbranch_scc1 L_fz_wf1
L_fz_wd1:
L_fz_p2w:
 s_barrier
 s_cmp_ge_u32 s3, 5
 s_cbranch_scc1 L_fz_p2nl
 s_sub_u32 s38, s37, s41
 s_add_u32 m0, s40, 128000
 s_add_u32 s42, s39, 0
 buffer_load_dwordx4 v2, s[12:15], s42 offen sc1 lds
 s_add_u32 m0, s40, 133120
 s_add_u32 s42, s39, 442368
 buffer_load_dwordx4 v2, s[12:15], s42 offen sc1 lds
 s_add_u32 m0, s40, 97280
 s_add_u32 s42, s38, 884736
 buffer_load_dwordx4 v2, s[12:15], s42 offen sc1 lds
 s_add_u32 m0, s40, 102400
 s_add_u32 s42, s38, 1327104
 buffer_load_dwordx4 v2, s[12:15], s42 offen sc1 lds
 s_add_u32 m0, s40, 87040
 s_add_u32 s42, s37, 0
 buffer_load_dwordx4 v2, s[12:15], s42 offen sc1 lds
 s_add_u32 m0, s40, 92160
 s_add_u32 s42, s37, 442368
 buffer_load_dwordx4 v2, s[12:15], s42 offen sc1 lds
 s_add_u32 m0, s40, 107520
 s_add_u32 s42, s37, 9216
 buffer_load_dwordx4 v2, s[12:15], s42 offen sc1 lds
 s_add_u32 m0, s40, 112640
 s_add_u32 s42, s37, 451584
 buffer_load_dwordx4 v2, s[12:15], s42 offen sc1 lds
 s_add_u32 m0, s40, 117760
 s_add_u32 s42, s38, 893952
 buffer_load_dwordx4 v2, s[12:15], s42 offen sc1 lds
 s_add_u32 m0, s40, 122880
 s_add_u32 s42, s38, 1336320
 buffer_load_dwordx4 v2, s[12:15], s42 offen sc1 lds
L_fz_p2nl:
 v_cmp_gt_u32 vcc, 32, v0
 v_mov_b32 v13, 0xf149
 v_lshlrev_b32 v1, 4, v0
 s_lshl_b32 s36, s2, 3
 s_add_u32 s36, s36, s3
 s_lshl_b32 s36, s36, 12
 v_cndmask_b32 v13, 0, v13, vcc
 s_waitcnt vmcnt(0)
 s_barrier
 ds_read_b64_tr_b16 v[40:41], v8 offset:40960
 ds_read_b64_tr_b16 v[42:43], v8 offset:41024
 ds_read_b64_tr_b16 v[44:45], v9 offset:40960
 ds_read_b64_tr_b16 v[16:17], v8 offset:0
 ds_read_b64_tr_b16 v[18:19], v8 offset:64
 ds_read_b64_tr_b16 v[20:21], v9 offset:0
 ds_read_b64_tr_b16 v[24:25], v8 offset:1280
 ds_read_b64_tr_b16 v[26:27], v8 offset:1344
 ds_read_b64_tr_b16 v[28:29], v9 offset:1280
 ds_write_b128 v11, v[48:51]
 v_lshrrev_b32 v244, 3, v0
 v_and_b32 v245, 7, v0
 v_lshlrev_b32 v244, 12, v244
 v_lshl_add_u32 v244, v245, 7, v244
 s_lshl_b32 s36, s2, 15
 s_lshl_b32 s37, s3, 10
 s_add_u32 s36, s36, s37
 s_cmp_lt_u32 s3, 2
 s_cselect_b32 s36, s36, 8388608
 buffer_load_dword v245, v244, s[20:23], s36 offen
 s_waitcnt lgkmcnt(7)
 v_cndmask_b32 v44, 0, v44, vcc
 v_mov_b32 v45, 0
 s_waitcnt lgkmcnt(4)
 v_mfma_f32_32x32x16_bf16 v[96:111], v[16:19], v[40:43], v[96:111]
 v_mfma_f32_32x32x16_bf16 v[96:111], v[20:23], v[44:47], v[96:111]
 ds_read_b64_tr_b16 v[32:33], v8 offset:2560
 ds_read_b64_tr_b16 v[34:35], v8 offset:2624
 ds_read_b64_tr_b16 v[36:37], v9 offset:2560
 s_waitcnt lgkmcnt(4)
 v_mfma_f32_32x32x16_bf16 v[112:127], v[24:27], v[40:43], 0
 v_mfma_f32_32x32x16_bf16 v[112:127], v[28:31], v[44:47], v[112:127]
 ds_read_b64_tr_b16 v[16:17], v8 offset:3840
 ds_read_b64_tr_b16 v[18:19], v8 offset:3904
 ds_read_b64_tr_b16 v[20:21], v9 offset:3840
 s_waitcnt lgkmcnt(3)
 v_mfma_f32_32x32x16_bf16 v[128:143], v[32:35], v[40:43], 0
 v_mfma_f32_32x32x16_bf16 v[128:143], v[36:39], v[44:47], v[128:143]
 ds_read_b64_tr_b16 v[24:25], v8 offset:5120
 ds_read_b64_tr_b16 v[26:27], v8 offset:5184
 ds_read_b64_tr_b16 v[28:29], v9 offset:5120
 s_cmp_lt_u32 0, s45
 s_cbranch_scc1 L_fz_p2sk0
 v_max3_f32 v88, v96, v97, v88
 v_max3_f32 v89, v98, v99, v89
 v_max3_f32 v90, v100, v101, v90
 v_max3_f32 v91, v102, v103, v91
 v_max3_f32 v88, v104, v105, v88
 v_max3_f32 v89, v106, v107, v89
 v_max3_f32 v90, v108, v109, v90
 v_max3_f32 v91, v110, v111, v91
L_fz_p2sk0:
 s_waitcnt lgkmcnt(3)
 v_mfma_f32_32x32x16_bf16 v[144:159], v[16:19], v[40:43], 0
 v_mfma_f32_32x32x16_bf16 v[144:159], v[20:23], v[44:47], v[144:159]
 ds_read_b64_tr_b16 v[32:33], v8 offset:6400
 ds_read_b64_tr_b16 v[34:35], v8 offset:6464
 ds_read_b64_tr_b16 v[36:37], v9 offset:6400
 s_cmp_lt_u32 1, s45
 s_cbranch_scc1 L_fz_p2sk1
 v_max3_f32 v88, v112, v113, v88
 v_max3_f32 v89, v114, v115, v89
 v_max3_f32 v90, v116, v117, v90
 v_max3_f32 v91, v118, v119, v91
 v_max3_f32 v88, v120, v121, v88
 v_max3_f32 v89, v122, v123, v89
 v_max3_f32 v90, v124, v125, v90
 v_max3_f32 v91, v126, v127, v91
L_fz_p2sk1:
 s_waitcnt lgkmcnt(3)
 v_mfma_f32_32x32x16_bf16 v[160:175], v[24:27], v[40:43], 0
 v_mfma_f32_32x32x16_bf16 v[160:175], v[28:31], v[44:47], v[160:175]
 ds_read_b64_tr_b16 v[16:17], v8 offset:7680
 ds_read_b64_tr_b16 v[18:19], v8 offset:7744
 ds_read_b64_tr_b16 v[20:21], v9 offset:7680
 s_cmp_lt_u32 2, s45
 s_cbranch_scc1 L_fz_p2sk2
 v_max3_f32 v88, v128, v129, v88
 v_max3_f32 v89, v130, v131, v89
 v_max3_f32 v90, v132, v133, v90
 v_max3_f32 v91, v134, v135, v91
 v_max3_f32 v88, v136, v137, v88
 v_max3_f32 v89, v138, v139, v89
 v_max3_f32 v90, v140, v141, v90
 v_max3_f32 v91, v142, v143, v91
L_fz_p2sk2:
 s_waitcnt lgkmcnt(3)
 v_mfma_f32_32x32x16_bf16 v[176:191], v[32:35], v[40:43], 0
 v_mfma_f32_32x32x16_bf16 v[176:191], v[36:39], v[44:47], v[176:191]
 ds_read_b64_tr_b16 v[24:25], v8 offset:8960
 ds_read_b64_tr_b16 v[26:27], v8 offset:9024
 ds_read_b64_tr_b16 v[28:29], v9 offset:8960
 s_cmp_lt_u32 3, s45
 s_cbranch_scc1 L_fz_p2sk3
 v_max3_f32 v88, v144, v145, v88
 v_max3_f32 v89, v146, v147, v89
 v_max3_f32 v90, v148, v149, v90
 v_max3_f32 v91, v150, v151, v91
 v_max3_f32 v88, v152, v153, v88
 v_max3_f32 v89, v154, v155, v89
 v_max3_f32 v90, v156, v157, v90
 v_max3_f32 v91, v158, v159, v91
L_fz_p2sk3:
 s_waitcnt lgkmcnt(3)
 v_mfma_f32_32x32x16_bf16 v[192:207], v[16:19], v[40:43], 0
 v_mfma_f32_32x32x16_bf16 v[192:207], v[20:23], v[44:47], v[192:207]
 ds_read_b64_tr_b16 v[32:33], v8 offset:10240
 ds_read_b64_tr_b16 v[34:35], v8 offset:10304
 ds_read_b64_tr_b16 v[36:37], v9 offset:10240
 s_cmp_lt_u32 4, s45
 s_cbranch_scc1 L_fz_p2sk4
 v_max3_f32 v88, v160, v161, v88
 v_max3_f32 v89, v162, v163, v89
 v_max3_f32 v90, v164, v165, v90
 v_max3_f32 v91, v166, v167, v91
 v_max3_f32 v88, v168, v169, v88
 v_max3_f32 v89, v170, v171, v89
 v_max3_f32 v90, v172, v173, v90
 v_max3_f32 v91, v174, v175, v91
L_fz_p2sk4:
 s_waitcnt lgkmcnt(3)
 v_mfma_f32_32x32x16_bf16 v[208:223], v[24:27], v[40:43], 0
 v_mfma_f32_32x32x16_bf16 v[208:223], v[28:31], v[44:47], v[208:223]
 s_cmp_lt_u32 5, s45
 s_cbranch_scc1 L_fz_p2sk5
 v_max3_f32 v88, v176, v177, v88
 v_max3_f32 v89, v178, v179, v89
 v_max3_f32 v90, v180, v181, v90
 v_max3_f32 v91, v182, v183, v91
 v_max3_f32 v88, v184, v185, v88
 v_max3_f32 v89, v186, v187, v89
 v_max3_f32 v90, v188, v189, v90
 v_max3_f32 v91, v190, v191, v91
L_fz_p2sk5:
 s_waitcnt lgkmcnt(0)
 v_mfma_f32_32x32x16_bf16 v[224:239], v[32:35], v[40:43], v[224:239]
 v_mfma_f32_32x32x16_bf16 v[224:239], v[36:39], v[44:47], v[224:239]
 s_cmp_lt_u32 6, s45
 s_cbranch_scc1 L_fz_p2sk6
 v_max3_f32 v88, v192, v193, v88
 v_max3_f32 v89, v194, v195, v89
 v_max3_f32 v90, v196, v197, v90
 v_max3_f32 v91, v198, v199, v91
 v_max3_f32 v88, v200, v201, v88
 v_max3_f32 v89, v202, v203, v89
 v_max3_f32 v90, v204, v205, v90
 v_max3_f32 v91, v206, v207, v91
L_fz_p2sk6:
 s_nop 2
 s_mov_b32 s12, s68
 s_mov_b32 s13, s69
 s_mov_b32 s14, 663552
 s_mov_b32 s15, 0x20000
 s_cmp_lt_u32 7, s45
 s_cbranch_scc1 L_fz_p2sk7
 v_max3_f32 v88, v208, v209, v88
 v_max3_f32 v89, v210, v211, v89
 v_max3_f32 v90, v212, v213, v90
 v_max3_f32 v91, v214, v215, v91
 v_max3_f32 v88, v216, v217, v88
 v_max3_f32 v89, v218, v219, v89
 v_max3_f32 v90, v220, v221, v90
 v_max3_f32 v91, v222, v223, v91
L_fz_p2sk7:
 ds_read_b128 v[64:67], v10 offset:0
 ds_read_b128 v[68:71], v10 offset:640
 ds_read_b128 v[72:75], v10 offset:1280
 ds_read_b128 v[76:79], v10 offset:1920
 s_nop 9
 v_max3_f32 v88, v224, v225, v88
 v_max3_f32 v89, v226, v227, v89
 v_max3_f32 v90, v228, v229, v90
 v_max3_f32 v91, v230, v231, v91
 v_max3_f32 v88, v232, v233, v88
 v_max3_f32 v89, v234, v235, v89
 v_max3_f32 v90, v236, v237, v90
 v_max3_f32 v91, v238, v239, v91
 v_max3_f32 v88, v88, v89, v90
 v_max_f32 v88, v88, v91
 v_mov_b32 v89, v88
 s_nop 1
 v_permlane32_swap_b32 v88, v89
 s_nop 1
 v_max_f32 v88, v88, v89
 v_cvt_pk_bf16_f32 v89, -v88, -v88
 v_lshlrev_b32 v89, 16, v89
 v_sub_f32 v89, -v88, v89
 v_cvt_pk_bf16_f32 v89, -v88, v89
 v_cndmask_b32 v88, 0, v89, vcc
 s_cmp_lt_u32 0, s45
 s_cselect_b64 s[46:47], -1, 0
 v_cndmask_b32 v84, v88, v13, s[46:47]
 s_cmp_lt_u32 1, s45
 s_cselect_b64 s[46:47], -1, 0
 v_cndmask_b32 v92, v88, v13, s[46:47]
 s_nop 0
 v_mfma_f32_32x32x16_bf16 v[96:111], v[80:83], v[84:87], v[96:111]
 v_mfma_f32_32x32x16_bf16 v[112:127], v[80:83], v[92:95], v[112:127]
 s_cmp_lt_u32 2, s45
 s_cselect_b64 s[46:47], -1, 0
 v_cndmask_b32 v84, v88, v13, s[46:47]
 s_nop 7
 v_mfma_f32_32x32x16_bf16 v[128:143], v[80:83], v[84:87], v[128:143]
 v_exp_f32 v96, v96
 v_exp_f32 v97, v97
 v_exp_f32 v98, v98
 v_exp_f32 v99, v99
 v_exp_f32 v100, v100
 s_add_u32 m0, s54, 0
 s_add_u32 s41, s52, 0
 buffer_load_dwordx4 v246, s[12:15], s41 offen lds
 v_exp_f32 v101, v101
 v_exp_f32 v102, v102
 v_exp_f32 v103, v103
 v_exp_f32 v104, v104
 v_exp_f32 v105, v105
 s_cmp_lt_u32 3, s45
 s_cselect_b64 s[46:47], -1, 0
 v_cndmask_b32 v92, v88, v13, s[46:47]
 v_exp_f32 v106, v106
 v_exp_f32 v107, v107
 v_exp_f32 v108, v108
 v_exp_f32 v109, v109
 v_exp_f32 v110, v110
 v_exp_f32 v111, v111
 v_cvt_pk_bf16_f32 v96, v96, v97
 v_cvt_pk_bf16_f32 v97, v98, v99
 v_cvt_pk_bf16_f32 v98, v100, v101
 v_cvt_pk_bf16_f32 v99, v102, v103
 v_cvt_pk_bf16_f32 v100, v104, v105
 v_cvt_pk_bf16_f32 v101, v106, v107
 v_cvt_pk_bf16_f32 v102, v108, v109
 v_cvt_pk_bf16_f32 v103, v110, v111
 v_mfma_f32_32x32x16_bf16 v[144:159], v[80:83], v[92:95], v[144:159]
 v_exp_f32 v112, v112
 v_exp_f32 v113, v113
 v_exp_f32 v114, v114
 v_exp_f32 v115, v115
 v_exp_f32 v116, v116
 s_add_u32 m0, s54, 1024
 s_add_u32 s41, s52, 20736
 buffer_load_dwordx4 v246, s[12:15], s41 offen lds
 s_waitcnt lgkmcnt(2)
 v_mfma_f32_32x32x16_bf16 v[48:63], v[64:67], v[96:99], 0
 v_exp_f32 v117, v117
 v_exp_f32 v118, v118
 v_exp_f32 v119, v119
 v_exp_f32 v120, v120
 v_exp_f32 v121, v121
 v_mfma_f32_32x32x16_bf16 v[48:63], v[68:71], v[100:103], v[48:63]
 ds_read_b128 v[64:67], v10 offset:2560
 ds_read_b128 v[68:71], v10 offset:3200
 s_cmp_lt_u32 4, s45
 s_cselect_b64 s[46:47], -1, 0
 v_cndmask_b32 v84, v88, v13, s[46:47]
 v_exp_f32 v122, v122
 v_exp_f32 v123, v123
 v_exp_f32 v124, v124
 v_exp_f32 v125, v125
 v_exp_f32 v126, v126
 v_exp_f32 v127, v127
 v_cvt_pk_bf16_f32 v112, v112, v113
 v_cvt_pk_bf16_f32 v113, v114, v115
 v_cvt_pk_bf16_f32 v114, v116, v117
 v_cvt_pk_bf16_f32 v115, v118, v119
 v_cvt_pk_bf16_f32 v116, v120, v121
 v_cvt_pk_bf16_f32 v117, v122, v123
 v_cvt_pk_bf16_f32 v118, v124, v125
 v_cvt_pk_bf16_f32 v119, v126, v127
 v_mfma_f32_32x32x16_bf16 v[160:175], v[80:83], v[84:87], v[160:175]
 v_exp_f32 v128, v128
 v_exp_f32 v129, v129
 v_exp_f32 v130, v130
 v_exp_f32 v131, v131
 v_exp_f32 v132, v132
 s_add_u32 m0, s54, 2048
 s_add_u32 s41, s52, 9216
 buffer_load_dwordx4 v246, s[12:15], s41 offen lds
 s_waitcnt lgkmcnt(2)
 v_mfma_f32_32x32x16_bf16 v[48:63], v[72:75], v[112:115], v[48:63]
 v_exp_f32 v133, v133
 v_exp_f32 v134, v134
 v_exp_f32 v135, v135
 v_exp_f32 v136, v136
 v_exp_f32 v137, v137
 v_mfma_f32_32x32x16_bf16 v[48:63], v[76:79], v[116:119], v[48:63]
 ds_read_b128 v[72:75], v10 offset:3840
 ds_read_b128 v[76:79], v10 offset:4480
 s_cmp_lt_u32 5, s45
 s_cselect_b64 s[46:47], -1, 0
 v_cndmask_b32 v92, v88, v13, s[46:47]
 v_exp_f32 v138, v138
 v_exp_f32 v139, v139
 v_exp_f32 v140, v140
 v_exp_f32 v141, v141
 v_exp_f32 v142, v142
 v_exp_f32 v143, v143
 v_cvt_pk_bf16_f32 v128, v128, v129
 v_cvt_pk_bf16_f32 v129, v130, v131
 v_cvt_pk_bf16_f32 v130, v132, v133
 v_cvt_pk_bf16_f32 v131, v134, v135
 v_cvt_pk_bf16_f32 v132, v136, v137
 v_cvt_pk_bf16_f32 v133, v138, v139
 v_cvt_pk_bf16_f32 v134, v140, v141
 v_cvt_pk_bf16_f32 v135, v142, v143
 v_mfma_f32_32x32x16_bf16 v[176:191], v[80:83], v[92:95], v[176:191]
 v_exp_f32 v144, v144
 v_exp_f32 v145, v145
 v_exp_f32 v146, v146
 v_exp_f32 v147, v147
 v_exp_f32 v148, v148
 s_add_u32 m0, s54, 3072
 s_add_u32 s41, s52, 29952
 buffer_load_dwordx4 v246, s[12:15], s41 offen lds
 s_waitcnt lgkmcnt(2)
 v_mfma_f32_32x32x16_bf16 v[48:63], v[64:67], v[128:131], v[48:63]
 v_exp_f32 v149, v149
 v_exp_f32 v150, v150
 v_exp_f32 v151, v151
 v_exp_f32 v152, v152
 v_exp_f32 v153, v153
 v_mfma_f32_32x32x16_bf16 v[48:63], v[68:71], v[132:135], v[48:63]
 ds_read_b128 v[64:67], v10 offset:5120
 ds_read_b128 v[68:71], v10 offset:5760
 s_cmp_lt_u32 6, s45
 s_cselect_b64 s[46:47], -1, 0
 v_cndmask_b32 v84, v88, v13, s[46:47]
 v_exp_f32 v154, v154
 v_exp_f32 v155, v155
 v_exp_f32 v156, v156
 v_exp_f32 v157, v157
 v_exp_f32 v158, v158
 v_exp_f32 v159, v159
 v_cvt_pk_bf16_f32 v144, v144, v145
 v_cvt_pk_bf16_f32 v145, v146, v147
 v_cvt_pk_bf16_f32 v146, v148, v149
 v_cvt_pk_bf16_f32 v147, v150, v151
 v_cvt_pk_bf16_f32 v148, v152, v153
 v_cvt_pk_bf16_f32 v149, v154, v155
 v_cvt_pk_bf16_f32 v150, v156, v157
 v_cvt_pk_bf16_f32 v151, v158, v159
 v_mfma_f32_32x32x16_bf16 v[192:207], v[80:83], v[84:87], v[192:207]
 v_exp_f32 v160, v160
 v_exp_f32 v161, v161
 v_exp_f32 v162, v162
 v_exp_f32 v163, v163
 v_exp_f32 v164, v164
 s_add_u32 m0, s54, 4096
 s_add_u32 s41, s52, 165888
 buffer_load_dwordx4 v246, s[12:15], s41 offen lds
 s_waitcnt lgkmcnt(2)
 v_mfma_f32_32x32x16_bf16 v[48:63], v[72:75], v[144:147], v[48:63]
 v_exp_f32 v165, v165
 v_exp_f32 v166, v166
 v_exp_f32 v167, v167
 v_exp_f32 v168, v168
 v_exp_f32 v169, v169
 v_mfma_f32_32x32x16_bf16 v[48:63], v[76:79], v[148:151], v[48:63]
 ds_read_b128 v[72:75], v10 offset:6400
 ds_read_b128 v[76:79], v10 offset:7040
 s_cmp_lt_u32 7, s45
 s_cselect_b64 s[46:47], -1, 0
 v_cndmask_b32 v92, v88, v13, s[46:47]
 v_exp_f32 v170, v170
 v_exp_f32 v171, v171
 v_exp_f32 v172, v172
 v_exp_f32 v173, v173
 v_exp_f32 v174, v174
 v_exp_f32 v175, v175
 v_cvt_pk_bf16_f32 v160, v160, v161
 v_cvt_pk_bf16_f32 v161, v162, v163
 v_cvt_pk_bf16_f32 v162, v164, v165
 v_cvt_pk_bf16_f32 v163, v166, v167
 v_cvt_pk_bf16_f32 v164, v168, v169
 v_cvt_pk_bf16_f32 v165, v170, v171
 v_cvt_pk_bf16_f32 v166, v172, v173
 v_cvt_pk_bf16_f32 v167, v174, v175
 v_mfma_f32_32x32x16_bf16 v[208:223], v[80:83], v[92:95], v[208:223]
 v_exp_f32 v176, v176
 v_exp_f32 v177, v177
 v_exp_f32 v178, v178
 v_exp_f32 v179, v179
 v_exp_f32 v180, v180
 s_add_u32 m0, s54, 5120
 s_add_u32 s41, s52, 186624
 buffer_load_dwordx4 v246, s[12:15], s41 offen lds
 s_waitcnt lgkmcnt(2)
 v_mfma_f32_32x32x16_bf16 v[48:63], v[64:67], v[160:163], v[48:63]
 v_exp_f32 v181, v181
 v_exp_f32 v182, v182
 v_exp_f32 v183, v183
 v_exp_f32 v184, v184
 v_exp_f32 v185, v185
 v_mfma_f32_32x32x16_bf16 v[48:63], v[68:71], v[164:167], v[48:63]
 ds_read_b128 v[64:67], v10 offset:7680
 ds_read_b128 v[68:71], v10 offset:8320
 s_cmp_lt_u32 8, s45
 s_cselect_b64 s[46:47], -1, 0
 v_cndmask_b32 v84, v88, v13, s[46:47]
 v_exp_f32 v186, v186
 v_exp_f32 v187, v187
 v_exp_f32 v188, v188
 v_exp_f32 v189, v189
 v_exp_f32 v190, v190
 v_exp_f32 v191, v191
 v_cvt_pk_bf16_f32 v176, v176, v177
 v_cvt_pk_bf16_f32 v177, v178, v179
 v_cvt_pk_bf16_f32 v178, v180, v181
 v_cvt_pk_bf16_f32 v179, v182, v183
 v_cvt_pk_bf16_f32 v180, v184, v185
 v_cvt_pk_bf16_f32 v181, v186, v187
 v_cvt_pk_bf16_f32 v182, v188, v189
 v_cvt_pk_bf16_f32 v183, v190, v191
 v_mfma_f32_32x32x16_bf16 v[224:239], v[80:83], v[84:87], v[224:239]
 v_exp_f32 v192, v192
 v_exp_f32 v193, v193
 v_exp_f32 v194, v194
 v_exp_f32 v195, v195
 v_exp_f32 v196, v196
 s_add_u32 m0, s54, 6144
 s_add_u32 s41, s52, 175104
 buffer_load_dwordx4 v246, s[12:15], s41 offen lds
 s_waitcnt lgkmcnt(2)
 v_mfma_f32_32x32x16_bf16 v[48:63], v[72:75], v[176:179], v[48:63]
 v_exp_f32 v197, v197
 v_exp_f32 v198, v198
 v_exp_f32 v199, v199
 v_exp_f32 v200, v200
 v_exp_f32 v201, v201
 v_mfma_f32_32x32x16_bf16 v[48:63], v[76:79], v[180:183], v[48:63]
 ds_read_b128 v[72:75], v10 offset:8960
 ds_read_b128 v[76:79], v10 offset:9600
 v_exp_f32 v202, v202
 v_exp_f32 v203, v203
 v_exp_f32 v204, v204
 v_exp_f32 v205, v205
 v_exp_f32 v206, v206
 v_exp_f32 v207, v207
 v_cvt_pk_bf16_f32 v192, v192, v193
 v_cvt_pk_bf16_f32 v193, v194, v195
 v_cvt_pk_bf16_f32 v194, v196, v197
 v_cvt_pk_bf16_f32 v195, v198, v199
 v_cvt_pk_bf16_f32 v196, v200, v201
 v_cvt_pk_bf16_f32 v197, v202, v203
 v_cvt_pk_bf16_f32 v198, v204, v205
 v_cvt_pk_bf16_f32 v199, v206, v207
 v_exp_f32 v208, v208
 v_exp_f32 v209, v209
 v_exp_f32 v210, v210
 v_exp_f32 v211, v211
 v_exp_f32 v212, v212
 s_add_u32 m0, s54, 7168
 s_add_u32 s41, s52, 195840
 buffer_load_dwordx4 v246, s[12:15], s41 offen lds
 s_waitcnt lgkmcnt(2)
 v_mfma_f32_32x32x16_bf16 v[48:63], v[64:67], v[192:195], v[48:63]
 v_exp_f32 v213, v213
 v_exp_f32 v214, v214
 v_exp_f32 v215, v215
 v_exp_f32 v216, v216
 v_exp_f32 v217, v217
 v_mfma_f32_32x32x16_bf16 v[48:63], v[68:71], v[196:199], v[48:63]
 ds_read_b128 v[64:67], v10 offset:10240
 ds_read_b128 v[68:71], v10 offset:10880
 v_exp_f32 v218, v218
 v_exp_f32 v219, v219
 v_exp_f32 v220, v220
 v_exp_f32 v221, v221
 v_exp_f32 v222, v222
 v_exp_f32 v223, v223
 v_cvt_pk_bf16_f32 v208, v208, v209
 v_cvt_pk_bf16_f32 v209, v210, v211
 v_cvt_pk_bf16_f32 v210, v212, v213
 v_cvt_pk_bf16_f32 v211, v214, v215
 v_cvt_pk_bf16_f32 v212, v216, v217
 v_cvt_pk_bf16_f32 v213, v218, v219
 v_cvt_pk_bf16_f32 v214, v220, v221
 v_cvt_pk_bf16_f32 v215, v222, v223
 v_exp_f32 v224, v224
 v_exp_f32 v225, v225
 v_exp_f32 v226, v226
 v_exp_f32 v227, v227
 v_exp_f32 v228, v228
 s_add_u32 m0, s53, 0
 s_mov_b32 s41, 0
 buffer_load_dwordx4 v247, s[12:15], s41 offen lds
 s_waitcnt lgkmcnt(2)
 v_mfma_f32_32x32x16_bf16 v[48:63], v[72:75], v[208:211], v[48:63]
 v_exp_f32 v229, v229
 v_exp_f32 v230, v230
 v_exp_f32 v231, v231
 v_exp_f32 v232, v232
 v_exp_f32 v233, v233
 v_mfma_f32_32x32x16_bf16 v[48:63], v[76:79], v[212:215], v[48:63]
 v_exp_f32 v234, v234
 v_exp_f32 v235, v235
 v_exp_f32 v236, v236
 v_exp_f32 v237, v237
 v_exp_f32 v238, v238
 v_exp_f32 v239, v239
 v_cvt_pk_bf16_f32 v224, v224, v225
 v_cvt_pk_bf16_f32 v225, v226, v227
 v_cvt_pk_bf16_f32 v226, v228, v229
 v_cvt_pk_bf16_f32 v227, v230, v231
 v_cvt_pk_bf16_f32 v228, v232, v233
 v_cvt_pk_bf16_f32 v229, v234, v235
 v_cvt_pk_bf16_f32 v230, v236, v237
 v_cvt_pk_bf16_f32 v231, v238, v239
 s_nop 1
 s_add_u32 m0, s53, 1024
 s_mov_b32 s41, 165888
 buffer_load_dwordx4 v247, s[12:15], s41 offen lds
 s_waitcnt lgkmcnt(0)
 v_mfma_f32_32x32x16_bf16 v[48:63], v[64:67], v[224:227], v[48:63]
 v_mfma_f32_32x32x16_bf16 v[48:63], v[68:71], v[228:231], v[48:63]
 s_nop 12
 v_mov_b32 v88, v58
 v_mov_b32 v89, v58
 s_nop 1
 v_permlane32_swap_b32 v88, v89
 s_nop 1
 v_rcp_f32 v88, v88
 s_nop 0
 v_mul_f32 v48, v48, v88
 v_mul_f32 v49, v49, v88
 v_mul_f32 v50, v50, v88
 v_mul_f32 v51, v51, v88
 v_mul_f32 v52, v52, v88
 v_mul_f32 v53, v53, v88
 v_mul_f32 v54, v54, v88
 v_mul_f32 v55, v55, v88
 v_mul_f32 v56, v56, v88
 v_mul_f32 v57, v57, v88
 v_cvt_pk_bf16_f32 v48, v48, v49
 v_cvt_pk_bf16_f32 v49, v50, v51
 v_cvt_pk_bf16_f32 v50, v52, v53
 v_cvt_pk_bf16_f32 v51, v54, v55
 v_cvt_pk_bf16_f32 v52, v56, v57
 buffer_store_dwordx4 v[48:51], v14, s[16:19], 0 offen sc1
 s_mov_b32 exec_hi, 0
 buffer_store_dword v52, v15, s[16:19], 0 offen sc1
 s_mov_b32 exec_hi, -1
 s_lshl_b32 s55, s34, 5
 s_add_u32 s55, s55, s33
 s_cmp_ge_u32 s62, 26
 s_cbranch_scc1 L_fz_p3pre
 s_mul_i32 s36, s62, 80
 s_lshr_b32 s37, s36, 8
 s_add_u32 s36, s36, 79
 s_lshr_b32 s36, s36, 8
 s_min_u32 s36, s36, 7
 s_sub_u32 s36, s36, s37
 s_add_u32 s36, s36, 1
 s_lshl_b32 s52, s36, 5
 s_lshl_b32 s53, s37, 5
 s_cmp_ge_u32 s3, 5
 s_cbranch_scc1 L_fz_p3pre
 s_mul_i32 s46, s62, 5
 s_add_u32 s46, s46, s3
 v_and_b32 v5, 15, v0
 v_lshrrev_b32 v6, 4, v0
 v_mul_u32_u24 v27, 1152, v5
 v_lshl_add_u32 v27, v6, 3, v27
 s_mul_i32 s36, s46, 18432
 s_lshl_b32 s37, s63, 7
 s_add_u32 s36, s36, s37
 s_mov_b32 s20, s64
 s_mov_b32 s21, s65
 s_mov_b32 s22, 2359296
 s_mov_b32 s23, 0x20000
 buffer_load_dwordx2 v[216:217], v27, s[20:23], s36 offen offset:0
 buffer_load_dwordx2 v[218:219], v27, s[20:23], s36 offen offset:32
 buffer_load_dwordx2 v[220:221], v27, s[20:23], s36 offen offset:64
 buffer_load_dwordx2 v[222:223], v27, s[20:23], s36 offen offset:96
 v_lshrrev_b32 v3, 2, v0
 v_bfe_u32 v4, v0, 3, 2
 v_lshlrev_b32 v3, 7, v3
 v_lshl_add_u32 v3, v4, 5, v3
 v_and_b32 v4, 3, v0
 v_lshl_add_u32 v21, v4, 3, v3
 v_xor_b32 v22, 32, v21
 v_xor_b32 v23, 64, v21
 v_xor_b32 v24, 96, v21
 v_lshlrev_b32 v16, 4, v0
 v_bfe_u32 v3, v0, 4, 1
 v_lshrrev_b32 v4, 5, v0
 v_lshl_add_u32 v3, v3, 1, v4
 v_lshlrev_b32 v28, 4, v5
 v_lshl_add_u32 v28, v3, 8, v28
 v_lshlrev_b32 v30, 3, v5
 v_cmp_eq_u32 vcc, 0, v6
 v_mov_b32 v5, 0x7fffffff
 s_mul_i32 s36, s46, 18432
 s_cmp_lt_u32 s46, 128
 s_cselect_b32 s37, 18432, 0
 v_cndmask_b32 v30, v5, v30, vcc
 s_add_u32 s38, s36, 8388608
 v_add_u32 v31, 65280, v21
 v_add_u32 v32, 65280, v22
 v_add_u32 v33, 65280, v23
 v_add_u32 v34, 65280, v24
 s_add_u32 s16, s8, s38
 s_addc_u32 s17, s9, 0
 s_mov_b32 s18, s37
 s_mov_b32 s19, 0x20000
 s_add_u32 s38, s36, 11534336
 s_add_u32 s28, s8, s38
 s_addc_u32 s29, s9, 0
 s_mov_b32 s30, s37
 s_mov_b32 s31, 0x20000
 s_lshl_b32 s36, s63, 14
 s_add_u32 s36, s36, 14680064
 s_lshl_b32 s47, s46, 7
 s_lshl_b32 s46, s63, 11
 s_add_u32 s24, s8, s36
 s_addc_u32 s25, s9, 0
 s_mov_b32 s26, 16384
 s_mov_b32 s27, 0x20000
L_fz_p3pre:
 s_waitcnt vmcnt(0)
 s_barrier
 s_cmp_lg_u32 s3, 7
 s_cbranch_scc1 L_fz_pub2
 s_add_u32 s56, s8, 16318464
 s_addc_u32 s57, s9, 0
 s_mov_b32 s58, 32768
 s_mov_b32 s59, 0x20000
 s_lshl_b32 s60, s55, 7
 v_mov_b32 v254, 0
 v_mov_b32 v255, s100
 s_mov_b64 exec, 1
 buffer_store_dword v255, v254, s[56:59], s60 offen sc1
 s_mov_b64 exec, -1
L_fz_pub2:
 s_cmp_ge_u32 s62, 26
 s_cbranch_scc1 L_fz_p3idle
 s_cmp_lg_u32 s3, 7
 s_cbranch_scc1 L_fz_p3w
 s_add_u32 s56, s8, 16318464
 s_addc_u32 s57, s9, 0
 s_mov_b32 s58, 32768
 s_mov_b32 s59, 0x20000
 s_sub_u32 s60, s52, 1
 v_min_u32 v8, s60, v0
 v_add_lshl_u32 v8, v8, s53, 7
 s_mov_b32 s61, 40000
L_fz_wf2:
 buffer_load_dword v9, v8, s[56:59], 0 offen sc1
 s_waitcnt vmcnt(0)
 v_cmp_ne_u32 vcc, s100, v9
 s_sub_u32 s61, s61, 1
 s_cbranch_vccz L_fz_wd2
 s_cmp_lg_u32 s61, 0
 s_cbranch_scc1 L_fz_wf2
L_fz_wd2:
L_fz_p3w:
 s_barrier
 s_cmp_ge_u32 s3, 5
 s_cbranch_scc1 L_fz_p3h
 ds_read_b64_tr_b16 v[168:169], v21 offset:0
 ds_read_b64_tr_b16 v[170:171], v21 offset:2048
 ds_read_b64_tr_b16 v[172:173], v22 offset:0
 ds_read_b64_tr_b16 v[174:175], v22 offset:2048
 ds_read_b64_tr_b16 v[176:177], v23 offset:0
 ds_read_b64_tr_b16 v[178:179], v23 offset:2048
 ds_read_b64_tr_b16 v[180:181], v24 offset:0
 ds_read_b64_tr_b16 v[182:183], v24 offset:2048
 s_mov_b32 s42, 0
 buffer_load_dwordx4 v[96:99], v16, s[16:19], s42 offen offset:0 sc1
 buffer_load_dwordx4 v[100:103], v16, s[16:19], s42 offen offset:1024 sc1
 buffer_load_dwordx4 v[104:107], v16, s[16:19], s42 offen offset:2048 sc1
 buffer_load_dwordx4 v[108:111], v16, s[16:19], s42 offen offset:3072 sc1
 s_mov_b32 s42, 4096
 buffer_load_dwordx4 v[112:115], v16, s[16:19], s42 offen offset:0 sc1
 buffer_load_dwordx4 v[116:119], v16, s[16:19], s42 offen offset:1024 sc1
 s_mov_b32 s42, 4096
 buffer_load_dwordx4 v[120:123], v16, s[16:19], s42 offen offset:2048 sc1
 s_waitcnt vmcnt(6)
 s_waitcnt lgkmcnt(6)
 v_mfma_f32_16x16x32_bf16 v[200:203], v[168:171], v[96:99], 0
 ds_read_b64_tr_b16 v[184:185], v21 offset:21760
 ds_read_b64_tr_b16 v[186:187], v21 offset:23808
 s_waitcnt lgkmcnt(6)
 v_mfma_f32_16x16x32_bf16 v[204:207], v[172:175], v[96:99], 0
 ds_read_b64_tr_b16 v[188:189], v22 offset:21760
 ds_read_b64_tr_b16 v[190:191], v22 offset:23808
 s_waitcnt lgkmcnt(6)
 v_mfma_f32_16x16x32_bf16 v[208:211], v[176:179], v[96:99], 0
 ds_read_b64_tr_b16 v[192:193], v23 offset:21760
 ds_read_b64_tr_b16 v[194:195], v23 offset:23808
 s_waitcnt lgkmcnt(6)
 v_mfma_f32_16x16x32_bf16 v[212:215], v[180:183], v[96:99], 0
 ds_read_b64_tr_b16 v[196:197], v24 offset:21760
 ds_read_b64_tr_b16 v[198:199], v24 offset:23808
 s_mov_b32 s42, 4096
 buffer_load_dwordx4 v[124:127], v16, s[16:19], s42 offen offset:3072 sc1
 s_waitcnt vmcnt(6)
 s_waitcnt lgkmcnt(6)
 v_mfma_f32_16x16x32_bf16 v[200:203], v[184:187], v[100:103], v[200:203]
 ds_read_b64_tr_b16 v[168:169], v21 offset:43520
 ds_read_b64_tr_b16 v[170:171], v21 offset:45568
 s_waitcnt lgkmcnt(6)
 v_mfma_f32_16x16x32_bf16 v[204:207], v[188:191], v[100:103], v[204:207]
 ds_read_b64_tr_b16 v[172:173], v22 offset:43520
 ds_read_b64_tr_b16 v[174:175], v22 offset:45568
 s_waitcnt lgkmcnt(6)
 v_mfma_f32_16x16x32_bf16 v[208:211], v[192:195], v[100:103], v[208:211]
 ds_read_b64_tr_b16 v[176:177], v23 offset:43520
 ds_read_b64_tr_b16 v[178:179], v23 offset:45568
 s_waitcnt lgkmcnt(6)
 v_mfma_f32_16x16x32_bf16 v[212:215], v[196:199], v[100:103], v[212:215]
 ds_read_b64_tr_b16 v[180:181], v24 offset:43520
 ds_read_b64_tr_b16 v[182:183], v24 offset:45568
 s_mov_b32 s42, 8192
 buffer_load_dwordx4 v[128:131], v16, s[16:19], s42 offen offset:0 sc1
 s_waitcnt vmcnt(6)
 s_waitcnt lgkmcnt(6)
 v_mfma_f32_16x16x32_bf16 v[200:203], v[168:171], v[104:107], v[200:203]
 ds_read_b64_tr_b16 v[184:185], v31 offset:0
 ds_read_b64_tr_b16 v[186:187], v31 offset:2048
 s_waitcnt lgkmcnt(6)
 v_mfma_f32_16x16x32_bf16 v[204:207], v[172:175], v[104:107], v[204:207]
 ds_read_b64_tr_b16 v[188:189], v32 offset:0
 ds_read_b64_tr_b16 v[190:191], v32 offset:2048
 s_waitcnt lgkmcnt(6)
 v_mfma_f32_16x16x32_bf16 v[208:211], v[176:179], v[104:107], v[208:211]
 ds_read_b64_tr_b16 v[192:193], v33 offset:0
 ds_read_b64_tr_b16 v[194:195], v33 offset:2048
 s_waitcnt lgkmcnt(6)
 v_mfma_f32_16x16x32_bf16 v[212:215], v[180:183], v[104:107], v[212:215]
 ds_read_b64_tr_b16 v[196:197], v34 offset:0
 ds_read_b64_tr_b16 v[198:199], v34 offset:2048
 s_mov_b32 s42, 8192
 buffer_load_dwordx4 v[132:135], v16, s[16:19], s42 offen offset:1024 sc1
 s_waitcnt vmcnt(6)
 s_waitcnt lgkmcnt(6)
 v_mfma_f32_16x16x32_bf16 v[200:203], v[184:187], v[108:111], v[200:203]
 ds_read_b64_tr_b16 v[168:169], v21 offset:4096
 ds_read_b64_tr_b16 v[170:171], v21 offset:6144
 s_waitcnt lgkmcnt(6)
 v_mfma_f32_16x16x32_bf16 v[204:207], v[188:191], v[108:111], v[204:207]
 ds_read_b64_tr_b16 v[172:173], v22 offset:4096
 ds_read_b64_tr_b16 v[174:175], v22 offset:6144
 s_waitcnt lgkmcnt(6)
 v_mfma_f32_16x16x32_bf16 v[208:211], v[192:195], v[108:111], v[208:211]
 ds_read_b64_tr_b16 v[176:177], v23 offset:4096
 ds_read_b64_tr_b16 v[178:179], v23 offset:6144
 s_waitcnt lgkmcnt(6)
 v_mfma_f32_16x16x32_bf16 v[212:215], v[196:199], v[108:111], v[212:215]
 ds_read_b64_tr_b16 v[180:181], v24 offset:4096
 ds_read_b64_tr_b16 v[182:183], v24 offset:6144
 s_mov_b32 s42, 8192
 buffer_load_dwordx4 v[136:139], v16, s[16:19], s42 offen offset:2048 sc1
 s_waitcnt vmcnt(6)
 s_waitcnt lgkmcnt(6)
 v_mfma_f32_16x16x32_bf16 v[200:203], v[168:171], v[112:115], v[200:203]
 ds_read_b64_tr_b16 v[184:185], v21 offset:25856
 ds_read_b64_tr_b16 v[186:187], v21 offset:27904
 s_waitcnt lgkmcnt(6)
 v_mfma_f32_16x16x32_bf16 v[204:207], v[172:175], v[112:115], v[204:207]
 ds_read_b64_tr_b16 v[188:189], v22 offset:25856
 ds_read_b64_tr_b16 v[190:191], v22 offset:27904
 s_waitcnt lgkmcnt(6)
 v_mfma_f32_16x16x32_bf16 v[208:211], v[176:179], v[112:115], v[208:211]
 ds_read_b64_tr_b16 v[192:193], v23 offset:25856
 ds_read_b64_tr_b16 v[194:195], v23 offset:27904
 s_waitcnt lgkmcnt(6)
 v_mfma_f32_16x16x32_bf16 v[212:215], v[180:183], v[112:115], v[212:215]
 ds_read_b64_tr_b16 v[196:197], v24 offset:25856
 ds_read_b64_tr_b16 v[198:199], v24 offset:27904
 s_mov_b32 s42, 8192
 buffer_load_dwordx4 v[140:143], v16, s[16:19], s42 offen offset:3072 sc1
 s_waitcnt vmcnt(6)
 s_waitcnt lgkmcnt(6)
 v_mfma_f32_16x16x32_bf16 v[200:203], v[184:187], v[116:119], v[200:203]
 ds_read_b64_tr_b16 v[168:169], v21 offset:47616
 ds_read_b64_tr_b16 v[170:171], v21 offset:49664
 s_waitcnt lgkmcnt(6)
 v_mfma_f32_16x16x32_bf16 v[204:207], v[188:191], v[116:119], v[204:207]
 ds_read_b64_tr_b16 v[172:173], v22 offset:47616
 ds_read_b64_tr_b16 v[174:175], v22 offset:49664
 s_waitcnt lgkmcnt(6)
 v_mfma_f32_16x16x32_bf16 v[208:211], v[192:195], v[116:119], v[208:211]
 ds_read_b64_tr_b16 v[176:177], v23 offset:47616
 ds_read_b64_tr_b16 v[178:179], v23 offset:49664
 s_waitcnt lgkmcnt(6)
 v_mfma_f32_16x16x32_bf16 v[212:215], v[196:199], v[116:119], v[212:215]
 ds_read_b64_tr_b16 v[180:181], v24 offset:47616
 ds_read_b64_tr_b16 v[182:183], v24 offset:49664
 s_mov_b32 s42, 12288
 buffer_load_dwordx4 v[144:147], v16, s[16:19], s42 offen offset:0 sc1
 s_waitcnt vmcnt(6)
 s_waitcnt lgkmcnt(6)
 v_mfma_f32_16x16x32_bf16 v[200:203], v[168:171], v[120:123], v[200:203]
 ds_read_b64_tr_b16 v[184:185], v31 offset:4096
 ds_read_b64_tr_b16 v[186:187], v31 offset:6144
 s_waitcnt lgkmcnt(6)
 v_mfma_f32_16x16x32_bf16 v[204:207], v[172:175], v[120:123], v[204:207]
 ds_read_b64_tr_b16 v[188:189], v32 offset:4096
 ds_read_b64_tr_b16 v[190:191], v32 offset:6144
 s_waitcnt lgkmcnt(6)
 v_mfma_f32_16x16x32_bf16 v[208:211], v[176:179], v[120:123], v[208:211]
 ds_read_b64_tr_b16 v[192:193], v33 offset:4096
 ds_read_b64_tr_b16 v[194:195], v33 offset:6144
 s_waitcnt lgkmcnt(6)
 v_mfma_f32_16x16x32_bf16 v[212:215], v[180:183], v[120:123], v[212:215]
 ds_read_b64_tr_b16 v[196:197], v34 offset:4096
 ds_read_b64_tr_b16 v[198:199], v34 offset:6144
 s_mov_b32 s42, 12288
 buffer_load_dwordx4 v[148:151], v16, s[16:19], s42 offen offset:1024 sc1
 s_waitcnt vmcnt(6)
 s_waitcnt lgkmcnt(6)
 v_mfma_f32_16x16x32_bf16 v[200:203], v[184:187], v[124:127], v[200:203]
 ds_read_b64_tr_b16 v[168:169], v21 offset:8192
 ds_read_b64_tr_b16 v[170:171], v21 offset:10240
 s_waitcnt lgkmcnt(6)
 v_mfma_f32_16x16x32_bf16 v[204:207], v[188:191], v[124:127], v[204:207]
 ds_read_b64_tr_b16 v[172:173], v22 offset:8192
 ds_read_b64_tr_b16 v[174:175], v22 offset:10240
 s_waitcnt lgkmcnt(6)
 v_mfma_f32_16x16x32_bf16 v[208:211], v[192:195], v[124:127], v[208:211]
 ds_read_b64_tr_b16 v[176:177], v23 offset:8192
 ds_read_b64_tr_b16 v[178:179], v23 offset:10240
 s_waitcnt lgkmcnt(6)
 v_mfma_f32_16x16x32_bf16 v[212:215], v[196:199], v[124:127], v[212:215]
 ds_read_b64_tr_b16 v[180:181], v24 offset:8192
 ds_read_b64_tr_b16 v[182:183], v24 offset:10240
 s_mov_b32 s42, 12288
 buffer_load_dwordx4 v[152:155], v16, s[16:19], s42 offen offset:2048 sc1
 s_waitcnt vmcnt(6)
 s_waitcnt lgkmcnt(6)
 v_mfma_f32_16x16x32_bf16 v[200:203], v[168:171], v[128:131], v[200:203]
 ds_read_b64_tr_b16 v[184:185], v21 offset:29952
 ds_read_b64_tr_b16 v[186:187], v21 offset:32000
 s_waitcnt lgkmcnt(6)
 v_mfma_f32_16x16x32_bf16 v[204:207], v[172:175], v[128:131], v[204:207]
 ds_read_b64_tr_b16 v[188:189], v22 offset:29952
 ds_read_b64_tr_b16 v[190:191], v22 offset:32000
 s_waitcnt lgkmcnt(6)
 v_mfma_f32_16x16x32_bf16 v[208:211], v[176:179], v[128:131], v[208:211]
 ds_read_b64_tr_b16 v[192:193], v23 offset:29952
 ds_read_b64_tr_b16 v[194:195], v23 offset:32000
 s_waitcnt lgkmcnt(6)
 v_mfma_f32_16x16x32_bf16 v[212:215], v[180:183], v[128:131], v[212:215]
 ds_read_b64_tr_b16 v[196:197], v24 offset:29952
 ds_read_b64_tr_b16 v[198:199], v24 offset:32000
 s_mov_b32 s42, 12288
 buffer_load_dwordx4 v[156:159], v16, s[16:19], s42 offen offset:3072 sc1
 s_waitcnt vmcnt(6)
 s_waitcnt lgkmcnt(6)
 v_mfma_f32_16x16x32_bf16 v[200:203], v[184:187], v[132:135], v[200:203]
 ds_read_b64_tr_b16 v[168:169], v21 offset:51712
 ds_read_b64_tr_b16 v[170:171], v21 offset:53760
 s_waitcnt lgkmcnt(6)
 v_mfma_f32_16x16x32_bf16 v[204:207], v[188:191], v[132:135], v[204:207]
 ds_read_b64_tr_b16 v[172:173], v22 offset:51712
 ds_read_b64_tr_b16 v[174:175], v22 offset:53760
 s_waitcnt lgkmcnt(6)
 v_mfma_f32_16x16x32_bf16 v[208:211], v[192:195], v[132:135], v[208:211]
 ds_read_b64_tr_b16 v[176:177], v23 offset:51712
 ds_read_b64_tr_b16 v[178:179], v23 offset:53760
 s_waitcnt lgkmcnt(6)
 v_mfma_f32_16x16x32_bf16 v[212:215], v[196:199], v[132:135], v[212:215]
 ds_read_b64_tr_b16 v[180:181], v24 offset:51712
 ds_read_b64_tr_b16 v[182:183], v24 offset:53760
 s_mov_b32 s42, 16384
 buffer_load_dwordx4 v[160:163], v16, s[16:19], s42 offen offset:0 sc1
 s_waitcnt vmcnt(6)
 s_waitcnt lgkmcnt(6)
 v_mfma_f32_16x16x32_bf16 v[200:203], v[168:171], v[136:139], v[200:203]
 ds_read_b64_tr_b16 v[184:185], v31 offset:8192
 ds_read_b64_tr_b16 v[186:187], v31 offset:10240
 s_waitcnt lgkmcnt(6)
 v_mfma_f32_16x16x32_bf16 v[204:207], v[172:175], v[136:139], v[204:207]
 ds_read_b64_tr_b16 v[188:189], v32 offset:8192
 ds_read_b64_tr_b16 v[190:191], v32 offset:10240
 s_waitcnt lgkmcnt(6)
 v_mfma_f32_16x16x32_bf16 v[208:211], v[176:179], v[136:139], v[208:211]
 ds_read_b64_tr_b16 v[192:193], v33 offset:8192
 ds_read_b64_tr_b16 v[194:195], v33 offset:10240
 s_waitcnt lgkmcnt(6)
 v_mfma_f32_16x16x32_bf16 v[212:215], v[180:183], v[136:139], v[212:215]
 ds_read_b64_tr_b16 v[196:197], v34 offset:8192
 ds_read_b64_tr_b16 v[198:199], v34 offset:10240
 s_mov_b32 s42, 16384
 buffer_load_dwordx4 v[164:167], v16, s[16:19], s42 offen offset:1024 sc1
 s_waitcnt vmcnt(6)
 s_waitcnt lgkmcnt(6)
 v_mfma_f32_16x16x32_bf16 v[200:203], v[184:187], v[140:143], v[200:203]
 ds_read_b64_tr_b16 v[168:169], v21 offset:12288
 ds_read_b64_tr_b16 v[170:171], v21 offset:14336
 s_waitcnt lgkmcnt(6)
 v_mfma_f32_16x16x32_bf16 v[204:207], v[188:191], v[140:143], v[204:207]
 ds_read_b64_tr_b16 v[172:173], v22 offset:12288
 ds_read_b64_tr_b16 v[174:175], v22 offset:14336
 s_waitcnt lgkmcnt(6)
 v_mfma_f32_16x16x32_bf16 v[208:211], v[192:195], v[140:143], v[208:211]
 ds_read_b64_tr_b16 v[176:177], v23 offset:12288
 ds_read_b64_tr_b16 v[178:179], v23 offset:14336
 s_waitcnt lgkmcnt(6)
 v_mfma_f32_16x16x32_bf16 v[212:215], v[196:199], v[140:143], v[212:215]
 ds_read_b64_tr_b16 v[180:181], v24 offset:12288
 ds_read_b64_tr_b16 v[182:183], v24 offset:14336
 s_waitcnt vmcnt(5)
 s_waitcnt lgkmcnt(6)
 v_mfma_f32_16x16x32_bf16 v[200:203], v[168:171], v[144:147], v[200:203]
 ds_read_b64_tr_b16 v[184:185], v21 offset:34048
 ds_read_b64_tr_b16 v[186:187], v21 offset:36096
 s_waitcnt lgkmcnt(6)
 v_mfma_f32_16x16x32_bf16 v[204:207], v[172:175], v[144:147], v[204:207]
 ds_read_b64_tr_b16 v[188:189], v22 offset:34048
 ds_read_b64_tr_b16 v[190:191], v22 offset:36096
 s_waitcnt lgkmcnt(6)
 v_mfma_f32_16x16x32_bf16 v[208:211], v[176:179], v[144:147], v[208:211]
 ds_read_b64_tr_b16 v[192:193], v23 offset:34048
 ds_read_b64_tr_b16 v[194:195], v23 offset:36096
 s_waitcnt lgkmcnt(6)
 v_mfma_f32_16x16x32_bf16 v[212:215], v[180:183], v[144:147], v[212:215]
 ds_read_b64_tr_b16 v[196:197], v24 offset:34048
 ds_read_b64_tr_b16 v[198:199], v24 offset:36096
 s_waitcnt vmcnt(4)
 s_waitcnt lgkmcnt(6)
 v_mfma_f32_16x16x32_bf16 v[200:203], v[184:187], v[148:151], v[200:203]
 ds_read_b64_tr_b16 v[168:169], v21 offset:55808
 ds_read_b64_tr_b16 v[170:171], v21 offset:57856
 s_waitcnt lgkmcnt(6)
 v_mfma_f32_16x16x32_bf16 v[204:207], v[188:191], v[148:151], v[204:207]
 ds_read_b64_tr_b16 v[172:173], v22 offset:55808
 ds_read_b64_tr_b16 v[174:175], v22 offset:57856
 s_waitcnt lgkmcnt(6)
 v_mfma_f32_16x16x32_bf16 v[208:211], v[192:195], v[148:151], v[208:211]
 ds_read_b64_tr_b16 v[176:177], v23 offset:55808
 ds_read_b64_tr_b16 v[178:179], v23 offset:57856
 s_waitcnt lgkmcnt(6)
 v_mfma_f32_16x16x32_bf16 v[212:215], v[196:199], v[148:151], v[212:215]
 ds_read_b64_tr_b16 v[180:181], v24 offset:55808
 ds_read_b64_tr_b16 v[182:183], v24 offset:57856
 s_waitcnt vmcnt(3)
 s_waitcnt lgkmcnt(6)
 v_mfma_f32_16x16x32_bf16 v[200:203], v[168:171], v[152:155], v[200:203]
 ds_read_b64_tr_b16 v[184:185], v31 offset:12288
 ds_read_b64_tr_b16 v[186:187], v31 offset:14336
 s_waitcnt lgkmcnt(6)
 v_mfma_f32_16x16x32_bf16 v[204:207], v[172:175], v[152:155], v[204:207]
 ds_read_b64_tr_b16 v[188:189], v32 offset:12288
 ds_read_b64_tr_b16 v[190:191], v32 offset:14336
 s_waitcnt lgkmcnt(6)
 v_mfma_f32_16x16x32_bf16 v[208:211], v[176:179], v[152:155], v[208:211]
 ds_read_b64_tr_b16 v[192:193], v33 offset:12288
 ds_read_b64_tr_b16 v[194:195], v33 offset:14336
 s_waitcnt lgkmcnt(6)
 v_mfma_f32_16x16x32_bf16 v[212:215], v[180:183], v[152:155], v[212:215]
 ds_read_b64_tr_b16 v[196:197], v34 offset:12288
 ds_read_b64_tr_b16 v[198:199], v34 offset:14336
 s_waitcnt vmcnt(2)
 s_waitcnt lgkmcnt(6)
 v_mfma_f32_16x16x32_bf16 v[200:203], v[184:187], v[156:159], v[200:203]
 ds_read_b64_tr_b16 v[168:169], v21 offset:16384
 ds_read_b64_tr_b16 v[170:171], v21 offset:18432
 s_waitcnt lgkmcnt(6)
 v_mfma_f32_16x16x32_bf16 v[204:207], v[188:191], v[156:159], v[204:207]
 ds_read_b64_tr_b16 v[172:173], v22 offset:16384
 ds_read_b64_tr_b16 v[174:175], v22 offset:18432
 s_waitcnt lgkmcnt(6)
 v_mfma_f32_16x16x32_bf16 v[208:211], v[192:195], v[156:159], v[208:211]
 ds_read_b64_tr_b16 v[176:177], v23 offset:16384
 ds_read_b64_tr_b16 v[178:179], v23 offset:18432
 s_waitcnt lgkmcnt(6)
 v_mfma_f32_16x16x32_bf16 v[212:215], v[196:199], v[156:159], v[212:215]
 ds_read_b64_tr_b16 v[180:181], v24 offset:16384
 ds_read_b64_tr_b16 v[182:183], v24 offset:18432
 s_waitcnt vmcnt(1)
 s_waitcnt lgkmcnt(6)
 v_mfma_f32_16x16x32_bf16 v[200:203], v[168:171], v[160:163], v[200:203]
 ds_read_b64_tr_b16 v[184:185], v21 offset:38144
 ds_read_b64_tr_b16 v[186:187], v21 offset:40192
 s_waitcnt lgkmcnt(6)
 v_mfma_f32_16x16x32_bf16 v[204:207], v[172:175], v[160:163], v[204:207]
 ds_read_b64_tr_b16 v[188:189], v22 offset:38144
 ds_read_b64_tr_b16 v[190:191], v22 offset:40192
 s_waitcnt lgkmcnt(6)
 v_mfma_f32_16x16x32_bf16 v[208:211], v[176:179], v[160:163], v[208:211]
 ds_read_b64_tr_b16 v[192:193], v23 offset:38144
 ds_read_b64_tr_b16 v[194:195], v23 offset:40192
 s_waitcnt lgkmcnt(6)
 v_mfma_f32_16x16x32_bf16 v[212:215], v[180:183], v[160:163], v[212:215]
 ds_read_b64_tr_b16 v[196:197], v24 offset:38144
 ds_read_b64_tr_b16 v[198:199], v24 offset:40192
 s_waitcnt vmcnt(0)
 s_waitcnt lgkmcnt(6)
 v_mfma_f32_16x16x32_bf16 v[200:203], v[184:187], v[164:167], v[200:203]
 s_waitcnt lgkmcnt(4)
 v_mfma_f32_16x16x32_bf16 v[204:207], v[188:191], v[164:167], v[204:207]
 s_waitcnt lgkmcnt(2)
 v_mfma_f32_16x16x32_bf16 v[208:211], v[192:195], v[164:167], v[208:211]
 s_waitcnt lgkmcnt(0)
 v_mfma_f32_16x16x32_bf16 v[212:215], v[196:199], v[164:167], v[212:215]
 v_lshlrev_b32 v96, 16, v216
 v_and_b32 v97, 0xffff0000, v216
 v_lshlrev_b32 v98, 16, v217
 v_and_b32 v99, 0xffff0000, v217
 v_lshlrev_b32 v100, 16, v218
 v_and_b32 v101, 0xffff0000, v218
 v_lshlrev_b32 v102, 16, v219
 v_and_b32 v103, 0xffff0000, v219
 v_lshlrev_b32 v104, 16, v220
 v_and_b32 v105, 0xffff0000, v220
 v_lshlrev_b32 v106, 16, v221
 v_and_b32 v107, 0xffff0000, v221
 v_lshlrev_b32 v108, 16, v222
 v_and_b32 v109, 0xffff0000, v222
 v_lshlrev_b32 v110, 16, v223
 v_and_b32 v111, 0xffff0000, v223
 v_pk_add_f32 v[200:201], v[200:201], v[96:97]
 v_pk_add_f32 v[202:203], v[202:203], v[98:99]
 v_pk_add_f32 v[204:205], v[204:205], v[100:101]
 v_pk_add_f32 v[206:207], v[206:207], v[102:103]
 v_pk_add_f32 v[208:209], v[208:209], v[104:105]
 v_pk_add_f32 v[210:211], v[210:211], v[106:107]
 v_pk_add_f32 v[212:213], v[212:213], v[108:109]
 v_pk_add_f32 v[214:215], v[214:215], v[110:111]
 v_cvt_pk_bf16_f32 v112, v200, v201
 v_cvt_pk_bf16_f32 v114, v204, v205
 v_cvt_pk_bf16_f32 v113, v202, v203
 v_cvt_pk_bf16_f32 v115, v206, v207
 s_nop 0
 v_permlane16_swap_b32 v112, v114
 v_permlane16_swap_b32 v113, v115
 buffer_store_dwordx4 v[112:115], v28, s[28:31], s46 offen offset:0 sc1
 v_cvt_pk_bf16_f32 v116, v208, v209
 v_cvt_pk_bf16_f32 v118, v212, v213
 v_cvt_pk_bf16_f32 v117, v210, v211
 v_cvt_pk_bf16_f32 v119, v214, v215
 s_nop 0
 v_permlane16_swap_b32 v116, v118
 v_permlane16_swap_b32 v117, v119
 buffer_store_dwordx4 v[116:119], v28, s[28:31], s46 offen offset:1024 sc1
 v_pk_mul_f32 v[98:99], v[200:201], v[200:201]
 v_pk_add_f32 v[96:97], v[200:201], v[202:203]
 v_pk_fma_f32 v[98:99], v[202:203], v[202:203], v[98:99]
 v_pk_fma_f32 v[98:99], v[204:205], v[204:205], v[98:99]
 v_pk_add_f32 v[96:97], v[96:97], v[204:205]
 v_pk_fma_f32 v[98:99], v[206:207], v[206:207], v[98:99]
 v_pk_add_f32 v[96:97], v[96:97], v[206:207]
 v_pk_fma_f32 v[98:99], v[208:209], v[208:209], v[98:99]
 v_pk_add_f32 v[96:97], v[96:97], v[208:209]
 v_pk_fma_f32 v[98:99], v[210:211], v[210:211], v[98:99]
 v_pk_add_f32 v[96:97], v[96:97], v[210:211]
 v_pk_fma_f32 v[98:99], v[212:213], v[212:213], v[98:99]
 v_pk_add_f32 v[96:97], v[96:97], v[212:213]
 v_pk_fma_f32 v[98:99], v[214:215], v[214:215], v[98:99]
 v_pk_add_f32 v[96:97], v[96:97], v[214:215]
 v_add_f32 v96, v96, v97
 v_add_f32 v97, v98, v99
 v_mov_b32 v98, v96
 v_mov_b32 v99, v97
 s_nop 0
 v_permlane16_swap_b32 v96, v98
 v_permlane16_swap_b32 v97, v99
 s_nop 0
 v_pk_add_f32 v[96:97], v[96:97], v[98:99]
 v_mov_b32 v98, v96
 v_mov_b32 v99, v97
 s_nop 0
 v_permlane32_swap_b32 v96, v98
 v_permlane32_swap_b32 v97, v99
 s_nop 0
 v_pk_add_f32 v[96:97], v[96:97], v[98:99]
 buffer_store_dwordx2 v[96:97], v30, s[24:27], s47 offen sc1
L_fz_p3h:
 s_cmp_ge_u32 s3, 5
 s_cbranch_scc0 L_fz_p3nh
 s_and_b32 s35, s2, 7
 s_lshr_b32 s36, s2, 3
 s_and_b32 s33, s35, 1
 s_lshl_b32 s33, s33, 3
 s_and_b32 s37, s36, 7
 s_add_u32 s33, s33, s37
 s_lshr_b32 s34, s35, 1
 s_lshl_b32 s34, s34, 2
 s_lshr_b32 s37, s36, 3
 s_add_u32 s34, s34, s37
 s_mul_i32 s38, s34, 9
 s_lshr_b32 s38, s38, 1
 s_and_b32 s39, s34, 1
 s_and_b32 s32, s3, 3
 s_lshr_b32 s44, s32, 1
 s_and_b32 s45, s32, 1
 s_mul_i32 s36, s34, 288
 s_sub_u32 s37, 5308416, s36
 s_add_u32 s16, s72, s36
 s_addc_u32 s17, s73, 0
 s_mov_b32 s18, s37
 s_mov_b32 s19, 0x20000
 s_lshl_b32 s48, s32, 12
 s_lshl_b32 s49, s44, 10
 v_lshlrev_b32 v1, 4, v0
 s_movk_i32 s37, 9216
 s_lshl_b32 s36, s32, 8
 s_add_u32 s36, s36, 0
 v_add_u32 v14, s36, v0
 v_mul_u32_u24 v15, 3641, v14
 v_lshrrev_b32 v15, 16, v15
 v_mul_u32_u24 v18, 18, v15
 v_sub_u32 v14, v14, v18
 v_and_b32 v18, 0x30, v15
 v_bfe_u32 v19, v15, 1, 3
 v_and_b32 v15, 1, v15
 v_lshl_or_b32 v18, v15, 3, v18
 v_or_b32 v18, v18, v19
 v_lshlrev_b32 v14, 4, v14
 v_mad_u32_u24 v232, v18, s37, v14
 s_lshl_b32 s36, s32, 8
 s_add_u32 s36, s36, 64
 v_add_u32 v14, s36, v0
 v_mul_u32_u24 v15, 3641, v14
 v_lshrrev_b32 v15, 16, v15
 v_mul_u32_u24 v18, 18, v15
 v_sub_u32 v14, v14, v18
 v_and_b32 v18, 0x30, v15
 v_bfe_u32 v19, v15, 1, 3
 v_and_b32 v15, 1, v15
 v_lshl_or_b32 v18, v15, 3, v18
 v_or_b32 v18, v18, v19
 v_lshlrev_b32 v14, 4, v14
 v_mad_u32_u24 v233, v18, s37, v14
 s_lshl_b32 s36, s32, 8
 s_add_u32 s36, s36, 128
 v_add_u32 v14, s36, v0
 v_mul_u32_u24 v15, 3641, v14
 v_lshrrev_b32 v15, 16, v15
 v_mul_u32_u24 v18, 18, v15
 v_sub_u32 v14, v14, v18
 v_and_b32 v18, 0x30, v15
 v_bfe_u32 v19, v15, 1, 3
 v_and_b32 v15, 1, v15
 v_lshl_or_b32 v18, v15, 3, v18
 v_or_b32 v18, v18, v19
 v_lshlrev_b32 v14, 4, v14
 v_mad_u32_u24 v234, v18, s37, v14
 s_lshl_b32 s36, s32, 8
 s_add_u32 s36, s36, 192
 v_add_u32 v14, s36, v0
 v_mul_u32_u24 v15, 3641, v14
 v_lshrrev_b32 v15, 16, v15
 v_mul_u32_u24 v18, 18, v15
 v_sub_u32 v14, v14, v18
 v_and_b32 v18, 0x30, v15
 v_bfe_u32 v19, v15, 1, 3
 v_and_b32 v15, 1, v15
 v_lshl_or_b32 v18, v15, 3, v18
 v_or_b32 v18, v18, v19
 v_lshlrev_b32 v14, 4, v14
 v_mad_u32_u24 v235, v18, s37, v14
 s_lshl_b32 s36, s44, 6
 s_add_u32 s36, s36, 1024
 v_add_u32 v14, s36, v0
 v_mul_u32_u24 v15, 3641, v14
 v_lshrrev_b32 v15, 16, v15
 v_mul_u32_u24 v18, 18, v15
 v_sub_u32 v14, v14, v18
 v_and_b32 v18, 0x30, v15
 v_bfe_u32 v19, v15, 1, 3
 v_and_b32 v15, 1, v15
 v_lshl_or_b32 v18, v15, 3, v18
 v_or_b32 v18, v18, v19
 v_lshlrev_b32 v14, 4, v14
 v_mad_u32_u24 v236, v18, s37, v14
 s_movk_i32 s36, 224
 s_add_u32 s56, s8, 16285696
 s_addc_u32 s57, s9, 0
 s_mov_b32 s58, 32768
 s_mov_b32 s59, 0x20000
 s_sub_u32 s60, 32, 1
 v_min_u32 v8, s60, v0
 v_add_lshl_u32 v8, v8, s36, 7
 s_mov_b32 s61, 40000
L_fz_wf1csa:
 buffer_load_dword v9, v8, s[56:59], 0 offen sc1
 s_waitcnt vmcnt(0)
 v_cmp_ne_u32 vcc, s100, v9
 s_sub_u32 s61, s61, 1
 s_cbranch_vccz L_fz_wd1csa
 s_cmp_lg_u32 s61, 0
 s_cbranch_scc1 L_fz_wf1csa
L_fz_wd1csa:
 s_cmp_eq_u32 s45, 0
 s_cbranch_scc0 L_fz_p4pl8a
 s_add_u32 m0, s48, 87040
 s_mov_b32 s42, 4608
 buffer_load_dwordx4 v232, s[16:19], s42 offen lds
 s_add_u32 m0, s48, 88064
 s_nop 0
 buffer_load_dwordx4 v233, s[16:19], s42 offen lds
 s_add_u32 m0, s48, 89088
 s_nop 0
 buffer_load_dwordx4 v234, s[16:19], s42 offen lds
 s_add_u32 m0, s48, 90112
 s_nop 0
 buffer_load_dwordx4 v235, s[16:19], s42 offen lds
 s_add_u32 m0, s49, 103424
 s_nop 0
 buffer_load_dwordx4 v236, s[16:19], s42 offen lds
 s_add_u32 m0, s48, 105472
 s_mov_b32 s42, 594432
 buffer_load_dwordx4 v232, s[16:19], s42 offen lds
 s_add_u32 m0, s48, 106496
 s_nop 0
 buffer_load_dwordx4 v233, s[16:19], s42 offen lds
 s_add_u32 m0, s48, 107520
 s_nop 0
 buffer_load_dwordx4 v234, s[16:19], s42 offen lds
 s_add_u32 m0, s48, 108544
 s_nop 0
 buffer_load_dwordx4 v235, s[16:19], s42 offen lds
 s_add_u32 m0, s49, 121856
 s_nop 0
 buffer_load_dwordx4 v236, s[16:19], s42 offen lds
 s_add_u32 m0, s48, 123904
 s_mov_b32 s42, 1184256
 buffer_load_dwordx4 v232, s[16:19], s42 offen lds
 s_add_u32 m0, s48, 124928
 s_nop 0
 buffer_load_dwordx4 v233, s[16:19], s42 offen lds
 s_add_u32 m0, s48, 125952
 s_nop 0
 buffer_load_dwordx4 v234, s[16:19], s42 offen lds
 s_add_u32 m0, s48, 126976
 s_nop 0
 buffer_load_dwordx4 v235, s[16:19], s42 offen lds
 s_add_u32 m0, s49, 140288
 s_nop 0
 buffer_load_dwordx4 v236, s[16:19], s42 offen lds
 s_add_u32 m0, s48, 142336
 s_mov_b32 s42, 1774080
 buffer_load_dwordx4 v232, s[16:19], s42 offen lds
 s_add_u32 m0, s48, 143360
 s_nop 0
 buffer_load_dwordx4 v233, s[16:19], s42 offen lds
 s_add_u32 m0, s48, 144384
 s_nop 0
 buffer_load_dwordx4 v234, s[16:19], s42 offen lds
 s_add_u32 m0, s48, 145408
 s_nop 0
 buffer_load_dwordx4 v235, s[16:19], s42 offen lds
 s_add_u32 m0, s49, 158720
 s_nop 0
 buffer_load_dwordx4 v236, s[16:19], s42 offen lds
 s_branch L_fz_p4pla
L_fz_p4pl8a:
 s_add_u32 m0, s48, 87040
 s_mov_b32 s42, 4608
 buffer_load_dwordx4 v232, s[16:19], s42 offen lds
 s_add_u32 m0, s48, 88064
 s_nop 0
 buffer_load_dwordx4 v233, s[16:19], s42 offen lds
 s_add_u32 m0, s48, 89088
 s_nop 0
 buffer_load_dwordx4 v234, s[16:19], s42 offen lds
 s_add_u32 m0, s48, 90112
 s_nop 0
 buffer_load_dwordx4 v235, s[16:19], s42 offen lds
 s_add_u32 m0, s48, 105472
 s_mov_b32 s42, 594432
 buffer_load_dwordx4 v232, s[16:19], s42 offen lds
 s_add_u32 m0, s48, 106496
 s_nop 0
 buffer_load_dwordx4 v233, s[16:19], s42 offen lds
 s_add_u32 m0, s48, 107520
 s_nop 0
 buffer_load_dwordx4 v234, s[16:19], s42 offen lds
 s_add_u32 m0, s48, 108544
 s_nop 0
 buffer_load_dwordx4 v235, s[16:19], s42 offen lds
 s_add_u32 m0, s48, 123904
 s_mov_b32 s42, 1184256
 buffer_load_dwordx4 v232, s[16:19], s42 offen lds
 s_add_u32 m0, s48, 124928
 s_nop 0
 buffer_load_dwordx4 v233, s[16:19], s42 offen lds
 s_add_u32 m0, s48, 125952
 s_nop 0
 buffer_load_dwordx4 v234, s[16:19], s42 offen lds
 s_add_u32 m0, s48, 126976
 s_nop 0
 buffer_load_dwordx4 v235, s[16:19], s42 offen lds
 s_add_u32 m0, s48, 142336
 s_mov_b32 s42, 1774080
 buffer_load_dwordx4 v232, s[16:19], s42 offen lds
 s_add_u32 m0, s48, 143360
 s_nop 0
 buffer_load_dwordx4 v233, s[16:19], s42 offen lds
 s_add_u32 m0, s48, 144384
 s_nop 0
 buffer_load_dwordx4 v234, s[16:19], s42 offen lds
 s_add_u32 m0, s48, 145408
 s_nop 0
 buffer_load_dwordx4 v235, s[16:19], s42 offen lds
L_fz_p4pla:
 s_lshl_b32 s36, s33, 1
 s_add_u32 s36, s36, s44
 s_lshl_b32 s36, s36, 7
 v_and_b32 v8, 15, v0
 v_lshlrev_b32 v8, 1, v8
 s_add_u32 s20, s76, s36
 s_addc_u32 s21, s77, 0
 s_mov_b32 s22, 128
 s_mov_b32 s23, 0x20000
 buffer_load_short_d16_hi v248, v8, s[20:23], 0 offen offset:0
 buffer_load_short_d16_hi v249, v8, s[20:23], 0 offen offset:32
 buffer_load_short_d16_hi v250, v8, s[20:23], 0 offen offset:64
 buffer_load_short_d16_hi v251, v8, s[20:23], 0 offen offset:96
 s_cmp_lg_u32 s3, 7
 s_cbranch_scc1 L_fz_p4cp
 s_getpc_b64 s[56:57]
L_fz_cp3:
 s_add_u32 s56, s56, L_fz_p3end-L_fz_cp3
 s_addc_u32 s57, s57, 0
 s_lshr_b32 s58, s2, 3
 s_lshl_b32 s58, s58, 10
 v_lshlrev_b32 v8, 4, v0
 s_add_u32 s59, s58, 0
 v_add_u32 v8, s59, v8
 v_min_u32 v8, L_fz_p5pub-L_fz_p3end-16, v8
 global_load_dwordx4 v[240:243], v8, s[56:57]
 v_lshlrev_b32 v8, 4, v0
 s_add_u32 s59, s58, 32768
 v_add_u32 v8, s59, v8
 v_min_u32 v8, L_fz_p5pub-L_fz_p3end-16, v8
 global_load_dwordx4 v[240:243], v8, s[56:57]
 v_lshlrev_b32 v8, 4, v0
 s_add_u32 s59, s58, 65536
 v_add_u32 v8, s59, v8
 v_min_u32 v8, L_fz_p5pub-L_fz_p3end-16, v8
 global_load_dwordx4 v[240:243], v8, s[56:57]
L_fz_p4cp:
L_fz_p3nh:
 s_mul_i32 s55, s62, 9
 s_add_u32 s55, s55, s63
 s_and_b32 s35, s2, 7
 s_lshr_b32 s36, s2, 3
 s_and_b32 s33, s35, 1
 s_lshl_b32 s33, s33, 3
 s_and_b32 s37, s36, 7
 s_add_u32 s33, s33, s37
 s_lshr_b32 s34, s35, 1
 s_lshl_b32 s34, s34, 2
 s_lshr_b32 s37, s36, 3
 s_add_u32 s34, s34, s37
 s_mul_i32 s38, s34, 9
 s_lshr_b32 s38, s38, 1
 s_and_b32 s39, s34, 1
 s_and_b32 s32, s3, 3
 s_lshr_b32 s44, s32, 1
 s_and_b32 s45, s32, 1
 v_lshlrev_b32 v1, 4, v0
 s_cmp_ge_u32 s3, 4
 s_cbranch_scc1 L_fz_p4pre1
 s_lshl_b32 s36, s44, 13
 v_add_u32 v2, s36, v1
 v_lshrrev_b32 v3, 5, v0
 v_bfe_u32 v4, v0, 2, 2
 v_lshlrev_b32 v3, 4, v3
 v_lshl_add_u32 v3, v4, 1, v3
 v_bfe_u32 v4, v0, 4, 1
 v_add_u32 v3, v3, v4
 v_mul_u32_u24 v3, 288, v3
 v_and_b32 v4, 3, v0
 v_lshl_add_u32 v4, v4, 3, v3
 s_lshl_b32 s36, s45, 2
 s_add_u32 s36, s36, s39
 s_lshl_b32 s36, s36, 5
 s_add_u32 s36, s36, 16384
 v_add_u32 v3, s36, v4
 s_cmp_eq_u32 s39, 0
 s_cselect_b32 s36, 256, 0
 s_add_u32 s36, s36, 16384
 v_add_u32 v4, s36, v4
 v_mov_b32 v8, v2
 v_add_u32 v9, 70656, v3
 v_add_u32 v10, 70656, v4
 v_mov_b32 v128, 0
 v_mov_b32 v129, 0
 v_mov_b32 v130, 0
 v_mov_b32 v131, 0
 v_mov_b32 v132, 0
 v_mov_b32 v133, 0
 v_mov_b32 v134, 0
 v_mov_b32 v135, 0
 v_mov_b32 v136, 0
 v_mov_b32 v137, 0
 v_mov_b32 v138, 0
 v_mov_b32 v139, 0
 v_mov_b32 v140, 0
 v_mov_b32 v141, 0
 v_mov_b32 v142, 0
 v_mov_b32 v143, 0
 s_branch L_fz_p4prf1
L_fz_p4pre1:
 s_lshl_b32 s36, s33, 3
 s_mul_i32 s36, s36, 18432
 s_add_u32 s36, s36, 11534336
 s_mul_i32 s37, s32, 36864
 v_add_u32 v16, s37, v1
 v_add_u32 v17, 16384, v16
 s_add_u32 s12, s8, s36
 s_addc_u32 s13, s9, 0
 s_mov_b32 s14, 147456
 s_mov_b32 s15, 0x20000
 s_lshl_b32 s36, s44, 13
 v_add_u32 v2, s36, v1
 v_lshrrev_b32 v3, 5, v0
 v_bfe_u32 v4, v0, 2, 2
 v_lshlrev_b32 v3, 4, v3
 v_lshl_add_u32 v3, v4, 1, v3
 v_bfe_u32 v4, v0, 4, 1
 v_add_u32 v3, v3, v4
 v_mul_u32_u24 v3, 288, v3
 v_and_b32 v4, 3, v0
 v_lshl_add_u32 v4, v4, 3, v3
 s_lshl_b32 s36, s45, 2
 s_add_u32 s36, s36, s39
 s_lshl_b32 s36, s36, 5
 s_add_u32 s36, s36, 16384
 v_add_u32 v3, s36, v4
 s_cmp_eq_u32 s39, 0
 s_cselect_b32 s36, 256, 0
 s_add_u32 s36, s36, 16384
 v_add_u32 v4, s36, v4
 v_add_u32 v8, 16384, v2
 v_add_u32 v9, 89088, v3
 v_add_u32 v10, 89088, v4
 v_mov_b32 v128, 0
 v_mov_b32 v129, 0
 v_mov_b32 v130, 0
 v_mov_b32 v131, 0
 v_mov_b32 v132, 0
 v_mov_b32 v133, 0
 v_mov_b32 v134, 0
 v_mov_b32 v135, 0
 v_mov_b32 v136, 0
 v_mov_b32 v137, 0
 v_mov_b32 v138, 0
 v_mov_b32 v139, 0
 v_mov_b32 v140, 0
 v_mov_b32 v141, 0
 v_mov_b32 v142, 0
 v_mov_b32 v143, 0
 s_lshl_b32 s36, s33, 7
 s_mul_i32 s37, s36, 3277
 s_lshr_b32 s37, s37, 18
 s_add_u32 s36, s36, 127
 s_mul_i32 s36, s36, 3277
 s_lshr_b32 s36, s36, 18
 s_sub_u32 s36, s36, s37
 s_add_u32 s36, s36, 1
 s_mul_i32 s52, s36, 9
 s_mul_i32 s53, s37, 9
L_fz_p4prf1:
 s_cmp_ge_u32 s3, 5
 s_cbranch_scc1 L_fz_pub3n
 s_waitcnt vmcnt(0)
L_fz_pub3n:
 s_barrier
 s_cmp_lg_u32 s3, 7
 s_cbranch_scc1 L_fz_pub3
 s_add_u32 s56, s8, 16351232
 s_addc_u32 s57, s9, 0
 s_mov_b32 s58, 32768
 s_mov_b32 s59, 0x20000
 s_lshl_b32 s60, s55, 7
 v_mov_b32 v254, 0
 v_mov_b32 v255, s100
 s_mov_b64 exec, 1
 buffer_store_dword v255, v254, s[56:59], s60 offen sc1
 s_mov_b64 exec, -1
L_fz_pub3:
 s_cmp_lg_u32 s3, 4
 s_cbranch_scc1 L_fz_p3end
 s_and_b32 s35, s2, 7
 s_lshr_b32 s36, s2, 3
 s_and_b32 s33, s35, 1
 s_lshl_b32 s33, s33, 3
 s_and_b32 s37, s36, 7
 s_add_u32 s33, s33, s37
 s_lshr_b32 s34, s35, 1
 s_lshl_b32 s34, s34, 2
 s_lshr_b32 s37, s36, 3
 s_add_u32 s34, s34, s37
 s_mul_i32 s38, s34, 9
 s_lshr_b32 s38, s38, 1
 s_and_b32 s39, s34, 1
 s_and_b32 s32, s3, 3
 s_lshr_b32 s44, s32, 1
 s_and_b32 s45, s32, 1
 s_mul_i32 s36, s34, 288
 s_sub_u32 s37, 5308416, s36
 s_add_u32 s16, s72, s36
 s_addc_u32 s17, s73, 0
 s_mov_b32 s18, s37
 s_mov_b32 s19, 0x20000
 s_lshl_b32 s48, s32, 12
 s_lshl_b32 s49, s44, 10
 v_lshlrev_b32 v1, 4, v0
 s_movk_i32 s37, 9216
 s_lshl_b32 s36, s32, 8
 s_add_u32 s36, s36, 0
 v_add_u32 v14, s36, v0
 v_mul_u32_u24 v15, 3641, v14
 v_lshrrev_b32 v15, 16, v15
 v_mul_u32_u24 v18, 18, v15
 v_sub_u32 v14, v14, v18
 v_and_b32 v18, 0x30, v15
 v_bfe_u32 v19, v15, 1, 3
 v_and_b32 v15, 1, v15
 v_lshl_or_b32 v18, v15, 3, v18
 v_or_b32 v18, v18, v19
 v_lshlrev_b32 v14, 4, v14
 v_mad_u32_u24 v232, v18, s37, v14
 s_lshl_b32 s36, s32, 8
 s_add_u32 s36, s36, 64
 v_add_u32 v14, s36, v0
 v_mul_u32_u24 v15, 3641, v14
 v_lshrrev_b32 v15, 16, v15
 v_mul_u32_u24 v18, 18, v15
 v_sub_u32 v14, v14, v18
 v_and_b32 v18, 0x30, v15
 v_bfe_u32 v19, v15, 1, 3
 v_and_b32 v15, 1, v15
 v_lshl_or_b32 v18, v15, 3, v18
 v_or_b32 v18, v18, v19
 v_lshlrev_b32 v14, 4, v14
 v_mad_u32_u24 v233, v18, s37, v14
 s_lshl_b32 s36, s32, 8
 s_add_u32 s36, s36, 128
 v_add_u32 v14, s36, v0
 v_mul_u32_u24 v15, 3641, v14
 v_lshrrev_b32 v15, 16, v15
 v_mul_u32_u24 v18, 18, v15
 v_sub_u32 v14, v14, v18
 v_and_b32 v18, 0x30, v15
 v_bfe_u32 v19, v15, 1, 3
 v_and_b32 v15, 1, v15
 v_lshl_or_b32 v18, v15, 3, v18
 v_or_b32 v18, v18, v19
 v_lshlrev_b32 v14, 4, v14
 v_mad_u32_u24 v234, v18, s37, v14
 s_lshl_b32 s36, s32, 8
 s_add_u32 s36, s36, 192
 v_add_u32 v14, s36, v0
 v_mul_u32_u24 v15, 3641, v14
 v_lshrrev_b32 v15, 16, v15
 v_mul_u32_u24 v18, 18, v15
 v_sub_u32 v14, v14, v18
 v_and_b32 v18, 0x30, v15
 v_bfe_u32 v19, v15, 1, 3
 v_and_b32 v15, 1, v15
 v_lshl_or_b32 v18, v15, 3, v18
 v_or_b32 v18, v18, v19
 v_lshlrev_b32 v14, 4, v14
 v_mad_u32_u24 v235, v18, s37, v14
 s_lshl_b32 s36, s44, 6
 s_add_u32 s36, s36, 1024
 v_add_u32 v14, s36, v0
 v_mul_u32_u24 v15, 3641, v14
 v_lshrrev_b32 v15, 16, v15
 v_mul_u32_u24 v18, 18, v15
 v_sub_u32 v14, v14, v18
 v_and_b32 v18, 0x30, v15
 v_bfe_u32 v19, v15, 1, 3
 v_and_b32 v15, 1, v15
 v_lshl_or_b32 v18, v15, 3, v18
 v_or_b32 v18, v18, v19
 v_lshlrev_b32 v14, 4, v14
 v_mad_u32_u24 v236, v18, s37, v14
 s_cmp_eq_u32 s45, 0
 s_cbranch_scc0 L_fz_p4pl8c
 s_add_u32 m0, s48, 87040
 s_mov_b32 s42, 4608
 buffer_load_dwordx4 v232, s[16:19], s42 offen lds
 s_add_u32 m0, s48, 88064
 s_nop 0
 buffer_load_dwordx4 v233, s[16:19], s42 offen lds
 s_add_u32 m0, s48, 89088
 s_nop 0
 buffer_load_dwordx4 v234, s[16:19], s42 offen lds
 s_add_u32 m0, s48, 90112
 s_nop 0
 buffer_load_dwordx4 v235, s[16:19], s42 offen lds
 s_add_u32 m0, s49, 103424
 s_nop 0
 buffer_load_dwordx4 v236, s[16:19], s42 offen lds
 s_add_u32 m0, s48, 105472
 s_mov_b32 s42, 594432
 buffer_load_dwordx4 v232, s[16:19], s42 offen lds
 s_add_u32 m0, s48, 106496
 s_nop 0
 buffer_load_dwordx4 v233, s[16:19], s42 offen lds
 s_add_u32 m0, s48, 107520
 s_nop 0
 buffer_load_dwordx4 v234, s[16:19], s42 offen lds
 s_add_u32 m0, s48, 108544
 s_nop 0
 buffer_load_dwordx4 v235, s[16:19], s42 offen lds
 s_add_u32 m0, s49, 121856
 s_nop 0
 buffer_load_dwordx4 v236, s[16:19], s42 offen lds
 s_add_u32 m0, s48, 123904
 s_mov_b32 s42, 1184256
 buffer_load_dwordx4 v232, s[16:19], s42 offen lds
 s_add_u32 m0, s48, 124928
 s_nop 0
 buffer_load_dwordx4 v233, s[16:19], s42 offen lds
 s_add_u32 m0, s48, 125952
 s_nop 0
 buffer_load_dwordx4 v234, s[16:19], s42 offen lds
 s_add_u32 m0, s48, 126976
 s_nop 0
 buffer_load_dwordx4 v235, s[16:19], s42 offen lds
 s_add_u32 m0, s49, 140288
 s_nop 0
 buffer_load_dwordx4 v236, s[16:19], s42 offen lds
 s_add_u32 m0, s48, 142336
 s_mov_b32 s42, 1774080
 buffer_load_dwordx4 v232, s[16:19], s42 offen lds
 s_add_u32 m0, s48, 143360
 s_nop 0
 buffer_load_dwordx4 v233, s[16:19], s42 offen lds
 s_add_u32 m0, s48, 144384
 s_nop 0
 buffer_load_dwordx4 v234, s[16:19], s42 offen lds
 s_add_u32 m0, s48, 145408
 s_nop 0
 buffer_load_dwordx4 v235, s[16:19], s42 offen lds
 s_add_u32 m0, s49, 158720
 s_nop 0
 buffer_load_dwordx4 v236, s[16:19], s42 offen lds
 s_branch L_fz_p4plc
L_fz_p4pl8c:
 s_add_u32 m0, s48, 87040
 s_mov_b32 s42, 4608
 buffer_load_dwordx4 v232, s[16:19], s42 offen lds
 s_add_u32 m0, s48, 88064
 s_nop 0
 buffer_load_dwordx4 v233, s[16:19], s42 offen lds
 s_add_u32 m0, s48, 89088
 s_nop 0
 buffer_load_dwordx4 v234, s[16:19], s42 offen lds
 s_add_u32 m0, s48, 90112
 s_nop 0
 buffer_load_dwordx4 v235, s[16:19], s42 offen lds
 s_add_u32 m0, s48, 105472
 s_mov_b32 s42, 594432
 buffer_load_dwordx4 v232, s[16:19], s42 offen lds
 s_add_u32 m0, s48, 106496
 s_nop 0
 buffer_load_dwordx4 v233, s[16:19], s42 offen lds
 s_add_u32 m0, s48, 107520
 s_nop 0
 buffer_load_dwordx4 v234, s[16:19], s42 offen lds
 s_add_u32 m0, s48, 108544
 s_nop 0
 buffer_load_dwordx4 v235, s[16:19], s42 offen lds
 s_add_u32 m0, s48, 123904
 s_mov_b32 s42, 1184256
 buffer_load_dwordx4 v232, s[16:19], s42 offen lds
 s_add_u32 m0, s48, 124928
 s_nop 0
 buffer_load_dwordx4 v233, s[16:19], s42 offen lds
 s_add_u32 m0, s48, 125952
 s_nop 0
 buffer_load_dwordx4 v234, s[16:19], s42 offen lds
 s_add_u32 m0, s48, 126976
 s_nop 0
 buffer_load_dwordx4 v235, s[16:19], s42 offen lds
 s_add_u32 m0, s48, 142336
 s_mov_b32 s42, 1774080
 buffer_load_dwordx4 v232, s[16:19], s42 offen lds
 s_add_u32 m0, s48, 143360
 s_nop 0
 buffer_load_dwordx4 v233, s[16:19], s42 offen lds
 s_add_u32 m0, s48, 144384
 s_nop 0
 buffer_load_dwordx4 v234, s[16:19], s42 offen lds
 s_add_u32 m0, s48, 145408
 s_nop 0
 buffer_load_dwordx4 v235, s[16:19], s42 offen lds
L_fz_p4plc:
 s_branch L_fz_p3end
L_fz_p3idle:
 s_mov_b32 s20, s74
 s_mov_b32 s21, s75
 s_mov_b32 s22, 8388608
 s_mov_b32 s23, 0x20000
 s_lshr_b32 s36, s2, 3
 s_and_b32 s37, s2, 7
 s_sub_u32 s35, s36, 30
 s_lshl_b32 s35, s35, 3
 s_add_u32 s35, s35, s37
 s_sub_u32 s37, s36, 8
 s_cmp_ge_u32 s36, 30
 s_cselect_b32 s35, s35, s37
 s_lshl_b32 s35, s35, 3
 s_add_u32 s35, s35, s3
 s_mul_i32 s35, s35, 49152
 v_lshlrev_b32 v1, 4, v0
 buffer_load_dwordx4 v[144:147], v1, s[20:23], s35 offen offset:2048
 s_add_u32 s35, s35, 4096
 buffer_load_dwordx4 v[148:151], v1, s[20:23], s35 offen offset:2048
 s_add_u32 s35, s35, 4096
 buffer_load_dwordx4 v[152:155], v1, s[20:23], s35 offen offset:2048
 s_add_u32 s35, s35, 4096
 buffer_load_dwordx4 v[156:159], v1, s[20:23], s35 offen offset:2048
 s_add_u32 s35, s35, 4096
 buffer_load_dwordx4 v[160:163], v1, s[20:23], s35 offen offset:2048
 s_add_u32 s35, s35, 4096
 buffer_load_dwordx4 v[164:167], v1, s[20:23], s35 offen offset:2048
 s_add_u32 s35, s35, 4096
 buffer_load_dwordx4 v[168:171], v1, s[20:23], s35 offen offset:2048
 s_add_u32 s35, s35, 4096
 buffer_load_dwordx4 v[172:175], v1, s[20:23], s35 offen offset:2048
 s_add_u32 s35, s35, 4096
 buffer_load_dwordx4 v[176:179], v1, s[20:23], s35 offen offset:2048
 s_add_u32 s35, s35, 4096
 buffer_load_dwordx4 v[180:183], v1, s[20:23], s35 offen offset:2048
 s_add_u32 s35, s35, 4096
 buffer_load_dwordx4 v[184:187], v1, s[20:23], s35 offen offset:2048
 s_add_u32 s35, s35, 4096
 buffer_load_dwordx4 v[188:191], v1, s[20:23], s35 offen offset:2048
 s_add_u32 s35, s35, 4096
 s_cmp_ge_u32 s3, 4
 s_cbranch_scc0 L_fz_p3i2
 s_and_b32 s35, s2, 7
 s_lshr_b32 s36, s2, 3
 s_and_b32 s33, s35, 1
 s_lshl_b32 s33, s33, 3
 s_and_b32 s37, s36, 7
 s_add_u32 s33, s33, s37
 s_lshr_b32 s34, s35, 1
 s_lshl_b32 s34, s34, 2
 s_lshr_b32 s37, s36, 3
 s_add_u32 s34, s34, s37
 s_mul_i32 s38, s34, 9
 s_lshr_b32 s38, s38, 1
 s_and_b32 s39, s34, 1
 s_and_b32 s32, s3, 3
 s_lshr_b32 s44, s32, 1
 s_and_b32 s45, s32, 1
 s_mul_i32 s36, s34, 288
 s_sub_u32 s37, 5308416, s36
 s_add_u32 s16, s72, s36
 s_addc_u32 s17, s73, 0
 s_mov_b32 s18, s37
 s_mov_b32 s19, 0x20000
 s_lshl_b32 s48, s32, 12
 s_lshl_b32 s49, s44, 10
 v_lshlrev_b32 v1, 4, v0
 s_movk_i32 s37, 9216
 s_lshl_b32 s36, s32, 8
 s_add_u32 s36, s36, 0
 v_add_u32 v14, s36, v0
 v_mul_u32_u24 v15, 3641, v14
 v_lshrrev_b32 v15, 16, v15
 v_mul_u32_u24 v18, 18, v15
 v_sub_u32 v14, v14, v18
 v_and_b32 v18, 0x30, v15
 v_bfe_u32 v19, v15, 1, 3
 v_and_b32 v15, 1, v15
 v_lshl_or_b32 v18, v15, 3, v18
 v_or_b32 v18, v18, v19
 v_lshlrev_b32 v14, 4, v14
 v_mad_u32_u24 v232, v18, s37, v14
 s_lshl_b32 s36, s32, 8
 s_add_u32 s36, s36, 64
 v_add_u32 v14, s36, v0
 v_mul_u32_u24 v15, 3641, v14
 v_lshrrev_b32 v15, 16, v15
 v_mul_u32_u24 v18, 18, v15
 v_sub_u32 v14, v14, v18
 v_and_b32 v18, 0x30, v15
 v_bfe_u32 v19, v15, 1, 3
 v_and_b32 v15, 1, v15
 v_lshl_or_b32 v18, v15, 3, v18
 v_or_b32 v18, v18, v19
 v_lshlrev_b32 v14, 4, v14
 v_mad_u32_u24 v233, v18, s37, v14
 s_lshl_b32 s36, s32, 8
 s_add_u32 s36, s36, 128
 v_add_u32 v14, s36, v0
 v_mul_u32_u24 v15, 3641, v14
 v_lshrrev_b32 v15, 16, v15
 v_mul_u32_u24 v18, 18, v15
 v_sub_u32 v14, v14, v18
 v_and_b32 v18, 0x30, v15
 v_bfe_u32 v19, v15, 1, 3
 v_and_b32 v15, 1, v15
 v_lshl_or_b32 v18, v15, 3, v18
 v_or_b32 v18, v18, v19
 v_lshlrev_b32 v14, 4, v14
 v_mad_u32_u24 v234, v18, s37, v14
 s_lshl_b32 s36, s32, 8
 s_add_u32 s36, s36, 192
 v_add_u32 v14, s36, v0
 v_mul_u32_u24 v15, 3641, v14
 v_lshrrev_b32 v15, 16, v15
 v_mul_u32_u24 v18, 18, v15
 v_sub_u32 v14, v14, v18
 v_and_b32 v18, 0x30, v15
 v_bfe_u32 v19, v15, 1, 3
 v_and_b32 v15, 1, v15
 v_lshl_or_b32 v18, v15, 3, v18
 v_or_b32 v18, v18, v19
 v_lshlrev_b32 v14, 4, v14
 v_mad_u32_u24 v235, v18, s37, v14
 s_lshl_b32 s36, s44, 6
 s_add_u32 s36, s36, 1024
 v_add_u32 v14, s36, v0
 v_mul_u32_u24 v15, 3641, v14
 v_lshrrev_b32 v15, 16, v15
 v_mul_u32_u24 v18, 18, v15
 v_sub_u32 v14, v14, v18
 v_and_b32 v18, 0x30, v15
 v_bfe_u32 v19, v15, 1, 3
 v_and_b32 v15, 1, v15
 v_lshl_or_b32 v18, v15, 3, v18
 v_or_b32 v18, v18, v19
 v_lshlrev_b32 v14, 4, v14
 v_mad_u32_u24 v236, v18, s37, v14
 s_movk_i32 s36, 224
 s_add_u32 s56, s8, 16285696
 s_addc_u32 s57, s9, 0
 s_mov_b32 s58, 32768
 s_mov_b32 s59, 0x20000
 s_sub_u32 s60, 32, 1
 v_min_u32 v8, s60, v0
 v_add_lshl_u32 v8, v8, s36, 7
 s_mov_b32 s61, 40000
L_fz_wf1csb:
 buffer_load_dword v9, v8, s[56:59], 0 offen sc1
 s_waitcnt vmcnt(0)
 v_cmp_ne_u32 vcc, s100, v9
 s_sub_u32 s61, s61, 1
 s_cbranch_vccz L_fz_wd1csb
 s_cmp_lg_u32 s61, 0
 s_cbranch_scc1 L_fz_wf1csb
L_fz_wd1csb:
 s_cmp_eq_u32 s45, 0
 s_cbranch_scc0 L_fz_p4pl8b
 s_add_u32 m0, s48, 87040
 s_mov_b32 s42, 4608
 buffer_load_dwordx4 v232, s[16:19], s42 offen lds
 s_add_u32 m0, s48, 88064
 s_nop 0
 buffer_load_dwordx4 v233, s[16:19], s42 offen lds
 s_add_u32 m0, s48, 89088
 s_nop 0
 buffer_load_dwordx4 v234, s[16:19], s42 offen lds
 s_add_u32 m0, s48, 90112
 s_nop 0
 buffer_load_dwordx4 v235, s[16:19], s42 offen lds
 s_add_u32 m0, s49, 103424
 s_nop 0
 buffer_load_dwordx4 v236, s[16:19], s42 offen lds
 s_add_u32 m0, s48, 105472
 s_mov_b32 s42, 594432
 buffer_load_dwordx4 v232, s[16:19], s42 offen lds
 s_add_u32 m0, s48, 106496
 s_nop 0
 buffer_load_dwordx4 v233, s[16:19], s42 offen lds
 s_add_u32 m0, s48, 107520
 s_nop 0
 buffer_load_dwordx4 v234, s[16:19], s42 offen lds
 s_add_u32 m0, s48, 108544
 s_nop 0
 buffer_load_dwordx4 v235, s[16:19], s42 offen lds
 s_add_u32 m0, s49, 121856
 s_nop 0
 buffer_load_dwordx4 v236, s[16:19], s42 offen lds
 s_add_u32 m0, s48, 123904
 s_mov_b32 s42, 1184256
 buffer_load_dwordx4 v232, s[16:19], s42 offen lds
 s_add_u32 m0, s48, 124928
 s_nop 0
 buffer_load_dwordx4 v233, s[16:19], s42 offen lds
 s_add_u32 m0, s48, 125952
 s_nop 0
 buffer_load_dwordx4 v234, s[16:19], s42 offen lds
 s_add_u32 m0, s48, 126976
 s_nop 0
 buffer_load_dwordx4 v235, s[16:19], s42 offen lds
 s_add_u32 m0, s49, 140288
 s_nop 0
 buffer_load_dwordx4 v236, s[16:19], s42 offen lds
 s_add_u32 m0, s48, 142336
 s_mov_b32 s42, 1774080
 buffer_load_dwordx4 v232, s[16:19], s42 offen lds
 s_add_u32 m0, s48, 143360
 s_nop 0
 buffer_load_dwordx4 v233, s[16:19], s42 offen lds
 s_add_u32 m0, s48, 144384
 s_nop 0
 buffer_load_dwordx4 v234, s[16:19], s42 offen lds
 s_add_u32 m0, s48, 145408
 s_nop 0
 buffer_load_dwordx4 v235, s[16:19], s42 offen lds
 s_add_u32 m0, s49, 158720
 s_nop 0
 buffer_load_dwordx4 v236, s[16:19], s42 offen lds
 s_branch L_fz_p4plb
L_fz_p4pl8b:
 s_add_u32 m0, s48, 87040
 s_mov_b32 s42, 4608
 buffer_load_dwordx4 v232, s[16:19], s42 offen lds
 s_add_u32 m0, s48, 88064
 s_nop 0
 buffer_load_dwordx4 v233, s[16:19], s42 offen lds
 s_add_u32 m0, s48, 89088
 s_nop 0
 buffer_load_dwordx4 v234, s[16:19], s42 offen lds
 s_add_u32 m0, s48, 90112
 s_nop 0
 buffer_load_dwordx4 v235, s[16:19], s42 offen lds
 s_add_u32 m0, s48, 105472
 s_mov_b32 s42, 594432
 buffer_load_dwordx4 v232, s[16:19], s42 offen lds
 s_add_u32 m0, s48, 106496
 s_nop 0
 buffer_load_dwordx4 v233, s[16:19], s42 offen lds
 s_add_u32 m0, s48, 107520
 s_nop 0
 buffer_load_dwordx4 v234, s[16:19], s42 offen lds
 s_add_u32 m0, s48, 108544
 s_nop 0
 buffer_load_dwordx4 v235, s[16:19], s42 offen lds
 s_add_u32 m0, s48, 123904
 s_mov_b32 s42, 1184256
 buffer_load_dwordx4 v232, s[16:19], s42 offen lds
 s_add_u32 m0, s48, 124928
 s_nop 0
 buffer_load_dwordx4 v233, s[16:19], s42 offen lds
 s_add_u32 m0, s48, 125952
 s_nop 0
 buffer_load_dwordx4 v234, s[16:19], s42 offen lds
 s_add_u32 m0, s48, 126976
 s_nop 0
 buffer_load_dwordx4 v235, s[16:19], s42 offen lds
 s_add_u32 m0, s48, 142336
 s_mov_b32 s42, 1774080
 buffer_load_dwordx4 v232, s[16:19], s42 offen lds
 s_add_u32 m0, s48, 143360
 s_nop 0
 buffer_load_dwordx4 v233, s[16:19], s42 offen lds
 s_add_u32 m0, s48, 144384
 s_nop 0
 buffer_load_dwordx4 v234, s[16:19], s42 offen lds
 s_add_u32 m0, s48, 145408
 s_nop 0
 buffer_load_dwordx4 v235, s[16:19], s42 offen lds
L_fz_p4plb:
 s_lshl_b32 s36, s33, 1
 s_add_u32 s36, s36, s44
 s_lshl_b32 s36, s36, 7
 v_and_b32 v8, 15, v0
 v_lshlrev_b32 v8, 1, v8
 s_add_u32 s20, s76, s36
 s_addc_u32 s21, s77, 0
 s_mov_b32 s22, 128
 s_mov_b32 s23, 0x20000
 buffer_load_short_d16_hi v248, v8, s[20:23], 0 offen offset:0
 buffer_load_short_d16_hi v249, v8, s[20:23], 0 offen offset:32
 buffer_load_short_d16_hi v250, v8, s[20:23], 0 offen offset:64
 buffer_load_short_d16_hi v251, v8, s[20:23], 0 offen offset:96
L_fz_p3i2:
 s_waitcnt vmcnt(0)
 s_and_b32 s35, s2, 7
 s_lshr_b32 s36, s2, 3
 s_and_b32 s33, s35, 1
 s_lshl_b32 s33, s33, 3
 s_and_b32 s37, s36, 7
 s_add_u32 s33, s33, s37
 s_lshr_b32 s34, s35, 1
 s_lshl_b32 s34, s34, 2
 s_lshr_b32 s37, s36, 3
 s_add_u32 s34, s34, s37
 s_mul_i32 s38, s34, 9
 s_lshr_b32 s38, s38, 1
 s_and_b32 s39, s34, 1
 s_and_b32 s32, s3, 3
 s_lshr_b32 s44, s32, 1
 s_and_b32 s45, s32, 1
 v_lshlrev_b32 v1, 4, v0
 s_cmp_ge_u32 s3, 4
 s_cbranch_scc1 L_fz_p4pre2
 s_lshl_b32 s36, s44, 13
 v_add_u32 v2, s36, v1
 v_lshrrev_b32 v3, 5, v0
 v_bfe_u32 v4, v0, 2, 2
 v_lshlrev_b32 v3, 4, v3
 v_lshl_add_u32 v3, v4, 1, v3
 v_bfe_u32 v4, v0, 4, 1
 v_add_u32 v3, v3, v4
 v_mul_u32_u24 v3, 288, v3
 v_and_b32 v4, 3, v0
 v_lshl_add_u32 v4, v4, 3, v3
 s_lshl_b32 s36, s45, 2
 s_add_u32 s36, s36, s39
 s_lshl_b32 s36, s36, 5
 s_add_u32 s36, s36, 16384
 v_add_u32 v3, s36, v4
 s_cmp_eq_u32 s39, 0
 s_cselect_b32 s36, 256, 0
 s_add_u32 s36, s36, 16384
 v_add_u32 v4, s36, v4
 v_mov_b32 v8, v2
 v_add_u32 v9, 70656, v3
 v_add_u32 v10, 70656, v4
 v_mov_b32 v128, 0
 v_mov_b32 v129, 0
 v_mov_b32 v130, 0
 v_mov_b32 v131, 0
 v_mov_b32 v132, 0
 v_mov_b32 v133, 0
 v_mov_b32 v134, 0
 v_mov_b32 v135, 0
 v_mov_b32 v136, 0
 v_mov_b32 v137, 0
 v_mov_b32 v138, 0
 v_mov_b32 v139, 0
 v_mov_b32 v140, 0
 v_mov_b32 v141, 0
 v_mov_b32 v142, 0
 v_mov_b32 v143, 0
 s_branch L_fz_p4prf2
L_fz_p4pre2:
 s_lshl_b32 s36, s33, 3
 s_mul_i32 s36, s36, 18432
 s_add_u32 s36, s36, 11534336
 s_mul_i32 s37, s32, 36864
 v_add_u32 v16, s37, v1
 v_add_u32 v17, 16384, v16
 s_add_u32 s12, s8, s36
 s_addc_u32 s13, s9, 0
 s_mov_b32 s14, 147456
 s_mov_b32 s15, 0x20000
 s_lshl_b32 s36, s44, 13
 v_add_u32 v2, s36, v1
 v_lshrrev_b32 v3, 5, v0
 v_bfe_u32 v4, v0, 2, 2
 v_lshlrev_b32 v3, 4, v3
 v_lshl_add_u32 v3, v4, 1, v3
 v_bfe_u32 v4, v0, 4, 1
 v_add_u32 v3, v3, v4
 v_mul_u32_u24 v3, 288, v3
 v_and_b32 v4, 3, v0
 v_lshl_add_u32 v4, v4, 3, v3
 s_lshl_b32 s36, s45, 2
 s_add_u32 s36, s36, s39
 s_lshl_b32 s36, s36, 5
 s_add_u32 s36, s36, 16384
 v_add_u32 v3, s36, v4
 s_cmp_eq_u32 s39, 0
 s_cselect_b32 s36, 256, 0
 s_add_u32 s36, s36, 16384
 v_add_u32 v4, s36, v4
 v_add_u32 v8, 16384, v2
 v_add_u32 v9, 89088, v3
 v_add_u32 v10, 89088, v4
 v_mov_b32 v128, 0
 v_mov_b32 v129, 0
 v_mov_b32 v130, 0
 v_mov_b32 v131, 0
 v_mov_b32 v132, 0
 v_mov_b32 v133, 0
 v_mov_b32 v134, 0
 v_mov_b32 v135, 0
 v_mov_b32 v136, 0
 v_mov_b32 v137, 0
 v_mov_b32 v138, 0
 v_mov_b32 v139, 0
 v_mov_b32 v140, 0
 v_mov_b32 v141, 0
 v_mov_b32 v142, 0
 v_mov_b32 v143, 0
 s_lshl_b32 s36, s33, 7
 s_mul_i32 s37, s36, 3277
 s_lshr_b32 s37, s37, 18
 s_add_u32 s36, s36, 127
 s_mul_i32 s36, s36, 3277
 s_lshr_b32 s36, s36, 18
 s_sub_u32 s36, s36, s37
 s_add_u32 s36, s36, 1
 s_mul_i32 s52, s36, 9
 s_mul_i32 s53, s37, 9
L_fz_p4prf2:
L_fz_p3end:
 s_cmp_ge_u32 s3, 4
 s_cbranch_scc1 L_fz_p4g1
 v_mov_b32 v18, -1
 v_mov_b32 v19, -1
 s_lshl_b32 s36, s44, 9
 s_add_u32 s36, s36, 77824
 v_lshl_add_u32 v27, v0, 3, s36
 ds_write_b64 v27, v[18:19]
 ds_write_b64 v27, v[18:19] offset:2560
 v_mov_b32 v18, 0
 v_lshlrev_b32 v19, 2, v0
 v_add_u32 v19, 79872, v19
 ds_write_b32 v19, v18
 s_barrier
 s_mul_i32 s36, s34, 576
 s_add_u32 s36, s36, 14951424
 v_lshrrev_b32 v18, 4, v0
 v_lshlrev_b32 v18, 4, v18
 s_lshl_b32 s37, s45, 2
 s_add_u32 s37, s37, s39
 s_lshl_b32 s37, s37, 6
 s_cmp_eq_u32 s39, 0
 s_cselect_b32 s46, 512, 0
 s_add_u32 s24, s8, s36
 s_addc_u32 s25, s9, 0
 s_mov_b32 s26, 576
 s_mov_b32 s27, 0x20000
 buffer_load_dwordx4 v[44:47], v18, s[24:27], s37 offen offset:0 sc1
 buffer_load_dwordx4 v[48:51], v18, s[24:27], s37 offen offset:64 sc1
 buffer_load_dwordx4 v[52:55], v18, s[24:27], s37 offen offset:128 sc1
 buffer_load_dwordx4 v[56:59], v18, s[24:27], s37 offen offset:192 sc1
 buffer_load_dwordx4 v[60:63], v18, s[24:27], s46 offen sc1
 s_lshl_b32 s36, s33, 1
 s_add_u32 s36, s36, s44
 s_lshl_b32 s36, s36, 7
 v_and_b32 v18, 15, v0
 v_lshlrev_b32 v18, 1, v18
 s_add_u32 s24, s76, s36
 s_addc_u32 s25, s77, 0
 s_mov_b32 s26, 128
 s_mov_b32 s27, 0x20000
 buffer_load_short_d16_hi v252, v18, s[24:27], 0 offen offset:0
 buffer_load_short_d16_hi v253, v18, s[24:27], 0 offen offset:32
 buffer_load_short_d16_hi v254, v18, s[24:27], 0 offen offset:64
 buffer_load_short_d16_hi v255, v18, s[24:27], 0 offen offset:96
 s_cmp_eq_u32 s45, 0
 s_cbranch_scc0 L_fz_p4g0b
 s_waitcnt lgkmcnt(0)
 s_barrier
 ds_read_b128 v[144:147], v8 offset:0
 ds_read_b64_tr_b16 v[160:161], v9 offset:0
 ds_read_b64_tr_b16 v[162:163], v9 offset:2304
 ds_read_b128 v[148:151], v8 offset:2048
 ds_read_b128 v[152:155], v8 offset:4096
 ds_read_b128 v[156:159], v8 offset:6144
 ds_read_b64_tr_b16 v[164:165], v9 offset:32
 ds_read_b64_tr_b16 v[166:167], v9 offset:2336
 ds_read_b64_tr_b16 v[168:169], v9 offset:64
 ds_read_b64_tr_b16 v[170:171], v9 offset:2368
 ds_read_b64_tr_b16 v[172:173], v9 offset:96
 ds_read_b64_tr_b16 v[174:175], v9 offset:2400
 ds_read_b64_tr_b16 v[176:177], v10 offset:0
 ds_read_b64_tr_b16 v[178:179], v10 offset:2304
 s_waitcnt lgkmcnt(8)
 v_mfma_f32_16x16x32_bf16 v[64:67], v[160:163], v[144:147], 0
 v_mfma_f32_16x16x32_bf16 v[68:71], v[160:163], v[148:151], 0
 v_mfma_f32_16x16x32_bf16 v[72:75], v[160:163], v[152:155], 0
 v_mfma_f32_16x16x32_bf16 v[76:79], v[160:163], v[156:159], 0
 s_waitcnt lgkmcnt(0)
 v_mfma_f32_16x16x32_bf16 v[128:131], v[176:179], v[144:147], v[128:131]
 ds_read_b128 v[180:183], v8 offset:1024
 v_mfma_f32_16x16x32_bf16 v[132:135], v[176:179], v[148:151], v[132:135]
 ds_read_b64_tr_b16 v[196:197], v9 offset:9216
 v_mfma_f32_16x16x32_bf16 v[136:139], v[176:179], v[152:155], v[136:139]
 ds_read_b64_tr_b16 v[198:199], v9 offset:11520
 v_mfma_f32_16x16x32_bf16 v[140:143], v[176:179], v[156:159], v[140:143]
 ds_read_b128 v[184:187], v8 offset:3072
 v_mfma_f32_16x16x32_bf16 v[80:83], v[164:167], v[144:147], 0
 ds_read_b128 v[188:191], v8 offset:5120
 v_mfma_f32_16x16x32_bf16 v[84:87], v[164:167], v[148:151], 0
 ds_read_b128 v[192:195], v8 offset:7168
 v_mfma_f32_16x16x32_bf16 v[88:91], v[164:167], v[152:155], 0
 ds_read_b64_tr_b16 v[200:201], v9 offset:9248
 v_mfma_f32_16x16x32_bf16 v[92:95], v[164:167], v[156:159], 0
 ds_read_b64_tr_b16 v[202:203], v9 offset:11552
 v_mfma_f32_16x16x32_bf16 v[96:99], v[168:171], v[144:147], 0
 ds_read_b64_tr_b16 v[204:205], v9 offset:9280
 v_mfma_f32_16x16x32_bf16 v[100:103], v[168:171], v[148:151], 0
 ds_read_b64_tr_b16 v[206:207], v9 offset:11584
 v_mfma_f32_16x16x32_bf16 v[104:107], v[168:171], v[152:155], 0
 ds_read_b64_tr_b16 v[208:209], v9 offset:9312
 v_mfma_f32_16x16x32_bf16 v[108:111], v[168:171], v[156:159], 0
 ds_read_b64_tr_b16 v[210:211], v9 offset:11616
 v_mfma_f32_16x16x32_bf16 v[112:115], v[172:175], v[144:147], 0
 v_add_u32 v8, 16384, v2
 v_mfma_f32_16x16x32_bf16 v[116:119], v[172:175], v[148:151], 0
 v_add_u32 v9, 89088, v3
 v_mfma_f32_16x16x32_bf16 v[120:123], v[172:175], v[152:155], 0
 v_add_u32 v10, 89088, v4
 v_mfma_f32_16x16x32_bf16 v[124:127], v[172:175], v[156:159], 0
 s_waitcnt lgkmcnt(6)
 v_mfma_f32_16x16x32_bf16 v[64:67], v[196:199], v[180:183], v[64:67]
 v_mfma_f32_16x16x32_bf16 v[68:71], v[196:199], v[184:187], v[68:71]
 v_mfma_f32_16x16x32_bf16 v[72:75], v[196:199], v[188:191], v[72:75]
 v_mfma_f32_16x16x32_bf16 v[76:79], v[196:199], v[192:195], v[76:79]
 s_waitcnt lgkmcnt(0)
 s_barrier
 v_mfma_f32_16x16x32_bf16 v[80:83], v[200:203], v[180:183], v[80:83]
 ds_read_b128 v[144:147], v8 offset:0
 v_mfma_f32_16x16x32_bf16 v[84:87], v[200:203], v[184:187], v[84:87]
 ds_read_b64_tr_b16 v[160:161], v9 offset:0
 v_mfma_f32_16x16x32_bf16 v[88:91], v[200:203], v[188:191], v[88:91]
 ds_read_b64_tr_b16 v[162:163], v9 offset:2304
 v_mfma_f32_16x16x32_bf16 v[92:95], v[200:203], v[192:195], v[92:95]
 ds_read_b128 v[148:151], v8 offset:2048
 v_mfma_f32_16x16x32_bf16 v[96:99], v[204:207], v[180:183], v[96:99]
 ds_read_b128 v[152:155], v8 offset:4096
 v_mfma_f32_16x16x32_bf16 v[100:103], v[204:207], v[184:187], v[100:103]
 ds_read_b128 v[156:159], v8 offset:6144
 v_mfma_f32_16x16x32_bf16 v[104:107], v[204:207], v[188:191], v[104:107]
 ds_read_b64_tr_b16 v[164:165], v9 offset:32
 v_mfma_f32_16x16x32_bf16 v[108:111], v[204:207], v[192:195], v[108:111]
 ds_read_b64_tr_b16 v[166:167], v9 offset:2336
 v_mfma_f32_16x16x32_bf16 v[112:115], v[208:211], v[180:183], v[112:115]
 ds_read_b64_tr_b16 v[168:169], v9 offset:64
 v_mfma_f32_16x16x32_bf16 v[116:119], v[208:211], v[184:187], v[116:119]
 ds_read_b64_tr_b16 v[170:171], v9 offset:2368
 v_mfma_f32_16x16x32_bf16 v[120:123], v[208:211], v[188:191], v[120:123]
 ds_read_b64_tr_b16 v[172:173], v9 offset:96
 v_mfma_f32_16x16x32_bf16 v[124:127], v[208:211], v[192:195], v[124:127]
 ds_read_b64_tr_b16 v[174:175], v9 offset:2400
 ds_read_b64_tr_b16 v[176:177], v10 offset:0
 ds_read_b64_tr_b16 v[178:179], v10 offset:2304
 s_waitcnt lgkmcnt(8)
 v_mfma_f32_16x16x32_bf16 v[64:67], v[160:163], v[144:147], v[64:67]
 v_mfma_f32_16x16x32_bf16 v[68:71], v[160:163], v[148:151], v[68:71]
 v_mfma_f32_16x16x32_bf16 v[72:75], v[160:163], v[152:155], v[72:75]
 v_mfma_f32_16x16x32_bf16 v[76:79], v[160:163], v[156:159], v[76:79]
 s_waitcnt lgkmcnt(0)
 v_mfma_f32_16x16x32_bf16 v[128:131], v[176:179], v[144:147], v[128:131]
 ds_read_b128 v[180:183], v8 offset:1024
 v_mfma_f32_16x16x32_bf16 v[132:135], v[176:179], v[148:151], v[132:135]
 ds_read_b64_tr_b16 v[196:197], v9 offset:9216
 v_mfma_f32_16x16x32_bf16 v[136:139], v[176:179], v[152:155], v[136:139]
 ds_read_b64_tr_b16 v[198:199], v9 offset:11520
 v_mfma_f32_16x16x32_bf16 v[140:143], v[176:179], v[156:159], v[140:143]
 ds_read_b128 v[184:187], v8 offset:3072
 v_mfma_f32_16x16x32_bf16 v[80:83], v[164:167], v[144:147], v[80:83]
 ds_read_b128 v[188:191], v8 offset:5120
 v_mfma_f32_16x16x32_bf16 v[84:87], v[164:167], v[148:151], v[84:87]
 ds_read_b128 v[192:195], v8 offset:7168
 v_mfma_f32_16x16x32_bf16 v[88:91], v[164:167], v[152:155], v[88:91]
 ds_read_b64_tr_b16 v[200:201], v9 offset:9248
 v_mfma_f32_16x16x32_bf16 v[92:95], v[164:167], v[156:159], v[92:95]
 ds_read_b64_tr_b16 v[202:203], v9 offset:11552
 v_mfma_f32_16x16x32_bf16 v[96:99], v[168:171], v[144:147], v[96:99]
 ds_read_b64_tr_b16 v[204:205], v9 offset:9280
 v_mfma_f32_16x16x32_bf16 v[100:103], v[168:171], v[148:151], v[100:103]
 ds_read_b64_tr_b16 v[206:207], v9 offset:11584
 v_mfma_f32_16x16x32_bf16 v[104:107], v[168:171], v[152:155], v[104:107]
 ds_read_b64_tr_b16 v[208:209], v9 offset:9312
 v_mfma_f32_16x16x32_bf16 v[108:111], v[168:171], v[156:159], v[108:111]
 ds_read_b64_tr_b16 v[210:211], v9 offset:11616
 v_mfma_f32_16x16x32_bf16 v[112:115], v[172:175], v[144:147], v[112:115]
 v_add_u32 v8, 32768, v2
 v_mfma_f32_16x16x32_bf16 v[116:119], v[172:175], v[148:151], v[116:119]
 v_add_u32 v9, 107520, v3
 v_mfma_f32_16x16x32_bf16 v[120:123], v[172:175], v[152:155], v[120:123]
 v_add_u32 v10, 107520, v4
 v_mfma_f32_16x16x32_bf16 v[124:127], v[172:175], v[156:159], v[124:127]
 s_waitcnt lgkmcnt(6)
 v_mfma_f32_16x16x32_bf16 v[64:67], v[196:199], v[180:183], v[64:67]
 v_mfma_f32_16x16x32_bf16 v[68:71], v[196:199], v[184:187], v[68:71]
 v_mfma_f32_16x16x32_bf16 v[72:75], v[196:199], v[188:191], v[72:75]
 v_mfma_f32_16x16x32_bf16 v[76:79], v[196:199], v[192:195], v[76:79]
 s_waitcnt lgkmcnt(0)
 s_barrier
 v_mfma_f32_16x16x32_bf16 v[80:83], v[200:203], v[180:183], v[80:83]
 ds_read_b128 v[144:147], v8 offset:0
 v_mfma_f32_16x16x32_bf16 v[84:87], v[200:203], v[184:187], v[84:87]
 ds_read_b64_tr_b16 v[160:161], v9 offset:0
 v_mfma_f32_16x16x32_bf16 v[88:91], v[200:203], v[188:191], v[88:91]
 ds_read_b64_tr_b16 v[162:163], v9 offset:2304
 v_mfma_f32_16x16x32_bf16 v[92:95], v[200:203], v[192:195], v[92:95]
 ds_read_b128 v[148:151], v8 offset:2048
 v_mfma_f32_16x16x32_bf16 v[96:99], v[204:207], v[180:183], v[96:99]
 ds_read_b128 v[152:155], v8 offset:4096
 v_mfma_f32_16x16x32_bf16 v[100:103], v[204:207], v[184:187], v[100:103]
 ds_read_b128 v[156:159], v8 offset:6144
 v_mfma_f32_16x16x32_bf16 v[104:107], v[204:207], v[188:191], v[104:107]
 ds_read_b64_tr_b16 v[164:165], v9 offset:32
 v_mfma_f32_16x16x32_bf16 v[108:111], v[204:207], v[192:195], v[108:111]
 ds_read_b64_tr_b16 v[166:167], v9 offset:2336
 v_mfma_f32_16x16x32_bf16 v[112:115], v[208:211], v[180:183], v[112:115]
 ds_read_b64_tr_b16 v[168:169], v9 offset:64
 v_mfma_f32_16x16x32_bf16 v[116:119], v[208:211], v[184:187], v[116:119]
 ds_read_b64_tr_b16 v[170:171], v9 offset:2368
 v_mfma_f32_16x16x32_bf16 v[120:123], v[208:211], v[188:191], v[120:123]
 ds_read_b64_tr_b16 v[172:173], v9 offset:96
 v_mfma_f32_16x16x32_bf16 v[124:127], v[208:211], v[192:195], v[124:127]
 ds_read_b64_tr_b16 v[174:175], v9 offset:2400
 ds_read_b64_tr_b16 v[176:177], v10 offset:0
 ds_read_b64_tr_b16 v[178:179], v10 offset:2304
 s_waitcnt lgkmcnt(8)
 v_mfma_f32_16x16x32_bf16 v[64:67], v[160:163], v[144:147], v[64:67]
 v_mfma_f32_16x16x32_bf16 v[68:71], v[160:163], v[148:151], v[68:71]
 v_mfma_f32_16x16x32_bf16 v[72:75], v[160:163], v[152:155], v[72:75]
 v_mfma_f32_16x16x32_bf16 v[76:79], v[160:163], v[156:159], v[76:79]
 s_waitcnt lgkmcnt(0)
 v_mfma_f32_16x16x32_bf16 v[128:131], v[176:179], v[144:147], v[128:131]
 ds_read_b128 v[180:183], v8 offset:1024
 v_mfma_f32_16x16x32_bf16 v[132:135], v[176:179], v[148:151], v[132:135]
 ds_read_b64_tr_b16 v[196:197], v9 offset:9216
 v_mfma_f32_16x16x32_bf16 v[136:139], v[176:179], v[152:155], v[136:139]
 ds_read_b64_tr_b16 v[198:199], v9 offset:11520
 v_mfma_f32_16x16x32_bf16 v[140:143], v[176:179], v[156:159], v[140:143]
 ds_read_b128 v[184:187], v8 offset:3072
 v_mfma_f32_16x16x32_bf16 v[80:83], v[164:167], v[144:147], v[80:83]
 ds_read_b128 v[188:191], v8 offset:5120
 v_mfma_f32_16x16x32_bf16 v[84:87], v[164:167], v[148:151], v[84:87]
 ds_read_b128 v[192:195], v8 offset:7168
 v_mfma_f32_16x16x32_bf16 v[88:91], v[164:167], v[152:155], v[88:91]
 ds_read_b64_tr_b16 v[200:201], v9 offset:9248
 v_mfma_f32_16x16x32_bf16 v[92:95], v[164:167], v[156:159], v[92:95]
 ds_read_b64_tr_b16 v[202:203], v9 offset:11552
 v_mfma_f32_16x16x32_bf16 v[96:99], v[168:171], v[144:147], v[96:99]
 ds_read_b64_tr_b16 v[204:205], v9 offset:9280
 v_mfma_f32_16x16x32_bf16 v[100:103], v[168:171], v[148:151], v[100:103]
 ds_read_b64_tr_b16 v[206:207], v9 offset:11584
 v_mfma_f32_16x16x32_bf16 v[104:107], v[168:171], v[152:155], v[104:107]
 ds_read_b64_tr_b16 v[208:209], v9 offset:9312
 v_mfma_f32_16x16x32_bf16 v[108:111], v[168:171], v[156:159], v[108:111]
 ds_read_b64_tr_b16 v[210:211], v9 offset:11616
 v_mfma_f32_16x16x32_bf16 v[112:115], v[172:175], v[144:147], v[112:115]
 v_add_u32 v8, 49152, v2
 v_mfma_f32_16x16x32_bf16 v[116:119], v[172:175], v[148:151], v[116:119]
 v_add_u32 v9, 125952, v3
 v_mfma_f32_16x16x32_bf16 v[120:123], v[172:175], v[152:155], v[120:123]
 v_add_u32 v10, 125952, v4
 v_mfma_f32_16x16x32_bf16 v[124:127], v[172:175], v[156:159], v[124:127]
 s_waitcnt lgkmcnt(6)
 v_mfma_f32_16x16x32_bf16 v[64:67], v[196:199], v[180:183], v[64:67]
 v_mfma_f32_16x16x32_bf16 v[68:71], v[196:199], v[184:187], v[68:71]
 v_mfma_f32_16x16x32_bf16 v[72:75], v[196:199], v[188:191], v[72:75]
 v_mfma_f32_16x16x32_bf16 v[76:79], v[196:199], v[192:195], v[76:79]
 s_waitcnt lgkmcnt(0)
 s_barrier
 v_mfma_f32_16x16x32_bf16 v[80:83], v[200:203], v[180:183], v[80:83]
 ds_read_b128 v[144:147], v8 offset:0
 v_mfma_f32_16x16x32_bf16 v[84:87], v[200:203], v[184:187], v[84:87]
 ds_read_b64_tr_b16 v[160:161], v9 offset:0
 v_mfma_f32_16x16x32_bf16 v[88:91], v[200:203], v[188:191], v[88:91]
 ds_read_b64_tr_b16 v[162:163], v9 offset:2304
 v_mfma_f32_16x16x32_bf16 v[92:95], v[200:203], v[192:195], v[92:95]
 ds_read_b128 v[148:151], v8 offset:2048
 v_mfma_f32_16x16x32_bf16 v[96:99], v[204:207], v[180:183], v[96:99]
 ds_read_b128 v[152:155], v8 offset:4096
 v_mfma_f32_16x16x32_bf16 v[100:103], v[204:207], v[184:187], v[100:103]
 ds_read_b128 v[156:159], v8 offset:6144
 v_mfma_f32_16x16x32_bf16 v[104:107], v[204:207], v[188:191], v[104:107]
 ds_read_b64_tr_b16 v[164:165], v9 offset:32
 v_mfma_f32_16x16x32_bf16 v[108:111], v[204:207], v[192:195], v[108:111]
 ds_read_b64_tr_b16 v[166:167], v9 offset:2336
 v_mfma_f32_16x16x32_bf16 v[112:115], v[208:211], v[180:183], v[112:115]
 ds_read_b64_tr_b16 v[168:169], v9 offset:64
 v_mfma_f32_16x16x32_bf16 v[116:119], v[208:211], v[184:187], v[116:119]
 ds_read_b64_tr_b16 v[170:171], v9 offset:2368
 v_mfma_f32_16x16x32_bf16 v[120:123], v[208:211], v[188:191], v[120:123]
 ds_read_b64_tr_b16 v[172:173], v9 offset:96
 v_mfma_f32_16x16x32_bf16 v[124:127], v[208:211], v[192:195], v[124:127]
 ds_read_b64_tr_b16 v[174:175], v9 offset:2400
 ds_read_b64_tr_b16 v[176:177], v10 offset:0
 ds_read_b64_tr_b16 v[178:179], v10 offset:2304
 s_waitcnt lgkmcnt(8)
 v_mfma_f32_16x16x32_bf16 v[64:67], v[160:163], v[144:147], v[64:67]
 v_mfma_f32_16x16x32_bf16 v[68:71], v[160:163], v[148:151], v[68:71]
 v_mfma_f32_16x16x32_bf16 v[72:75], v[160:163], v[152:155], v[72:75]
 v_mfma_f32_16x16x32_bf16 v[76:79], v[160:163], v[156:159], v[76:79]
 s_waitcnt lgkmcnt(0)
 v_mfma_f32_16x16x32_bf16 v[128:131], v[176:179], v[144:147], v[128:131]
 ds_read_b128 v[180:183], v8 offset:1024
 v_mfma_f32_16x16x32_bf16 v[132:135], v[176:179], v[148:151], v[132:135]
 ds_read_b64_tr_b16 v[196:197], v9 offset:9216
 v_mfma_f32_16x16x32_bf16 v[136:139], v[176:179], v[152:155], v[136:139]
 ds_read_b64_tr_b16 v[198:199], v9 offset:11520
 v_mfma_f32_16x16x32_bf16 v[140:143], v[176:179], v[156:159], v[140:143]
 ds_read_b128 v[184:187], v8 offset:3072
 v_mfma_f32_16x16x32_bf16 v[80:83], v[164:167], v[144:147], v[80:83]
 ds_read_b128 v[188:191], v8 offset:5120
 v_mfma_f32_16x16x32_bf16 v[84:87], v[164:167], v[148:151], v[84:87]
 ds_read_b128 v[192:195], v8 offset:7168
 v_mfma_f32_16x16x32_bf16 v[88:91], v[164:167], v[152:155], v[88:91]
 ds_read_b64_tr_b16 v[200:201], v9 offset:9248
 v_mfma_f32_16x16x32_bf16 v[92:95], v[164:167], v[156:159], v[92:95]
 ds_read_b64_tr_b16 v[202:203], v9 offset:11552
 v_mfma_f32_16x16x32_bf16 v[96:99], v[168:171], v[144:147], v[96:99]
 ds_read_b64_tr_b16 v[204:205], v9 offset:9280
 v_mfma_f32_16x16x32_bf16 v[100:103], v[168:171], v[148:151], v[100:103]
 ds_read_b64_tr_b16 v[206:207], v9 offset:11584
 v_mfma_f32_16x16x32_bf16 v[104:107], v[168:171], v[152:155], v[104:107]
 ds_read_b64_tr_b16 v[208:209], v9 offset:9312
 v_mfma_f32_16x16x32_bf16 v[108:111], v[168:171], v[156:159], v[108:111]
 ds_read_b64_tr_b16 v[210:211], v9 offset:11616
 v_mfma_f32_16x16x32_bf16 v[112:115], v[172:175], v[144:147], v[112:115]
 v_mov_b32 v8, v2
 v_mfma_f32_16x16x32_bf16 v[116:119], v[172:175], v[148:151], v[116:119]
 v_add_u32 v9, 70656, v3
 v_mfma_f32_16x16x32_bf16 v[120:123], v[172:175], v[152:155], v[120:123]
 v_add_u32 v10, 70656, v4
 v_mfma_f32_16x16x32_bf16 v[124:127], v[172:175], v[156:159], v[124:127]
 s_waitcnt lgkmcnt(6)
 v_mfma_f32_16x16x32_bf16 v[64:67], v[196:199], v[180:183], v[64:67]
 v_mfma_f32_16x16x32_bf16 v[68:71], v[196:199], v[184:187], v[68:71]
 v_mfma_f32_16x16x32_bf16 v[72:75], v[196:199], v[188:191], v[72:75]
 v_mfma_f32_16x16x32_bf16 v[76:79], v[196:199], v[192:195], v[76:79]
 s_waitcnt lgkmcnt(0)
 s_barrier
 v_mfma_f32_16x16x32_bf16 v[80:83], v[200:203], v[180:183], v[80:83]
 ds_read_b128 v[144:147], v8 offset:0
 v_mfma_f32_16x16x32_bf16 v[84:87], v[200:203], v[184:187], v[84:87]
 ds_read_b64_tr_b16 v[160:161], v9 offset:0
 v_mfma_f32_16x16x32_bf16 v[88:91], v[200:203], v[188:191], v[88:91]
 ds_read_b64_tr_b16 v[162:163], v9 offset:2304
 v_mfma_f32_16x16x32_bf16 v[92:95], v[200:203], v[192:195], v[92:95]
 ds_read_b128 v[148:151], v8 offset:2048
 v_mfma_f32_16x16x32_bf16 v[96:99], v[204:207], v[180:183], v[96:99]
 ds_read_b128 v[152:155], v8 offset:4096
 v_mfma_f32_16x16x32_bf16 v[100:103], v[204:207], v[184:187], v[100:103]
 ds_read_b128 v[156:159], v8 offset:6144
 v_mfma_f32_16x16x32_bf16 v[104:107], v[204:207], v[188:191], v[104:107]
 ds_read_b64_tr_b16 v[164:165], v9 offset:32
 v_mfma_f32_16x16x32_bf16 v[108:111], v[204:207], v[192:195], v[108:111]
 ds_read_b64_tr_b16 v[166:167], v9 offset:2336
 v_mfma_f32_16x16x32_bf16 v[112:115], v[208:211], v[180:183], v[112:115]
 ds_read_b64_tr_b16 v[168:169], v9 offset:64
 v_mfma_f32_16x16x32_bf16 v[116:119], v[208:211], v[184:187], v[116:119]
 ds_read_b64_tr_b16 v[170:171], v9 offset:2368
 v_mfma_f32_16x16x32_bf16 v[120:123], v[208:211], v[188:191], v[120:123]
 ds_read_b64_tr_b16 v[172:173], v9 offset:96
 v_mfma_f32_16x16x32_bf16 v[124:127], v[208:211], v[192:195], v[124:127]
 ds_read_b64_tr_b16 v[174:175], v9 offset:2400
 ds_read_b64_tr_b16 v[176:177], v10 offset:0
 ds_read_b64_tr_b16 v[178:179], v10 offset:2304
 s_waitcnt lgkmcnt(8)
 v_mfma_f32_16x16x32_bf16 v[64:67], v[160:163], v[144:147], v[64:67]
 v_mfma_f32_16x16x32_bf16 v[68:71], v[160:163], v[148:151], v[68:71]
 v_mfma_f32_16x16x32_bf16 v[72:75], v[160:163], v[152:155], v[72:75]
 v_mfma_f32_16x16x32_bf16 v[76:79], v[160:163], v[156:159], v[76:79]
 s_waitcnt lgkmcnt(0)
 v_mfma_f32_16x16x32_bf16 v[128:131], v[176:179], v[144:147], v[128:131]
 ds_read_b128 v[180:183], v8 offset:1024
 v_mfma_f32_16x16x32_bf16 v[132:135], v[176:179], v[148:151], v[132:135]
 ds_read_b64_tr_b16 v[196:197], v9 offset:9216
 v_mfma_f32_16x16x32_bf16 v[136:139], v[176:179], v[152:155], v[136:139]
 ds_read_b64_tr_b16 v[198:199], v9 offset:11520
 v_mfma_f32_16x16x32_bf16 v[140:143], v[176:179], v[156:159], v[140:143]
 ds_read_b128 v[184:187], v8 offset:3072
 v_mfma_f32_16x16x32_bf16 v[80:83], v[164:167], v[144:147], v[80:83]
 ds_read_b128 v[188:191], v8 offset:5120
 v_mfma_f32_16x16x32_bf16 v[84:87], v[164:167], v[148:151], v[84:87]
 ds_read_b128 v[192:195], v8 offset:7168
 v_mfma_f32_16x16x32_bf16 v[88:91], v[164:167], v[152:155], v[88:91]
 ds_read_b64_tr_b16 v[200:201], v9 offset:9248
 v_mfma_f32_16x16x32_bf16 v[92:95], v[164:167], v[156:159], v[92:95]
 ds_read_b64_tr_b16 v[202:203], v9 offset:11552
 v_mfma_f32_16x16x32_bf16 v[96:99], v[168:171], v[144:147], v[96:99]
 ds_read_b64_tr_b16 v[204:205], v9 offset:9280
 v_mfma_f32_16x16x32_bf16 v[100:103], v[168:171], v[148:151], v[100:103]
 ds_read_b64_tr_b16 v[206:207], v9 offset:11584
 v_mfma_f32_16x16x32_bf16 v[104:107], v[168:171], v[152:155], v[104:107]
 ds_read_b64_tr_b16 v[208:209], v9 offset:9312
 v_mfma_f32_16x16x32_bf16 v[108:111], v[168:171], v[156:159], v[108:111]
 ds_read_b64_tr_b16 v[210:211], v9 offset:11616
 v_mfma_f32_16x16x32_bf16 v[112:115], v[172:175], v[144:147], v[112:115]
 v_add_u32 v8, 16384, v2
 v_mfma_f32_16x16x32_bf16 v[116:119], v[172:175], v[148:151], v[116:119]
 v_add_u32 v9, 89088, v3
 v_mfma_f32_16x16x32_bf16 v[120:123], v[172:175], v[152:155], v[120:123]
 v_add_u32 v10, 89088, v4
 v_mfma_f32_16x16x32_bf16 v[124:127], v[172:175], v[156:159], v[124:127]
 s_waitcnt lgkmcnt(6)
 v_mfma_f32_16x16x32_bf16 v[64:67], v[196:199], v[180:183], v[64:67]
 v_mfma_f32_16x16x32_bf16 v[68:71], v[196:199], v[184:187], v[68:71]
 v_mfma_f32_16x16x32_bf16 v[72:75], v[196:199], v[188:191], v[72:75]
 v_mfma_f32_16x16x32_bf16 v[76:79], v[196:199], v[192:195], v[76:79]
 s_waitcnt lgkmcnt(0)
 s_barrier
 v_mfma_f32_16x16x32_bf16 v[80:83], v[200:203], v[180:183], v[80:83]
 ds_read_b128 v[144:147], v8 offset:0
 v_mfma_f32_16x16x32_bf16 v[84:87], v[200:203], v[184:187], v[84:87]
 ds_read_b64_tr_b16 v[160:161], v9 offset:0
 v_mfma_f32_16x16x32_bf16 v[88:91], v[200:203], v[188:191], v[88:91]
 ds_read_b64_tr_b16 v[162:163], v9 offset:2304
 v_mfma_f32_16x16x32_bf16 v[92:95], v[200:203], v[192:195], v[92:95]
 ds_read_b128 v[148:151], v8 offset:2048
 v_mfma_f32_16x16x32_bf16 v[96:99], v[204:207], v[180:183], v[96:99]
 ds_read_b128 v[152:155], v8 offset:4096
 v_mfma_f32_16x16x32_bf16 v[100:103], v[204:207], v[184:187], v[100:103]
 ds_read_b128 v[156:159], v8 offset:6144
 v_mfma_f32_16x16x32_bf16 v[104:107], v[204:207], v[188:191], v[104:107]
 ds_read_b64_tr_b16 v[164:165], v9 offset:32
 v_mfma_f32_16x16x32_bf16 v[108:111], v[204:207], v[192:195], v[108:111]
 ds_read_b64_tr_b16 v[166:167], v9 offset:2336
 v_mfma_f32_16x16x32_bf16 v[112:115], v[208:211], v[180:183], v[112:115]
 ds_read_b64_tr_b16 v[168:169], v9 offset:64
 v_mfma_f32_16x16x32_bf16 v[116:119], v[208:211], v[184:187], v[116:119]
 ds_read_b64_tr_b16 v[170:171], v9 offset:2368
 v_mfma_f32_16x16x32_bf16 v[120:123], v[208:211], v[188:191], v[120:123]
 ds_read_b64_tr_b16 v[172:173], v9 offset:96
 v_mfma_f32_16x16x32_bf16 v[124:127], v[208:211], v[192:195], v[124:127]
 ds_read_b64_tr_b16 v[174:175], v9 offset:2400
 ds_read_b64_tr_b16 v[176:177], v10 offset:0
 ds_read_b64_tr_b16 v[178:179], v10 offset:2304
 s_waitcnt lgkmcnt(8)
 v_mfma_f32_16x16x32_bf16 v[64:67], v[160:163], v[144:147], v[64:67]
 v_mfma_f32_16x16x32_bf16 v[68:71], v[160:163], v[148:151], v[68:71]
 v_mfma_f32_16x16x32_bf16 v[72:75], v[160:163], v[152:155], v[72:75]
 v_mfma_f32_16x16x32_bf16 v[76:79], v[160:163], v[156:159], v[76:79]
 s_waitcnt lgkmcnt(0)
 v_mfma_f32_16x16x32_bf16 v[128:131], v[176:179], v[144:147], v[128:131]
 ds_read_b128 v[180:183], v8 offset:1024
 v_mfma_f32_16x16x32_bf16 v[132:135], v[176:179], v[148:151], v[132:135]
 ds_read_b64_tr_b16 v[196:197], v9 offset:9216
 v_mfma_f32_16x16x32_bf16 v[136:139], v[176:179], v[152:155], v[136:139]
 ds_read_b64_tr_b16 v[198:199], v9 offset:11520
 v_mfma_f32_16x16x32_bf16 v[140:143], v[176:179], v[156:159], v[140:143]
 ds_read_b128 v[184:187], v8 offset:3072
 v_mfma_f32_16x16x32_bf16 v[80:83], v[164:167], v[144:147], v[80:83]
 ds_read_b128 v[188:191], v8 offset:5120
 v_mfma_f32_16x16x32_bf16 v[84:87], v[164:167], v[148:151], v[84:87]
 ds_read_b128 v[192:195], v8 offset:7168
 v_mfma_f32_16x16x32_bf16 v[88:91], v[164:167], v[152:155], v[88:91]
 ds_read_b64_tr_b16 v[200:201], v9 offset:9248
 v_mfma_f32_16x16x32_bf16 v[92:95], v[164:167], v[156:159], v[92:95]
 ds_read_b64_tr_b16 v[202:203], v9 offset:11552
 v_mfma_f32_16x16x32_bf16 v[96:99], v[168:171], v[144:147], v[96:99]
 ds_read_b64_tr_b16 v[204:205], v9 offset:9280
 v_mfma_f32_16x16x32_bf16 v[100:103], v[168:171], v[148:151], v[100:103]
 ds_read_b64_tr_b16 v[206:207], v9 offset:11584
 v_mfma_f32_16x16x32_bf16 v[104:107], v[168:171], v[152:155], v[104:107]
 ds_read_b64_tr_b16 v[208:209], v9 offset:9312
 v_mfma_f32_16x16x32_bf16 v[108:111], v[168:171], v[156:159], v[108:111]
 ds_read_b64_tr_b16 v[210:211], v9 offset:11616
 v_mfma_f32_16x16x32_bf16 v[112:115], v[172:175], v[144:147], v[112:115]
 v_add_u32 v8, 32768, v2
 v_mfma_f32_16x16x32_bf16 v[116:119], v[172:175], v[148:151], v[116:119]
 v_add_u32 v9, 107520, v3
 v_mfma_f32_16x16x32_bf16 v[120:123], v[172:175], v[152:155], v[120:123]
 v_add_u32 v10, 107520, v4
 v_mfma_f32_16x16x32_bf16 v[124:127], v[172:175], v[156:159], v[124:127]
 s_waitcnt lgkmcnt(6)
 v_mfma_f32_16x16x32_bf16 v[64:67], v[196:199], v[180:183], v[64:67]
 v_mfma_f32_16x16x32_bf16 v[68:71], v[196:199], v[184:187], v[68:71]
 v_mfma_f32_16x16x32_bf16 v[72:75], v[196:199], v[188:191], v[72:75]
 v_mfma_f32_16x16x32_bf16 v[76:79], v[196:199], v[192:195], v[76:79]
 s_waitcnt lgkmcnt(0)
 s_barrier
 v_mfma_f32_16x16x32_bf16 v[80:83], v[200:203], v[180:183], v[80:83]
 ds_read_b128 v[144:147], v8 offset:0
 v_mfma_f32_16x16x32_bf16 v[84:87], v[200:203], v[184:187], v[84:87]
 ds_read_b64_tr_b16 v[160:161], v9 offset:0
 v_mfma_f32_16x16x32_bf16 v[88:91], v[200:203], v[188:191], v[88:91]
 ds_read_b64_tr_b16 v[162:163], v9 offset:2304
 v_mfma_f32_16x16x32_bf16 v[92:95], v[200:203], v[192:195], v[92:95]
 ds_read_b128 v[148:151], v8 offset:2048
 v_mfma_f32_16x16x32_bf16 v[96:99], v[204:207], v[180:183], v[96:99]
 ds_read_b128 v[152:155], v8 offset:4096
 v_mfma_f32_16x16x32_bf16 v[100:103], v[204:207], v[184:187], v[100:103]
 ds_read_b128 v[156:159], v8 offset:6144
 v_mfma_f32_16x16x32_bf16 v[104:107], v[204:207], v[188:191], v[104:107]
 ds_read_b64_tr_b16 v[164:165], v9 offset:32
 v_mfma_f32_16x16x32_bf16 v[108:111], v[204:207], v[192:195], v[108:111]
 ds_read_b64_tr_b16 v[166:167], v9 offset:2336
 v_mfma_f32_16x16x32_bf16 v[112:115], v[208:211], v[180:183], v[112:115]
 ds_read_b64_tr_b16 v[168:169], v9 offset:64
 v_mfma_f32_16x16x32_bf16 v[116:119], v[208:211], v[184:187], v[116:119]
 ds_read_b64_tr_b16 v[170:171], v9 offset:2368
 v_mfma_f32_16x16x32_bf16 v[120:123], v[208:211], v[188:191], v[120:123]
 ds_read_b64_tr_b16 v[172:173], v9 offset:96
 v_mfma_f32_16x16x32_bf16 v[124:127], v[208:211], v[192:195], v[124:127]
 ds_read_b64_tr_b16 v[174:175], v9 offset:2400
 ds_read_b64_tr_b16 v[176:177], v10 offset:0
 ds_read_b64_tr_b16 v[178:179], v10 offset:2304
 s_waitcnt lgkmcnt(8)
 v_mfma_f32_16x16x32_bf16 v[64:67], v[160:163], v[144:147], v[64:67]
 v_mfma_f32_16x16x32_bf16 v[68:71], v[160:163], v[148:151], v[68:71]
 v_mfma_f32_16x16x32_bf16 v[72:75], v[160:163], v[152:155], v[72:75]
 v_mfma_f32_16x16x32_bf16 v[76:79], v[160:163], v[156:159], v[76:79]
 s_waitcnt lgkmcnt(0)
 v_mfma_f32_16x16x32_bf16 v[128:131], v[176:179], v[144:147], v[128:131]
 ds_read_b128 v[180:183], v8 offset:1024
 v_mfma_f32_16x16x32_bf16 v[132:135], v[176:179], v[148:151], v[132:135]
 ds_read_b64_tr_b16 v[196:197], v9 offset:9216
 v_mfma_f32_16x16x32_bf16 v[136:139], v[176:179], v[152:155], v[136:139]
 ds_read_b64_tr_b16 v[198:199], v9 offset:11520
 v_mfma_f32_16x16x32_bf16 v[140:143], v[176:179], v[156:159], v[140:143]
 ds_read_b128 v[184:187], v8 offset:3072
 v_mfma_f32_16x16x32_bf16 v[80:83], v[164:167], v[144:147], v[80:83]
 ds_read_b128 v[188:191], v8 offset:5120
 v_mfma_f32_16x16x32_bf16 v[84:87], v[164:167], v[148:151], v[84:87]
 ds_read_b128 v[192:195], v8 offset:7168
 v_mfma_f32_16x16x32_bf16 v[88:91], v[164:167], v[152:155], v[88:91]
 ds_read_b64_tr_b16 v[200:201], v9 offset:9248
 v_mfma_f32_16x16x32_bf16 v[92:95], v[164:167], v[156:159], v[92:95]
 ds_read_b64_tr_b16 v[202:203], v9 offset:11552
 v_mfma_f32_16x16x32_bf16 v[96:99], v[168:171], v[144:147], v[96:99]
 ds_read_b64_tr_b16 v[204:205], v9 offset:9280
 v_mfma_f32_16x16x32_bf16 v[100:103], v[168:171], v[148:151], v[100:103]
 ds_read_b64_tr_b16 v[206:207], v9 offset:11584
 v_mfma_f32_16x16x32_bf16 v[104:107], v[168:171], v[152:155], v[104:107]
 ds_read_b64_tr_b16 v[208:209], v9 offset:9312
 v_mfma_f32_16x16x32_bf16 v[108:111], v[168:171], v[156:159], v[108:111]
 ds_read_b64_tr_b16 v[210:211], v9 offset:11616
 v_mfma_f32_16x16x32_bf16 v[112:115], v[172:175], v[144:147], v[112:115]
 v_add_u32 v8, 49152, v2
 v_mfma_f32_16x16x32_bf16 v[116:119], v[172:175], v[148:151], v[116:119]
 v_add_u32 v9, 125952, v3
 v_mfma_f32_16x16x32_bf16 v[120:123], v[172:175], v[152:155], v[120:123]
 v_add_u32 v10, 125952, v4
 v_mfma_f32_16x16x32_bf16 v[124:127], v[172:175], v[156:159], v[124:127]
 s_waitcnt lgkmcnt(6)
 v_mfma_f32_16x16x32_bf16 v[64:67], v[196:199], v[180:183], v[64:67]
 v_mfma_f32_16x16x32_bf16 v[68:71], v[196:199], v[184:187], v[68:71]
 v_mfma_f32_16x16x32_bf16 v[72:75], v[196:199], v[188:191], v[72:75]
 v_mfma_f32_16x16x32_bf16 v[76:79], v[196:199], v[192:195], v[76:79]
 s_waitcnt lgkmcnt(0)
 s_barrier
 v_mfma_f32_16x16x32_bf16 v[80:83], v[200:203], v[180:183], v[80:83]
 ds_read_b128 v[144:147], v8 offset:0
 v_mfma_f32_16x16x32_bf16 v[84:87], v[200:203], v[184:187], v[84:87]
 ds_read_b64_tr_b16 v[160:161], v9 offset:0
 v_mfma_f32_16x16x32_bf16 v[88:91], v[200:203], v[188:191], v[88:91]
 ds_read_b64_tr_b16 v[162:163], v9 offset:2304
 v_mfma_f32_16x16x32_bf16 v[92:95], v[200:203], v[192:195], v[92:95]
 ds_read_b128 v[148:151], v8 offset:2048
 v_mfma_f32_16x16x32_bf16 v[96:99], v[204:207], v[180:183], v[96:99]
 ds_read_b128 v[152:155], v8 offset:4096
 v_mfma_f32_16x16x32_bf16 v[100:103], v[204:207], v[184:187], v[100:103]
 ds_read_b128 v[156:159], v8 offset:6144
 v_mfma_f32_16x16x32_bf16 v[104:107], v[204:207], v[188:191], v[104:107]
 ds_read_b64_tr_b16 v[164:165], v9 offset:32
 v_mfma_f32_16x16x32_bf16 v[108:111], v[204:207], v[192:195], v[108:111]
 ds_read_b64_tr_b16 v[166:167], v9 offset:2336
 v_mfma_f32_16x16x32_bf16 v[112:115], v[208:211], v[180:183], v[112:115]
 ds_read_b64_tr_b16 v[168:169], v9 offset:64
 v_mfma_f32_16x16x32_bf16 v[116:119], v[208:211], v[184:187], v[116:119]
 ds_read_b64_tr_b16 v[170:171], v9 offset:2368
 v_mfma_f32_16x16x32_bf16 v[120:123], v[208:211], v[188:191], v[120:123]
 ds_read_b64_tr_b16 v[172:173], v9 offset:96
 v_mfma_f32_16x16x32_bf16 v[124:127], v[208:211], v[192:195], v[124:127]
 ds_read_b64_tr_b16 v[174:175], v9 offset:2400
 ds_read_b64_tr_b16 v[176:177], v10 offset:0
 ds_read_b64_tr_b16 v[178:179], v10 offset:2304
 s_waitcnt lgkmcnt(8)
 v_mfma_f32_16x16x32_bf16 v[64:67], v[160:163], v[144:147], v[64:67]
 v_mfma_f32_16x16x32_bf16 v[68:71], v[160:163], v[148:151], v[68:71]
 v_mfma_f32_16x16x32_bf16 v[72:75], v[160:163], v[152:155], v[72:75]
 v_mfma_f32_16x16x32_bf16 v[76:79], v[160:163], v[156:159], v[76:79]
 s_waitcnt lgkmcnt(0)
 v_mfma_f32_16x16x32_bf16 v[128:131], v[176:179], v[144:147], v[128:131]
 ds_read_b128 v[180:183], v8 offset:1024
 v_mfma_f32_16x16x32_bf16 v[132:135], v[176:179], v[148:151], v[132:135]
 ds_read_b64_tr_b16 v[196:197], v9 offset:9216
 v_mfma_f32_16x16x32_bf16 v[136:139], v[176:179], v[152:155], v[136:139]
 ds_read_b64_tr_b16 v[198:199], v9 offset:11520
 v_mfma_f32_16x16x32_bf16 v[140:143], v[176:179], v[156:159], v[140:143]
 ds_read_b128 v[184:187], v8 offset:3072
 v_mfma_f32_16x16x32_bf16 v[80:83], v[164:167], v[144:147], v[80:83]
 ds_read_b128 v[188:191], v8 offset:5120
 v_mfma_f32_16x16x32_bf16 v[84:87], v[164:167], v[148:151], v[84:87]
 ds_read_b128 v[192:195], v8 offset:7168
 v_mfma_f32_16x16x32_bf16 v[88:91], v[164:167], v[152:155], v[88:91]
 ds_read_b64_tr_b16 v[200:201], v9 offset:9248
 v_mfma_f32_16x16x32_bf16 v[92:95], v[164:167], v[156:159], v[92:95]
 ds_read_b64_tr_b16 v[202:203], v9 offset:11552
 v_mfma_f32_16x16x32_bf16 v[96:99], v[168:171], v[144:147], v[96:99]
 ds_read_b64_tr_b16 v[204:205], v9 offset:9280
 v_mfma_f32_16x16x32_bf16 v[100:103], v[168:171], v[148:151], v[100:103]
 ds_read_b64_tr_b16 v[206:207], v9 offset:11584
 v_mfma_f32_16x16x32_bf16 v[104:107], v[168:171], v[152:155], v[104:107]
 ds_read_b64_tr_b16 v[208:209], v9 offset:9312
 v_mfma_f32_16x16x32_bf16 v[108:111], v[168:171], v[156:159], v[108:111]
 ds_read_b64_tr_b16 v[210:211], v9 offset:11616
 v_mfma_f32_16x16x32_bf16 v[112:115], v[172:175], v[144:147], v[112:115]
 v_mov_b32 v8, v2
 v_mfma_f32_16x16x32_bf16 v[116:119], v[172:175], v[148:151], v[116:119]
 v_add_u32 v9, 70656, v3
 v_mfma_f32_16x16x32_bf16 v[120:123], v[172:175], v[152:155], v[120:123]
 v_add_u32 v10, 70656, v4
 v_mfma_f32_16x16x32_bf16 v[124:127], v[172:175], v[156:159], v[124:127]
 s_waitcnt lgkmcnt(6)
 v_mfma_f32_16x16x32_bf16 v[64:67], v[196:199], v[180:183], v[64:67]
 v_mfma_f32_16x16x32_bf16 v[68:71], v[196:199], v[184:187], v[68:71]
 v_mfma_f32_16x16x32_bf16 v[72:75], v[196:199], v[188:191], v[72:75]
 v_mfma_f32_16x16x32_bf16 v[76:79], v[196:199], v[192:195], v[76:79]
 s_waitcnt lgkmcnt(0)
 s_barrier
 v_mfma_f32_16x16x32_bf16 v[80:83], v[200:203], v[180:183], v[80:83]
 ds_read_b128 v[144:147], v8 offset:0
 v_mfma_f32_16x16x32_bf16 v[84:87], v[200:203], v[184:187], v[84:87]
 ds_read_b64_tr_b16 v[160:161], v9 offset:0
 v_mfma_f32_16x16x32_bf16 v[88:91], v[200:203], v[188:191], v[88:91]
 ds_read_b64_tr_b16 v[162:163], v9 offset:2304
 v_mfma_f32_16x16x32_bf16 v[92:95], v[200:203], v[192:195], v[92:95]
 ds_read_b128 v[148:151], v8 offset:2048
 v_mfma_f32_16x16x32_bf16 v[96:99], v[204:207], v[180:183], v[96:99]
 ds_read_b128 v[152:155], v8 offset:4096
 v_mfma_f32_16x16x32_bf16 v[100:103], v[204:207], v[184:187], v[100:103]
 ds_read_b128 v[156:159], v8 offset:6144
 v_mfma_f32_16x16x32_bf16 v[104:107], v[204:207], v[188:191], v[104:107]
 ds_read_b64_tr_b16 v[164:165], v9 offset:32
 v_mfma_f32_16x16x32_bf16 v[108:111], v[204:207], v[192:195], v[108:111]
 ds_read_b64_tr_b16 v[166:167], v9 offset:2336
 v_mfma_f32_16x16x32_bf16 v[112:115], v[208:211], v[180:183], v[112:115]
 ds_read_b64_tr_b16 v[168:169], v9 offset:64
 v_mfma_f32_16x16x32_bf16 v[116:119], v[208:211], v[184:187], v[116:119]
 ds_read_b64_tr_b16 v[170:171], v9 offset:2368
 v_mfma_f32_16x16x32_bf16 v[120:123], v[208:211], v[188:191], v[120:123]
 ds_read_b64_tr_b16 v[172:173], v9 offset:96
 v_mfma_f32_16x16x32_bf16 v[124:127], v[208:211], v[192:195], v[124:127]
 ds_read_b64_tr_b16 v[174:175], v9 offset:2400
 ds_read_b64_tr_b16 v[176:177], v10 offset:0
 ds_read_b64_tr_b16 v[178:179], v10 offset:2304
 s_waitcnt lgkmcnt(8)
 v_mfma_f32_16x16x32_bf16 v[64:67], v[160:163], v[144:147], v[64:67]
 v_mfma_f32_16x16x32_bf16 v[68:71], v[160:163], v[148:151], v[68:71]
 v_mfma_f32_16x16x32_bf16 v[72:75], v[160:163], v[152:155], v[72:75]
 v_mfma_f32_16x16x32_bf16 v[76:79], v[160:163], v[156:159], v[76:79]
 s_waitcnt lgkmcnt(0)
 v_mfma_f32_16x16x32_bf16 v[128:131], v[176:179], v[144:147], v[128:131]
 ds_read_b128 v[180:183], v8 offset:1024
 v_mfma_f32_16x16x32_bf16 v[132:135], v[176:179], v[148:151], v[132:135]
 ds_read_b64_tr_b16 v[196:197], v9 offset:9216
 v_mfma_f32_16x16x32_bf16 v[136:139], v[176:179], v[152:155], v[136:139]
 ds_read_b64_tr_b16 v[198:199], v9 offset:11520
 v_mfma_f32_16x16x32_bf16 v[140:143], v[176:179], v[156:159], v[140:143]
 ds_read_b128 v[184:187], v8 offset:3072
 v_mfma_f32_16x16x32_bf16 v[80:83], v[164:167], v[144:147], v[80:83]
 ds_read_b128 v[188:191], v8 offset:5120
 v_mfma_f32_16x16x32_bf16 v[84:87], v[164:167], v[148:151], v[84:87]
 ds_read_b128 v[192:195], v8 offset:7168
 v_mfma_f32_16x16x32_bf16 v[88:91], v[164:167], v[152:155], v[88:91]
 ds_read_b64_tr_b16 v[200:201], v9 offset:9248
 v_mfma_f32_16x16x32_bf16 v[92:95], v[164:167], v[156:159], v[92:95]
 ds_read_b64_tr_b16 v[202:203], v9 offset:11552
 v_mfma_f32_16x16x32_bf16 v[96:99], v[168:171], v[144:147], v[96:99]
 ds_read_b64_tr_b16 v[204:205], v9 offset:9280
 v_mfma_f32_16x16x32_bf16 v[100:103], v[168:171], v[148:151], v[100:103]
 ds_read_b64_tr_b16 v[206:207], v9 offset:11584
 v_mfma_f32_16x16x32_bf16 v[104:107], v[168:171], v[152:155], v[104:107]
 ds_read_b64_tr_b16 v[208:209], v9 offset:9312
 v_mfma_f32_16x16x32_bf16 v[108:111], v[168:171], v[156:159], v[108:111]
 ds_read_b64_tr_b16 v[210:211], v9 offset:11616
 v_mfma_f32_16x16x32_bf16 v[112:115], v[172:175], v[144:147], v[112:115]
 v_add_u32 v8, 16384, v2
 v_mfma_f32_16x16x32_bf16 v[116:119], v[172:175], v[148:151], v[116:119]
 v_add_u32 v9, 89088, v3
 v_mfma_f32_16x16x32_bf16 v[120:123], v[172:175], v[152:155], v[120:123]
 v_add_u32 v10, 89088, v4
 v_mfma_f32_16x16x32_bf16 v[124:127], v[172:175], v[156:159], v[124:127]
 s_waitcnt lgkmcnt(0)
 s_barrier
 s_lshl_b32 s36, s44, 8
 s_add_u32 s36, s36, 78848
 v_and_b32 v19, 15, v0
 v_lshl_add_u32 v19, v19, 2, s36
 ds_read_b32 v28, v19 offset:0
 ds_read_b32 v32, v19 offset:512
 ds_read_b32 v29, v19 offset:64
 ds_read_b32 v33, v19 offset:576
 ds_read_b32 v30, v19 offset:128
 ds_read_b32 v34, v19 offset:640
 ds_read_b32 v31, v19 offset:192
 ds_read_b32 v35, v19 offset:704
 v_mfma_f32_16x16x32_bf16 v[64:67], v[196:199], v[180:183], v[64:67]
 v_mfma_f32_16x16x32_bf16 v[68:71], v[196:199], v[184:187], v[68:71]
 v_mfma_f32_16x16x32_bf16 v[72:75], v[196:199], v[188:191], v[72:75]
 v_mfma_f32_16x16x32_bf16 v[76:79], v[196:199], v[192:195], v[76:79]
 v_mfma_f32_16x16x32_bf16 v[80:83], v[200:203], v[180:183], v[80:83]
 v_mfma_f32_16x16x32_bf16 v[84:87], v[200:203], v[184:187], v[84:87]
 v_mfma_f32_16x16x32_bf16 v[88:91], v[200:203], v[188:191], v[88:91]
 v_mfma_f32_16x16x32_bf16 v[92:95], v[200:203], v[192:195], v[92:95]
 v_mfma_f32_16x16x32_bf16 v[96:99], v[204:207], v[180:183], v[96:99]
 v_mfma_f32_16x16x32_bf16 v[100:103], v[204:207], v[184:187], v[100:103]
 v_mfma_f32_16x16x32_bf16 v[104:107], v[204:207], v[188:191], v[104:107]
 v_mfma_f32_16x16x32_bf16 v[108:111], v[204:207], v[192:195], v[108:111]
 v_mfma_f32_16x16x32_bf16 v[112:115], v[208:211], v[180:183], v[112:115]
 v_mfma_f32_16x16x32_bf16 v[116:119], v[208:211], v[184:187], v[116:119]
 v_mfma_f32_16x16x32_bf16 v[120:123], v[208:211], v[188:191], v[120:123]
 v_mfma_f32_16x16x32_bf16 v[124:127], v[208:211], v[192:195], v[124:127]
 s_lshl_b32 s36, s32, 11
 s_add_u32 s36, s36, 69632
 v_add_u32 v25, s36, v1
 v_xor_b32 v26, 2048, v25
 v_mov_b32 v160, 0
 v_mov_b32 v161, 0
 v_mov_b32 v162, 0
 v_mov_b32 v163, 0
 v_mov_b32 v164, 0
 v_mov_b32 v165, 0
 v_mov_b32 v166, 0
 v_mov_b32 v167, 0
 v_mov_b32 v168, 0
 v_mov_b32 v169, 0
 v_mov_b32 v170, 0
 v_mov_b32 v171, 0
 v_mov_b32 v172, 0
 v_mov_b32 v173, 0
 v_mov_b32 v174, 0
 v_mov_b32 v175, 0
 ds_write_b128 v25, v[136:139] offset:0
 ds_write_b128 v25, v[140:143] offset:1024
 s_waitcnt vmcnt(0) lgkmcnt(2)
 v_mul_f32 v36, -2.302208198144325, v32
 v_mul_f32 v37, v32, v32
 v_mul_f32 v37, v37, v36
 v_mul_f32 v37, 0.044715, v37
 v_mul_f32 v38, -2.302208198144325, v33
 v_mul_f32 v39, v33, v33
 v_mul_f32 v39, v39, v38
 v_mul_f32 v39, 0.044715, v39
 v_mul_f32 v40, -2.302208198144325, v34
 v_mul_f32 v41, v34, v34
 v_mul_f32 v41, v41, v40
 v_mul_f32 v41, 0.044715, v41
 v_mul_f32 v42, -2.302208198144325, v35
 v_mul_f32 v43, v35, v35
 v_mul_f32 v43, v43, v42
 v_mul_f32 v43, 0.044715, v43
 s_lshl_b32 s36, s32, 2
 s_add_u32 s36, s36, 79936
 v_mov_b32 v24, s36
 v_mov_b32 v18, 1
 ds_write_b32 v24, v18
 v_xor_b32 v24, 4, v24
 v_fma_f32 v64, -v28, v44, v64
 v_fma_f32 v65, -v28, v45, v65
 v_fma_f32 v66, -v28, v46, v66
 v_fma_f32 v67, -v28, v47, v67
 v_fma_f32 v68, -v29, v44, v68
 v_fma_f32 v69, -v29, v45, v69
 v_fma_f32 v70, -v29, v46, v70
 v_fma_f32 v71, -v29, v47, v71
 v_fma_f32 v72, -v30, v44, v72
 v_fma_f32 v73, -v30, v45, v73
 v_fma_f32 v74, -v30, v46, v74
 v_fma_f32 v75, -v30, v47, v75
 v_fma_f32 v76, -v31, v44, v76
 v_fma_f32 v77, -v31, v45, v77
 v_fma_f32 v78, -v31, v46, v78
 v_fma_f32 v79, -v31, v47, v79
 v_mul_f32 v144, v64, v64
 v_mul_f32 v145, v65, v65
 v_mul_f32 v146, v66, v66
 v_mul_f32 v147, v67, v67
 v_mul_f32 v148, v68, v68
 v_mul_f32 v149, v69, v69
 v_mul_f32 v150, v70, v70
 v_mul_f32 v151, v71, v71
 v_mul_f32 v152, v72, v72
 v_mul_f32 v153, v73, v73
 v_mul_f32 v154, v74, v74
 v_mul_f32 v155, v75, v75
 v_mul_f32 v156, v76, v76
 v_mul_f32 v157, v77, v77
 v_mul_f32 v158, v78, v78
 v_mul_f32 v159, v79, v79
 v_fma_f32 v144, v144, v37, v36
 v_fma_f32 v145, v145, v37, v36
 v_fma_f32 v146, v146, v37, v36
 v_fma_f32 v147, v147, v37, v36
 v_fma_f32 v148, v148, v39, v38
 v_fma_f32 v149, v149, v39, v38
 v_fma_f32 v150, v150, v39, v38
 v_fma_f32 v151, v151, v39, v38
 v_fma_f32 v152, v152, v41, v40
 v_fma_f32 v153, v153, v41, v40
 v_fma_f32 v154, v154, v41, v40
 v_fma_f32 v155, v155, v41, v40
 v_fma_f32 v156, v156, v43, v42
 v_fma_f32 v157, v157, v43, v42
 v_fma_f32 v158, v158, v43, v42
 v_fma_f32 v159, v159, v43, v42
 v_mul_f32 v144, v144, v64
 v_mul_f32 v145, v145, v65
 v_mul_f32 v146, v146, v66
 v_mul_f32 v147, v147, v67
 v_mul_f32 v148, v148, v68
 v_mul_f32 v149, v149, v69
 v_mul_f32 v150, v150, v70
 v_mul_f32 v151, v151, v71
 v_mul_f32 v152, v152, v72
 v_mul_f32 v153, v153, v73
 v_mul_f32 v154, v154, v74
 v_mul_f32 v155, v155, v75
 v_mul_f32 v156, v156, v76
 v_mul_f32 v157, v157, v77
 v_mul_f32 v158, v158, v78
 v_mul_f32 v159, v159, v79
 v_exp_f32 v144, v144
 v_exp_f32 v145, v145
 v_exp_f32 v146, v146
 v_exp_f32 v147, v147
 v_exp_f32 v148, v148
 v_exp_f32 v149, v149
 v_exp_f32 v150, v150
 v_exp_f32 v151, v151
 v_exp_f32 v152, v152
 v_exp_f32 v153, v153
 v_exp_f32 v154, v154
 v_exp_f32 v155, v155
 v_exp_f32 v156, v156
 v_exp_f32 v157, v157
 v_exp_f32 v158, v158
 v_exp_f32 v159, v159
 v_add_f32 v144, 1.0, v144
 v_add_f32 v145, 1.0, v145
 v_add_f32 v146, 1.0, v146
 v_add_f32 v147, 1.0, v147
 v_add_f32 v148, 1.0, v148
 v_add_f32 v149, 1.0, v149
 v_add_f32 v150, 1.0, v150
 v_add_f32 v151, 1.0, v151
 v_add_f32 v152, 1.0, v152
 v_add_f32 v153, 1.0, v153
 v_add_f32 v154, 1.0, v154
 v_add_f32 v155, 1.0, v155
 v_add_f32 v156, 1.0, v156
 v_add_f32 v157, 1.0, v157
 v_add_f32 v158, 1.0, v158
 v_add_f32 v159, 1.0, v159
 v_rcp_f32 v144, v144
 v_rcp_f32 v145, v145
 v_rcp_f32 v146, v146
 v_rcp_f32 v147, v147
 v_rcp_f32 v148, v148
 v_rcp_f32 v149, v149
 v_rcp_f32 v150, v150
 v_rcp_f32 v151, v151
 v_rcp_f32 v152, v152
 v_rcp_f32 v153, v153
 v_rcp_f32 v154, v154
 v_rcp_f32 v155, v155
 v_rcp_f32 v156, v156
 v_rcp_f32 v157, v157
 v_rcp_f32 v158, v158
 v_rcp_f32 v159, v159
 v_mul_f32 v64, v64, v144
 v_mul_f32 v65, v65, v145
 v_mul_f32 v66, v66, v146
 v_mul_f32 v67, v67, v147
 v_mul_f32 v68, v68, v148
 v_mul_f32 v69, v69, v149
 v_mul_f32 v70, v70, v150
 v_mul_f32 v71, v71, v151
 v_mul_f32 v72, v72, v152
 v_mul_f32 v73, v73, v153
 v_mul_f32 v74, v74, v154
 v_mul_f32 v75, v75, v155
 v_mul_f32 v76, v76, v156
 v_mul_f32 v77, v77, v157
 v_mul_f32 v78, v78, v158
 v_mul_f32 v79, v79, v159
 v_add_f32 v160, v160, v64
 v_fmac_f32 v168, v64, v64
 v_add_f32 v162, v162, v68
 v_fmac_f32 v170, v68, v68
 v_add_f32 v164, v164, v72
 v_fmac_f32 v172, v72, v72
 v_add_f32 v166, v166, v76
 v_fmac_f32 v174, v76, v76
 v_add_f32 v161, v161, v65
 v_fmac_f32 v169, v65, v65
 v_add_f32 v163, v163, v69
 v_fmac_f32 v171, v69, v69
 v_add_f32 v165, v165, v73
 v_fmac_f32 v173, v73, v73
 v_add_f32 v167, v167, v77
 v_fmac_f32 v175, v77, v77
 v_add_f32 v160, v160, v66
 v_fmac_f32 v168, v66, v66
 v_add_f32 v162, v162, v70
 v_fmac_f32 v170, v70, v70
 v_add_f32 v164, v164, v74
 v_fmac_f32 v172, v74, v74
 v_add_f32 v166, v166, v78
 v_fmac_f32 v174, v78, v78
 v_add_f32 v161, v161, v67
 v_fmac_f32 v169, v67, v67
 v_add_f32 v163, v163, v71
 v_fmac_f32 v171, v71, v71
 v_add_f32 v165, v165, v75
 v_fmac_f32 v173, v75, v75
 v_add_f32 v167, v167, v79
 v_fmac_f32 v175, v79, v79
 v_fma_f32 v80, -v28, v48, v80
 v_fma_f32 v81, -v28, v49, v81
 v_fma_f32 v82, -v28, v50, v82
 v_fma_f32 v83, -v28, v51, v83
 v_fma_f32 v84, -v29, v48, v84
 v_fma_f32 v85, -v29, v49, v85
 v_fma_f32 v86, -v29, v50, v86
 v_fma_f32 v87, -v29, v51, v87
 v_fma_f32 v88, -v30, v48, v88
 v_fma_f32 v89, -v30, v49, v89
 v_fma_f32 v90, -v30, v50, v90
 v_fma_f32 v91, -v30, v51, v91
 v_fma_f32 v92, -v31, v48, v92
 v_fma_f32 v93, -v31, v49, v93
 v_fma_f32 v94, -v31, v50, v94
 v_fma_f32 v95, -v31, v51, v95
 v_mul_f32 v144, v80, v80
 v_mul_f32 v145, v81, v81
 v_mul_f32 v146, v82, v82
 v_mul_f32 v147, v83, v83
 v_mul_f32 v148, v84, v84
 v_mul_f32 v149, v85, v85
 v_mul_f32 v150, v86, v86
 v_mul_f32 v151, v87, v87
 v_mul_f32 v152, v88, v88
 v_mul_f32 v153, v89, v89
 v_mul_f32 v154, v90, v90
 v_mul_f32 v155, v91, v91
 v_mul_f32 v156, v92, v92
 v_mul_f32 v157, v93, v93
 v_mul_f32 v158, v94, v94
 v_mul_f32 v159, v95, v95
 v_fma_f32 v144, v144, v37, v36
 v_fma_f32 v145, v145, v37, v36
 v_fma_f32 v146, v146, v37, v36
 v_fma_f32 v147, v147, v37, v36
 v_fma_f32 v148, v148, v39, v38
 v_fma_f32 v149, v149, v39, v38
 v_fma_f32 v150, v150, v39, v38
 v_fma_f32 v151, v151, v39, v38
 v_fma_f32 v152, v152, v41, v40
 v_fma_f32 v153, v153, v41, v40
 v_fma_f32 v154, v154, v41, v40
 v_fma_f32 v155, v155, v41, v40
 v_fma_f32 v156, v156, v43, v42
 v_fma_f32 v157, v157, v43, v42
 v_fma_f32 v158, v158, v43, v42
 v_fma_f32 v159, v159, v43, v42
 v_mul_f32 v144, v144, v80
 v_mul_f32 v145, v145, v81
 v_mul_f32 v146, v146, v82
 v_mul_f32 v147, v147, v83
 v_mul_f32 v148, v148, v84
 v_mul_f32 v149, v149, v85
 v_mul_f32 v150, v150, v86
 v_mul_f32 v151, v151, v87
 v_mul_f32 v152, v152, v88
 v_mul_f32 v153, v153, v89
 v_mul_f32 v154, v154, v90
 v_mul_f32 v155, v155, v91
 v_mul_f32 v156, v156, v92
 v_mul_f32 v157, v157, v93
 v_mul_f32 v158, v158, v94
 v_mul_f32 v159, v159, v95
 v_exp_f32 v144, v144
 v_exp_f32 v145, v145
 v_exp_f32 v146, v146
 v_exp_f32 v147, v147
 v_exp_f32 v148, v148
 v_exp_f32 v149, v149
 v_exp_f32 v150, v150
 v_exp_f32 v151, v151
 v_exp_f32 v152, v152
 v_exp_f32 v153, v153
 v_exp_f32 v154, v154
 v_exp_f32 v155, v155
 v_exp_f32 v156, v156
 v_exp_f32 v157, v157
 v_exp_f32 v158, v158
 v_exp_f32 v159, v159
 v_add_f32 v144, 1.0, v144
 v_add_f32 v145, 1.0, v145
 v_add_f32 v146, 1.0, v146
 v_add_f32 v147, 1.0, v147
 v_add_f32 v148, 1.0, v148
 v_add_f32 v149, 1.0, v149
 v_add_f32 v150, 1.0, v150
 v_add_f32 v151, 1.0, v151
 v_add_f32 v152, 1.0, v152
 v_add_f32 v153, 1.0, v153
 v_add_f32 v154, 1.0, v154
 v_add_f32 v155, 1.0, v155
 v_add_f32 v156, 1.0, v156
 v_add_f32 v157, 1.0, v157
 v_add_f32 v158, 1.0, v158
 v_add_f32 v159, 1.0, v159
 v_rcp_f32 v144, v144
 v_rcp_f32 v145, v145
 v_rcp_f32 v146, v146
 v_rcp_f32 v147, v147
 v_rcp_f32 v148, v148
 v_rcp_f32 v149, v149
 v_rcp_f32 v150, v150
 v_rcp_f32 v151, v151
 v_rcp_f32 v152, v152
 v_rcp_f32 v153, v153
 v_rcp_f32 v154, v154
 v_rcp_f32 v155, v155
 v_rcp_f32 v156, v156
 v_rcp_f32 v157, v157
 v_rcp_f32 v158, v158
 v_rcp_f32 v159, v159
 v_mul_f32 v80, v80, v144
 v_mul_f32 v81, v81, v145
 v_mul_f32 v82, v82, v146
 v_mul_f32 v83, v83, v147
 v_mul_f32 v84, v84, v148
 v_mul_f32 v85, v85, v149
 v_mul_f32 v86, v86, v150
 v_mul_f32 v87, v87, v151
 v_mul_f32 v88, v88, v152
 v_mul_f32 v89, v89, v153
 v_mul_f32 v90, v90, v154
 v_mul_f32 v91, v91, v155
 v_mul_f32 v92, v92, v156
 v_mul_f32 v93, v93, v157
 v_mul_f32 v94, v94, v158
 v_mul_f32 v95, v95, v159
 v_add_f32 v160, v160, v80
 v_fmac_f32 v168, v80, v80
 v_add_f32 v162, v162, v84
 v_fmac_f32 v170, v84, v84
 v_add_f32 v164, v164, v88
 v_fmac_f32 v172, v88, v88
 v_add_f32 v166, v166, v92
 v_fmac_f32 v174, v92, v92
 v_add_f32 v161, v161, v81
 v_fmac_f32 v169, v81, v81
 v_add_f32 v163, v163, v85
 v_fmac_f32 v171, v85, v85
 v_add_f32 v165, v165, v89
 v_fmac_f32 v173, v89, v89
 v_add_f32 v167, v167, v93
 v_fmac_f32 v175, v93, v93
 v_add_f32 v160, v160, v82
 v_fmac_f32 v168, v82, v82
 v_add_f32 v162, v162, v86
 v_fmac_f32 v170, v86, v86
 v_add_f32 v164, v164, v90
 v_fmac_f32 v172, v90, v90
 v_add_f32 v166, v166, v94
 v_fmac_f32 v174, v94, v94
 v_add_f32 v161, v161, v83
 v_fmac_f32 v169, v83, v83
 v_add_f32 v163, v163, v87
 v_fmac_f32 v171, v87, v87
 v_add_f32 v165, v165, v91
 v_fmac_f32 v173, v91, v91
 v_add_f32 v167, v167, v95
 v_fmac_f32 v175, v95, v95
 v_fma_f32 v96, -v28, v52, v96
 v_fma_f32 v97, -v28, v53, v97
 v_fma_f32 v98, -v28, v54, v98
 v_fma_f32 v99, -v28, v55, v99
 v_fma_f32 v100, -v29, v52, v100
 v_fma_f32 v101, -v29, v53, v101
 v_fma_f32 v102, -v29, v54, v102
 v_fma_f32 v103, -v29, v55, v103
 v_fma_f32 v104, -v30, v52, v104
 v_fma_f32 v105, -v30, v53, v105
 v_fma_f32 v106, -v30, v54, v106
 v_fma_f32 v107, -v30, v55, v107
 v_fma_f32 v108, -v31, v52, v108
 v_fma_f32 v109, -v31, v53, v109
 v_fma_f32 v110, -v31, v54, v110
 v_fma_f32 v111, -v31, v55, v111
 v_mul_f32 v144, v96, v96
 v_mul_f32 v145, v97, v97
 v_mul_f32 v146, v98, v98
 v_mul_f32 v147, v99, v99
 v_mul_f32 v148, v100, v100
 v_mul_f32 v149, v101, v101
 v_mul_f32 v150, v102, v102
 v_mul_f32 v151, v103, v103
 v_mul_f32 v152, v104, v104
 v_mul_f32 v153, v105, v105
 v_mul_f32 v154, v106, v106
 v_mul_f32 v155, v107, v107
 v_mul_f32 v156, v108, v108
 v_mul_f32 v157, v109, v109
 v_mul_f32 v158, v110, v110
 v_mul_f32 v159, v111, v111
 v_fma_f32 v144, v144, v37, v36
 v_fma_f32 v145, v145, v37, v36
 v_fma_f32 v146, v146, v37, v36
 v_fma_f32 v147, v147, v37, v36
 v_fma_f32 v148, v148, v39, v38
 v_fma_f32 v149, v149, v39, v38
 v_fma_f32 v150, v150, v39, v38
 v_fma_f32 v151, v151, v39, v38
 v_fma_f32 v152, v152, v41, v40
 v_fma_f32 v153, v153, v41, v40
 v_fma_f32 v154, v154, v41, v40
 v_fma_f32 v155, v155, v41, v40
 v_fma_f32 v156, v156, v43, v42
 v_fma_f32 v157, v157, v43, v42
 v_fma_f32 v158, v158, v43, v42
 v_fma_f32 v159, v159, v43, v42
 v_mul_f32 v144, v144, v96
 v_mul_f32 v145, v145, v97
 v_mul_f32 v146, v146, v98
 v_mul_f32 v147, v147, v99
 v_mul_f32 v148, v148, v100
 v_mul_f32 v149, v149, v101
 v_mul_f32 v150, v150, v102
 v_mul_f32 v151, v151, v103
 v_mul_f32 v152, v152, v104
 v_mul_f32 v153, v153, v105
 v_mul_f32 v154, v154, v106
 v_mul_f32 v155, v155, v107
 v_mul_f32 v156, v156, v108
 v_mul_f32 v157, v157, v109
 v_mul_f32 v158, v158, v110
 v_mul_f32 v159, v159, v111
 v_exp_f32 v144, v144
 v_exp_f32 v145, v145
 v_exp_f32 v146, v146
 v_exp_f32 v147, v147
 v_exp_f32 v148, v148
 v_exp_f32 v149, v149
 v_exp_f32 v150, v150
 v_exp_f32 v151, v151
 v_exp_f32 v152, v152
 v_exp_f32 v153, v153
 v_exp_f32 v154, v154
 v_exp_f32 v155, v155
 v_exp_f32 v156, v156
 v_exp_f32 v157, v157
 v_exp_f32 v158, v158
 v_exp_f32 v159, v159
 v_add_f32 v144, 1.0, v144
 v_add_f32 v145, 1.0, v145
 v_add_f32 v146, 1.0, v146
 v_add_f32 v147, 1.0, v147
 v_add_f32 v148, 1.0, v148
 v_add_f32 v149, 1.0, v149
 v_add_f32 v150, 1.0, v150
 v_add_f32 v151, 1.0, v151
 v_add_f32 v152, 1.0, v152
 v_add_f32 v153, 1.0, v153
 v_add_f32 v154, 1.0, v154
 v_add_f32 v155, 1.0, v155
 v_add_f32 v156, 1.0, v156
 v_add_f32 v157, 1.0, v157
 v_add_f32 v158, 1.0, v158
 v_add_f32 v159, 1.0, v159
 v_rcp_f32 v144, v144
 v_rcp_f32 v145, v145
 v_rcp_f32 v146, v146
 v_rcp_f32 v147, v147
 v_rcp_f32 v148, v148
 v_rcp_f32 v149, v149
 v_rcp_f32 v150, v150
 v_rcp_f32 v151, v151
 v_rcp_f32 v152, v152
 v_rcp_f32 v153, v153
 v_rcp_f32 v154, v154
 v_rcp_f32 v155, v155
 v_rcp_f32 v156, v156
 v_rcp_f32 v157, v157
 v_rcp_f32 v158, v158
 v_rcp_f32 v159, v159
 v_mul_f32 v96, v96, v144
 v_mul_f32 v97, v97, v145
 v_mul_f32 v98, v98, v146
 v_mul_f32 v99, v99, v147
 v_mul_f32 v100, v100, v148
 v_mul_f32 v101, v101, v149
 v_mul_f32 v102, v102, v150
 v_mul_f32 v103, v103, v151
 v_mul_f32 v104, v104, v152
 v_mul_f32 v105, v105, v153
 v_mul_f32 v106, v106, v154
 v_mul_f32 v107, v107, v155
 v_mul_f32 v108, v108, v156
 v_mul_f32 v109, v109, v157
 v_mul_f32 v110, v110, v158
 v_mul_f32 v111, v111, v159
 v_add_f32 v160, v160, v96
 v_fmac_f32 v168, v96, v96
 v_add_f32 v162, v162, v100
 v_fmac_f32 v170, v100, v100
 v_add_f32 v164, v164, v104
 v_fmac_f32 v172, v104, v104
 v_add_f32 v166, v166, v108
 v_fmac_f32 v174, v108, v108
 v_add_f32 v161, v161, v97
 v_fmac_f32 v169, v97, v97
 v_add_f32 v163, v163, v101
 v_fmac_f32 v171, v101, v101
 v_add_f32 v165, v165, v105
 v_fmac_f32 v173, v105, v105
 v_add_f32 v167, v167, v109
 v_fmac_f32 v175, v109, v109
 v_add_f32 v160, v160, v98
 v_fmac_f32 v168, v98, v98
 v_add_f32 v162, v162, v102
 v_fmac_f32 v170, v102, v102
 v_add_f32 v164, v164, v106
 v_fmac_f32 v172, v106, v106
 v_add_f32 v166, v166, v110
 v_fmac_f32 v174, v110, v110
 v_add_f32 v161, v161, v99
 v_fmac_f32 v169, v99, v99
 v_add_f32 v163, v163, v103
 v_fmac_f32 v171, v103, v103
 v_add_f32 v165, v165, v107
 v_fmac_f32 v173, v107, v107
 v_add_f32 v167, v167, v111
 v_fmac_f32 v175, v111, v111
 s_mov_b32 s46, 20000
L_fz_p4x0:
 ds_read_b32 v18, v24
 s_waitcnt lgkmcnt(0)
 v_cmp_ne_u32 vcc, 1, v18
 s_sub_u32 s46, s46, 1
 s_cbranch_vccz L_fz_p4x0r
 s_cmp_lg_u32 s46, 0
 s_cbranch_scc1 L_fz_p4x0
L_fz_p4x0r:
 ds_read_b128 v[136:139], v26 offset:0
 ds_read_b128 v[140:143], v26 offset:1024
 v_fma_f32 v112, -v28, v56, v112
 v_fma_f32 v113, -v28, v57, v113
 v_fma_f32 v114, -v28, v58, v114
 v_fma_f32 v115, -v28, v59, v115
 v_fma_f32 v116, -v29, v56, v116
 v_fma_f32 v117, -v29, v57, v117
 v_fma_f32 v118, -v29, v58, v118
 v_fma_f32 v119, -v29, v59, v119
 v_fma_f32 v120, -v30, v56, v120
 v_fma_f32 v121, -v30, v57, v121
 v_fma_f32 v122, -v30, v58, v122
 v_fma_f32 v123, -v30, v59, v123
 v_fma_f32 v124, -v31, v56, v124
 v_fma_f32 v125, -v31, v57, v125
 v_fma_f32 v126, -v31, v58, v126
 v_fma_f32 v127, -v31, v59, v127
 v_mul_f32 v144, v112, v112
 v_mul_f32 v145, v113, v113
 v_mul_f32 v146, v114, v114
 v_mul_f32 v147, v115, v115
 v_mul_f32 v148, v116, v116
 v_mul_f32 v149, v117, v117
 v_mul_f32 v150, v118, v118
 v_mul_f32 v151, v119, v119
 v_mul_f32 v152, v120, v120
 v_mul_f32 v153, v121, v121
 v_mul_f32 v154, v122, v122
 v_mul_f32 v155, v123, v123
 v_mul_f32 v156, v124, v124
 v_mul_f32 v157, v125, v125
 v_mul_f32 v158, v126, v126
 v_mul_f32 v159, v127, v127
 v_fma_f32 v144, v144, v37, v36
 v_fma_f32 v145, v145, v37, v36
 v_fma_f32 v146, v146, v37, v36
 v_fma_f32 v147, v147, v37, v36
 v_fma_f32 v148, v148, v39, v38
 v_fma_f32 v149, v149, v39, v38
 v_fma_f32 v150, v150, v39, v38
 v_fma_f32 v151, v151, v39, v38
 v_fma_f32 v152, v152, v41, v40
 v_fma_f32 v153, v153, v41, v40
 v_fma_f32 v154, v154, v41, v40
 v_fma_f32 v155, v155, v41, v40
 v_fma_f32 v156, v156, v43, v42
 v_fma_f32 v157, v157, v43, v42
 v_fma_f32 v158, v158, v43, v42
 v_fma_f32 v159, v159, v43, v42
 v_mul_f32 v144, v144, v112
 v_mul_f32 v145, v145, v113
 v_mul_f32 v146, v146, v114
 v_mul_f32 v147, v147, v115
 v_mul_f32 v148, v148, v116
 v_mul_f32 v149, v149, v117
 v_mul_f32 v150, v150, v118
 v_mul_f32 v151, v151, v119
 v_mul_f32 v152, v152, v120
 v_mul_f32 v153, v153, v121
 v_mul_f32 v154, v154, v122
 v_mul_f32 v155, v155, v123
 v_mul_f32 v156, v156, v124
 v_mul_f32 v157, v157, v125
 v_mul_f32 v158, v158, v126
 v_mul_f32 v159, v159, v127
 v_exp_f32 v144, v144
 v_exp_f32 v145, v145
 v_exp_f32 v146, v146
 v_exp_f32 v147, v147
 v_exp_f32 v148, v148
 v_exp_f32 v149, v149
 v_exp_f32 v150, v150
 v_exp_f32 v151, v151
 v_exp_f32 v152, v152
 v_exp_f32 v153, v153
 v_exp_f32 v154, v154
 v_exp_f32 v155, v155
 v_exp_f32 v156, v156
 v_exp_f32 v157, v157
 v_exp_f32 v158, v158
 v_exp_f32 v159, v159
 v_add_f32 v144, 1.0, v144
 v_add_f32 v145, 1.0, v145
 v_add_f32 v146, 1.0, v146
 v_add_f32 v147, 1.0, v147
 v_add_f32 v148, 1.0, v148
 v_add_f32 v149, 1.0, v149
 v_add_f32 v150, 1.0, v150
 v_add_f32 v151, 1.0, v151
 v_add_f32 v152, 1.0, v152
 v_add_f32 v153, 1.0, v153
 v_add_f32 v154, 1.0, v154
 v_add_f32 v155, 1.0, v155
 v_add_f32 v156, 1.0, v156
 v_add_f32 v157, 1.0, v157
 v_add_f32 v158, 1.0, v158
 v_add_f32 v159, 1.0, v159
 v_rcp_f32 v144, v144
 v_rcp_f32 v145, v145
 v_rcp_f32 v146, v146
 v_rcp_f32 v147, v147
 v_rcp_f32 v148, v148
 v_rcp_f32 v149, v149
 v_rcp_f32 v150, v150
 v_rcp_f32 v151, v151
 v_rcp_f32 v152, v152
 v_rcp_f32 v153, v153
 v_rcp_f32 v154, v154
 v_rcp_f32 v155, v155
 v_rcp_f32 v156, v156
 v_rcp_f32 v157, v157
 v_rcp_f32 v158, v158
 v_rcp_f32 v159, v159
 v_mul_f32 v112, v112, v144
 v_mul_f32 v113, v113, v145
 v_mul_f32 v114, v114, v146
 v_mul_f32 v115, v115, v147
 v_mul_f32 v116, v116, v148
 v_mul_f32 v117, v117, v149
 v_mul_f32 v118, v118, v150
 v_mul_f32 v119, v119, v151
 v_mul_f32 v120, v120, v152
 v_mul_f32 v121, v121, v153
 v_mul_f32 v122, v122, v154
 v_mul_f32 v123, v123, v155
 v_mul_f32 v124, v124, v156
 v_mul_f32 v125, v125, v157
 v_mul_f32 v126, v126, v158
 v_mul_f32 v127, v127, v159
 v_add_f32 v160, v160, v112
 v_fmac_f32 v168, v112, v112
 v_add_f32 v162, v162, v116
 v_fmac_f32 v170, v116, v116
 v_add_f32 v164, v164, v120
 v_fmac_f32 v172, v120, v120
 v_add_f32 v166, v166, v124
 v_fmac_f32 v174, v124, v124
 v_add_f32 v161, v161, v113
 v_fmac_f32 v169, v113, v113
 v_add_f32 v163, v163, v117
 v_fmac_f32 v171, v117, v117
 v_add_f32 v165, v165, v121
 v_fmac_f32 v173, v121, v121
 v_add_f32 v167, v167, v125
 v_fmac_f32 v175, v125, v125
 v_add_f32 v160, v160, v114
 v_fmac_f32 v168, v114, v114
 v_add_f32 v162, v162, v118
 v_fmac_f32 v170, v118, v118
 v_add_f32 v164, v164, v122
 v_fmac_f32 v172, v122, v122
 v_add_f32 v166, v166, v126
 v_fmac_f32 v174, v126, v126
 v_add_f32 v161, v161, v115
 v_fmac_f32 v169, v115, v115
 v_add_f32 v163, v163, v119
 v_fmac_f32 v171, v119, v119
 v_add_f32 v165, v165, v123
 v_fmac_f32 v173, v123, v123
 v_add_f32 v167, v167, v127
 v_fmac_f32 v175, v127, v127
 s_waitcnt lgkmcnt(0)
 v_add_f32 v128, v128, v136
 v_add_f32 v129, v129, v137
 v_add_f32 v130, v130, v138
 v_add_f32 v131, v131, v139
 v_add_f32 v132, v132, v140
 v_add_f32 v133, v133, v141
 v_add_f32 v134, v134, v142
 v_add_f32 v135, v135, v143
 v_fma_f32 v128, -v28, v60, v128
 v_fma_f32 v129, -v28, v61, v129
 v_fma_f32 v130, -v28, v62, v130
 v_fma_f32 v131, -v28, v63, v131
 v_fma_f32 v132, -v29, v60, v132
 v_fma_f32 v133, -v29, v61, v133
 v_fma_f32 v134, -v29, v62, v134
 v_fma_f32 v135, -v29, v63, v135
 v_mul_f32 v144, v128, v128
 v_mul_f32 v145, v129, v129
 v_mul_f32 v146, v130, v130
 v_mul_f32 v147, v131, v131
 v_mul_f32 v148, v132, v132
 v_mul_f32 v149, v133, v133
 v_mul_f32 v150, v134, v134
 v_mul_f32 v151, v135, v135
 v_fma_f32 v144, v144, v37, v36
 v_fma_f32 v145, v145, v37, v36
 v_fma_f32 v146, v146, v37, v36
 v_fma_f32 v147, v147, v37, v36
 v_fma_f32 v148, v148, v39, v38
 v_fma_f32 v149, v149, v39, v38
 v_fma_f32 v150, v150, v39, v38
 v_fma_f32 v151, v151, v39, v38
 v_mul_f32 v144, v144, v128
 v_mul_f32 v145, v145, v129
 v_mul_f32 v146, v146, v130
 v_mul_f32 v147, v147, v131
 v_mul_f32 v148, v148, v132
 v_mul_f32 v149, v149, v133
 v_mul_f32 v150, v150, v134
 v_mul_f32 v151, v151, v135
 v_exp_f32 v144, v144
 v_exp_f32 v145, v145
 v_exp_f32 v146, v146
 v_exp_f32 v147, v147
 v_exp_f32 v148, v148
 v_exp_f32 v149, v149
 v_exp_f32 v150, v150
 v_exp_f32 v151, v151
 v_add_f32 v144, 1.0, v144
 v_add_f32 v145, 1.0, v145
 v_add_f32 v146, 1.0, v146
 v_add_f32 v147, 1.0, v147
 v_add_f32 v148, 1.0, v148
 v_add_f32 v149, 1.0, v149
 v_add_f32 v150, 1.0, v150
 v_add_f32 v151, 1.0, v151
 v_rcp_f32 v144, v144
 v_rcp_f32 v145, v145
 v_rcp_f32 v146, v146
 v_rcp_f32 v147, v147
 v_rcp_f32 v148, v148
 v_rcp_f32 v149, v149
 v_rcp_f32 v150, v150
 v_rcp_f32 v151, v151
 v_mul_f32 v128, v128, v144
 v_mul_f32 v129, v129, v145
 v_mul_f32 v130, v130, v146
 v_mul_f32 v131, v131, v147
 v_mul_f32 v132, v132, v148
 v_mul_f32 v133, v133, v149
 v_mul_f32 v134, v134, v150
 v_mul_f32 v135, v135, v151
 v_add_f32 v160, v160, v128
 v_fmac_f32 v168, v128, v128
 v_add_f32 v162, v162, v132
 v_fmac_f32 v170, v132, v132
 v_add_f32 v161, v161, v129
 v_fmac_f32 v169, v129, v129
 v_add_f32 v163, v163, v133
 v_fmac_f32 v171, v133, v133
 v_add_f32 v160, v160, v130
 v_fmac_f32 v168, v130, v130
 v_add_f32 v162, v162, v134
 v_fmac_f32 v170, v134, v134
 v_add_f32 v161, v161, v131
 v_fmac_f32 v169, v131, v131
 v_add_f32 v163, v163, v135
 v_fmac_f32 v171, v135, v135
 v_add_f32 v144, v160, v161
 v_add_f32 v148, v168, v169
 v_add_f32 v145, v162, v163
 v_add_f32 v149, v170, v171
 v_add_f32 v146, v164, v165
 v_add_f32 v150, v172, v173
 v_add_f32 v147, v166, v167
 v_add_f32 v151, v174, v175
 s_nop 0
 v_permlane32_swap_b32 v144, v146
 v_permlane32_swap_b32 v145, v147
 v_permlane32_swap_b32 v148, v150
 v_permlane32_swap_b32 v149, v151
 v_add_f32 v144, v144, v146
 v_add_f32 v145, v145, v147
 v_add_f32 v148, v148, v150
 v_add_f32 v149, v149, v151
 s_nop 0
 v_permlane16_swap_b32 v144, v145
 v_permlane16_swap_b32 v148, v149
 s_lshl_b32 s36, s33, 14
 s_lshl_b32 s37, s44, 9
 v_add_f32 v160, v144, v145
 v_add_f32 v161, v148, v149
 s_add_u32 s36, s36, s37
 s_add_u32 s36, s36, 15728640
 s_add_u32 s28, s8, s36
 s_addc_u32 s29, s9, 0
 s_mov_b32 s30, 16384
 s_mov_b32 s31, 0x20000
 v_lshlrev_b32 v18, 3, v0
 s_mov_b32 s46, 20000
L_fz_p4hs:
 ds_read_b64 v[162:163], v27
 s_waitcnt lgkmcnt(0)
 v_cmp_eq_u32 vcc, -1, v163
 s_sub_u32 s46, s46, 1
 s_cbranch_vccz L_fz_p4hsr
 s_cmp_lg_u32 s46, 0
 s_cbranch_scc1 L_fz_p4hs
L_fz_p4hsr:
 v_add_f32 v160, v160, v162
 v_add_f32 v161, v161, v163
 s_lshl_b32 s36, s34, 10
 buffer_store_dwordx2 v[160:161], v18, s[28:31], s36 offen sc1
 s_branch L_fz_p4g0j
L_fz_p4g0b:
 s_waitcnt lgkmcnt(0)
 s_barrier
 ds_read_b128 v[144:147], v8 offset:0
 ds_read_b64_tr_b16 v[160:161], v9 offset:0
 ds_read_b64_tr_b16 v[162:163], v9 offset:2304
 ds_read_b128 v[148:151], v8 offset:2048
 ds_read_b128 v[152:155], v8 offset:4096
 ds_read_b128 v[156:159], v8 offset:6144
 ds_read_b64_tr_b16 v[164:165], v9 offset:32
 ds_read_b64_tr_b16 v[166:167], v9 offset:2336
 ds_read_b64_tr_b16 v[168:169], v9 offset:64
 ds_read_b64_tr_b16 v[170:171], v9 offset:2368
 ds_read_b64_tr_b16 v[172:173], v9 offset:96
 ds_read_b64_tr_b16 v[174:175], v9 offset:2400
 s_waitcnt lgkmcnt(6)
 v_mfma_f32_16x16x32_bf16 v[64:67], v[160:163], v[144:147], 0
 v_mfma_f32_16x16x32_bf16 v[68:71], v[160:163], v[148:151], 0
 v_mfma_f32_16x16x32_bf16 v[72:75], v[160:163], v[152:155], 0
 v_mfma_f32_16x16x32_bf16 v[76:79], v[160:163], v[156:159], 0
 s_waitcnt lgkmcnt(0)
 v_mfma_f32_16x16x32_bf16 v[80:83], v[164:167], v[144:147], 0
 ds_read_b128 v[180:183], v8 offset:1024
 v_mfma_f32_16x16x32_bf16 v[84:87], v[164:167], v[148:151], 0
 ds_read_b64_tr_b16 v[196:197], v9 offset:9216
 v_mfma_f32_16x16x32_bf16 v[88:91], v[164:167], v[152:155], 0
 ds_read_b64_tr_b16 v[198:199], v9 offset:11520
 v_mfma_f32_16x16x32_bf16 v[92:95], v[164:167], v[156:159], 0
 ds_read_b128 v[184:187], v8 offset:3072
 v_mfma_f32_16x16x32_bf16 v[96:99], v[168:171], v[144:147], 0
 ds_read_b128 v[188:191], v8 offset:5120
 v_mfma_f32_16x16x32_bf16 v[100:103], v[168:171], v[148:151], 0
 ds_read_b128 v[192:195], v8 offset:7168
 v_mfma_f32_16x16x32_bf16 v[104:107], v[168:171], v[152:155], 0
 ds_read_b64_tr_b16 v[200:201], v9 offset:9248
 v_mfma_f32_16x16x32_bf16 v[108:111], v[168:171], v[156:159], 0
 ds_read_b64_tr_b16 v[202:203], v9 offset:11552
 v_mfma_f32_16x16x32_bf16 v[112:115], v[172:175], v[144:147], 0
 ds_read_b64_tr_b16 v[204:205], v9 offset:9280
 v_mfma_f32_16x16x32_bf16 v[116:119], v[172:175], v[148:151], 0
 ds_read_b64_tr_b16 v[206:207], v9 offset:11584
 v_mfma_f32_16x16x32_bf16 v[120:123], v[172:175], v[152:155], 0
 ds_read_b64_tr_b16 v[208:209], v9 offset:9312
 v_mfma_f32_16x16x32_bf16 v[124:127], v[172:175], v[156:159], 0
 ds_read_b64_tr_b16 v[210:211], v9 offset:11616
 ds_read_b64_tr_b16 v[212:213], v10 offset:9216
 ds_read_b64_tr_b16 v[214:215], v10 offset:11520
 v_add_u32 v8, 16384, v2
 v_add_u32 v9, 89088, v3
 v_add_u32 v10, 89088, v4
 s_waitcnt lgkmcnt(8)
 v_mfma_f32_16x16x32_bf16 v[64:67], v[196:199], v[180:183], v[64:67]
 v_mfma_f32_16x16x32_bf16 v[68:71], v[196:199], v[184:187], v[68:71]
 v_mfma_f32_16x16x32_bf16 v[72:75], v[196:199], v[188:191], v[72:75]
 v_mfma_f32_16x16x32_bf16 v[76:79], v[196:199], v[192:195], v[76:79]
 s_waitcnt lgkmcnt(0)
 s_barrier
 v_mfma_f32_16x16x32_bf16 v[128:131], v[212:215], v[180:183], v[128:131]
 ds_read_b128 v[144:147], v8 offset:0
 v_mfma_f32_16x16x32_bf16 v[132:135], v[212:215], v[184:187], v[132:135]
 ds_read_b64_tr_b16 v[160:161], v9 offset:0
 v_mfma_f32_16x16x32_bf16 v[136:139], v[212:215], v[188:191], v[136:139]
 ds_read_b64_tr_b16 v[162:163], v9 offset:2304
 v_mfma_f32_16x16x32_bf16 v[140:143], v[212:215], v[192:195], v[140:143]
 ds_read_b128 v[148:151], v8 offset:2048
 v_mfma_f32_16x16x32_bf16 v[80:83], v[200:203], v[180:183], v[80:83]
 ds_read_b128 v[152:155], v8 offset:4096
 v_mfma_f32_16x16x32_bf16 v[84:87], v[200:203], v[184:187], v[84:87]
 ds_read_b128 v[156:159], v8 offset:6144
 v_mfma_f32_16x16x32_bf16 v[88:91], v[200:203], v[188:191], v[88:91]
 ds_read_b64_tr_b16 v[164:165], v9 offset:32
 v_mfma_f32_16x16x32_bf16 v[92:95], v[200:203], v[192:195], v[92:95]
 ds_read_b64_tr_b16 v[166:167], v9 offset:2336
 v_mfma_f32_16x16x32_bf16 v[96:99], v[204:207], v[180:183], v[96:99]
 ds_read_b64_tr_b16 v[168:169], v9 offset:64
 v_mfma_f32_16x16x32_bf16 v[100:103], v[204:207], v[184:187], v[100:103]
 ds_read_b64_tr_b16 v[170:171], v9 offset:2368
 v_mfma_f32_16x16x32_bf16 v[104:107], v[204:207], v[188:191], v[104:107]
 ds_read_b64_tr_b16 v[172:173], v9 offset:96
 v_mfma_f32_16x16x32_bf16 v[108:111], v[204:207], v[192:195], v[108:111]
 ds_read_b64_tr_b16 v[174:175], v9 offset:2400
 v_mfma_f32_16x16x32_bf16 v[112:115], v[208:211], v[180:183], v[112:115]
 v_mfma_f32_16x16x32_bf16 v[116:119], v[208:211], v[184:187], v[116:119]
 v_mfma_f32_16x16x32_bf16 v[120:123], v[208:211], v[188:191], v[120:123]
 v_mfma_f32_16x16x32_bf16 v[124:127], v[208:211], v[192:195], v[124:127]
 s_waitcnt lgkmcnt(6)
 v_mfma_f32_16x16x32_bf16 v[64:67], v[160:163], v[144:147], v[64:67]
 v_mfma_f32_16x16x32_bf16 v[68:71], v[160:163], v[148:151], v[68:71]
 v_mfma_f32_16x16x32_bf16 v[72:75], v[160:163], v[152:155], v[72:75]
 v_mfma_f32_16x16x32_bf16 v[76:79], v[160:163], v[156:159], v[76:79]
 s_waitcnt lgkmcnt(0)
 v_mfma_f32_16x16x32_bf16 v[80:83], v[164:167], v[144:147], v[80:83]
 ds_read_b128 v[180:183], v8 offset:1024
 v_mfma_f32_16x16x32_bf16 v[84:87], v[164:167], v[148:151], v[84:87]
 ds_read_b64_tr_b16 v[196:197], v9 offset:9216
 v_mfma_f32_16x16x32_bf16 v[88:91], v[164:167], v[152:155], v[88:91]
 ds_read_b64_tr_b16 v[198:199], v9 offset:11520
 v_mfma_f32_16x16x32_bf16 v[92:95], v[164:167], v[156:159], v[92:95]
 ds_read_b128 v[184:187], v8 offset:3072
 v_mfma_f32_16x16x32_bf16 v[96:99], v[168:171], v[144:147], v[96:99]
 ds_read_b128 v[188:191], v8 offset:5120
 v_mfma_f32_16x16x32_bf16 v[100:103], v[168:171], v[148:151], v[100:103]
 ds_read_b128 v[192:195], v8 offset:7168
 v_mfma_f32_16x16x32_bf16 v[104:107], v[168:171], v[152:155], v[104:107]
 ds_read_b64_tr_b16 v[200:201], v9 offset:9248
 v_mfma_f32_16x16x32_bf16 v[108:111], v[168:171], v[156:159], v[108:111]
 ds_read_b64_tr_b16 v[202:203], v9 offset:11552
 v_mfma_f32_16x16x32_bf16 v[112:115], v[172:175], v[144:147], v[112:115]
 ds_read_b64_tr_b16 v[204:205], v9 offset:9280
 v_mfma_f32_16x16x32_bf16 v[116:119], v[172:175], v[148:151], v[116:119]
 ds_read_b64_tr_b16 v[206:207], v9 offset:11584
 v_mfma_f32_16x16x32_bf16 v[120:123], v[172:175], v[152:155], v[120:123]
 ds_read_b64_tr_b16 v[208:209], v9 offset:9312
 v_mfma_f32_16x16x32_bf16 v[124:127], v[172:175], v[156:159], v[124:127]
 ds_read_b64_tr_b16 v[210:211], v9 offset:11616
 ds_read_b64_tr_b16 v[212:213], v10 offset:9216
 ds_read_b64_tr_b16 v[214:215], v10 offset:11520
 v_add_u32 v8, 32768, v2
 v_add_u32 v9, 107520, v3
 v_add_u32 v10, 107520, v4
 s_waitcnt lgkmcnt(8)
 v_mfma_f32_16x16x32_bf16 v[64:67], v[196:199], v[180:183], v[64:67]
 v_mfma_f32_16x16x32_bf16 v[68:71], v[196:199], v[184:187], v[68:71]
 v_mfma_f32_16x16x32_bf16 v[72:75], v[196:199], v[188:191], v[72:75]
 v_mfma_f32_16x16x32_bf16 v[76:79], v[196:199], v[192:195], v[76:79]
 s_waitcnt lgkmcnt(0)
 s_barrier
 v_mfma_f32_16x16x32_bf16 v[128:131], v[212:215], v[180:183], v[128:131]
 ds_read_b128 v[144:147], v8 offset:0
 v_mfma_f32_16x16x32_bf16 v[132:135], v[212:215], v[184:187], v[132:135]
 ds_read_b64_tr_b16 v[160:161], v9 offset:0
 v_mfma_f32_16x16x32_bf16 v[136:139], v[212:215], v[188:191], v[136:139]
 ds_read_b64_tr_b16 v[162:163], v9 offset:2304
 v_mfma_f32_16x16x32_bf16 v[140:143], v[212:215], v[192:195], v[140:143]
 ds_read_b128 v[148:151], v8 offset:2048
 v_mfma_f32_16x16x32_bf16 v[80:83], v[200:203], v[180:183], v[80:83]
 ds_read_b128 v[152:155], v8 offset:4096
 v_mfma_f32_16x16x32_bf16 v[84:87], v[200:203], v[184:187], v[84:87]
 ds_read_b128 v[156:159], v8 offset:6144
 v_mfma_f32_16x16x32_bf16 v[88:91], v[200:203], v[188:191], v[88:91]
 ds_read_b64_tr_b16 v[164:165], v9 offset:32
 v_mfma_f32_16x16x32_bf16 v[92:95], v[200:203], v[192:195], v[92:95]
 ds_read_b64_tr_b16 v[166:167], v9 offset:2336
 v_mfma_f32_16x16x32_bf16 v[96:99], v[204:207], v[180:183], v[96:99]
 ds_read_b64_tr_b16 v[168:169], v9 offset:64
 v_mfma_f32_16x16x32_bf16 v[100:103], v[204:207], v[184:187], v[100:103]
 ds_read_b64_tr_b16 v[170:171], v9 offset:2368
 v_mfma_f32_16x16x32_bf16 v[104:107], v[204:207], v[188:191], v[104:107]
 ds_read_b64_tr_b16 v[172:173], v9 offset:96
 v_mfma_f32_16x16x32_bf16 v[108:111], v[204:207], v[192:195], v[108:111]
 ds_read_b64_tr_b16 v[174:175], v9 offset:2400
 v_mfma_f32_16x16x32_bf16 v[112:115], v[208:211], v[180:183], v[112:115]
 v_mfma_f32_16x16x32_bf16 v[116:119], v[208:211], v[184:187], v[116:119]
 v_mfma_f32_16x16x32_bf16 v[120:123], v[208:211], v[188:191], v[120:123]
 v_mfma_f32_16x16x32_bf16 v[124:127], v[208:211], v[192:195], v[124:127]
 s_waitcnt lgkmcnt(6)
 v_mfma_f32_16x16x32_bf16 v[64:67], v[160:163], v[144:147], v[64:67]
 v_mfma_f32_16x16x32_bf16 v[68:71], v[160:163], v[148:151], v[68:71]
 v_mfma_f32_16x16x32_bf16 v[72:75], v[160:163], v[152:155], v[72:75]
 v_mfma_f32_16x16x32_bf16 v[76:79], v[160:163], v[156:159], v[76:79]
 s_waitcnt lgkmcnt(0)
 v_mfma_f32_16x16x32_bf16 v[80:83], v[164:167], v[144:147], v[80:83]
 ds_read_b128 v[180:183], v8 offset:1024
 v_mfma_f32_16x16x32_bf16 v[84:87], v[164:167], v[148:151], v[84:87]
 ds_read_b64_tr_b16 v[196:197], v9 offset:9216
 v_mfma_f32_16x16x32_bf16 v[88:91], v[164:167], v[152:155], v[88:91]
 ds_read_b64_tr_b16 v[198:199], v9 offset:11520
 v_mfma_f32_16x16x32_bf16 v[92:95], v[164:167], v[156:159], v[92:95]
 ds_read_b128 v[184:187], v8 offset:3072
 v_mfma_f32_16x16x32_bf16 v[96:99], v[168:171], v[144:147], v[96:99]
 ds_read_b128 v[188:191], v8 offset:5120
 v_mfma_f32_16x16x32_bf16 v[100:103], v[168:171], v[148:151], v[100:103]
 ds_read_b128 v[192:195], v8 offset:7168
 v_mfma_f32_16x16x32_bf16 v[104:107], v[168:171], v[152:155], v[104:107]
 ds_read_b64_tr_b16 v[200:201], v9 offset:9248
 v_mfma_f32_16x16x32_bf16 v[108:111], v[168:171], v[156:159], v[108:111]
 ds_read_b64_tr_b16 v[202:203], v9 offset:11552
 v_mfma_f32_16x16x32_bf16 v[112:115], v[172:175], v[144:147], v[112:115]
 ds_read_b64_tr_b16 v[204:205], v9 offset:9280
 v_mfma_f32_16x16x32_bf16 v[116:119], v[172:175], v[148:151], v[116:119]
 ds_read_b64_tr_b16 v[206:207], v9 offset:11584
 v_mfma_f32_16x16x32_bf16 v[120:123], v[172:175], v[152:155], v[120:123]
 ds_read_b64_tr_b16 v[208:209], v9 offset:9312
 v_mfma_f32_16x16x32_bf16 v[124:127], v[172:175], v[156:159], v[124:127]
 ds_read_b64_tr_b16 v[210:211], v9 offset:11616
 ds_read_b64_tr_b16 v[212:213], v10 offset:9216
 ds_read_b64_tr_b16 v[214:215], v10 offset:11520
 v_add_u32 v8, 49152, v2
 v_add_u32 v9, 125952, v3
 v_add_u32 v10, 125952, v4
 s_waitcnt lgkmcnt(8)
 v_mfma_f32_16x16x32_bf16 v[64:67], v[196:199], v[180:183], v[64:67]
 v_mfma_f32_16x16x32_bf16 v[68:71], v[196:199], v[184:187], v[68:71]
 v_mfma_f32_16x16x32_bf16 v[72:75], v[196:199], v[188:191], v[72:75]
 v_mfma_f32_16x16x32_bf16 v[76:79], v[196:199], v[192:195], v[76:79]
 s_waitcnt lgkmcnt(0)
 s_barrier
 v_mfma_f32_16x16x32_bf16 v[128:131], v[212:215], v[180:183], v[128:131]
 ds_read_b128 v[144:147], v8 offset:0
 v_mfma_f32_16x16x32_bf16 v[132:135], v[212:215], v[184:187], v[132:135]
 ds_read_b64_tr_b16 v[160:161], v9 offset:0
 v_mfma_f32_16x16x32_bf16 v[136:139], v[212:215], v[188:191], v[136:139]
 ds_read_b64_tr_b16 v[162:163], v9 offset:2304
 v_mfma_f32_16x16x32_bf16 v[140:143], v[212:215], v[192:195], v[140:143]
 ds_read_b128 v[148:151], v8 offset:2048
 v_mfma_f32_16x16x32_bf16 v[80:83], v[200:203], v[180:183], v[80:83]
 ds_read_b128 v[152:155], v8 offset:4096
 v_mfma_f32_16x16x32_bf16 v[84:87], v[200:203], v[184:187], v[84:87]
 ds_read_b128 v[156:159], v8 offset:6144
 v_mfma_f32_16x16x32_bf16 v[88:91], v[200:203], v[188:191], v[88:91]
 ds_read_b64_tr_b16 v[164:165], v9 offset:32
 v_mfma_f32_16x16x32_bf16 v[92:95], v[200:203], v[192:195], v[92:95]
 ds_read_b64_tr_b16 v[166:167], v9 offset:2336
 v_mfma_f32_16x16x32_bf16 v[96:99], v[204:207], v[180:183], v[96:99]
 ds_read_b64_tr_b16 v[168:169], v9 offset:64
 v_mfma_f32_16x16x32_bf16 v[100:103], v[204:207], v[184:187], v[100:103]
 ds_read_b64_tr_b16 v[170:171], v9 offset:2368
 v_mfma_f32_16x16x32_bf16 v[104:107], v[204:207], v[188:191], v[104:107]
 ds_read_b64_tr_b16 v[172:173], v9 offset:96
 v_mfma_f32_16x16x32_bf16 v[108:111], v[204:207], v[192:195], v[108:111]
 ds_read_b64_tr_b16 v[174:175], v9 offset:2400
 v_mfma_f32_16x16x32_bf16 v[112:115], v[208:211], v[180:183], v[112:115]
 v_mfma_f32_16x16x32_bf16 v[116:119], v[208:211], v[184:187], v[116:119]
 v_mfma_f32_16x16x32_bf16 v[120:123], v[208:211], v[188:191], v[120:123]
 v_mfma_f32_16x16x32_bf16 v[124:127], v[208:211], v[192:195], v[124:127]
 s_waitcnt lgkmcnt(6)
 v_mfma_f32_16x16x32_bf16 v[64:67], v[160:163], v[144:147], v[64:67]
 v_mfma_f32_16x16x32_bf16 v[68:71], v[160:163], v[148:151], v[68:71]
 v_mfma_f32_16x16x32_bf16 v[72:75], v[160:163], v[152:155], v[72:75]
 v_mfma_f32_16x16x32_bf16 v[76:79], v[160:163], v[156:159], v[76:79]
 s_waitcnt lgkmcnt(0)
 v_mfma_f32_16x16x32_bf16 v[80:83], v[164:167], v[144:147], v[80:83]
 ds_read_b128 v[180:183], v8 offset:1024
 v_mfma_f32_16x16x32_bf16 v[84:87], v[164:167], v[148:151], v[84:87]
 ds_read_b64_tr_b16 v[196:197], v9 offset:9216
 v_mfma_f32_16x16x32_bf16 v[88:91], v[164:167], v[152:155], v[88:91]
 ds_read_b64_tr_b16 v[198:199], v9 offset:11520
 v_mfma_f32_16x16x32_bf16 v[92:95], v[164:167], v[156:159], v[92:95]
 ds_read_b128 v[184:187], v8 offset:3072
 v_mfma_f32_16x16x32_bf16 v[96:99], v[168:171], v[144:147], v[96:99]
 ds_read_b128 v[188:191], v8 offset:5120
 v_mfma_f32_16x16x32_bf16 v[100:103], v[168:171], v[148:151], v[100:103]
 ds_read_b128 v[192:195], v8 offset:7168
 v_mfma_f32_16x16x32_bf16 v[104:107], v[168:171], v[152:155], v[104:107]
 ds_read_b64_tr_b16 v[200:201], v9 offset:9248
 v_mfma_f32_16x16x32_bf16 v[108:111], v[168:171], v[156:159], v[108:111]
 ds_read_b64_tr_b16 v[202:203], v9 offset:11552
 v_mfma_f32_16x16x32_bf16 v[112:115], v[172:175], v[144:147], v[112:115]
 ds_read_b64_tr_b16 v[204:205], v9 offset:9280
 v_mfma_f32_16x16x32_bf16 v[116:119], v[172:175], v[148:151], v[116:119]
 ds_read_b64_tr_b16 v[206:207], v9 offset:11584
 v_mfma_f32_16x16x32_bf16 v[120:123], v[172:175], v[152:155], v[120:123]
 ds_read_b64_tr_b16 v[208:209], v9 offset:9312
 v_mfma_f32_16x16x32_bf16 v[124:127], v[172:175], v[156:159], v[124:127]
 ds_read_b64_tr_b16 v[210:211], v9 offset:11616
 ds_read_b64_tr_b16 v[212:213], v10 offset:9216
 ds_read_b64_tr_b16 v[214:215], v10 offset:11520
 v_mov_b32 v8, v2
 v_add_u32 v9, 70656, v3
 v_add_u32 v10, 70656, v4
 s_waitcnt lgkmcnt(8)
 v_mfma_f32_16x16x32_bf16 v[64:67], v[196:199], v[180:183], v[64:67]
 v_mfma_f32_16x16x32_bf16 v[68:71], v[196:199], v[184:187], v[68:71]
 v_mfma_f32_16x16x32_bf16 v[72:75], v[196:199], v[188:191], v[72:75]
 v_mfma_f32_16x16x32_bf16 v[76:79], v[196:199], v[192:195], v[76:79]
 s_waitcnt lgkmcnt(0)
 s_barrier
 v_mfma_f32_16x16x32_bf16 v[128:131], v[212:215], v[180:183], v[128:131]
 ds_read_b128 v[144:147], v8 offset:0
 v_mfma_f32_16x16x32_bf16 v[132:135], v[212:215], v[184:187], v[132:135]
 ds_read_b64_tr_b16 v[160:161], v9 offset:0
 v_mfma_f32_16x16x32_bf16 v[136:139], v[212:215], v[188:191], v[136:139]
 ds_read_b64_tr_b16 v[162:163], v9 offset:2304
 v_mfma_f32_16x16x32_bf16 v[140:143], v[212:215], v[192:195], v[140:143]
 ds_read_b128 v[148:151], v8 offset:2048
 v_mfma_f32_16x16x32_bf16 v[80:83], v[200:203], v[180:183], v[80:83]
 ds_read_b128 v[152:155], v8 offset:4096
 v_mfma_f32_16x16x32_bf16 v[84:87], v[200:203], v[184:187], v[84:87]
 ds_read_b128 v[156:159], v8 offset:6144
 v_mfma_f32_16x16x32_bf16 v[88:91], v[200:203], v[188:191], v[88:91]
 ds_read_b64_tr_b16 v[164:165], v9 offset:32
 v_mfma_f32_16x16x32_bf16 v[92:95], v[200:203], v[192:195], v[92:95]
 ds_read_b64_tr_b16 v[166:167], v9 offset:2336
 v_mfma_f32_16x16x32_bf16 v[96:99], v[204:207], v[180:183], v[96:99]
 ds_read_b64_tr_b16 v[168:169], v9 offset:64
 v_mfma_f32_16x16x32_bf16 v[100:103], v[204:207], v[184:187], v[100:103]
 ds_read_b64_tr_b16 v[170:171], v9 offset:2368
 v_mfma_f32_16x16x32_bf16 v[104:107], v[204:207], v[188:191], v[104:107]
 ds_read_b64_tr_b16 v[172:173], v9 offset:96
 v_mfma_f32_16x16x32_bf16 v[108:111], v[204:207], v[192:195], v[108:111]
 ds_read_b64_tr_b16 v[174:175], v9 offset:2400
 v_mfma_f32_16x16x32_bf16 v[112:115], v[208:211], v[180:183], v[112:115]
 v_mfma_f32_16x16x32_bf16 v[116:119], v[208:211], v[184:187], v[116:119]
 v_mfma_f32_16x16x32_bf16 v[120:123], v[208:211], v[188:191], v[120:123]
 v_mfma_f32_16x16x32_bf16 v[124:127], v[208:211], v[192:195], v[124:127]
 s_waitcnt lgkmcnt(6)
 v_mfma_f32_16x16x32_bf16 v[64:67], v[160:163], v[144:147], v[64:67]
 v_mfma_f32_16x16x32_bf16 v[68:71], v[160:163], v[148:151], v[68:71]
 v_mfma_f32_16x16x32_bf16 v[72:75], v[160:163], v[152:155], v[72:75]
 v_mfma_f32_16x16x32_bf16 v[76:79], v[160:163], v[156:159], v[76:79]
 s_waitcnt lgkmcnt(0)
 v_mfma_f32_16x16x32_bf16 v[80:83], v[164:167], v[144:147], v[80:83]
 ds_read_b128 v[180:183], v8 offset:1024
 v_mfma_f32_16x16x32_bf16 v[84:87], v[164:167], v[148:151], v[84:87]
 ds_read_b64_tr_b16 v[196:197], v9 offset:9216
 v_mfma_f32_16x16x32_bf16 v[88:91], v[164:167], v[152:155], v[88:91]
 ds_read_b64_tr_b16 v[198:199], v9 offset:11520
 v_mfma_f32_16x16x32_bf16 v[92:95], v[164:167], v[156:159], v[92:95]
 ds_read_b128 v[184:187], v8 offset:3072
 v_mfma_f32_16x16x32_bf16 v[96:99], v[168:171], v[144:147], v[96:99]
 ds_read_b128 v[188:191], v8 offset:5120
 v_mfma_f32_16x16x32_bf16 v[100:103], v[168:171], v[148:151], v[100:103]
 ds_read_b128 v[192:195], v8 offset:7168
 v_mfma_f32_16x16x32_bf16 v[104:107], v[168:171], v[152:155], v[104:107]
 ds_read_b64_tr_b16 v[200:201], v9 offset:9248
 v_mfma_f32_16x16x32_bf16 v[108:111], v[168:171], v[156:159], v[108:111]
 ds_read_b64_tr_b16 v[202:203], v9 offset:11552
 v_mfma_f32_16x16x32_bf16 v[112:115], v[172:175], v[144:147], v[112:115]
 ds_read_b64_tr_b16 v[204:205], v9 offset:9280
 v_mfma_f32_16x16x32_bf16 v[116:119], v[172:175], v[148:151], v[116:119]
 ds_read_b64_tr_b16 v[206:207], v9 offset:11584
 v_mfma_f32_16x16x32_bf16 v[120:123], v[172:175], v[152:155], v[120:123]
 ds_read_b64_tr_b16 v[208:209], v9 offset:9312
 v_mfma_f32_16x16x32_bf16 v[124:127], v[172:175], v[156:159], v[124:127]
 ds_read_b64_tr_b16 v[210:211], v9 offset:11616
 ds_read_b64_tr_b16 v[212:213], v10 offset:9216
 ds_read_b64_tr_b16 v[214:215], v10 offset:11520
 v_add_u32 v8, 16384, v2
 v_add_u32 v9, 89088, v3
 v_add_u32 v10, 89088, v4
 s_waitcnt lgkmcnt(8)
 v_mfma_f32_16x16x32_bf16 v[64:67], v[196:199], v[180:183], v[64:67]
 v_mfma_f32_16x16x32_bf16 v[68:71], v[196:199], v[184:187], v[68:71]
 v_mfma_f32_16x16x32_bf16 v[72:75], v[196:199], v[188:191], v[72:75]
 v_mfma_f32_16x16x32_bf16 v[76:79], v[196:199], v[192:195], v[76:79]
 s_waitcnt lgkmcnt(0)
 s_barrier
 v_mfma_f32_16x16x32_bf16 v[128:131], v[212:215], v[180:183], v[128:131]
 ds_read_b128 v[144:147], v8 offset:0
 v_mfma_f32_16x16x32_bf16 v[132:135], v[212:215], v[184:187], v[132:135]
 ds_read_b64_tr_b16 v[160:161], v9 offset:0
 v_mfma_f32_16x16x32_bf16 v[136:139], v[212:215], v[188:191], v[136:139]
 ds_read_b64_tr_b16 v[162:163], v9 offset:2304
 v_mfma_f32_16x16x32_bf16 v[140:143], v[212:215], v[192:195], v[140:143]
 ds_read_b128 v[148:151], v8 offset:2048
 v_mfma_f32_16x16x32_bf16 v[80:83], v[200:203], v[180:183], v[80:83]
 ds_read_b128 v[152:155], v8 offset:4096
 v_mfma_f32_16x16x32_bf16 v[84:87], v[200:203], v[184:187], v[84:87]
 ds_read_b128 v[156:159], v8 offset:6144
 v_mfma_f32_16x16x32_bf16 v[88:91], v[200:203], v[188:191], v[88:91]
 ds_read_b64_tr_b16 v[164:165], v9 offset:32
 v_mfma_f32_16x16x32_bf16 v[92:95], v[200:203], v[192:195], v[92:95]
 ds_read_b64_tr_b16 v[166:167], v9 offset:2336
 v_mfma_f32_16x16x32_bf16 v[96:99], v[204:207], v[180:183], v[96:99]
 ds_read_b64_tr_b16 v[168:169], v9 offset:64
 v_mfma_f32_16x16x32_bf16 v[100:103], v[204:207], v[184:187], v[100:103]
 ds_read_b64_tr_b16 v[170:171], v9 offset:2368
 v_mfma_f32_16x16x32_bf16 v[104:107], v[204:207], v[188:191], v[104:107]
 ds_read_b64_tr_b16 v[172:173], v9 offset:96
 v_mfma_f32_16x16x32_bf16 v[108:111], v[204:207], v[192:195], v[108:111]
 ds_read_b64_tr_b16 v[174:175], v9 offset:2400
 v_mfma_f32_16x16x32_bf16 v[112:115], v[208:211], v[180:183], v[112:115]
 v_mfma_f32_16x16x32_bf16 v[116:119], v[208:211], v[184:187], v[116:119]
 v_mfma_f32_16x16x32_bf16 v[120:123], v[208:211], v[188:191], v[120:123]
 v_mfma_f32_16x16x32_bf16 v[124:127], v[208:211], v[192:195], v[124:127]
 s_waitcnt lgkmcnt(6)
 v_mfma_f32_16x16x32_bf16 v[64:67], v[160:163], v[144:147], v[64:67]
 v_mfma_f32_16x16x32_bf16 v[68:71], v[160:163], v[148:151], v[68:71]
 v_mfma_f32_16x16x32_bf16 v[72:75], v[160:163], v[152:155], v[72:75]
 v_mfma_f32_16x16x32_bf16 v[76:79], v[160:163], v[156:159], v[76:79]
 s_waitcnt lgkmcnt(0)
 v_mfma_f32_16x16x32_bf16 v[80:83], v[164:167], v[144:147], v[80:83]
 ds_read_b128 v[180:183], v8 offset:1024
 v_mfma_f32_16x16x32_bf16 v[84:87], v[164:167], v[148:151], v[84:87]
 ds_read_b64_tr_b16 v[196:197], v9 offset:9216
 v_mfma_f32_16x16x32_bf16 v[88:91], v[164:167], v[152:155], v[88:91]
 ds_read_b64_tr_b16 v[198:199], v9 offset:11520
 v_mfma_f32_16x16x32_bf16 v[92:95], v[164:167], v[156:159], v[92:95]
 ds_read_b128 v[184:187], v8 offset:3072
 v_mfma_f32_16x16x32_bf16 v[96:99], v[168:171], v[144:147], v[96:99]
 ds_read_b128 v[188:191], v8 offset:5120
 v_mfma_f32_16x16x32_bf16 v[100:103], v[168:171], v[148:151], v[100:103]
 ds_read_b128 v[192:195], v8 offset:7168
 v_mfma_f32_16x16x32_bf16 v[104:107], v[168:171], v[152:155], v[104:107]
 ds_read_b64_tr_b16 v[200:201], v9 offset:9248
 v_mfma_f32_16x16x32_bf16 v[108:111], v[168:171], v[156:159], v[108:111]
 ds_read_b64_tr_b16 v[202:203], v9 offset:11552
 v_mfma_f32_16x16x32_bf16 v[112:115], v[172:175], v[144:147], v[112:115]
 ds_read_b64_tr_b16 v[204:205], v9 offset:9280
 v_mfma_f32_16x16x32_bf16 v[116:119], v[172:175], v[148:151], v[116:119]
 ds_read_b64_tr_b16 v[206:207], v9 offset:11584
 v_mfma_f32_16x16x32_bf16 v[120:123], v[172:175], v[152:155], v[120:123]
 ds_read_b64_tr_b16 v[208:209], v9 offset:9312
 v_mfma_f32_16x16x32_bf16 v[124:127], v[172:175], v[156:159], v[124:127]
 ds_read_b64_tr_b16 v[210:211], v9 offset:11616
 ds_read_b64_tr_b16 v[212:213], v10 offset:9216
 ds_read_b64_tr_b16 v[214:215], v10 offset:11520
 v_add_u32 v8, 32768, v2
 v_add_u32 v9, 107520, v3
 v_add_u32 v10, 107520, v4
 s_waitcnt lgkmcnt(8)
 v_mfma_f32_16x16x32_bf16 v[64:67], v[196:199], v[180:183], v[64:67]
 v_mfma_f32_16x16x32_bf16 v[68:71], v[196:199], v[184:187], v[68:71]
 v_mfma_f32_16x16x32_bf16 v[72:75], v[196:199], v[188:191], v[72:75]
 v_mfma_f32_16x16x32_bf16 v[76:79], v[196:199], v[192:195], v[76:79]
 s_waitcnt lgkmcnt(0)
 s_barrier
 v_mfma_f32_16x16x32_bf16 v[128:131], v[212:215], v[180:183], v[128:131]
 ds_read_b128 v[144:147], v8 offset:0
 v_mfma_f32_16x16x32_bf16 v[132:135], v[212:215], v[184:187], v[132:135]
 ds_read_b64_tr_b16 v[160:161], v9 offset:0
 v_mfma_f32_16x16x32_bf16 v[136:139], v[212:215], v[188:191], v[136:139]
 ds_read_b64_tr_b16 v[162:163], v9 offset:2304
 v_mfma_f32_16x16x32_bf16 v[140:143], v[212:215], v[192:195], v[140:143]
 ds_read_b128 v[148:151], v8 offset:2048
 v_mfma_f32_16x16x32_bf16 v[80:83], v[200:203], v[180:183], v[80:83]
 ds_read_b128 v[152:155], v8 offset:4096
 v_mfma_f32_16x16x32_bf16 v[84:87], v[200:203], v[184:187], v[84:87]
 ds_read_b128 v[156:159], v8 offset:6144
 v_mfma_f32_16x16x32_bf16 v[88:91], v[200:203], v[188:191], v[88:91]
 ds_read_b64_tr_b16 v[164:165], v9 offset:32
 v_mfma_f32_16x16x32_bf16 v[92:95], v[200:203], v[192:195], v[92:95]
 ds_read_b64_tr_b16 v[166:167], v9 offset:2336
 v_mfma_f32_16x16x32_bf16 v[96:99], v[204:207], v[180:183], v[96:99]
 ds_read_b64_tr_b16 v[168:169], v9 offset:64
 v_mfma_f32_16x16x32_bf16 v[100:103], v[204:207], v[184:187], v[100:103]
 ds_read_b64_tr_b16 v[170:171], v9 offset:2368
 v_mfma_f32_16x16x32_bf16 v[104:107], v[204:207], v[188:191], v[104:107]
 ds_read_b64_tr_b16 v[172:173], v9 offset:96
 v_mfma_f32_16x16x32_bf16 v[108:111], v[204:207], v[192:195], v[108:111]
 ds_read_b64_tr_b16 v[174:175], v9 offset:2400
 v_mfma_f32_16x16x32_bf16 v[112:115], v[208:211], v[180:183], v[112:115]
 v_mfma_f32_16x16x32_bf16 v[116:119], v[208:211], v[184:187], v[116:119]
 v_mfma_f32_16x16x32_bf16 v[120:123], v[208:211], v[188:191], v[120:123]
 v_mfma_f32_16x16x32_bf16 v[124:127], v[208:211], v[192:195], v[124:127]
 s_waitcnt lgkmcnt(6)
 v_mfma_f32_16x16x32_bf16 v[64:67], v[160:163], v[144:147], v[64:67]
 v_mfma_f32_16x16x32_bf16 v[68:71], v[160:163], v[148:151], v[68:71]
 v_mfma_f32_16x16x32_bf16 v[72:75], v[160:163], v[152:155], v[72:75]
 v_mfma_f32_16x16x32_bf16 v[76:79], v[160:163], v[156:159], v[76:79]
 s_waitcnt lgkmcnt(0)
 v_mfma_f32_16x16x32_bf16 v[80:83], v[164:167], v[144:147], v[80:83]
 ds_read_b128 v[180:183], v8 offset:1024
 v_mfma_f32_16x16x32_bf16 v[84:87], v[164:167], v[148:151], v[84:87]
 ds_read_b64_tr_b16 v[196:197], v9 offset:9216
 v_mfma_f32_16x16x32_bf16 v[88:91], v[164:167], v[152:155], v[88:91]
 ds_read_b64_tr_b16 v[198:199], v9 offset:11520
 v_mfma_f32_16x16x32_bf16 v[92:95], v[164:167], v[156:159], v[92:95]
 ds_read_b128 v[184:187], v8 offset:3072
 v_mfma_f32_16x16x32_bf16 v[96:99], v[168:171], v[144:147], v[96:99]
 ds_read_b128 v[188:191], v8 offset:5120
 v_mfma_f32_16x16x32_bf16 v[100:103], v[168:171], v[148:151], v[100:103]
 ds_read_b128 v[192:195], v8 offset:7168
 v_mfma_f32_16x16x32_bf16 v[104:107], v[168:171], v[152:155], v[104:107]
 ds_read_b64_tr_b16 v[200:201], v9 offset:9248
 v_mfma_f32_16x16x32_bf16 v[108:111], v[168:171], v[156:159], v[108:111]
 ds_read_b64_tr_b16 v[202:203], v9 offset:11552
 v_mfma_f32_16x16x32_bf16 v[112:115], v[172:175], v[144:147], v[112:115]
 ds_read_b64_tr_b16 v[204:205], v9 offset:9280
 v_mfma_f32_16x16x32_bf16 v[116:119], v[172:175], v[148:151], v[116:119]
 ds_read_b64_tr_b16 v[206:207], v9 offset:11584
 v_mfma_f32_16x16x32_bf16 v[120:123], v[172:175], v[152:155], v[120:123]
 ds_read_b64_tr_b16 v[208:209], v9 offset:9312
 v_mfma_f32_16x16x32_bf16 v[124:127], v[172:175], v[156:159], v[124:127]
 ds_read_b64_tr_b16 v[210:211], v9 offset:11616
 ds_read_b64_tr_b16 v[212:213], v10 offset:9216
 ds_read_b64_tr_b16 v[214:215], v10 offset:11520
 v_add_u32 v8, 49152, v2
 v_add_u32 v9, 125952, v3
 v_add_u32 v10, 125952, v4
 s_waitcnt lgkmcnt(8)
 v_mfma_f32_16x16x32_bf16 v[64:67], v[196:199], v[180:183], v[64:67]
 v_mfma_f32_16x16x32_bf16 v[68:71], v[196:199], v[184:187], v[68:71]
 v_mfma_f32_16x16x32_bf16 v[72:75], v[196:199], v[188:191], v[72:75]
 v_mfma_f32_16x16x32_bf16 v[76:79], v[196:199], v[192:195], v[76:79]
 s_waitcnt lgkmcnt(0)
 s_barrier
 v_mfma_f32_16x16x32_bf16 v[128:131], v[212:215], v[180:183], v[128:131]
 ds_read_b128 v[144:147], v8 offset:0
 v_mfma_f32_16x16x32_bf16 v[132:135], v[212:215], v[184:187], v[132:135]
 ds_read_b64_tr_b16 v[160:161], v9 offset:0
 v_mfma_f32_16x16x32_bf16 v[136:139], v[212:215], v[188:191], v[136:139]
 ds_read_b64_tr_b16 v[162:163], v9 offset:2304
 v_mfma_f32_16x16x32_bf16 v[140:143], v[212:215], v[192:195], v[140:143]
 ds_read_b128 v[148:151], v8 offset:2048
 v_mfma_f32_16x16x32_bf16 v[80:83], v[200:203], v[180:183], v[80:83]
 ds_read_b128 v[152:155], v8 offset:4096
 v_mfma_f32_16x16x32_bf16 v[84:87], v[200:203], v[184:187], v[84:87]
 ds_read_b128 v[156:159], v8 offset:6144
 v_mfma_f32_16x16x32_bf16 v[88:91], v[200:203], v[188:191], v[88:91]
 ds_read_b64_tr_b16 v[164:165], v9 offset:32
 v_mfma_f32_16x16x32_bf16 v[92:95], v[200:203], v[192:195], v[92:95]
 ds_read_b64_tr_b16 v[166:167], v9 offset:2336
 v_mfma_f32_16x16x32_bf16 v[96:99], v[204:207], v[180:183], v[96:99]
 ds_read_b64_tr_b16 v[168:169], v9 offset:64
 v_mfma_f32_16x16x32_bf16 v[100:103], v[204:207], v[184:187], v[100:103]
 ds_read_b64_tr_b16 v[170:171], v9 offset:2368
 v_mfma_f32_16x16x32_bf16 v[104:107], v[204:207], v[188:191], v[104:107]
 ds_read_b64_tr_b16 v[172:173], v9 offset:96
 v_mfma_f32_16x16x32_bf16 v[108:111], v[204:207], v[192:195], v[108:111]
 ds_read_b64_tr_b16 v[174:175], v9 offset:2400
 v_mfma_f32_16x16x32_bf16 v[112:115], v[208:211], v[180:183], v[112:115]
 v_mfma_f32_16x16x32_bf16 v[116:119], v[208:211], v[184:187], v[116:119]
 v_mfma_f32_16x16x32_bf16 v[120:123], v[208:211], v[188:191], v[120:123]
 v_mfma_f32_16x16x32_bf16 v[124:127], v[208:211], v[192:195], v[124:127]
 s_waitcnt lgkmcnt(6)
 v_mfma_f32_16x16x32_bf16 v[64:67], v[160:163], v[144:147], v[64:67]
 v_mfma_f32_16x16x32_bf16 v[68:71], v[160:163], v[148:151], v[68:71]
 v_mfma_f32_16x16x32_bf16 v[72:75], v[160:163], v[152:155], v[72:75]
 v_mfma_f32_16x16x32_bf16 v[76:79], v[160:163], v[156:159], v[76:79]
 s_waitcnt lgkmcnt(0)
 v_mfma_f32_16x16x32_bf16 v[80:83], v[164:167], v[144:147], v[80:83]
 ds_read_b128 v[180:183], v8 offset:1024
 v_mfma_f32_16x16x32_bf16 v[84:87], v[164:167], v[148:151], v[84:87]
 ds_read_b64_tr_b16 v[196:197], v9 offset:9216
 v_mfma_f32_16x16x32_bf16 v[88:91], v[164:167], v[152:155], v[88:91]
 ds_read_b64_tr_b16 v[198:199], v9 offset:11520
 v_mfma_f32_16x16x32_bf16 v[92:95], v[164:167], v[156:159], v[92:95]
 ds_read_b128 v[184:187], v8 offset:3072
 v_mfma_f32_16x16x32_bf16 v[96:99], v[168:171], v[144:147], v[96:99]
 ds_read_b128 v[188:191], v8 offset:5120
 v_mfma_f32_16x16x32_bf16 v[100:103], v[168:171], v[148:151], v[100:103]
 ds_read_b128 v[192:195], v8 offset:7168
 v_mfma_f32_16x16x32_bf16 v[104:107], v[168:171], v[152:155], v[104:107]
 ds_read_b64_tr_b16 v[200:201], v9 offset:9248
 v_mfma_f32_16x16x32_bf16 v[108:111], v[168:171], v[156:159], v[108:111]
 ds_read_b64_tr_b16 v[202:203], v9 offset:11552
 v_mfma_f32_16x16x32_bf16 v[112:115], v[172:175], v[144:147], v[112:115]
 ds_read_b64_tr_b16 v[204:205], v9 offset:9280
 v_mfma_f32_16x16x32_bf16 v[116:119], v[172:175], v[148:151], v[116:119]
 ds_read_b64_tr_b16 v[206:207], v9 offset:11584
 v_mfma_f32_16x16x32_bf16 v[120:123], v[172:175], v[152:155], v[120:123]
 ds_read_b64_tr_b16 v[208:209], v9 offset:9312
 v_mfma_f32_16x16x32_bf16 v[124:127], v[172:175], v[156:159], v[124:127]
 ds_read_b64_tr_b16 v[210:211], v9 offset:11616
 ds_read_b64_tr_b16 v[212:213], v10 offset:9216
 ds_read_b64_tr_b16 v[214:215], v10 offset:11520
 v_mov_b32 v8, v2
 v_add_u32 v9, 70656, v3
 v_add_u32 v10, 70656, v4
 s_waitcnt lgkmcnt(8)
 v_mfma_f32_16x16x32_bf16 v[64:67], v[196:199], v[180:183], v[64:67]
 v_mfma_f32_16x16x32_bf16 v[68:71], v[196:199], v[184:187], v[68:71]
 v_mfma_f32_16x16x32_bf16 v[72:75], v[196:199], v[188:191], v[72:75]
 v_mfma_f32_16x16x32_bf16 v[76:79], v[196:199], v[192:195], v[76:79]
 s_waitcnt lgkmcnt(0)
 s_barrier
 v_mfma_f32_16x16x32_bf16 v[128:131], v[212:215], v[180:183], v[128:131]
 ds_read_b128 v[144:147], v8 offset:0
 v_mfma_f32_16x16x32_bf16 v[132:135], v[212:215], v[184:187], v[132:135]
 ds_read_b64_tr_b16 v[160:161], v9 offset:0
 v_mfma_f32_16x16x32_bf16 v[136:139], v[212:215], v[188:191], v[136:139]
 ds_read_b64_tr_b16 v[162:163], v9 offset:2304
 v_mfma_f32_16x16x32_bf16 v[140:143], v[212:215], v[192:195], v[140:143]
 ds_read_b128 v[148:151], v8 offset:2048
 v_mfma_f32_16x16x32_bf16 v[80:83], v[200:203], v[180:183], v[80:83]
 ds_read_b128 v[152:155], v8 offset:4096
 v_mfma_f32_16x16x32_bf16 v[84:87], v[200:203], v[184:187], v[84:87]
 ds_read_b128 v[156:159], v8 offset:6144
 v_mfma_f32_16x16x32_bf16 v[88:91], v[200:203], v[188:191], v[88:91]
 ds_read_b64_tr_b16 v[164:165], v9 offset:32
 v_mfma_f32_16x16x32_bf16 v[92:95], v[200:203], v[192:195], v[92:95]
 ds_read_b64_tr_b16 v[166:167], v9 offset:2336
 v_mfma_f32_16x16x32_bf16 v[96:99], v[204:207], v[180:183], v[96:99]
 ds_read_b64_tr_b16 v[168:169], v9 offset:64
 v_mfma_f32_16x16x32_bf16 v[100:103], v[204:207], v[184:187], v[100:103]
 ds_read_b64_tr_b16 v[170:171], v9 offset:2368
 v_mfma_f32_16x16x32_bf16 v[104:107], v[204:207], v[188:191], v[104:107]
 ds_read_b64_tr_b16 v[172:173], v9 offset:96
 v_mfma_f32_16x16x32_bf16 v[108:111], v[204:207], v[192:195], v[108:111]
 ds_read_b64_tr_b16 v[174:175], v9 offset:2400
 v_mfma_f32_16x16x32_bf16 v[112:115], v[208:211], v[180:183], v[112:115]
 v_mfma_f32_16x16x32_bf16 v[116:119], v[208:211], v[184:187], v[116:119]
 v_mfma_f32_16x16x32_bf16 v[120:123], v[208:211], v[188:191], v[120:123]
 v_mfma_f32_16x16x32_bf16 v[124:127], v[208:211], v[192:195], v[124:127]
 s_waitcnt lgkmcnt(6)
 v_mfma_f32_16x16x32_bf16 v[64:67], v[160:163], v[144:147], v[64:67]
 v_mfma_f32_16x16x32_bf16 v[68:71], v[160:163], v[148:151], v[68:71]
 v_mfma_f32_16x16x32_bf16 v[72:75], v[160:163], v[152:155], v[72:75]
 v_mfma_f32_16x16x32_bf16 v[76:79], v[160:163], v[156:159], v[76:79]
 s_waitcnt lgkmcnt(0)
 v_mfma_f32_16x16x32_bf16 v[80:83], v[164:167], v[144:147], v[80:83]
 ds_read_b128 v[180:183], v8 offset:1024
 v_mfma_f32_16x16x32_bf16 v[84:87], v[164:167], v[148:151], v[84:87]
 ds_read_b64_tr_b16 v[196:197], v9 offset:9216
 v_mfma_f32_16x16x32_bf16 v[88:91], v[164:167], v[152:155], v[88:91]
 ds_read_b64_tr_b16 v[198:199], v9 offset:11520
 v_mfma_f32_16x16x32_bf16 v[92:95], v[164:167], v[156:159], v[92:95]
 ds_read_b128 v[184:187], v8 offset:3072
 v_mfma_f32_16x16x32_bf16 v[96:99], v[168:171], v[144:147], v[96:99]
 ds_read_b128 v[188:191], v8 offset:5120
 v_mfma_f32_16x16x32_bf16 v[100:103], v[168:171], v[148:151], v[100:103]
 ds_read_b128 v[192:195], v8 offset:7168
 v_mfma_f32_16x16x32_bf16 v[104:107], v[168:171], v[152:155], v[104:107]
 ds_read_b64_tr_b16 v[200:201], v9 offset:9248
 v_mfma_f32_16x16x32_bf16 v[108:111], v[168:171], v[156:159], v[108:111]
 ds_read_b64_tr_b16 v[202:203], v9 offset:11552
 v_mfma_f32_16x16x32_bf16 v[112:115], v[172:175], v[144:147], v[112:115]
 ds_read_b64_tr_b16 v[204:205], v9 offset:9280
 v_mfma_f32_16x16x32_bf16 v[116:119], v[172:175], v[148:151], v[116:119]
 ds_read_b64_tr_b16 v[206:207], v9 offset:11584
 v_mfma_f32_16x16x32_bf16 v[120:123], v[172:175], v[152:155], v[120:123]
 ds_read_b64_tr_b16 v[208:209], v9 offset:9312
 v_mfma_f32_16x16x32_bf16 v[124:127], v[172:175], v[156:159], v[124:127]
 ds_read_b64_tr_b16 v[210:211], v9 offset:11616
 ds_read_b64_tr_b16 v[212:213], v10 offset:9216
 ds_read_b64_tr_b16 v[214:215], v10 offset:11520
 v_add_u32 v8, 16384, v2
 v_add_u32 v9, 89088, v3
 v_add_u32 v10, 89088, v4
 s_waitcnt lgkmcnt(0)
 s_barrier
 s_lshl_b32 s36, s44, 8
 s_add_u32 s36, s36, 78848
 v_and_b32 v19, 15, v0
 v_lshl_add_u32 v19, v19, 2, s36
 ds_read_b32 v28, v19 offset:0
 ds_read_b32 v32, v19 offset:512
 ds_read_b32 v29, v19 offset:64
 ds_read_b32 v33, v19 offset:576
 ds_read_b32 v30, v19 offset:128
 ds_read_b32 v34, v19 offset:640
 ds_read_b32 v31, v19 offset:192
 ds_read_b32 v35, v19 offset:704
 v_mfma_f32_16x16x32_bf16 v[64:67], v[196:199], v[180:183], v[64:67]
 v_mfma_f32_16x16x32_bf16 v[68:71], v[196:199], v[184:187], v[68:71]
 v_mfma_f32_16x16x32_bf16 v[72:75], v[196:199], v[188:191], v[72:75]
 v_mfma_f32_16x16x32_bf16 v[76:79], v[196:199], v[192:195], v[76:79]
 v_mfma_f32_16x16x32_bf16 v[128:131], v[212:215], v[180:183], v[128:131]
 v_mfma_f32_16x16x32_bf16 v[132:135], v[212:215], v[184:187], v[132:135]
 v_mfma_f32_16x16x32_bf16 v[136:139], v[212:215], v[188:191], v[136:139]
 v_mfma_f32_16x16x32_bf16 v[140:143], v[212:215], v[192:195], v[140:143]
 v_mfma_f32_16x16x32_bf16 v[80:83], v[200:203], v[180:183], v[80:83]
 v_mfma_f32_16x16x32_bf16 v[84:87], v[200:203], v[184:187], v[84:87]
 v_mfma_f32_16x16x32_bf16 v[88:91], v[200:203], v[188:191], v[88:91]
 v_mfma_f32_16x16x32_bf16 v[92:95], v[200:203], v[192:195], v[92:95]
 v_mfma_f32_16x16x32_bf16 v[96:99], v[204:207], v[180:183], v[96:99]
 v_mfma_f32_16x16x32_bf16 v[100:103], v[204:207], v[184:187], v[100:103]
 v_mfma_f32_16x16x32_bf16 v[104:107], v[204:207], v[188:191], v[104:107]
 v_mfma_f32_16x16x32_bf16 v[108:111], v[204:207], v[192:195], v[108:111]
 v_mfma_f32_16x16x32_bf16 v[112:115], v[208:211], v[180:183], v[112:115]
 v_mfma_f32_16x16x32_bf16 v[116:119], v[208:211], v[184:187], v[116:119]
 v_mfma_f32_16x16x32_bf16 v[120:123], v[208:211], v[188:191], v[120:123]
 v_mfma_f32_16x16x32_bf16 v[124:127], v[208:211], v[192:195], v[124:127]
 s_lshl_b32 s36, s32, 11
 s_add_u32 s36, s36, 69632
 v_add_u32 v25, s36, v1
 v_xor_b32 v26, 2048, v25
 v_mov_b32 v160, 0
 v_mov_b32 v161, 0
 v_mov_b32 v162, 0
 v_mov_b32 v163, 0
 v_mov_b32 v164, 0
 v_mov_b32 v165, 0
 v_mov_b32 v166, 0
 v_mov_b32 v167, 0
 v_mov_b32 v168, 0
 v_mov_b32 v169, 0
 v_mov_b32 v170, 0
 v_mov_b32 v171, 0
 v_mov_b32 v172, 0
 v_mov_b32 v173, 0
 v_mov_b32 v174, 0
 v_mov_b32 v175, 0
 ds_write_b128 v25, v[128:131] offset:0
 ds_write_b128 v25, v[132:135] offset:1024
 s_waitcnt vmcnt(0) lgkmcnt(2)
 v_mul_f32 v36, -2.302208198144325, v32
 v_mul_f32 v37, v32, v32
 v_mul_f32 v37, v37, v36
 v_mul_f32 v37, 0.044715, v37
 v_mul_f32 v38, -2.302208198144325, v33
 v_mul_f32 v39, v33, v33
 v_mul_f32 v39, v39, v38
 v_mul_f32 v39, 0.044715, v39
 v_mul_f32 v40, -2.302208198144325, v34
 v_mul_f32 v41, v34, v34
 v_mul_f32 v41, v41, v40
 v_mul_f32 v41, 0.044715, v41
 v_mul_f32 v42, -2.302208198144325, v35
 v_mul_f32 v43, v35, v35
 v_mul_f32 v43, v43, v42
 v_mul_f32 v43, 0.044715, v43
 s_lshl_b32 s36, s32, 2
 s_add_u32 s36, s36, 79936
 v_mov_b32 v24, s36
 v_mov_b32 v18, 1
 ds_write_b32 v24, v18
 v_xor_b32 v24, 4, v24
 v_fma_f32 v64, -v28, v44, v64
 v_fma_f32 v65, -v28, v45, v65
 v_fma_f32 v66, -v28, v46, v66
 v_fma_f32 v67, -v28, v47, v67
 v_fma_f32 v68, -v29, v44, v68
 v_fma_f32 v69, -v29, v45, v69
 v_fma_f32 v70, -v29, v46, v70
 v_fma_f32 v71, -v29, v47, v71
 v_fma_f32 v72, -v30, v44, v72
 v_fma_f32 v73, -v30, v45, v73
 v_fma_f32 v74, -v30, v46, v74
 v_fma_f32 v75, -v30, v47, v75
 v_fma_f32 v76, -v31, v44, v76
 v_fma_f32 v77, -v31, v45, v77
 v_fma_f32 v78, -v31, v46, v78
 v_fma_f32 v79, -v31, v47, v79
 v_mul_f32 v144, v64, v64
 v_mul_f32 v145, v65, v65
 v_mul_f32 v146, v66, v66
 v_mul_f32 v147, v67, v67
 v_mul_f32 v148, v68, v68
 v_mul_f32 v149, v69, v69
 v_mul_f32 v150, v70, v70
 v_mul_f32 v151, v71, v71
 v_mul_f32 v152, v72, v72
 v_mul_f32 v153, v73, v73
 v_mul_f32 v154, v74, v74
 v_mul_f32 v155, v75, v75
 v_mul_f32 v156, v76, v76
 v_mul_f32 v157, v77, v77
 v_mul_f32 v158, v78, v78
 v_mul_f32 v159, v79, v79
 v_fma_f32 v144, v144, v37, v36
 v_fma_f32 v145, v145, v37, v36
 v_fma_f32 v146, v146, v37, v36
 v_fma_f32 v147, v147, v37, v36
 v_fma_f32 v148, v148, v39, v38
 v_fma_f32 v149, v149, v39, v38
 v_fma_f32 v150, v150, v39, v38
 v_fma_f32 v151, v151, v39, v38
 v_fma_f32 v152, v152, v41, v40
 v_fma_f32 v153, v153, v41, v40
 v_fma_f32 v154, v154, v41, v40
 v_fma_f32 v155, v155, v41, v40
 v_fma_f32 v156, v156, v43, v42
 v_fma_f32 v157, v157, v43, v42
 v_fma_f32 v158, v158, v43, v42
 v_fma_f32 v159, v159, v43, v42
 v_mul_f32 v144, v144, v64
 v_mul_f32 v145, v145, v65
 v_mul_f32 v146, v146, v66
 v_mul_f32 v147, v147, v67
 v_mul_f32 v148, v148, v68
 v_mul_f32 v149, v149, v69
 v_mul_f32 v150, v150, v70
 v_mul_f32 v151, v151, v71
 v_mul_f32 v152, v152, v72
 v_mul_f32 v153, v153, v73
 v_mul_f32 v154, v154, v74
 v_mul_f32 v155, v155, v75
 v_mul_f32 v156, v156, v76
 v_mul_f32 v157, v157, v77
 v_mul_f32 v158, v158, v78
 v_mul_f32 v159, v159, v79
 v_exp_f32 v144, v144
 v_exp_f32 v145, v145
 v_exp_f32 v146, v146
 v_exp_f32 v147, v147
 v_exp_f32 v148, v148
 v_exp_f32 v149, v149
 v_exp_f32 v150, v150
 v_exp_f32 v151, v151
 v_exp_f32 v152, v152
 v_exp_f32 v153, v153
 v_exp_f32 v154, v154
 v_exp_f32 v155, v155
 v_exp_f32 v156, v156
 v_exp_f32 v157, v157
 v_exp_f32 v158, v158
 v_exp_f32 v159, v159
 v_add_f32 v144, 1.0, v144
 v_add_f32 v145, 1.0, v145
 v_add_f32 v146, 1.0, v146
 v_add_f32 v147, 1.0, v147
 v_add_f32 v148, 1.0, v148
 v_add_f32 v149, 1.0, v149
 v_add_f32 v150, 1.0, v150
 v_add_f32 v151, 1.0, v151
 v_add_f32 v152, 1.0, v152
 v_add_f32 v153, 1.0, v153
 v_add_f32 v154, 1.0, v154
 v_add_f32 v155, 1.0, v155
 v_add_f32 v156, 1.0, v156
 v_add_f32 v157, 1.0, v157
 v_add_f32 v158, 1.0, v158
 v_add_f32 v159, 1.0, v159
 v_rcp_f32 v144, v144
 v_rcp_f32 v145, v145
 v_rcp_f32 v146, v146
 v_rcp_f32 v147, v147
 v_rcp_f32 v148, v148
 v_rcp_f32 v149, v149
 v_rcp_f32 v150, v150
 v_rcp_f32 v151, v151
 v_rcp_f32 v152, v152
 v_rcp_f32 v153, v153
 v_rcp_f32 v154, v154
 v_rcp_f32 v155, v155
 v_rcp_f32 v156, v156
 v_rcp_f32 v157, v157
 v_rcp_f32 v158, v158
 v_rcp_f32 v159, v159
 v_mul_f32 v64, v64, v144
 v_mul_f32 v65, v65, v145
 v_mul_f32 v66, v66, v146
 v_mul_f32 v67, v67, v147
 v_mul_f32 v68, v68, v148
 v_mul_f32 v69, v69, v149
 v_mul_f32 v70, v70, v150
 v_mul_f32 v71, v71, v151
 v_mul_f32 v72, v72, v152
 v_mul_f32 v73, v73, v153
 v_mul_f32 v74, v74, v154
 v_mul_f32 v75, v75, v155
 v_mul_f32 v76, v76, v156
 v_mul_f32 v77, v77, v157
 v_mul_f32 v78, v78, v158
 v_mul_f32 v79, v79, v159
 v_add_f32 v160, v160, v64
 v_fmac_f32 v168, v64, v64
 v_add_f32 v162, v162, v68
 v_fmac_f32 v170, v68, v68
 v_add_f32 v164, v164, v72
 v_fmac_f32 v172, v72, v72
 v_add_f32 v166, v166, v76
 v_fmac_f32 v174, v76, v76
 v_add_f32 v161, v161, v65
 v_fmac_f32 v169, v65, v65
 v_add_f32 v163, v163, v69
 v_fmac_f32 v171, v69, v69
 v_add_f32 v165, v165, v73
 v_fmac_f32 v173, v73, v73
 v_add_f32 v167, v167, v77
 v_fmac_f32 v175, v77, v77
 v_add_f32 v160, v160, v66
 v_fmac_f32 v168, v66, v66
 v_add_f32 v162, v162, v70
 v_fmac_f32 v170, v70, v70
 v_add_f32 v164, v164, v74
 v_fmac_f32 v172, v74, v74
 v_add_f32 v166, v166, v78
 v_fmac_f32 v174, v78, v78
 v_add_f32 v161, v161, v67
 v_fmac_f32 v169, v67, v67
 v_add_f32 v163, v163, v71
 v_fmac_f32 v171, v71, v71
 v_add_f32 v165, v165, v75
 v_fmac_f32 v173, v75, v75
 v_add_f32 v167, v167, v79
 v_fmac_f32 v175, v79, v79
 v_fma_f32 v80, -v28, v48, v80
 v_fma_f32 v81, -v28, v49, v81
 v_fma_f32 v82, -v28, v50, v82
 v_fma_f32 v83, -v28, v51, v83
 v_fma_f32 v84, -v29, v48, v84
 v_fma_f32 v85, -v29, v49, v85
 v_fma_f32 v86, -v29, v50, v86
 v_fma_f32 v87, -v29, v51, v87
 v_fma_f32 v88, -v30, v48, v88
 v_fma_f32 v89, -v30, v49, v89
 v_fma_f32 v90, -v30, v50, v90
 v_fma_f32 v91, -v30, v51, v91
 v_fma_f32 v92, -v31, v48, v92
 v_fma_f32 v93, -v31, v49, v93
 v_fma_f32 v94, -v31, v50, v94
 v_fma_f32 v95, -v31, v51, v95
 v_mul_f32 v144, v80, v80
 v_mul_f32 v145, v81, v81
 v_mul_f32 v146, v82, v82
 v_mul_f32 v147, v83, v83
 v_mul_f32 v148, v84, v84
 v_mul_f32 v149, v85, v85
 v_mul_f32 v150, v86, v86
 v_mul_f32 v151, v87, v87
 v_mul_f32 v152, v88, v88
 v_mul_f32 v153, v89, v89
 v_mul_f32 v154, v90, v90
 v_mul_f32 v155, v91, v91
 v_mul_f32 v156, v92, v92
 v_mul_f32 v157, v93, v93
 v_mul_f32 v158, v94, v94
 v_mul_f32 v159, v95, v95
 v_fma_f32 v144, v144, v37, v36
 v_fma_f32 v145, v145, v37, v36
 v_fma_f32 v146, v146, v37, v36
 v_fma_f32 v147, v147, v37, v36
 v_fma_f32 v148, v148, v39, v38
 v_fma_f32 v149, v149, v39, v38
 v_fma_f32 v150, v150, v39, v38
 v_fma_f32 v151, v151, v39, v38
 v_fma_f32 v152, v152, v41, v40
 v_fma_f32 v153, v153, v41, v40
 v_fma_f32 v154, v154, v41, v40
 v_fma_f32 v155, v155, v41, v40
 v_fma_f32 v156, v156, v43, v42
 v_fma_f32 v157, v157, v43, v42
 v_fma_f32 v158, v158, v43, v42
 v_fma_f32 v159, v159, v43, v42
 v_mul_f32 v144, v144, v80
 v_mul_f32 v145, v145, v81
 v_mul_f32 v146, v146, v82
 v_mul_f32 v147, v147, v83
 v_mul_f32 v148, v148, v84
 v_mul_f32 v149, v149, v85
 v_mul_f32 v150, v150, v86
 v_mul_f32 v151, v151, v87
 v_mul_f32 v152, v152, v88
 v_mul_f32 v153, v153, v89
 v_mul_f32 v154, v154, v90
 v_mul_f32 v155, v155, v91
 v_mul_f32 v156, v156, v92
 v_mul_f32 v157, v157, v93
 v_mul_f32 v158, v158, v94
 v_mul_f32 v159, v159, v95
 v_exp_f32 v144, v144
 v_exp_f32 v145, v145
 v_exp_f32 v146, v146
 v_exp_f32 v147, v147
 v_exp_f32 v148, v148
 v_exp_f32 v149, v149
 v_exp_f32 v150, v150
 v_exp_f32 v151, v151
 v_exp_f32 v152, v152
 v_exp_f32 v153, v153
 v_exp_f32 v154, v154
 v_exp_f32 v155, v155
 v_exp_f32 v156, v156
 v_exp_f32 v157, v157
 v_exp_f32 v158, v158
 v_exp_f32 v159, v159
 v_add_f32 v144, 1.0, v144
 v_add_f32 v145, 1.0, v145
 v_add_f32 v146, 1.0, v146
 v_add_f32 v147, 1.0, v147
 v_add_f32 v148, 1.0, v148
 v_add_f32 v149, 1.0, v149
 v_add_f32 v150, 1.0, v150
 v_add_f32 v151, 1.0, v151
 v_add_f32 v152, 1.0, v152
 v_add_f32 v153, 1.0, v153
 v_add_f32 v154, 1.0, v154
 v_add_f32 v155, 1.0, v155
 v_add_f32 v156, 1.0, v156
 v_add_f32 v157, 1.0, v157
 v_add_f32 v158, 1.0, v158
 v_add_f32 v159, 1.0, v159
 v_rcp_f32 v144, v144
 v_rcp_f32 v145, v145
 v_rcp_f32 v146, v146
 v_rcp_f32 v147, v147
 v_rcp_f32 v148, v148
 v_rcp_f32 v149, v149
 v_rcp_f32 v150, v150
 v_rcp_f32 v151, v151
 v_rcp_f32 v152, v152
 v_rcp_f32 v153, v153
 v_rcp_f32 v154, v154
 v_rcp_f32 v155, v155
 v_rcp_f32 v156, v156
 v_rcp_f32 v157, v157
 v_rcp_f32 v158, v158
 v_rcp_f32 v159, v159
 v_mul_f32 v80, v80, v144
 v_mul_f32 v81, v81, v145
 v_mul_f32 v82, v82, v146
 v_mul_f32 v83, v83, v147
 v_mul_f32 v84, v84, v148
 v_mul_f32 v85, v85, v149
 v_mul_f32 v86, v86, v150
 v_mul_f32 v87, v87, v151
 v_mul_f32 v88, v88, v152
 v_mul_f32 v89, v89, v153
 v_mul_f32 v90, v90, v154
 v_mul_f32 v91, v91, v155
 v_mul_f32 v92, v92, v156
 v_mul_f32 v93, v93, v157
 v_mul_f32 v94, v94, v158
 v_mul_f32 v95, v95, v159
 v_add_f32 v160, v160, v80
 v_fmac_f32 v168, v80, v80
 v_add_f32 v162, v162, v84
 v_fmac_f32 v170, v84, v84
 v_add_f32 v164, v164, v88
 v_fmac_f32 v172, v88, v88
 v_add_f32 v166, v166, v92
 v_fmac_f32 v174, v92, v92
 v_add_f32 v161, v161, v81
 v_fmac_f32 v169, v81, v81
 v_add_f32 v163, v163, v85
 v_fmac_f32 v171, v85, v85
 v_add_f32 v165, v165, v89
 v_fmac_f32 v173, v89, v89
 v_add_f32 v167, v167, v93
 v_fmac_f32 v175, v93, v93
 v_add_f32 v160, v160, v82
 v_fmac_f32 v168, v82, v82
 v_add_f32 v162, v162, v86
 v_fmac_f32 v170, v86, v86
 v_add_f32 v164, v164, v90
 v_fmac_f32 v172, v90, v90
 v_add_f32 v166, v166, v94
 v_fmac_f32 v174, v94, v94
 v_add_f32 v161, v161, v83
 v_fmac_f32 v169, v83, v83
 v_add_f32 v163, v163, v87
 v_fmac_f32 v171, v87, v87
 v_add_f32 v165, v165, v91
 v_fmac_f32 v173, v91, v91
 v_add_f32 v167, v167, v95
 v_fmac_f32 v175, v95, v95
 v_fma_f32 v96, -v28, v52, v96
 v_fma_f32 v97, -v28, v53, v97
 v_fma_f32 v98, -v28, v54, v98
 v_fma_f32 v99, -v28, v55, v99
 v_fma_f32 v100, -v29, v52, v100
 v_fma_f32 v101, -v29, v53, v101
 v_fma_f32 v102, -v29, v54, v102
 v_fma_f32 v103, -v29, v55, v103
 v_fma_f32 v104, -v30, v52, v104
 v_fma_f32 v105, -v30, v53, v105
 v_fma_f32 v106, -v30, v54, v106
 v_fma_f32 v107, -v30, v55, v107
 v_fma_f32 v108, -v31, v52, v108
 v_fma_f32 v109, -v31, v53, v109
 v_fma_f32 v110, -v31, v54, v110
 v_fma_f32 v111, -v31, v55, v111
 v_mul_f32 v144, v96, v96
 v_mul_f32 v145, v97, v97
 v_mul_f32 v146, v98, v98
 v_mul_f32 v147, v99, v99
 v_mul_f32 v148, v100, v100
 v_mul_f32 v149, v101, v101
 v_mul_f32 v150, v102, v102
 v_mul_f32 v151, v103, v103
 v_mul_f32 v152, v104, v104
 v_mul_f32 v153, v105, v105
 v_mul_f32 v154, v106, v106
 v_mul_f32 v155, v107, v107
 v_mul_f32 v156, v108, v108
 v_mul_f32 v157, v109, v109
 v_mul_f32 v158, v110, v110
 v_mul_f32 v159, v111, v111
 v_fma_f32 v144, v144, v37, v36
 v_fma_f32 v145, v145, v37, v36
 v_fma_f32 v146, v146, v37, v36
 v_fma_f32 v147, v147, v37, v36
 v_fma_f32 v148, v148, v39, v38
 v_fma_f32 v149, v149, v39, v38
 v_fma_f32 v150, v150, v39, v38
 v_fma_f32 v151, v151, v39, v38
 v_fma_f32 v152, v152, v41, v40
 v_fma_f32 v153, v153, v41, v40
 v_fma_f32 v154, v154, v41, v40
 v_fma_f32 v155, v155, v41, v40
 v_fma_f32 v156, v156, v43, v42
 v_fma_f32 v157, v157, v43, v42
 v_fma_f32 v158, v158, v43, v42
 v_fma_f32 v159, v159, v43, v42
 v_mul_f32 v144, v144, v96
 v_mul_f32 v145, v145, v97
 v_mul_f32 v146, v146, v98
 v_mul_f32 v147, v147, v99
 v_mul_f32 v148, v148, v100
 v_mul_f32 v149, v149, v101
 v_mul_f32 v150, v150, v102
 v_mul_f32 v151, v151, v103
 v_mul_f32 v152, v152, v104
 v_mul_f32 v153, v153, v105
 v_mul_f32 v154, v154, v106
 v_mul_f32 v155, v155, v107
 v_mul_f32 v156, v156, v108
 v_mul_f32 v157, v157, v109
 v_mul_f32 v158, v158, v110
 v_mul_f32 v159, v159, v111
 v_exp_f32 v144, v144
 v_exp_f32 v145, v145
 v_exp_f32 v146, v146
 v_exp_f32 v147, v147
 v_exp_f32 v148, v148
 v_exp_f32 v149, v149
 v_exp_f32 v150, v150
 v_exp_f32 v151, v151
 v_exp_f32 v152, v152
 v_exp_f32 v153, v153
 v_exp_f32 v154, v154
 v_exp_f32 v155, v155
 v_exp_f32 v156, v156
 v_exp_f32 v157, v157
 v_exp_f32 v158, v158
 v_exp_f32 v159, v159
 v_add_f32 v144, 1.0, v144
 v_add_f32 v145, 1.0, v145
 v_add_f32 v146, 1.0, v146
 v_add_f32 v147, 1.0, v147
 v_add_f32 v148, 1.0, v148
 v_add_f32 v149, 1.0, v149
 v_add_f32 v150, 1.0, v150
 v_add_f32 v151, 1.0, v151
 v_add_f32 v152, 1.0, v152
 v_add_f32 v153, 1.0, v153
 v_add_f32 v154, 1.0, v154
 v_add_f32 v155, 1.0, v155
 v_add_f32 v156, 1.0, v156
 v_add_f32 v157, 1.0, v157
 v_add_f32 v158, 1.0, v158
 v_add_f32 v159, 1.0, v159
 v_rcp_f32 v144, v144
 v_rcp_f32 v145, v145
 v_rcp_f32 v146, v146
 v_rcp_f32 v147, v147
 v_rcp_f32 v148, v148
 v_rcp_f32 v149, v149
 v_rcp_f32 v150, v150
 v_rcp_f32 v151, v151
 v_rcp_f32 v152, v152
 v_rcp_f32 v153, v153
 v_rcp_f32 v154, v154
 v_rcp_f32 v155, v155
 v_rcp_f32 v156, v156
 v_rcp_f32 v157, v157
 v_rcp_f32 v158, v158
 v_rcp_f32 v159, v159
 v_mul_f32 v96, v96, v144
 v_mul_f32 v97, v97, v145
 v_mul_f32 v98, v98, v146
 v_mul_f32 v99, v99, v147
 v_mul_f32 v100, v100, v148
 v_mul_f32 v101, v101, v149
 v_mul_f32 v102, v102, v150
 v_mul_f32 v103, v103, v151
 v_mul_f32 v104, v104, v152
 v_mul_f32 v105, v105, v153
 v_mul_f32 v106, v106, v154
 v_mul_f32 v107, v107, v155
 v_mul_f32 v108, v108, v156
 v_mul_f32 v109, v109, v157
 v_mul_f32 v110, v110, v158
 v_mul_f32 v111, v111, v159
 v_add_f32 v160, v160, v96
 v_fmac_f32 v168, v96, v96
 v_add_f32 v162, v162, v100
 v_fmac_f32 v170, v100, v100
 v_add_f32 v164, v164, v104
 v_fmac_f32 v172, v104, v104
 v_add_f32 v166, v166, v108
 v_fmac_f32 v174, v108, v108
 v_add_f32 v161, v161, v97
 v_fmac_f32 v169, v97, v97
 v_add_f32 v163, v163, v101
 v_fmac_f32 v171, v101, v101
 v_add_f32 v165, v165, v105
 v_fmac_f32 v173, v105, v105
 v_add_f32 v167, v167, v109
 v_fmac_f32 v175, v109, v109
 v_add_f32 v160, v160, v98
 v_fmac_f32 v168, v98, v98
 v_add_f32 v162, v162, v102
 v_fmac_f32 v170, v102, v102
 v_add_f32 v164, v164, v106
 v_fmac_f32 v172, v106, v106
 v_add_f32 v166, v166, v110
 v_fmac_f32 v174, v110, v110
 v_add_f32 v161, v161, v99
 v_fmac_f32 v169, v99, v99
 v_add_f32 v163, v163, v103
 v_fmac_f32 v171, v103, v103
 v_add_f32 v165, v165, v107
 v_fmac_f32 v173, v107, v107
 v_add_f32 v167, v167, v111
 v_fmac_f32 v175, v111, v111
 s_mov_b32 s46, 20000
L_fz_p4x1:
 ds_read_b32 v18, v24
 s_waitcnt lgkmcnt(0)
 v_cmp_ne_u32 vcc, 1, v18
 s_sub_u32 s46, s46, 1
 s_cbranch_vccz L_fz_p4x1r
 s_cmp_lg_u32 s46, 0
 s_cbranch_scc1 L_fz_p4x1
L_fz_p4x1r:
 ds_read_b128 v[128:131], v26 offset:0
 ds_read_b128 v[132:135], v26 offset:1024
 v_fma_f32 v112, -v28, v56, v112
 v_fma_f32 v113, -v28, v57, v113
 v_fma_f32 v114, -v28, v58, v114
 v_fma_f32 v115, -v28, v59, v115
 v_fma_f32 v116, -v29, v56, v116
 v_fma_f32 v117, -v29, v57, v117
 v_fma_f32 v118, -v29, v58, v118
 v_fma_f32 v119, -v29, v59, v119
 v_fma_f32 v120, -v30, v56, v120
 v_fma_f32 v121, -v30, v57, v121
 v_fma_f32 v122, -v30, v58, v122
 v_fma_f32 v123, -v30, v59, v123
 v_fma_f32 v124, -v31, v56, v124
 v_fma_f32 v125, -v31, v57, v125
 v_fma_f32 v126, -v31, v58, v126
 v_fma_f32 v127, -v31, v59, v127
 v_mul_f32 v144, v112, v112
 v_mul_f32 v145, v113, v113
 v_mul_f32 v146, v114, v114
 v_mul_f32 v147, v115, v115
 v_mul_f32 v148, v116, v116
 v_mul_f32 v149, v117, v117
 v_mul_f32 v150, v118, v118
 v_mul_f32 v151, v119, v119
 v_mul_f32 v152, v120, v120
 v_mul_f32 v153, v121, v121
 v_mul_f32 v154, v122, v122
 v_mul_f32 v155, v123, v123
 v_mul_f32 v156, v124, v124
 v_mul_f32 v157, v125, v125
 v_mul_f32 v158, v126, v126
 v_mul_f32 v159, v127, v127
 v_fma_f32 v144, v144, v37, v36
 v_fma_f32 v145, v145, v37, v36
 v_fma_f32 v146, v146, v37, v36
 v_fma_f32 v147, v147, v37, v36
 v_fma_f32 v148, v148, v39, v38
 v_fma_f32 v149, v149, v39, v38
 v_fma_f32 v150, v150, v39, v38
 v_fma_f32 v151, v151, v39, v38
 v_fma_f32 v152, v152, v41, v40
 v_fma_f32 v153, v153, v41, v40
 v_fma_f32 v154, v154, v41, v40
 v_fma_f32 v155, v155, v41, v40
 v_fma_f32 v156, v156, v43, v42
 v_fma_f32 v157, v157, v43, v42
 v_fma_f32 v158, v158, v43, v42
 v_fma_f32 v159, v159, v43, v42
 v_mul_f32 v144, v144, v112
 v_mul_f32 v145, v145, v113
 v_mul_f32 v146, v146, v114
 v_mul_f32 v147, v147, v115
 v_mul_f32 v148, v148, v116
 v_mul_f32 v149, v149, v117
 v_mul_f32 v150, v150, v118
 v_mul_f32 v151, v151, v119
 v_mul_f32 v152, v152, v120
 v_mul_f32 v153, v153, v121
 v_mul_f32 v154, v154, v122
 v_mul_f32 v155, v155, v123
 v_mul_f32 v156, v156, v124
 v_mul_f32 v157, v157, v125
 v_mul_f32 v158, v158, v126
 v_mul_f32 v159, v159, v127
 v_exp_f32 v144, v144
 v_exp_f32 v145, v145
 v_exp_f32 v146, v146
 v_exp_f32 v147, v147
 v_exp_f32 v148, v148
 v_exp_f32 v149, v149
 v_exp_f32 v150, v150
 v_exp_f32 v151, v151
 v_exp_f32 v152, v152
 v_exp_f32 v153, v153
 v_exp_f32 v154, v154
 v_exp_f32 v155, v155
 v_exp_f32 v156, v156
 v_exp_f32 v157, v157
 v_exp_f32 v158, v158
 v_exp_f32 v159, v159
 v_add_f32 v144, 1.0, v144
 v_add_f32 v145, 1.0, v145
 v_add_f32 v146, 1.0, v146
 v_add_f32 v147, 1.0, v147
 v_add_f32 v148, 1.0, v148
 v_add_f32 v149, 1.0, v149
 v_add_f32 v150, 1.0, v150
 v_add_f32 v151, 1.0, v151
 v_add_f32 v152, 1.0, v152
 v_add_f32 v153, 1.0, v153
 v_add_f32 v154, 1.0, v154
 v_add_f32 v155, 1.0, v155
 v_add_f32 v156, 1.0, v156
 v_add_f32 v157, 1.0, v157
 v_add_f32 v158, 1.0, v158
 v_add_f32 v159, 1.0, v159
 v_rcp_f32 v144, v144
 v_rcp_f32 v145, v145
 v_rcp_f32 v146, v146
 v_rcp_f32 v147, v147
 v_rcp_f32 v148, v148
 v_rcp_f32 v149, v149
 v_rcp_f32 v150, v150
 v_rcp_f32 v151, v151
 v_rcp_f32 v152, v152
 v_rcp_f32 v153, v153
 v_rcp_f32 v154, v154
 v_rcp_f32 v155, v155
 v_rcp_f32 v156, v156
 v_rcp_f32 v157, v157
 v_rcp_f32 v158, v158
 v_rcp_f32 v159, v159
 v_mul_f32 v112, v112, v144
 v_mul_f32 v113, v113, v145
 v_mul_f32 v114, v114, v146
 v_mul_f32 v115, v115, v147
 v_mul_f32 v116, v116, v148
 v_mul_f32 v117, v117, v149
 v_mul_f32 v118, v118, v150
 v_mul_f32 v119, v119, v151
 v_mul_f32 v120, v120, v152
 v_mul_f32 v121, v121, v153
 v_mul_f32 v122, v122, v154
 v_mul_f32 v123, v123, v155
 v_mul_f32 v124, v124, v156
 v_mul_f32 v125, v125, v157
 v_mul_f32 v126, v126, v158
 v_mul_f32 v127, v127, v159
 v_add_f32 v160, v160, v112
 v_fmac_f32 v168, v112, v112
 v_add_f32 v162, v162, v116
 v_fmac_f32 v170, v116, v116
 v_add_f32 v164, v164, v120
 v_fmac_f32 v172, v120, v120
 v_add_f32 v166, v166, v124
 v_fmac_f32 v174, v124, v124
 v_add_f32 v161, v161, v113
 v_fmac_f32 v169, v113, v113
 v_add_f32 v163, v163, v117
 v_fmac_f32 v171, v117, v117
 v_add_f32 v165, v165, v121
 v_fmac_f32 v173, v121, v121
 v_add_f32 v167, v167, v125
 v_fmac_f32 v175, v125, v125
 v_add_f32 v160, v160, v114
 v_fmac_f32 v168, v114, v114
 v_add_f32 v162, v162, v118
 v_fmac_f32 v170, v118, v118
 v_add_f32 v164, v164, v122
 v_fmac_f32 v172, v122, v122
 v_add_f32 v166, v166, v126
 v_fmac_f32 v174, v126, v126
 v_add_f32 v161, v161, v115
 v_fmac_f32 v169, v115, v115
 v_add_f32 v163, v163, v119
 v_fmac_f32 v171, v119, v119
 v_add_f32 v165, v165, v123
 v_fmac_f32 v173, v123, v123
 v_add_f32 v167, v167, v127
 v_fmac_f32 v175, v127, v127
 s_waitcnt lgkmcnt(0)
 v_add_f32 v136, v136, v128
 v_add_f32 v137, v137, v129
 v_add_f32 v138, v138, v130
 v_add_f32 v139, v139, v131
 v_add_f32 v140, v140, v132
 v_add_f32 v141, v141, v133
 v_add_f32 v142, v142, v134
 v_add_f32 v143, v143, v135
 v_fma_f32 v136, -v30, v60, v136
 v_fma_f32 v137, -v30, v61, v137
 v_fma_f32 v138, -v30, v62, v138
 v_fma_f32 v139, -v30, v63, v139
 v_fma_f32 v140, -v31, v60, v140
 v_fma_f32 v141, -v31, v61, v141
 v_fma_f32 v142, -v31, v62, v142
 v_fma_f32 v143, -v31, v63, v143
 v_mul_f32 v144, v136, v136
 v_mul_f32 v145, v137, v137
 v_mul_f32 v146, v138, v138
 v_mul_f32 v147, v139, v139
 v_mul_f32 v148, v140, v140
 v_mul_f32 v149, v141, v141
 v_mul_f32 v150, v142, v142
 v_mul_f32 v151, v143, v143
 v_fma_f32 v144, v144, v41, v40
 v_fma_f32 v145, v145, v41, v40
 v_fma_f32 v146, v146, v41, v40
 v_fma_f32 v147, v147, v41, v40
 v_fma_f32 v148, v148, v43, v42
 v_fma_f32 v149, v149, v43, v42
 v_fma_f32 v150, v150, v43, v42
 v_fma_f32 v151, v151, v43, v42
 v_mul_f32 v144, v144, v136
 v_mul_f32 v145, v145, v137
 v_mul_f32 v146, v146, v138
 v_mul_f32 v147, v147, v139
 v_mul_f32 v148, v148, v140
 v_mul_f32 v149, v149, v141
 v_mul_f32 v150, v150, v142
 v_mul_f32 v151, v151, v143
 v_exp_f32 v144, v144
 v_exp_f32 v145, v145
 v_exp_f32 v146, v146
 v_exp_f32 v147, v147
 v_exp_f32 v148, v148
 v_exp_f32 v149, v149
 v_exp_f32 v150, v150
 v_exp_f32 v151, v151
 v_add_f32 v144, 1.0, v144
 v_add_f32 v145, 1.0, v145
 v_add_f32 v146, 1.0, v146
 v_add_f32 v147, 1.0, v147
 v_add_f32 v148, 1.0, v148
 v_add_f32 v149, 1.0, v149
 v_add_f32 v150, 1.0, v150
 v_add_f32 v151, 1.0, v151
 v_rcp_f32 v144, v144
 v_rcp_f32 v145, v145
 v_rcp_f32 v146, v146
 v_rcp_f32 v147, v147
 v_rcp_f32 v148, v148
 v_rcp_f32 v149, v149
 v_rcp_f32 v150, v150
 v_rcp_f32 v151, v151
 v_mul_f32 v136, v136, v144
 v_mul_f32 v137, v137, v145
 v_mul_f32 v138, v138, v146
 v_mul_f32 v139, v139, v147
 v_mul_f32 v140, v140, v148
 v_mul_f32 v141, v141, v149
 v_mul_f32 v142, v142, v150
 v_mul_f32 v143, v143, v151
 v_add_f32 v164, v164, v136
 v_fmac_f32 v172, v136, v136
 v_add_f32 v166, v166, v140
 v_fmac_f32 v174, v140, v140
 v_add_f32 v165, v165, v137
 v_fmac_f32 v173, v137, v137
 v_add_f32 v167, v167, v141
 v_fmac_f32 v175, v141, v141
 v_add_f32 v164, v164, v138
 v_fmac_f32 v172, v138, v138
 v_add_f32 v166, v166, v142
 v_fmac_f32 v174, v142, v142
 v_add_f32 v165, v165, v139
 v_fmac_f32 v173, v139, v139
 v_add_f32 v167, v167, v143
 v_fmac_f32 v175, v143, v143
 v_add_f32 v144, v160, v161
 v_add_f32 v148, v168, v169
 v_add_f32 v145, v162, v163
 v_add_f32 v149, v170, v171
 v_add_f32 v146, v164, v165
 v_add_f32 v150, v172, v173
 v_add_f32 v147, v166, v167
 v_add_f32 v151, v174, v175
 s_nop 0
 v_permlane32_swap_b32 v144, v146
 v_permlane32_swap_b32 v145, v147
 v_permlane32_swap_b32 v148, v150
 v_permlane32_swap_b32 v149, v151
 v_add_f32 v144, v144, v146
 v_add_f32 v145, v145, v147
 v_add_f32 v148, v148, v150
 v_add_f32 v149, v149, v151
 s_nop 0
 v_permlane16_swap_b32 v144, v145
 v_permlane16_swap_b32 v148, v149
 s_lshl_b32 s36, s33, 14
 s_lshl_b32 s37, s44, 9
 v_add_f32 v160, v144, v145
 v_add_f32 v161, v148, v149
 s_add_u32 s36, s36, s37
 s_add_u32 s36, s36, 15728640
 s_add_u32 s28, s8, s36
 s_addc_u32 s29, s9, 0
 s_mov_b32 s30, 16384
 s_mov_b32 s31, 0x20000
 v_lshlrev_b32 v18, 3, v0
 ds_write_b64 v27, v[160:161]
L_fz_p4g0j:
 s_lshl_b32 s46, s33, 3
 s_lshl_b32 s47, s44, 2
 s_add_u32 s46, s46, s47
 s_mul_i32 s46, s46, 72
 s_add_u32 s46, s46, s38
 s_lshl_b32 s46, s46, 10
 s_add_u32 s46, s46, 16777216
 v_and_b32 v14, 15, v0
 v_lshrrev_b32 v15, 4, v0
 v_and_b32 v16, 7, v0
 v_xor_b32 v16, v15, v16
 v_lshlrev_b32 v16, 4, v16
 v_lshl_add_u32 v2, v14, 7, v16
 s_lshl_b32 s47, s44, 13
 v_add_u32 v2, s47, v2
 v_xor_b32 v3, 64, v2
 v_and_b32 v16, 3, v0
 v_bfe_u32 v17, v0, 2, 2
 v_lshrrev_b32 v18, 1, v16
 v_and_b32 v16, 1, v16
 v_lshl_add_u32 v19, v15, 3, v17
 v_lshl_add_u32 v19, v18, 2, v19
 v_lshlrev_b32 v19, 4, v19
 v_lshl_add_u32 v19, v16, 3, v19
 v_lshl_add_u32 v4, v18, 10, v19
 s_lshl_b32 s47, s45, 12
 s_add_u32 s47, s47, 16384
 v_add_u32 v4, s47, v4
 v_xor_b32 v5, 64, v4
 v_lshl_add_u32 v6, v18, 9, v19
 v_add_u32 v6, 24576, v6
 v_xor_b32 v7, 64, v6
 s_add_u32 s20, s8, s46
 s_addc_u32 s21, s9, 0
 s_mov_b32 s22, 294912
 s_mov_b32 s23, 0x20000
 v_lshlrev_b32 v16, 4, v14
 v_lshrrev_b32 v17, 5, v0
 v_lshl_add_u32 v16, v17, 8, v16
 v_bfe_u32 v17, v0, 4, 1
 v_lshl_add_u32 v20, v17, 9, v16
 s_lshl_b32 s46, s45, 1
 s_add_u32 s46, s46, s39
 s_lshl_b32 s46, s46, 10
 v_add_u32 v20, s46, v20
 v_mul_u32_u24 v17, 73728, v17
 s_movk_i32 s47, 512
 s_cmp_eq_u32 s39, 0
 s_cselect_b32 s46, 4096, s47
 s_mul_i32 s47, s45, 147456
 s_add_u32 s46, s46, s47
 v_add3_u32 v21, v16, v17, s46
 s_mov_b32 s50, 73728
 s_mov_b32 s51, 147456
 s_mov_b32 s52, 221184
 s_mul_i32 s46, s32, 9216
 s_add_u32 s46, s46, 123904
 v_add_u32 v14, s46, v1
 v_add_u32 v8, 32768, v2
 v_add_u32 v9, 32768, v3
 v_add_u32 v10, 107520, v4
 v_add_u32 v11, 107520, v5
 v_add_u32 v12, 107520, v6
 v_add_u32 v13, 107520, v7
 s_add_u32 s56, s8, 16515072
 s_addc_u32 s57, s9, 0
 s_mov_b32 s58, 131072
 s_mov_b32 s59, 0x20000
 s_lshl_b32 s60, s34, 4
 s_add_u32 s60, s60, s33
 s_lshl_b32 s60, s60, 2
 s_add_u32 s60, s60, s32
 s_lshl_b32 s60, s60, 7
 v_lshlrev_b32 v18, 3, v0
 v_and_b32 v19, 15, v0
 v_lshrrev_b32 v15, 5, v0
 v_lshlrev_b32 v16, 2, v15
 v_xor_b32 v16, v16, v19
 v_lshlrev_b32 v16, 4, v16
 v_lshl_add_u32 v16, v15, 10, v16
 v_bfe_u32 v15, v0, 4, 1
 v_lshl_add_u32 v22, v15, 9, v16
 v_lshl_add_u32 v23, v15, 8, v16
 s_lshl_b32 s36, s39, 9
 v_add_u32 v23, s36, v23
 v_lshlrev_b32 v19, 2, v19
 s_lshl_b32 s36, s33, 2
 s_lshl_b32 s37, s44, 1
 s_add_u32 s36, s36, s37
 s_lshl_b32 s36, s36, 11
 s_lshl_b32 s37, s38, 17
 s_add_u32 s36, s36, s37
 s_sub_u32 s37, 9437184, s36
 s_add_u32 s36, s36, 27262976
 s_add_u32 s24, s8, s36
 s_addc_u32 s25, s9, 0
 s_mov_b32 s26, s37
 s_mov_b32 s27, 0x20000
 s_mov_b32 s47, 20000
 v_add_u32 v27, 2560, v27
 s_cmp_eq_u32 s45, 0
 s_cbranch_scc0 L_fz_p4hw
L_fz_p4poll:
 s_mov_b32 s46, 0
 buffer_load_dwordx2 v[144:145], v18, s[28:31], s46 offen offset:0 sc1
 buffer_load_dwordx2 v[146:147], v18, s[28:31], s46 offen offset:1024 sc1
 buffer_load_dwordx2 v[148:149], v18, s[28:31], s46 offen offset:2048 sc1
 buffer_load_dwordx2 v[150:151], v18, s[28:31], s46 offen offset:3072 sc1
 s_mov_b32 s46, 4096
 buffer_load_dwordx2 v[152:153], v18, s[28:31], s46 offen offset:0 sc1
 buffer_load_dwordx2 v[154:155], v18, s[28:31], s46 offen offset:1024 sc1
 buffer_load_dwordx2 v[156:157], v18, s[28:31], s46 offen offset:2048 sc1
 buffer_load_dwordx2 v[158:159], v18, s[28:31], s46 offen offset:3072 sc1
 s_mov_b32 s46, 8192
 buffer_load_dwordx2 v[160:161], v18, s[28:31], s46 offen offset:0 sc1
 buffer_load_dwordx2 v[162:163], v18, s[28:31], s46 offen offset:1024 sc1
 buffer_load_dwordx2 v[164:165], v18, s[28:31], s46 offen offset:2048 sc1
 buffer_load_dwordx2 v[166:167], v18, s[28:31], s46 offen offset:3072 sc1
 s_mov_b32 s46, 12288
 buffer_load_dwordx2 v[168:169], v18, s[28:31], s46 offen offset:0 sc1
 buffer_load_dwordx2 v[170:171], v18, s[28:31], s46 offen offset:1024 sc1
 buffer_load_dwordx2 v[172:173], v18, s[28:31], s46 offen offset:2048 sc1
 buffer_load_dwordx2 v[174:175], v18, s[28:31], s46 offen offset:3072 sc1
 s_waitcnt vmcnt(0)
 v_max3_u32 v196, v145, v147, v149
 v_max3_u32 v197, v151, v153, v155
 v_max3_u32 v196, v196, v157, v159
 v_max3_u32 v197, v197, v161, v163
 v_max3_u32 v196, v196, v165, v167
 v_max3_u32 v197, v197, v169, v171
 v_max3_u32 v196, v196, v173, v175
 v_max_u32 v196, v196, v197
 v_cmp_eq_u32 vcc, -1, v196
 s_sub_u32 s47, s47, 1
 s_cbranch_vccz L_fz_p4rdy
 s_cmp_lg_u32 s47, 0
 s_cbranch_scc1 L_fz_p4poll
L_fz_p4rdy:
 v_add_f32 v144, v144, v160
 v_add_f32 v145, v145, v161
 v_add_f32 v146, v146, v162
 v_add_f32 v147, v147, v163
 v_add_f32 v148, v148, v164
 v_add_f32 v149, v149, v165
 v_add_f32 v150, v150, v166
 v_add_f32 v151, v151, v167
 v_add_f32 v152, v152, v168
 v_add_f32 v153, v153, v169
 v_add_f32 v154, v154, v170
 v_add_f32 v155, v155, v171
 v_add_f32 v156, v156, v172
 v_add_f32 v157, v157, v173
 v_add_f32 v158, v158, v174
 v_add_f32 v159, v159, v175
 v_add_f32 v144, v144, v152
 v_add_f32 v145, v145, v153
 v_add_f32 v146, v146, v154
 v_add_f32 v147, v147, v155
 v_add_f32 v148, v148, v156
 v_add_f32 v149, v149, v157
 v_add_f32 v150, v150, v158
 v_add_f32 v151, v151, v159
 v_add_f32 v144, v144, v148
 v_add_f32 v145, v145, v149
 v_add_f32 v146, v146, v150
 v_add_f32 v147, v147, v151
 v_add_f32 v144, v144, v146
 v_add_f32 v145, v145, v147
 v_mul_f32 v144, -0.00043402777777777775, v144
 v_mul_f32 v145, 0.00043402777777777775, v145
 v_fma_f32 v145, -v144, v144, v145
 v_max_f32 v145, 0, v145
 ds_write_b64 v27, v[144:145]
 s_branch L_fz_p4hx
L_fz_p4hw:
 s_mov_b32 s46, 200000
L_fz_p4hy:
 s_sleep 1
 ds_read_b64 v[144:145], v27
 s_waitcnt lgkmcnt(0)
 v_cmp_eq_u32 vcc, -1, v145
 s_sub_u32 s46, s46, 1
 s_cbranch_vccz L_fz_p4hyr
 s_cmp_lg_u32 s46, 0
 s_cbranch_scc1 L_fz_p4hy
L_fz_p4hyr:
L_fz_p4hx:
 ds_bpermute_b32 v28, v19, v144 offset:0
 ds_bpermute_b32 v148, v19, v145 offset:0
 ds_bpermute_b32 v29, v19, v144 offset:64
 ds_bpermute_b32 v149, v19, v145 offset:64
 ds_bpermute_b32 v30, v19, v144 offset:128
 ds_bpermute_b32 v150, v19, v145 offset:128
 ds_bpermute_b32 v31, v19, v144 offset:192
 ds_bpermute_b32 v151, v19, v145 offset:192
 s_waitcnt lgkmcnt(0)
 v_mul_f32 v152, v32, v32
 v_mov_b32 v156, 0x3727c5ac
 v_mul_f32 v153, v33, v33
 v_mov_b32 v157, 0x3727c5ac
 v_mul_f32 v154, v34, v34
 v_mov_b32 v158, 0x3727c5ac
 v_mul_f32 v155, v35, v35
 v_mov_b32 v159, 0x3727c5ac
 v_fmac_f32 v156, v152, v148
 v_fmac_f32 v157, v153, v149
 v_fmac_f32 v158, v154, v150
 v_fmac_f32 v159, v155, v151
 v_rsq_f32 v156, v156
 v_rsq_f32 v157, v157
 v_rsq_f32 v158, v158
 v_rsq_f32 v159, v159
 v_mul_f32 v36, v156, v32
 v_mul_f32 v38, v157, v33
 v_mul_f32 v40, v158, v34
 v_mul_f32 v42, v159, v35
 v_mul_f32 v37, v36, v28
 v_mul_f32 v39, v38, v29
 v_mul_f32 v41, v40, v30
 v_mul_f32 v43, v42, v31
 s_lshl_b32 s37, s45, 1
 s_add_u32 s37, s37, s39
 s_add_u32 s36, s37, 0
 s_lshl_b32 s36, s36, 17
 v_fma_f32 v64, v64, v36, v37
 v_fma_f32 v65, v65, v36, v37
 v_fma_f32 v66, v66, v36, v37
 v_fma_f32 v67, v67, v36, v37
 v_fma_f32 v80, v80, v36, v37
 v_fma_f32 v81, v81, v36, v37
 v_fma_f32 v82, v82, v36, v37
 v_fma_f32 v83, v83, v36, v37
 v_cvt_pk_bf16_f32 v216, v64, v65
 v_cvt_pk_bf16_f32 v218, v80, v81
 v_cvt_pk_bf16_f32 v217, v66, v67
 v_cvt_pk_bf16_f32 v219, v82, v83
 s_nop 0
 v_permlane16_swap_b32 v216, v218
 v_permlane16_swap_b32 v217, v219
 buffer_store_dwordx4 v[216:219], v22, s[24:27], s36 offen offset:0 sc1
 v_fma_f32 v68, v68, v38, v39
 v_fma_f32 v69, v69, v38, v39
 v_fma_f32 v70, v70, v38, v39
 v_fma_f32 v71, v71, v38, v39
 v_fma_f32 v84, v84, v38, v39
 v_fma_f32 v85, v85, v38, v39
 v_fma_f32 v86, v86, v38, v39
 v_fma_f32 v87, v87, v38, v39
 v_cvt_pk_bf16_f32 v220, v68, v69
 v_cvt_pk_bf16_f32 v222, v84, v85
 v_cvt_pk_bf16_f32 v221, v70, v71
 v_cvt_pk_bf16_f32 v223, v86, v87
 s_nop 0
 v_permlane16_swap_b32 v220, v222
 v_permlane16_swap_b32 v221, v223
 buffer_store_dwordx4 v[220:223], v22, s[24:27], s36 offen offset:256 sc1
 v_fma_f32 v72, v72, v40, v41
 v_fma_f32 v73, v73, v40, v41
 v_fma_f32 v74, v74, v40, v41
 v_fma_f32 v75, v75, v40, v41
 v_fma_f32 v88, v88, v40, v41
 v_fma_f32 v89, v89, v40, v41
 v_fma_f32 v90, v90, v40, v41
 v_fma_f32 v91, v91, v40, v41
 v_cvt_pk_bf16_f32 v224, v72, v73
 v_cvt_pk_bf16_f32 v226, v88, v89
 v_cvt_pk_bf16_f32 v225, v74, v75
 v_cvt_pk_bf16_f32 v227, v90, v91
 s_nop 0
 v_permlane16_swap_b32 v224, v226
 v_permlane16_swap_b32 v225, v227
 buffer_store_dwordx4 v[224:227], v22, s[24:27], s36 offen offset:2048 sc1
 v_fma_f32 v76, v76, v42, v43
 v_fma_f32 v77, v77, v42, v43
 v_fma_f32 v78, v78, v42, v43
 v_fma_f32 v79, v79, v42, v43
 v_fma_f32 v92, v92, v42, v43
 v_fma_f32 v93, v93, v42, v43
 v_fma_f32 v94, v94, v42, v43
 v_fma_f32 v95, v95, v42, v43
 v_cvt_pk_bf16_f32 v228, v76, v77
 v_cvt_pk_bf16_f32 v230, v92, v93
 v_cvt_pk_bf16_f32 v229, v78, v79
 v_cvt_pk_bf16_f32 v231, v94, v95
 s_nop 0
 v_permlane16_swap_b32 v228, v230
 v_permlane16_swap_b32 v229, v231
 buffer_store_dwordx4 v[228:231], v22, s[24:27], s36 offen offset:2304 sc1
 s_add_u32 s36, s37, 1
 s_lshl_b32 s36, s36, 17
 v_fma_f32 v96, v96, v36, v37
 v_fma_f32 v97, v97, v36, v37
 v_fma_f32 v98, v98, v36, v37
 v_fma_f32 v99, v99, v36, v37
 v_fma_f32 v112, v112, v36, v37
 v_fma_f32 v113, v113, v36, v37
 v_fma_f32 v114, v114, v36, v37
 v_fma_f32 v115, v115, v36, v37
 v_cvt_pk_bf16_f32 v232, v96, v97
 v_cvt_pk_bf16_f32 v234, v112, v113
 v_cvt_pk_bf16_f32 v233, v98, v99
 v_cvt_pk_bf16_f32 v235, v114, v115
 s_nop 0
 v_permlane16_swap_b32 v232, v234
 v_permlane16_swap_b32 v233, v235
 buffer_store_dwordx4 v[232:235], v22, s[24:27], s36 offen offset:0 sc1
 v_fma_f32 v100, v100, v38, v39
 v_fma_f32 v101, v101, v38, v39
 v_fma_f32 v102, v102, v38, v39
 v_fma_f32 v103, v103, v38, v39
 v_fma_f32 v116, v116, v38, v39
 v_fma_f32 v117, v117, v38, v39
 v_fma_f32 v118, v118, v38, v39
 v_fma_f32 v119, v119, v38, v39
 v_cvt_pk_bf16_f32 v236, v100, v101
 v_cvt_pk_bf16_f32 v238, v116, v117
 v_cvt_pk_bf16_f32 v237, v102, v103
 v_cvt_pk_bf16_f32 v239, v118, v119
 s_nop 0
 v_permlane16_swap_b32 v236, v238
 v_permlane16_swap_b32 v237, v239
 buffer_store_dwordx4 v[236:239], v22, s[24:27], s36 offen offset:256 sc1
 v_fma_f32 v104, v104, v40, v41
 v_fma_f32 v105, v105, v40, v41
 v_fma_f32 v106, v106, v40, v41
 v_fma_f32 v107, v107, v40, v41
 v_fma_f32 v120, v120, v40, v41
 v_fma_f32 v121, v121, v40, v41
 v_fma_f32 v122, v122, v40, v41
 v_fma_f32 v123, v123, v40, v41
 v_cvt_pk_bf16_f32 v240, v104, v105
 v_cvt_pk_bf16_f32 v242, v120, v121
 v_cvt_pk_bf16_f32 v241, v106, v107
 v_cvt_pk_bf16_f32 v243, v122, v123
 s_nop 0
 v_permlane16_swap_b32 v240, v242
 v_permlane16_swap_b32 v241, v243
 buffer_store_dwordx4 v[240:243], v22, s[24:27], s36 offen offset:2048 sc1
 v_fma_f32 v108, v108, v42, v43
 v_fma_f32 v109, v109, v42, v43
 v_fma_f32 v110, v110, v42, v43
 v_fma_f32 v111, v111, v42, v43
 v_fma_f32 v124, v124, v42, v43
 v_fma_f32 v125, v125, v42, v43
 v_fma_f32 v126, v126, v42, v43
 v_fma_f32 v127, v127, v42, v43
 v_cvt_pk_bf16_f32 v244, v108, v109
 v_cvt_pk_bf16_f32 v246, v124, v125
 v_cvt_pk_bf16_f32 v245, v110, v111
 v_cvt_pk_bf16_f32 v247, v126, v127
 s_nop 0
 v_permlane16_swap_b32 v244, v246
 v_permlane16_swap_b32 v245, v247
 buffer_store_dwordx4 v[244:247], v22, s[24:27], s36 offen offset:2304 sc1
 s_cmp_eq_u32 s39, 0
 s_cselect_b32 s36, 524288, 0
 s_cmp_eq_u32 s45, 0
 s_cbranch_scc0 L_fz_p4n1
 v_fma_f32 v128, v128, v36, v37
 v_fma_f32 v129, v129, v36, v37
 v_fma_f32 v130, v130, v36, v37
 v_fma_f32 v131, v131, v36, v37
 v_fma_f32 v132, v132, v38, v39
 v_fma_f32 v133, v133, v38, v39
 v_fma_f32 v134, v134, v38, v39
 v_fma_f32 v135, v135, v38, v39
 v_cvt_pk_bf16_f32 v248, v128, v129
 v_cvt_pk_bf16_f32 v250, v132, v133
 v_cvt_pk_bf16_f32 v249, v130, v131
 v_cvt_pk_bf16_f32 v251, v134, v135
 s_nop 0
 v_permlane16_swap_b32 v248, v250
 v_permlane16_swap_b32 v249, v251
 buffer_store_dwordx4 v[248:251], v23, s[24:27], s36 offen offset:0 sc1
 s_branch L_fz_p4n2
L_fz_p4n1:
 v_fma_f32 v136, v136, v40, v41
 v_fma_f32 v137, v137, v40, v41
 v_fma_f32 v138, v138, v40, v41
 v_fma_f32 v139, v139, v40, v41
 v_fma_f32 v140, v140, v42, v43
 v_fma_f32 v141, v141, v42, v43
 v_fma_f32 v142, v142, v42, v43
 v_fma_f32 v143, v143, v42, v43
 v_cvt_pk_bf16_f32 v248, v136, v137
 v_cvt_pk_bf16_f32 v250, v140, v141
 v_cvt_pk_bf16_f32 v249, v138, v139
 v_cvt_pk_bf16_f32 v251, v142, v143
 s_nop 0
 v_permlane16_swap_b32 v248, v250
 v_permlane16_swap_b32 v249, v251
 buffer_store_dwordx4 v[248:251], v23, s[24:27], s36 offen offset:2048 sc1
L_fz_p4n2:
 v_and_b32 v252, 0xffff0000, v252
 v_mov_b32 v36, v32
 v_and_b32 v253, 0xffff0000, v253
 v_mov_b32 v38, v33
 v_and_b32 v254, 0xffff0000, v254
 v_mov_b32 v40, v34
 v_and_b32 v255, 0xffff0000, v255
 v_mov_b32 v42, v35
 v_mul_f32 v37, v252, v32
 v_mul_f32 v39, v253, v33
 v_mul_f32 v41, v254, v34
 v_mul_f32 v43, v255, v35
 v_mov_b32 v128, 0
 v_mov_b32 v129, 0
 v_mov_b32 v130, 0
 v_mov_b32 v131, 0
 v_mov_b32 v132, 0
 v_mov_b32 v133, 0
 v_mov_b32 v134, 0
 v_mov_b32 v135, 0
 v_mov_b32 v136, 0
 v_mov_b32 v137, 0
 v_mov_b32 v138, 0
 v_mov_b32 v139, 0
 v_mov_b32 v140, 0
 v_mov_b32 v141, 0
 v_mov_b32 v142, 0
 v_mov_b32 v143, 0
 v_mov_b32 v254, 0
 v_mov_b32 v255, s100
 s_waitcnt vmcnt(0)
 s_mov_b64 exec, 1
 buffer_store_dword v255, v254, s[56:59], s60 offen sc1
 s_mov_b64 exec, -1
 s_cmp_eq_u32 s45, 0
 s_cbranch_scc0 L_fz_p5a1
 s_waitcnt lgkmcnt(0)
 s_barrier
 ds_read_b128 v[144:147], v8 offset:0
 ds_read_b64_tr_b16 v[160:161], v10 offset:0
 ds_read_b64_tr_b16 v[162:163], v11 offset:0
 ds_read_b128 v[148:151], v8 offset:2048
 ds_read_b128 v[152:155], v8 offset:4096
 ds_read_b128 v[156:159], v8 offset:6144
 ds_read_b64_tr_b16 v[164:165], v10 offset:512
 ds_read_b64_tr_b16 v[166:167], v11 offset:512
 ds_read_b64_tr_b16 v[168:169], v10 offset:2048
 ds_read_b64_tr_b16 v[170:171], v11 offset:2048
 ds_read_b64_tr_b16 v[172:173], v10 offset:2560
 ds_read_b64_tr_b16 v[174:175], v11 offset:2560
 ds_read_b64_tr_b16 v[176:177], v12 offset:0
 ds_read_b64_tr_b16 v[178:179], v13 offset:0
 s_waitcnt lgkmcnt(8)
 v_mfma_f32_16x16x32_bf16 v[64:67], v[160:163], v[144:147], 0
 v_mfma_f32_16x16x32_bf16 v[68:71], v[160:163], v[148:151], 0
 v_mfma_f32_16x16x32_bf16 v[72:75], v[160:163], v[152:155], 0
 v_mfma_f32_16x16x32_bf16 v[76:79], v[160:163], v[156:159], 0
 s_waitcnt lgkmcnt(0)
 v_mfma_f32_16x16x32_bf16 v[128:131], v[176:179], v[144:147], v[128:131]
 ds_read_b128 v[180:183], v9 offset:0
 v_mfma_f32_16x16x32_bf16 v[132:135], v[176:179], v[148:151], v[132:135]
 ds_read_b64_tr_b16 v[196:197], v10 offset:9216
 v_mfma_f32_16x16x32_bf16 v[136:139], v[176:179], v[152:155], v[136:139]
 ds_read_b64_tr_b16 v[198:199], v11 offset:9216
 v_mfma_f32_16x16x32_bf16 v[140:143], v[176:179], v[156:159], v[140:143]
 ds_read_b128 v[184:187], v9 offset:2048
 v_mfma_f32_16x16x32_bf16 v[80:83], v[164:167], v[144:147], 0
 ds_read_b128 v[188:191], v9 offset:4096
 v_mfma_f32_16x16x32_bf16 v[84:87], v[164:167], v[148:151], 0
 ds_read_b128 v[192:195], v9 offset:6144
 v_mfma_f32_16x16x32_bf16 v[88:91], v[164:167], v[152:155], 0
 ds_read_b64_tr_b16 v[200:201], v10 offset:9728
 v_mfma_f32_16x16x32_bf16 v[92:95], v[164:167], v[156:159], 0
 ds_read_b64_tr_b16 v[202:203], v11 offset:9728
 v_mfma_f32_16x16x32_bf16 v[96:99], v[168:171], v[144:147], 0
 ds_read_b64_tr_b16 v[204:205], v10 offset:11264
 v_mfma_f32_16x16x32_bf16 v[100:103], v[168:171], v[148:151], 0
 ds_read_b64_tr_b16 v[206:207], v11 offset:11264
 v_mfma_f32_16x16x32_bf16 v[104:107], v[168:171], v[152:155], 0
 ds_read_b64_tr_b16 v[208:209], v10 offset:11776
 v_mfma_f32_16x16x32_bf16 v[108:111], v[168:171], v[156:159], 0
 ds_read_b64_tr_b16 v[210:211], v11 offset:11776
 v_mfma_f32_16x16x32_bf16 v[112:115], v[172:175], v[144:147], 0
 v_add_u32 v8, 49152, v2
 v_mfma_f32_16x16x32_bf16 v[116:119], v[172:175], v[148:151], 0
 v_add_u32 v9, 49152, v3
 v_mfma_f32_16x16x32_bf16 v[120:123], v[172:175], v[152:155], 0
 v_add_u32 v10, 125952, v4
 v_mfma_f32_16x16x32_bf16 v[124:127], v[172:175], v[156:159], 0
 v_add_u32 v11, 125952, v5
 v_add_u32 v12, 125952, v6
 v_add_u32 v13, 125952, v7
 s_waitcnt lgkmcnt(6)
 v_mfma_f32_16x16x32_bf16 v[64:67], v[196:199], v[180:183], v[64:67]
 v_mfma_f32_16x16x32_bf16 v[68:71], v[196:199], v[184:187], v[68:71]
 v_mfma_f32_16x16x32_bf16 v[72:75], v[196:199], v[188:191], v[72:75]
 v_mfma_f32_16x16x32_bf16 v[76:79], v[196:199], v[192:195], v[76:79]
 s_waitcnt lgkmcnt(0)
 s_barrier
 v_mfma_f32_16x16x32_bf16 v[80:83], v[200:203], v[180:183], v[80:83]
 ds_read_b128 v[144:147], v8 offset:0
 v_mfma_f32_16x16x32_bf16 v[84:87], v[200:203], v[184:187], v[84:87]
 ds_read_b64_tr_b16 v[160:161], v10 offset:0
 v_mfma_f32_16x16x32_bf16 v[88:91], v[200:203], v[188:191], v[88:91]
 ds_read_b64_tr_b16 v[162:163], v11 offset:0
 v_mfma_f32_16x16x32_bf16 v[92:95], v[200:203], v[192:195], v[92:95]
 ds_read_b128 v[148:151], v8 offset:2048
 v_mfma_f32_16x16x32_bf16 v[96:99], v[204:207], v[180:183], v[96:99]
 ds_read_b128 v[152:155], v8 offset:4096
 v_mfma_f32_16x16x32_bf16 v[100:103], v[204:207], v[184:187], v[100:103]
 ds_read_b128 v[156:159], v8 offset:6144
 v_mfma_f32_16x16x32_bf16 v[104:107], v[204:207], v[188:191], v[104:107]
 ds_read_b64_tr_b16 v[164:165], v10 offset:512
 v_mfma_f32_16x16x32_bf16 v[108:111], v[204:207], v[192:195], v[108:111]
 ds_read_b64_tr_b16 v[166:167], v11 offset:512
 v_mfma_f32_16x16x32_bf16 v[112:115], v[208:211], v[180:183], v[112:115]
 ds_read_b64_tr_b16 v[168:169], v10 offset:2048
 v_mfma_f32_16x16x32_bf16 v[116:119], v[208:211], v[184:187], v[116:119]
 ds_read_b64_tr_b16 v[170:171], v11 offset:2048
 v_mfma_f32_16x16x32_bf16 v[120:123], v[208:211], v[188:191], v[120:123]
 ds_read_b64_tr_b16 v[172:173], v10 offset:2560
 v_mfma_f32_16x16x32_bf16 v[124:127], v[208:211], v[192:195], v[124:127]
 ds_read_b64_tr_b16 v[174:175], v11 offset:2560
 ds_read_b64_tr_b16 v[176:177], v12 offset:0
 ds_read_b64_tr_b16 v[178:179], v13 offset:0
 s_waitcnt lgkmcnt(8)
 v_mfma_f32_16x16x32_bf16 v[64:67], v[160:163], v[144:147], v[64:67]
 v_mfma_f32_16x16x32_bf16 v[68:71], v[160:163], v[148:151], v[68:71]
 v_mfma_f32_16x16x32_bf16 v[72:75], v[160:163], v[152:155], v[72:75]
 v_mfma_f32_16x16x32_bf16 v[76:79], v[160:163], v[156:159], v[76:79]
 s_waitcnt lgkmcnt(0)
 v_mfma_f32_16x16x32_bf16 v[128:131], v[176:179], v[144:147], v[128:131]
 ds_read_b128 v[180:183], v9 offset:0
 v_mfma_f32_16x16x32_bf16 v[132:135], v[176:179], v[148:151], v[132:135]
 ds_read_b64_tr_b16 v[196:197], v10 offset:9216
 v_mfma_f32_16x16x32_bf16 v[136:139], v[176:179], v[152:155], v[136:139]
 ds_read_b64_tr_b16 v[198:199], v11 offset:9216
 v_mfma_f32_16x16x32_bf16 v[140:143], v[176:179], v[156:159], v[140:143]
 ds_read_b128 v[184:187], v9 offset:2048
 v_mfma_f32_16x16x32_bf16 v[80:83], v[164:167], v[144:147], v[80:83]
 ds_read_b128 v[188:191], v9 offset:4096
 v_mfma_f32_16x16x32_bf16 v[84:87], v[164:167], v[148:151], v[84:87]
 ds_read_b128 v[192:195], v9 offset:6144
 v_mfma_f32_16x16x32_bf16 v[88:91], v[164:167], v[152:155], v[88:91]
 ds_read_b64_tr_b16 v[200:201], v10 offset:9728
 v_mfma_f32_16x16x32_bf16 v[92:95], v[164:167], v[156:159], v[92:95]
 ds_read_b64_tr_b16 v[202:203], v11 offset:9728
 v_mfma_f32_16x16x32_bf16 v[96:99], v[168:171], v[144:147], v[96:99]
 ds_read_b64_tr_b16 v[204:205], v10 offset:11264
 v_mfma_f32_16x16x32_bf16 v[100:103], v[168:171], v[148:151], v[100:103]
 ds_read_b64_tr_b16 v[206:207], v11 offset:11264
 v_mfma_f32_16x16x32_bf16 v[104:107], v[168:171], v[152:155], v[104:107]
 ds_read_b64_tr_b16 v[208:209], v10 offset:11776
 v_mfma_f32_16x16x32_bf16 v[108:111], v[168:171], v[156:159], v[108:111]
 ds_read_b64_tr_b16 v[210:211], v11 offset:11776
 v_mfma_f32_16x16x32_bf16 v[112:115], v[172:175], v[144:147], v[112:115]
 v_mov_b32 v8, v2
 v_mfma_f32_16x16x32_bf16 v[116:119], v[172:175], v[148:151], v[116:119]
 v_mov_b32 v9, v3
 v_mfma_f32_16x16x32_bf16 v[120:123], v[172:175], v[152:155], v[120:123]
 v_add_u32 v10, 70656, v4
 v_mfma_f32_16x16x32_bf16 v[124:127], v[172:175], v[156:159], v[124:127]
 v_add_u32 v11, 70656, v5
 v_add_u32 v12, 70656, v6
 v_add_u32 v13, 70656, v7
 s_waitcnt lgkmcnt(6)
 v_mfma_f32_16x16x32_bf16 v[64:67], v[196:199], v[180:183], v[64:67]
 v_mfma_f32_16x16x32_bf16 v[68:71], v[196:199], v[184:187], v[68:71]
 v_mfma_f32_16x16x32_bf16 v[72:75], v[196:199], v[188:191], v[72:75]
 v_mfma_f32_16x16x32_bf16 v[76:79], v[196:199], v[192:195], v[76:79]
 s_waitcnt lgkmcnt(0)
 s_barrier
 v_mfma_f32_16x16x32_bf16 v[80:83], v[200:203], v[180:183], v[80:83]
 ds_read_b128 v[144:147], v8 offset:0
 v_mfma_f32_16x16x32_bf16 v[84:87], v[200:203], v[184:187], v[84:87]
 ds_read_b64_tr_b16 v[160:161], v10 offset:0
 v_mfma_f32_16x16x32_bf16 v[88:91], v[200:203], v[188:191], v[88:91]
 ds_read_b64_tr_b16 v[162:163], v11 offset:0
 v_mfma_f32_16x16x32_bf16 v[92:95], v[200:203], v[192:195], v[92:95]
 ds_read_b128 v[148:151], v8 offset:2048
 v_mfma_f32_16x16x32_bf16 v[96:99], v[204:207], v[180:183], v[96:99]
 ds_read_b128 v[152:155], v8 offset:4096
 v_mfma_f32_16x16x32_bf16 v[100:103], v[204:207], v[184:187], v[100:103]
 ds_read_b128 v[156:159], v8 offset:6144
 v_mfma_f32_16x16x32_bf16 v[104:107], v[204:207], v[188:191], v[104:107]
 ds_read_b64_tr_b16 v[164:165], v10 offset:512
 v_mfma_f32_16x16x32_bf16 v[108:111], v[204:207], v[192:195], v[108:111]
 ds_read_b64_tr_b16 v[166:167], v11 offset:512
 v_mfma_f32_16x16x32_bf16 v[112:115], v[208:211], v[180:183], v[112:115]
 ds_read_b64_tr_b16 v[168:169], v10 offset:2048
 v_mfma_f32_16x16x32_bf16 v[116:119], v[208:211], v[184:187], v[116:119]
 ds_read_b64_tr_b16 v[170:171], v11 offset:2048
 v_mfma_f32_16x16x32_bf16 v[120:123], v[208:211], v[188:191], v[120:123]
 ds_read_b64_tr_b16 v[172:173], v10 offset:2560
 v_mfma_f32_16x16x32_bf16 v[124:127], v[208:211], v[192:195], v[124:127]
 ds_read_b64_tr_b16 v[174:175], v11 offset:2560
 ds_read_b64_tr_b16 v[176:177], v12 offset:0
 ds_read_b64_tr_b16 v[178:179], v13 offset:0
 s_waitcnt lgkmcnt(8)
 v_mfma_f32_16x16x32_bf16 v[64:67], v[160:163], v[144:147], v[64:67]
 v_mfma_f32_16x16x32_bf16 v[68:71], v[160:163], v[148:151], v[68:71]
 v_mfma_f32_16x16x32_bf16 v[72:75], v[160:163], v[152:155], v[72:75]
 v_mfma_f32_16x16x32_bf16 v[76:79], v[160:163], v[156:159], v[76:79]
 s_waitcnt lgkmcnt(0)
 v_mfma_f32_16x16x32_bf16 v[128:131], v[176:179], v[144:147], v[128:131]
 ds_read_b128 v[180:183], v9 offset:0
 v_mfma_f32_16x16x32_bf16 v[132:135], v[176:179], v[148:151], v[132:135]
 ds_read_b64_tr_b16 v[196:197], v10 offset:9216
 v_mfma_f32_16x16x32_bf16 v[136:139], v[176:179], v[152:155], v[136:139]
 ds_read_b64_tr_b16 v[198:199], v11 offset:9216
 v_mfma_f32_16x16x32_bf16 v[140:143], v[176:179], v[156:159], v[140:143]
 ds_read_b128 v[184:187], v9 offset:2048
 v_mfma_f32_16x16x32_bf16 v[80:83], v[164:167], v[144:147], v[80:83]
 ds_read_b128 v[188:191], v9 offset:4096
 v_mfma_f32_16x16x32_bf16 v[84:87], v[164:167], v[148:151], v[84:87]
 ds_read_b128 v[192:195], v9 offset:6144
 v_mfma_f32_16x16x32_bf16 v[88:91], v[164:167], v[152:155], v[88:91]
 ds_read_b64_tr_b16 v[200:201], v10 offset:9728
 v_mfma_f32_16x16x32_bf16 v[92:95], v[164:167], v[156:159], v[92:95]
 ds_read_b64_tr_b16 v[202:203], v11 offset:9728
 v_mfma_f32_16x16x32_bf16 v[96:99], v[168:171], v[144:147], v[96:99]
 ds_read_b64_tr_b16 v[204:205], v10 offset:11264
 v_mfma_f32_16x16x32_bf16 v[100:103], v[168:171], v[148:151], v[100:103]
 ds_read_b64_tr_b16 v[206:207], v11 offset:11264
 v_mfma_f32_16x16x32_bf16 v[104:107], v[168:171], v[152:155], v[104:107]
 ds_read_b64_tr_b16 v[208:209], v10 offset:11776
 v_mfma_f32_16x16x32_bf16 v[108:111], v[168:171], v[156:159], v[108:111]
 ds_read_b64_tr_b16 v[210:211], v11 offset:11776
 v_mfma_f32_16x16x32_bf16 v[112:115], v[172:175], v[144:147], v[112:115]
 v_add_u32 v8, 16384, v2
 v_mfma_f32_16x16x32_bf16 v[116:119], v[172:175], v[148:151], v[116:119]
 v_add_u32 v9, 16384, v3
 v_mfma_f32_16x16x32_bf16 v[120:123], v[172:175], v[152:155], v[120:123]
 v_add_u32 v10, 89088, v4
 v_mfma_f32_16x16x32_bf16 v[124:127], v[172:175], v[156:159], v[124:127]
 v_add_u32 v11, 89088, v5
 v_add_u32 v12, 89088, v6
 v_add_u32 v13, 89088, v7
 s_waitcnt lgkmcnt(6)
 v_mfma_f32_16x16x32_bf16 v[64:67], v[196:199], v[180:183], v[64:67]
 v_mfma_f32_16x16x32_bf16 v[68:71], v[196:199], v[184:187], v[68:71]
 v_mfma_f32_16x16x32_bf16 v[72:75], v[196:199], v[188:191], v[72:75]
 v_mfma_f32_16x16x32_bf16 v[76:79], v[196:199], v[192:195], v[76:79]
 s_waitcnt lgkmcnt(0)
 s_barrier
 v_mfma_f32_16x16x32_bf16 v[80:83], v[200:203], v[180:183], v[80:83]
 ds_read_b128 v[144:147], v8 offset:0
 v_mfma_f32_16x16x32_bf16 v[84:87], v[200:203], v[184:187], v[84:87]
 ds_read_b64_tr_b16 v[160:161], v10 offset:0
 v_mfma_f32_16x16x32_bf16 v[88:91], v[200:203], v[188:191], v[88:91]
 ds_read_b64_tr_b16 v[162:163], v11 offset:0
 v_mfma_f32_16x16x32_bf16 v[92:95], v[200:203], v[192:195], v[92:95]
 ds_read_b128 v[148:151], v8 offset:2048
 v_mfma_f32_16x16x32_bf16 v[96:99], v[204:207], v[180:183], v[96:99]
 ds_read_b128 v[152:155], v8 offset:4096
 v_mfma_f32_16x16x32_bf16 v[100:103], v[204:207], v[184:187], v[100:103]
 ds_read_b128 v[156:159], v8 offset:6144
 v_mfma_f32_16x16x32_bf16 v[104:107], v[204:207], v[188:191], v[104:107]
 ds_read_b64_tr_b16 v[164:165], v10 offset:512
 v_mfma_f32_16x16x32_bf16 v[108:111], v[204:207], v[192:195], v[108:111]
 ds_read_b64_tr_b16 v[166:167], v11 offset:512
 v_mfma_f32_16x16x32_bf16 v[112:115], v[208:211], v[180:183], v[112:115]
 ds_read_b64_tr_b16 v[168:169], v10 offset:2048
 v_mfma_f32_16x16x32_bf16 v[116:119], v[208:211], v[184:187], v[116:119]
 ds_read_b64_tr_b16 v[170:171], v11 offset:2048
 v_mfma_f32_16x16x32_bf16 v[120:123], v[208:211], v[188:191], v[120:123]
 ds_read_b64_tr_b16 v[172:173], v10 offset:2560
 v_mfma_f32_16x16x32_bf16 v[124:127], v[208:211], v[192:195], v[124:127]
 ds_read_b64_tr_b16 v[174:175], v11 offset:2560
 ds_read_b64_tr_b16 v[176:177], v12 offset:0
 ds_read_b64_tr_b16 v[178:179], v13 offset:0
 s_waitcnt lgkmcnt(8)
 v_mfma_f32_16x16x32_bf16 v[64:67], v[160:163], v[144:147], v[64:67]
 v_mfma_f32_16x16x32_bf16 v[68:71], v[160:163], v[148:151], v[68:71]
 v_mfma_f32_16x16x32_bf16 v[72:75], v[160:163], v[152:155], v[72:75]
 v_mfma_f32_16x16x32_bf16 v[76:79], v[160:163], v[156:159], v[76:79]
 s_waitcnt lgkmcnt(0)
 v_mfma_f32_16x16x32_bf16 v[128:131], v[176:179], v[144:147], v[128:131]
 ds_read_b128 v[180:183], v9 offset:0
 v_mfma_f32_16x16x32_bf16 v[132:135], v[176:179], v[148:151], v[132:135]
 ds_read_b64_tr_b16 v[196:197], v10 offset:9216
 v_mfma_f32_16x16x32_bf16 v[136:139], v[176:179], v[152:155], v[136:139]
 ds_read_b64_tr_b16 v[198:199], v11 offset:9216
 v_mfma_f32_16x16x32_bf16 v[140:143], v[176:179], v[156:159], v[140:143]
 ds_read_b128 v[184:187], v9 offset:2048
 v_mfma_f32_16x16x32_bf16 v[80:83], v[164:167], v[144:147], v[80:83]
 ds_read_b128 v[188:191], v9 offset:4096
 v_mfma_f32_16x16x32_bf16 v[84:87], v[164:167], v[148:151], v[84:87]
 ds_read_b128 v[192:195], v9 offset:6144
 v_mfma_f32_16x16x32_bf16 v[88:91], v[164:167], v[152:155], v[88:91]
 ds_read_b64_tr_b16 v[200:201], v10 offset:9728
 v_mfma_f32_16x16x32_bf16 v[92:95], v[164:167], v[156:159], v[92:95]
 ds_read_b64_tr_b16 v[202:203], v11 offset:9728
 v_mfma_f32_16x16x32_bf16 v[96:99], v[168:171], v[144:147], v[96:99]
 ds_read_b64_tr_b16 v[204:205], v10 offset:11264
 v_mfma_f32_16x16x32_bf16 v[100:103], v[168:171], v[148:151], v[100:103]
 ds_read_b64_tr_b16 v[206:207], v11 offset:11264
 v_mfma_f32_16x16x32_bf16 v[104:107], v[168:171], v[152:155], v[104:107]
 ds_read_b64_tr_b16 v[208:209], v10 offset:11776
 v_mfma_f32_16x16x32_bf16 v[108:111], v[168:171], v[156:159], v[108:111]
 ds_read_b64_tr_b16 v[210:211], v11 offset:11776
 v_mfma_f32_16x16x32_bf16 v[112:115], v[172:175], v[144:147], v[112:115]
 v_add_u32 v8, 32768, v2
 v_mfma_f32_16x16x32_bf16 v[116:119], v[172:175], v[148:151], v[116:119]
 v_add_u32 v9, 32768, v3
 v_mfma_f32_16x16x32_bf16 v[120:123], v[172:175], v[152:155], v[120:123]
 v_add_u32 v10, 107520, v4
 v_mfma_f32_16x16x32_bf16 v[124:127], v[172:175], v[156:159], v[124:127]
 v_add_u32 v11, 107520, v5
 v_add_u32 v12, 107520, v6
 v_add_u32 v13, 107520, v7
 s_mov_b32 s40, 4
L_fz_p5c0:
 s_waitcnt lgkmcnt(6)
 v_mfma_f32_16x16x32_bf16 v[64:67], v[196:199], v[180:183], v[64:67]
 v_mfma_f32_16x16x32_bf16 v[68:71], v[196:199], v[184:187], v[68:71]
 v_mfma_f32_16x16x32_bf16 v[72:75], v[196:199], v[188:191], v[72:75]
 v_mfma_f32_16x16x32_bf16 v[76:79], v[196:199], v[192:195], v[76:79]
 s_waitcnt lgkmcnt(0)
 s_barrier
 v_mfma_f32_16x16x32_bf16 v[80:83], v[200:203], v[180:183], v[80:83]
 ds_read_b128 v[144:147], v8 offset:0
 v_mfma_f32_16x16x32_bf16 v[84:87], v[200:203], v[184:187], v[84:87]
 ds_read_b64_tr_b16 v[160:161], v10 offset:0
 v_mfma_f32_16x16x32_bf16 v[88:91], v[200:203], v[188:191], v[88:91]
 ds_read_b64_tr_b16 v[162:163], v11 offset:0
 v_mfma_f32_16x16x32_bf16 v[92:95], v[200:203], v[192:195], v[92:95]
 ds_read_b128 v[148:151], v8 offset:2048
 v_mfma_f32_16x16x32_bf16 v[96:99], v[204:207], v[180:183], v[96:99]
 ds_read_b128 v[152:155], v8 offset:4096
 v_mfma_f32_16x16x32_bf16 v[100:103], v[204:207], v[184:187], v[100:103]
 ds_read_b128 v[156:159], v8 offset:6144
 v_mfma_f32_16x16x32_bf16 v[104:107], v[204:207], v[188:191], v[104:107]
 ds_read_b64_tr_b16 v[164:165], v10 offset:512
 v_mfma_f32_16x16x32_bf16 v[108:111], v[204:207], v[192:195], v[108:111]
 ds_read_b64_tr_b16 v[166:167], v11 offset:512
 v_mfma_f32_16x16x32_bf16 v[112:115], v[208:211], v[180:183], v[112:115]
 ds_read_b64_tr_b16 v[168:169], v10 offset:2048
 v_mfma_f32_16x16x32_bf16 v[116:119], v[208:211], v[184:187], v[116:119]
 ds_read_b64_tr_b16 v[170:171], v11 offset:2048
 v_mfma_f32_16x16x32_bf16 v[120:123], v[208:211], v[188:191], v[120:123]
 ds_read_b64_tr_b16 v[172:173], v10 offset:2560
 v_mfma_f32_16x16x32_bf16 v[124:127], v[208:211], v[192:195], v[124:127]
 ds_read_b64_tr_b16 v[174:175], v11 offset:2560
 ds_read_b64_tr_b16 v[176:177], v12 offset:0
 ds_read_b64_tr_b16 v[178:179], v13 offset:0
 s_waitcnt lgkmcnt(8)
 v_mfma_f32_16x16x32_bf16 v[64:67], v[160:163], v[144:147], v[64:67]
 v_mfma_f32_16x16x32_bf16 v[68:71], v[160:163], v[148:151], v[68:71]
 v_mfma_f32_16x16x32_bf16 v[72:75], v[160:163], v[152:155], v[72:75]
 v_mfma_f32_16x16x32_bf16 v[76:79], v[160:163], v[156:159], v[76:79]
 s_waitcnt lgkmcnt(0)
 v_mfma_f32_16x16x32_bf16 v[128:131], v[176:179], v[144:147], v[128:131]
 ds_read_b128 v[180:183], v9 offset:0
 v_mfma_f32_16x16x32_bf16 v[132:135], v[176:179], v[148:151], v[132:135]
 ds_read_b64_tr_b16 v[196:197], v10 offset:9216
 v_mfma_f32_16x16x32_bf16 v[136:139], v[176:179], v[152:155], v[136:139]
 ds_read_b64_tr_b16 v[198:199], v11 offset:9216
 v_mfma_f32_16x16x32_bf16 v[140:143], v[176:179], v[156:159], v[140:143]
 ds_read_b128 v[184:187], v9 offset:2048
 v_mfma_f32_16x16x32_bf16 v[80:83], v[164:167], v[144:147], v[80:83]
 ds_read_b128 v[188:191], v9 offset:4096
 v_mfma_f32_16x16x32_bf16 v[84:87], v[164:167], v[148:151], v[84:87]
 ds_read_b128 v[192:195], v9 offset:6144
 v_mfma_f32_16x16x32_bf16 v[88:91], v[164:167], v[152:155], v[88:91]
 ds_read_b64_tr_b16 v[200:201], v10 offset:9728
 v_mfma_f32_16x16x32_bf16 v[92:95], v[164:167], v[156:159], v[92:95]
 ds_read_b64_tr_b16 v[202:203], v11 offset:9728
 v_mfma_f32_16x16x32_bf16 v[96:99], v[168:171], v[144:147], v[96:99]
 ds_read_b64_tr_b16 v[204:205], v10 offset:11264
 v_mfma_f32_16x16x32_bf16 v[100:103], v[168:171], v[148:151], v[100:103]
 ds_read_b64_tr_b16 v[206:207], v11 offset:11264
 v_mfma_f32_16x16x32_bf16 v[104:107], v[168:171], v[152:155], v[104:107]
 ds_read_b64_tr_b16 v[208:209], v10 offset:11776
 v_mfma_f32_16x16x32_bf16 v[108:111], v[168:171], v[156:159], v[108:111]
 ds_read_b64_tr_b16 v[210:211], v11 offset:11776
 v_mfma_f32_16x16x32_bf16 v[112:115], v[172:175], v[144:147], v[112:115]
 v_add_u32 v8, 49152, v2
 v_mfma_f32_16x16x32_bf16 v[116:119], v[172:175], v[148:151], v[116:119]
 v_add_u32 v9, 49152, v3
 v_mfma_f32_16x16x32_bf16 v[120:123], v[172:175], v[152:155], v[120:123]
 v_add_u32 v10, 125952, v4
 v_mfma_f32_16x16x32_bf16 v[124:127], v[172:175], v[156:159], v[124:127]
 v_add_u32 v11, 125952, v5
 v_add_u32 v12, 125952, v6
 v_add_u32 v13, 125952, v7
 s_waitcnt lgkmcnt(6)
 v_mfma_f32_16x16x32_bf16 v[64:67], v[196:199], v[180:183], v[64:67]
 v_mfma_f32_16x16x32_bf16 v[68:71], v[196:199], v[184:187], v[68:71]
 v_mfma_f32_16x16x32_bf16 v[72:75], v[196:199], v[188:191], v[72:75]
 v_mfma_f32_16x16x32_bf16 v[76:79], v[196:199], v[192:195], v[76:79]
 s_waitcnt lgkmcnt(0)
 s_barrier
 v_mfma_f32_16x16x32_bf16 v[80:83], v[200:203], v[180:183], v[80:83]
 ds_read_b128 v[144:147], v8 offset:0
 v_mfma_f32_16x16x32_bf16 v[84:87], v[200:203], v[184:187], v[84:87]
 ds_read_b64_tr_b16 v[160:161], v10 offset:0
 v_mfma_f32_16x16x32_bf16 v[88:91], v[200:203], v[188:191], v[88:91]
 ds_read_b64_tr_b16 v[162:163], v11 offset:0
 v_mfma_f32_16x16x32_bf16 v[92:95], v[200:203], v[192:195], v[92:95]
 ds_read_b128 v[148:151], v8 offset:2048
 v_mfma_f32_16x16x32_bf16 v[96:99], v[204:207], v[180:183], v[96:99]
 ds_read_b128 v[152:155], v8 offset:4096
 v_mfma_f32_16x16x32_bf16 v[100:103], v[204:207], v[184:187], v[100:103]
 ds_read_b128 v[156:159], v8 offset:6144
 v_mfma_f32_16x16x32_bf16 v[104:107], v[204:207], v[188:191], v[104:107]
 ds_read_b64_tr_b16 v[164:165], v10 offset:512
 v_mfma_f32_16x16x32_bf16 v[108:111], v[204:207], v[192:195], v[108:111]
 ds_read_b64_tr_b16 v[166:167], v11 offset:512
 v_mfma_f32_16x16x32_bf16 v[112:115], v[208:211], v[180:183], v[112:115]
 ds_read_b64_tr_b16 v[168:169], v10 offset:2048
 v_mfma_f32_16x16x32_bf16 v[116:119], v[208:211], v[184:187], v[116:119]
 ds_read_b64_tr_b16 v[170:171], v11 offset:2048
 v_mfma_f32_16x16x32_bf16 v[120:123], v[208:211], v[188:191], v[120:123]
 ds_read_b64_tr_b16 v[172:173], v10 offset:2560
 v_mfma_f32_16x16x32_bf16 v[124:127], v[208:211], v[192:195], v[124:127]
 ds_read_b64_tr_b16 v[174:175], v11 offset:2560
 ds_read_b64_tr_b16 v[176:177], v12 offset:0
 ds_read_b64_tr_b16 v[178:179], v13 offset:0
 s_waitcnt lgkmcnt(8)
 v_mfma_f32_16x16x32_bf16 v[64:67], v[160:163], v[144:147], v[64:67]
 v_mfma_f32_16x16x32_bf16 v[68:71], v[160:163], v[148:151], v[68:71]
 v_mfma_f32_16x16x32_bf16 v[72:75], v[160:163], v[152:155], v[72:75]
 v_mfma_f32_16x16x32_bf16 v[76:79], v[160:163], v[156:159], v[76:79]
 s_waitcnt lgkmcnt(0)
 v_mfma_f32_16x16x32_bf16 v[128:131], v[176:179], v[144:147], v[128:131]
 ds_read_b128 v[180:183], v9 offset:0
 v_mfma_f32_16x16x32_bf16 v[132:135], v[176:179], v[148:151], v[132:135]
 ds_read_b64_tr_b16 v[196:197], v10 offset:9216
 v_mfma_f32_16x16x32_bf16 v[136:139], v[176:179], v[152:155], v[136:139]
 ds_read_b64_tr_b16 v[198:199], v11 offset:9216
 v_mfma_f32_16x16x32_bf16 v[140:143], v[176:179], v[156:159], v[140:143]
 ds_read_b128 v[184:187], v9 offset:2048
 v_mfma_f32_16x16x32_bf16 v[80:83], v[164:167], v[144:147], v[80:83]
 ds_read_b128 v[188:191], v9 offset:4096
 v_mfma_f32_16x16x32_bf16 v[84:87], v[164:167], v[148:151], v[84:87]
 ds_read_b128 v[192:195], v9 offset:6144
 v_mfma_f32_16x16x32_bf16 v[88:91], v[164:167], v[152:155], v[88:91]
 ds_read_b64_tr_b16 v[200:201], v10 offset:9728
 v_mfma_f32_16x16x32_bf16 v[92:95], v[164:167], v[156:159], v[92:95]
 ds_read_b64_tr_b16 v[202:203], v11 offset:9728
 v_mfma_f32_16x16x32_bf16 v[96:99], v[168:171], v[144:147], v[96:99]
 ds_read_b64_tr_b16 v[204:205], v10 offset:11264
 v_mfma_f32_16x16x32_bf16 v[100:103], v[168:171], v[148:151], v[100:103]
 ds_read_b64_tr_b16 v[206:207], v11 offset:11264
 v_mfma_f32_16x16x32_bf16 v[104:107], v[168:171], v[152:155], v[104:107]
 ds_read_b64_tr_b16 v[208:209], v10 offset:11776
 v_mfma_f32_16x16x32_bf16 v[108:111], v[168:171], v[156:159], v[108:111]
 ds_read_b64_tr_b16 v[210:211], v11 offset:11776
 v_mfma_f32_16x16x32_bf16 v[112:115], v[172:175], v[144:147], v[112:115]
 v_mov_b32 v8, v2
 v_mfma_f32_16x16x32_bf16 v[116:119], v[172:175], v[148:151], v[116:119]
 v_mov_b32 v9, v3
 v_mfma_f32_16x16x32_bf16 v[120:123], v[172:175], v[152:155], v[120:123]
 v_add_u32 v10, 70656, v4
 v_mfma_f32_16x16x32_bf16 v[124:127], v[172:175], v[156:159], v[124:127]
 v_add_u32 v11, 70656, v5
 v_add_u32 v12, 70656, v6
 v_add_u32 v13, 70656, v7
 s_waitcnt lgkmcnt(6)
 v_mfma_f32_16x16x32_bf16 v[64:67], v[196:199], v[180:183], v[64:67]
 v_mfma_f32_16x16x32_bf16 v[68:71], v[196:199], v[184:187], v[68:71]
 v_mfma_f32_16x16x32_bf16 v[72:75], v[196:199], v[188:191], v[72:75]
 v_mfma_f32_16x16x32_bf16 v[76:79], v[196:199], v[192:195], v[76:79]
 s_waitcnt lgkmcnt(0)
 s_barrier
 v_mfma_f32_16x16x32_bf16 v[80:83], v[200:203], v[180:183], v[80:83]
 ds_read_b128 v[144:147], v8 offset:0
 v_mfma_f32_16x16x32_bf16 v[84:87], v[200:203], v[184:187], v[84:87]
 ds_read_b64_tr_b16 v[160:161], v10 offset:0
 v_mfma_f32_16x16x32_bf16 v[88:91], v[200:203], v[188:191], v[88:91]
 ds_read_b64_tr_b16 v[162:163], v11 offset:0
 v_mfma_f32_16x16x32_bf16 v[92:95], v[200:203], v[192:195], v[92:95]
 ds_read_b128 v[148:151], v8 offset:2048
 v_mfma_f32_16x16x32_bf16 v[96:99], v[204:207], v[180:183], v[96:99]
 ds_read_b128 v[152:155], v8 offset:4096
 v_mfma_f32_16x16x32_bf16 v[100:103], v[204:207], v[184:187], v[100:103]
 ds_read_b128 v[156:159], v8 offset:6144
 v_mfma_f32_16x16x32_bf16 v[104:107], v[204:207], v[188:191], v[104:107]
 ds_read_b64_tr_b16 v[164:165], v10 offset:512
 v_mfma_f32_16x16x32_bf16 v[108:111], v[204:207], v[192:195], v[108:111]
 ds_read_b64_tr_b16 v[166:167], v11 offset:512
 v_mfma_f32_16x16x32_bf16 v[112:115], v[208:211], v[180:183], v[112:115]
 ds_read_b64_tr_b16 v[168:169], v10 offset:2048
 v_mfma_f32_16x16x32_bf16 v[116:119], v[208:211], v[184:187], v[116:119]
 ds_read_b64_tr_b16 v[170:171], v11 offset:2048
 v_mfma_f32_16x16x32_bf16 v[120:123], v[208:211], v[188:191], v[120:123]
 ds_read_b64_tr_b16 v[172:173], v10 offset:2560
 v_mfma_f32_16x16x32_bf16 v[124:127], v[208:211], v[192:195], v[124:127]
 ds_read_b64_tr_b16 v[174:175], v11 offset:2560
 ds_read_b64_tr_b16 v[176:177], v12 offset:0
 ds_read_b64_tr_b16 v[178:179], v13 offset:0
 s_waitcnt lgkmcnt(8)
 v_mfma_f32_16x16x32_bf16 v[64:67], v[160:163], v[144:147], v[64:67]
 v_mfma_f32_16x16x32_bf16 v[68:71], v[160:163], v[148:151], v[68:71]
 v_mfma_f32_16x16x32_bf16 v[72:75], v[160:163], v[152:155], v[72:75]
 v_mfma_f32_16x16x32_bf16 v[76:79], v[160:163], v[156:159], v[76:79]
 s_waitcnt lgkmcnt(0)
 v_mfma_f32_16x16x32_bf16 v[128:131], v[176:179], v[144:147], v[128:131]
 ds_read_b128 v[180:183], v9 offset:0
 v_mfma_f32_16x16x32_bf16 v[132:135], v[176:179], v[148:151], v[132:135]
 ds_read_b64_tr_b16 v[196:197], v10 offset:9216
 v_mfma_f32_16x16x32_bf16 v[136:139], v[176:179], v[152:155], v[136:139]
 ds_read_b64_tr_b16 v[198:199], v11 offset:9216
 v_mfma_f32_16x16x32_bf16 v[140:143], v[176:179], v[156:159], v[140:143]
 ds_read_b128 v[184:187], v9 offset:2048
 v_mfma_f32_16x16x32_bf16 v[80:83], v[164:167], v[144:147], v[80:83]
 ds_read_b128 v[188:191], v9 offset:4096
 v_mfma_f32_16x16x32_bf16 v[84:87], v[164:167], v[148:151], v[84:87]
 ds_read_b128 v[192:195], v9 offset:6144
 v_mfma_f32_16x16x32_bf16 v[88:91], v[164:167], v[152:155], v[88:91]
 ds_read_b64_tr_b16 v[200:201], v10 offset:9728
 v_mfma_f32_16x16x32_bf16 v[92:95], v[164:167], v[156:159], v[92:95]
 ds_read_b64_tr_b16 v[202:203], v11 offset:9728
 v_mfma_f32_16x16x32_bf16 v[96:99], v[168:171], v[144:147], v[96:99]
 ds_read_b64_tr_b16 v[204:205], v10 offset:11264
 v_mfma_f32_16x16x32_bf16 v[100:103], v[168:171], v[148:151], v[100:103]
 ds_read_b64_tr_b16 v[206:207], v11 offset:11264
 v_mfma_f32_16x16x32_bf16 v[104:107], v[168:171], v[152:155], v[104:107]
 ds_read_b64_tr_b16 v[208:209], v10 offset:11776
 v_mfma_f32_16x16x32_bf16 v[108:111], v[168:171], v[156:159], v[108:111]
 ds_read_b64_tr_b16 v[210:211], v11 offset:11776
 v_mfma_f32_16x16x32_bf16 v[112:115], v[172:175], v[144:147], v[112:115]
 v_add_u32 v8, 16384, v2
 v_mfma_f32_16x16x32_bf16 v[116:119], v[172:175], v[148:151], v[116:119]
 v_add_u32 v9, 16384, v3
 v_mfma_f32_16x16x32_bf16 v[120:123], v[172:175], v[152:155], v[120:123]
 v_add_u32 v10, 89088, v4
 v_mfma_f32_16x16x32_bf16 v[124:127], v[172:175], v[156:159], v[124:127]
 v_add_u32 v11, 89088, v5
 v_add_u32 v12, 89088, v6
 v_add_u32 v13, 89088, v7
 s_waitcnt lgkmcnt(6)
 v_mfma_f32_16x16x32_bf16 v[64:67], v[196:199], v[180:183], v[64:67]
 v_mfma_f32_16x16x32_bf16 v[68:71], v[196:199], v[184:187], v[68:71]
 v_mfma_f32_16x16x32_bf16 v[72:75], v[196:199], v[188:191], v[72:75]
 v_mfma_f32_16x16x32_bf16 v[76:79], v[196:199], v[192:195], v[76:79]
 s_waitcnt lgkmcnt(0)
 s_barrier
 v_mfma_f32_16x16x32_bf16 v[80:83], v[200:203], v[180:183], v[80:83]
 ds_read_b128 v[144:147], v8 offset:0
 v_mfma_f32_16x16x32_bf16 v[84:87], v[200:203], v[184:187], v[84:87]
 ds_read_b64_tr_b16 v[160:161], v10 offset:0
 v_mfma_f32_16x16x32_bf16 v[88:91], v[200:203], v[188:191], v[88:91]
 ds_read_b64_tr_b16 v[162:163], v11 offset:0
 v_mfma_f32_16x16x32_bf16 v[92:95], v[200:203], v[192:195], v[92:95]
 ds_read_b128 v[148:151], v8 offset:2048
 v_mfma_f32_16x16x32_bf16 v[96:99], v[204:207], v[180:183], v[96:99]
 ds_read_b128 v[152:155], v8 offset:4096
 v_mfma_f32_16x16x32_bf16 v[100:103], v[204:207], v[184:187], v[100:103]
 ds_read_b128 v[156:159], v8 offset:6144
 v_mfma_f32_16x16x32_bf16 v[104:107], v[204:207], v[188:191], v[104:107]
 ds_read_b64_tr_b16 v[164:165], v10 offset:512
 v_mfma_f32_16x16x32_bf16 v[108:111], v[204:207], v[192:195], v[108:111]
 ds_read_b64_tr_b16 v[166:167], v11 offset:512
 v_mfma_f32_16x16x32_bf16 v[112:115], v[208:211], v[180:183], v[112:115]
 ds_read_b64_tr_b16 v[168:169], v10 offset:2048
 v_mfma_f32_16x16x32_bf16 v[116:119], v[208:211], v[184:187], v[116:119]
 ds_read_b64_tr_b16 v[170:171], v11 offset:2048
 v_mfma_f32_16x16x32_bf16 v[120:123], v[208:211], v[188:191], v[120:123]
 ds_read_b64_tr_b16 v[172:173], v10 offset:2560
 v_mfma_f32_16x16x32_bf16 v[124:127], v[208:211], v[192:195], v[124:127]
 ds_read_b64_tr_b16 v[174:175], v11 offset:2560
 ds_read_b64_tr_b16 v[176:177], v12 offset:0
 ds_read_b64_tr_b16 v[178:179], v13 offset:0
 s_waitcnt lgkmcnt(8)
 v_mfma_f32_16x16x32_bf16 v[64:67], v[160:163], v[144:147], v[64:67]
 v_mfma_f32_16x16x32_bf16 v[68:71], v[160:163], v[148:151], v[68:71]
 v_mfma_f32_16x16x32_bf16 v[72:75], v[160:163], v[152:155], v[72:75]
 v_mfma_f32_16x16x32_bf16 v[76:79], v[160:163], v[156:159], v[76:79]
 s_waitcnt lgkmcnt(0)
 v_mfma_f32_16x16x32_bf16 v[128:131], v[176:179], v[144:147], v[128:131]
 ds_read_b128 v[180:183], v9 offset:0
 v_mfma_f32_16x16x32_bf16 v[132:135], v[176:179], v[148:151], v[132:135]
 ds_read_b64_tr_b16 v[196:197], v10 offset:9216
 v_mfma_f32_16x16x32_bf16 v[136:139], v[176:179], v[152:155], v[136:139]
 ds_read_b64_tr_b16 v[198:199], v11 offset:9216
 v_mfma_f32_16x16x32_bf16 v[140:143], v[176:179], v[156:159], v[140:143]
 ds_read_b128 v[184:187], v9 offset:2048
 v_mfma_f32_16x16x32_bf16 v[80:83], v[164:167], v[144:147], v[80:83]
 ds_read_b128 v[188:191], v9 offset:4096
 v_mfma_f32_16x16x32_bf16 v[84:87], v[164:167], v[148:151], v[84:87]
 ds_read_b128 v[192:195], v9 offset:6144
 v_mfma_f32_16x16x32_bf16 v[88:91], v[164:167], v[152:155], v[88:91]
 ds_read_b64_tr_b16 v[200:201], v10 offset:9728
 v_mfma_f32_16x16x32_bf16 v[92:95], v[164:167], v[156:159], v[92:95]
 ds_read_b64_tr_b16 v[202:203], v11 offset:9728
 v_mfma_f32_16x16x32_bf16 v[96:99], v[168:171], v[144:147], v[96:99]
 ds_read_b64_tr_b16 v[204:205], v10 offset:11264
 v_mfma_f32_16x16x32_bf16 v[100:103], v[168:171], v[148:151], v[100:103]
 ds_read_b64_tr_b16 v[206:207], v11 offset:11264
 v_mfma_f32_16x16x32_bf16 v[104:107], v[168:171], v[152:155], v[104:107]
 ds_read_b64_tr_b16 v[208:209], v10 offset:11776
 v_mfma_f32_16x16x32_bf16 v[108:111], v[168:171], v[156:159], v[108:111]
 ds_read_b64_tr_b16 v[210:211], v11 offset:11776
 v_mfma_f32_16x16x32_bf16 v[112:115], v[172:175], v[144:147], v[112:115]
 v_add_u32 v8, 32768, v2
 v_mfma_f32_16x16x32_bf16 v[116:119], v[172:175], v[148:151], v[116:119]
 v_add_u32 v9, 32768, v3
 v_mfma_f32_16x16x32_bf16 v[120:123], v[172:175], v[152:155], v[120:123]
 v_add_u32 v10, 107520, v4
 v_mfma_f32_16x16x32_bf16 v[124:127], v[172:175], v[156:159], v[124:127]
 v_add_u32 v11, 107520, v5
 v_add_u32 v12, 107520, v6
 v_add_u32 v13, 107520, v7
 s_add_u32 s40, s40, 4
 s_cmp_lt_u32 s40, 32
 s_cbranch_scc1 L_fz_p5c0
 s_waitcnt lgkmcnt(0)
 v_mfma_f32_16x16x32_bf16 v[64:67], v[196:199], v[180:183], v[64:67]
 v_mfma_f32_16x16x32_bf16 v[68:71], v[196:199], v[184:187], v[68:71]
 v_mfma_f32_16x16x32_bf16 v[72:75], v[196:199], v[188:191], v[72:75]
 v_mfma_f32_16x16x32_bf16 v[76:79], v[196:199], v[192:195], v[76:79]
 v_mfma_f32_16x16x32_bf16 v[80:83], v[200:203], v[180:183], v[80:83]
 v_mfma_f32_16x16x32_bf16 v[84:87], v[200:203], v[184:187], v[84:87]
 v_mfma_f32_16x16x32_bf16 v[88:91], v[200:203], v[188:191], v[88:91]
 v_mfma_f32_16x16x32_bf16 v[92:95], v[200:203], v[192:195], v[92:95]
 v_mfma_f32_16x16x32_bf16 v[96:99], v[204:207], v[180:183], v[96:99]
 v_mfma_f32_16x16x32_bf16 v[100:103], v[204:207], v[184:187], v[100:103]
 v_mfma_f32_16x16x32_bf16 v[104:107], v[204:207], v[188:191], v[104:107]
 v_mfma_f32_16x16x32_bf16 v[108:111], v[204:207], v[192:195], v[108:111]
 v_mfma_f32_16x16x32_bf16 v[112:115], v[208:211], v[180:183], v[112:115]
 v_mfma_f32_16x16x32_bf16 v[116:119], v[208:211], v[184:187], v[116:119]
 v_mfma_f32_16x16x32_bf16 v[120:123], v[208:211], v[188:191], v[120:123]
 v_mfma_f32_16x16x32_bf16 v[124:127], v[208:211], v[192:195], v[124:127]
 ds_read_b128 v[216:219], v14 offset:0
 ds_read_b128 v[220:223], v14 offset:1024
 ds_read_b128 v[224:227], v14 offset:2048
 ds_read_b128 v[228:231], v14 offset:3072
 ds_read_b128 v[232:235], v14 offset:4096
 ds_read_b128 v[236:239], v14 offset:5120
 ds_read_b128 v[240:243], v14 offset:6144
 ds_read_b128 v[244:247], v14 offset:7168
 ds_write_b128 v25, v[136:139] offset:0
 ds_write_b128 v25, v[140:143] offset:1024
 ds_read_b128 v[248:251], v14 offset:8192
 s_waitcnt lgkmcnt(0)
 s_barrier
 ds_read_b128 v[136:139], v26 offset:0
 ds_read_b128 v[140:143], v26 offset:1024
 v_pk_fma_f32 v[64:65], v[64:65], v[36:37], v[36:37] op_sel:[0,0,1] op_sel_hi:[1,0,1]
 v_pk_fma_f32 v[66:67], v[66:67], v[36:37], v[36:37] op_sel:[0,0,1] op_sel_hi:[1,0,1]
 v_pk_fma_f32 v[80:81], v[80:81], v[36:37], v[36:37] op_sel:[0,0,1] op_sel_hi:[1,0,1]
 v_pk_fma_f32 v[82:83], v[82:83], v[36:37], v[36:37] op_sel:[0,0,1] op_sel_hi:[1,0,1]
 v_lshlrev_b32 v44, 16, v216
 v_and_b32 v45, 0xffff0000, v216
 v_lshlrev_b32 v46, 16, v217
 v_and_b32 v47, 0xffff0000, v217
 v_lshlrev_b32 v48, 16, v218
 v_and_b32 v49, 0xffff0000, v218
 v_lshlrev_b32 v50, 16, v219
 v_and_b32 v51, 0xffff0000, v219
 v_pk_mul_f32 v[64:65], v[64:65], v[44:45]
 v_pk_mul_f32 v[66:67], v[66:67], v[46:47]
 v_pk_mul_f32 v[80:81], v[80:81], v[48:49]
 v_pk_mul_f32 v[82:83], v[82:83], v[50:51]
 v_cvt_pk_bf16_f32 v216, v64, v65
 v_cvt_pk_bf16_f32 v218, v80, v81
 v_cvt_pk_bf16_f32 v217, v66, v67
 v_cvt_pk_bf16_f32 v219, v82, v83
 s_nop 0
 v_permlane16_swap_b32 v216, v218
 v_permlane16_swap_b32 v217, v219
 buffer_store_dwordx4 v[216:219], v20, s[20:23], 0 offen offset:0 sc1
 v_pk_fma_f32 v[96:97], v[96:97], v[36:37], v[36:37] op_sel:[0,0,1] op_sel_hi:[1,0,1]
 v_pk_fma_f32 v[98:99], v[98:99], v[36:37], v[36:37] op_sel:[0,0,1] op_sel_hi:[1,0,1]
 v_pk_fma_f32 v[112:113], v[112:113], v[36:37], v[36:37] op_sel:[0,0,1] op_sel_hi:[1,0,1]
 v_pk_fma_f32 v[114:115], v[114:115], v[36:37], v[36:37] op_sel:[0,0,1] op_sel_hi:[1,0,1]
 v_lshlrev_b32 v44, 16, v220
 v_and_b32 v45, 0xffff0000, v220
 v_lshlrev_b32 v46, 16, v221
 v_and_b32 v47, 0xffff0000, v221
 v_lshlrev_b32 v48, 16, v222
 v_and_b32 v49, 0xffff0000, v222
 v_lshlrev_b32 v50, 16, v223
 v_and_b32 v51, 0xffff0000, v223
 v_pk_mul_f32 v[96:97], v[96:97], v[44:45]
 v_pk_mul_f32 v[98:99], v[98:99], v[46:47]
 v_pk_mul_f32 v[112:113], v[112:113], v[48:49]
 v_pk_mul_f32 v[114:115], v[114:115], v[50:51]
 v_cvt_pk_bf16_f32 v220, v96, v97
 v_cvt_pk_bf16_f32 v222, v112, v113
 v_cvt_pk_bf16_f32 v221, v98, v99
 v_cvt_pk_bf16_f32 v223, v114, v115
 s_nop 0
 v_permlane16_swap_b32 v220, v222
 v_permlane16_swap_b32 v221, v223
 buffer_store_dwordx4 v[220:223], v20, s[20:23], 0 offen offset:1024 sc1
 v_pk_fma_f32 v[68:69], v[68:69], v[38:39], v[38:39] op_sel:[0,0,1] op_sel_hi:[1,0,1]
 v_pk_fma_f32 v[70:71], v[70:71], v[38:39], v[38:39] op_sel:[0,0,1] op_sel_hi:[1,0,1]
 v_pk_fma_f32 v[84:85], v[84:85], v[38:39], v[38:39] op_sel:[0,0,1] op_sel_hi:[1,0,1]
 v_pk_fma_f32 v[86:87], v[86:87], v[38:39], v[38:39] op_sel:[0,0,1] op_sel_hi:[1,0,1]
 v_lshlrev_b32 v44, 16, v224
 v_and_b32 v45, 0xffff0000, v224
 v_lshlrev_b32 v46, 16, v225
 v_and_b32 v47, 0xffff0000, v225
 v_lshlrev_b32 v48, 16, v226
 v_and_b32 v49, 0xffff0000, v226
 v_lshlrev_b32 v50, 16, v227
 v_and_b32 v51, 0xffff0000, v227
 v_pk_mul_f32 v[68:69], v[68:69], v[44:45]
 v_pk_mul_f32 v[70:71], v[70:71], v[46:47]
 v_pk_mul_f32 v[84:85], v[84:85], v[48:49]
 v_pk_mul_f32 v[86:87], v[86:87], v[50:51]
 v_cvt_pk_bf16_f32 v224, v68, v69
 v_cvt_pk_bf16_f32 v226, v84, v85
 v_cvt_pk_bf16_f32 v225, v70, v71
 v_cvt_pk_bf16_f32 v227, v86, v87
 s_nop 0
 v_permlane16_swap_b32 v224, v226
 v_permlane16_swap_b32 v225, v227
 buffer_store_dwordx4 v[224:227], v20, s[20:23], s50 offen offset:0 sc1
 v_pk_fma_f32 v[100:101], v[100:101], v[38:39], v[38:39] op_sel:[0,0,1] op_sel_hi:[1,0,1]
 v_pk_fma_f32 v[102:103], v[102:103], v[38:39], v[38:39] op_sel:[0,0,1] op_sel_hi:[1,0,1]
 v_pk_fma_f32 v[116:117], v[116:117], v[38:39], v[38:39] op_sel:[0,0,1] op_sel_hi:[1,0,1]
 v_pk_fma_f32 v[118:119], v[118:119], v[38:39], v[38:39] op_sel:[0,0,1] op_sel_hi:[1,0,1]
 v_lshlrev_b32 v44, 16, v228
 v_and_b32 v45, 0xffff0000, v228
 v_lshlrev_b32 v46, 16, v229
 v_and_b32 v47, 0xffff0000, v229
 v_lshlrev_b32 v48, 16, v230
 v_and_b32 v49, 0xffff0000, v230
 v_lshlrev_b32 v50, 16, v231
 v_and_b32 v51, 0xffff0000, v231
 v_pk_mul_f32 v[100:101], v[100:101], v[44:45]
 v_pk_mul_f32 v[102:103], v[102:103], v[46:47]
 v_pk_mul_f32 v[116:117], v[116:117], v[48:49]
 v_pk_mul_f32 v[118:119], v[118:119], v[50:51]
 v_cvt_pk_bf16_f32 v228, v100, v101
 v_cvt_pk_bf16_f32 v230, v116, v117
 v_cvt_pk_bf16_f32 v229, v102, v103
 v_cvt_pk_bf16_f32 v231, v118, v119
 s_nop 0
 v_permlane16_swap_b32 v228, v230
 v_permlane16_swap_b32 v229, v231
 buffer_store_dwordx4 v[228:231], v20, s[20:23], s50 offen offset:1024 sc1
 v_pk_fma_f32 v[72:73], v[72:73], v[40:41], v[40:41] op_sel:[0,0,1] op_sel_hi:[1,0,1]
 v_pk_fma_f32 v[74:75], v[74:75], v[40:41], v[40:41] op_sel:[0,0,1] op_sel_hi:[1,0,1]
 v_pk_fma_f32 v[88:89], v[88:89], v[40:41], v[40:41] op_sel:[0,0,1] op_sel_hi:[1,0,1]
 v_pk_fma_f32 v[90:91], v[90:91], v[40:41], v[40:41] op_sel:[0,0,1] op_sel_hi:[1,0,1]
 v_lshlrev_b32 v44, 16, v232
 v_and_b32 v45, 0xffff0000, v232
 v_lshlrev_b32 v46, 16, v233
 v_and_b32 v47, 0xffff0000, v233
 v_lshlrev_b32 v48, 16, v234
 v_and_b32 v49, 0xffff0000, v234
 v_lshlrev_b32 v50, 16, v235
 v_and_b32 v51, 0xffff0000, v235
 v_pk_mul_f32 v[72:73], v[72:73], v[44:45]
 v_pk_mul_f32 v[74:75], v[74:75], v[46:47]
 v_pk_mul_f32 v[88:89], v[88:89], v[48:49]
 v_pk_mul_f32 v[90:91], v[90:91], v[50:51]
 v_cvt_pk_bf16_f32 v232, v72, v73
 v_cvt_pk_bf16_f32 v234, v88, v89
 v_cvt_pk_bf16_f32 v233, v74, v75
 v_cvt_pk_bf16_f32 v235, v90, v91
 s_nop 0
 v_permlane16_swap_b32 v232, v234
 v_permlane16_swap_b32 v233, v235
 buffer_store_dwordx4 v[232:235], v20, s[20:23], s51 offen offset:0 sc1
 v_pk_fma_f32 v[104:105], v[104:105], v[40:41], v[40:41] op_sel:[0,0,1] op_sel_hi:[1,0,1]
 v_pk_fma_f32 v[106:107], v[106:107], v[40:41], v[40:41] op_sel:[0,0,1] op_sel_hi:[1,0,1]
 v_pk_fma_f32 v[120:121], v[120:121], v[40:41], v[40:41] op_sel:[0,0,1] op_sel_hi:[1,0,1]
 v_pk_fma_f32 v[122:123], v[122:123], v[40:41], v[40:41] op_sel:[0,0,1] op_sel_hi:[1,0,1]
 v_lshlrev_b32 v44, 16, v236
 v_and_b32 v45, 0xffff0000, v236
 v_lshlrev_b32 v46, 16, v237
 v_and_b32 v47, 0xffff0000, v237
 v_lshlrev_b32 v48, 16, v238
 v_and_b32 v49, 0xffff0000, v238
 v_lshlrev_b32 v50, 16, v239
 v_and_b32 v51, 0xffff0000, v239
 v_pk_mul_f32 v[104:105], v[104:105], v[44:45]
 v_pk_mul_f32 v[106:107], v[106:107], v[46:47]
 v_pk_mul_f32 v[120:121], v[120:121], v[48:49]
 v_pk_mul_f32 v[122:123], v[122:123], v[50:51]
 v_cvt_pk_bf16_f32 v236, v104, v105
 v_cvt_pk_bf16_f32 v238, v120, v121
 v_cvt_pk_bf16_f32 v237, v106, v107
 v_cvt_pk_bf16_f32 v239, v122, v123
 s_nop 0
 v_permlane16_swap_b32 v236, v238
 v_permlane16_swap_b32 v237, v239
 buffer_store_dwordx4 v[236:239], v20, s[20:23], s51 offen offset:1024 sc1
 v_pk_fma_f32 v[76:77], v[76:77], v[42:43], v[42:43] op_sel:[0,0,1] op_sel_hi:[1,0,1]
 v_pk_fma_f32 v[78:79], v[78:79], v[42:43], v[42:43] op_sel:[0,0,1] op_sel_hi:[1,0,1]
 v_pk_fma_f32 v[92:93], v[92:93], v[42:43], v[42:43] op_sel:[0,0,1] op_sel_hi:[1,0,1]
 v_pk_fma_f32 v[94:95], v[94:95], v[42:43], v[42:43] op_sel:[0,0,1] op_sel_hi:[1,0,1]
 v_lshlrev_b32 v44, 16, v240
 v_and_b32 v45, 0xffff0000, v240
 v_lshlrev_b32 v46, 16, v241
 v_and_b32 v47, 0xffff0000, v241
 v_lshlrev_b32 v48, 16, v242
 v_and_b32 v49, 0xffff0000, v242
 v_lshlrev_b32 v50, 16, v243
 v_and_b32 v51, 0xffff0000, v243
 v_pk_mul_f32 v[76:77], v[76:77], v[44:45]
 v_pk_mul_f32 v[78:79], v[78:79], v[46:47]
 v_pk_mul_f32 v[92:93], v[92:93], v[48:49]
 v_pk_mul_f32 v[94:95], v[94:95], v[50:51]
 v_cvt_pk_bf16_f32 v240, v76, v77
 v_cvt_pk_bf16_f32 v242, v92, v93
 v_cvt_pk_bf16_f32 v241, v78, v79
 v_cvt_pk_bf16_f32 v243, v94, v95
 s_nop 0
 v_permlane16_swap_b32 v240, v242
 v_permlane16_swap_b32 v241, v243
 buffer_store_dwordx4 v[240:243], v20, s[20:23], s52 offen offset:0 sc1
 v_pk_fma_f32 v[108:109], v[108:109], v[42:43], v[42:43] op_sel:[0,0,1] op_sel_hi:[1,0,1]
 v_pk_fma_f32 v[110:111], v[110:111], v[42:43], v[42:43] op_sel:[0,0,1] op_sel_hi:[1,0,1]
 v_pk_fma_f32 v[124:125], v[124:125], v[42:43], v[42:43] op_sel:[0,0,1] op_sel_hi:[1,0,1]
 v_pk_fma_f32 v[126:127], v[126:127], v[42:43], v[42:43] op_sel:[0,0,1] op_sel_hi:[1,0,1]
 v_lshlrev_b32 v44, 16, v244
 v_and_b32 v45, 0xffff0000, v244
 v_lshlrev_b32 v46, 16, v245
 v_and_b32 v47, 0xffff0000, v245
 v_lshlrev_b32 v48, 16, v246
 v_and_b32 v49, 0xffff0000, v246
 v_lshlrev_b32 v50, 16, v247
 v_and_b32 v51, 0xffff0000, v247
 v_pk_mul_f32 v[108:109], v[108:109], v[44:45]
 v_pk_mul_f32 v[110:111], v[110:111], v[46:47]
 v_pk_mul_f32 v[124:125], v[124:125], v[48:49]
 v_pk_mul_f32 v[126:127], v[126:127], v[50:51]
 v_cvt_pk_bf16_f32 v244, v108, v109
 v_cvt_pk_bf16_f32 v246, v124, v125
 v_cvt_pk_bf16_f32 v245, v110, v111
 v_cvt_pk_bf16_f32 v247, v126, v127
 s_nop 0
 v_permlane16_swap_b32 v244, v246
 v_permlane16_swap_b32 v245, v247
 buffer_store_dwordx4 v[244:247], v20, s[20:23], s52 offen offset:1024 sc1
 s_waitcnt lgkmcnt(0)
 v_pk_add_f32 v[128:129], v[128:129], v[136:137]
 v_pk_add_f32 v[130:131], v[130:131], v[138:139]
 v_pk_fma_f32 v[128:129], v[128:129], v[36:37], v[36:37] op_sel:[0,0,1] op_sel_hi:[1,0,1]
 v_pk_fma_f32 v[130:131], v[130:131], v[36:37], v[36:37] op_sel:[0,0,1] op_sel_hi:[1,0,1]
 v_lshlrev_b32 v44, 16, v248
 v_and_b32 v45, 0xffff0000, v248
 v_lshlrev_b32 v46, 16, v249
 v_and_b32 v47, 0xffff0000, v249
 v_pk_mul_f32 v[128:129], v[128:129], v[44:45]
 v_pk_mul_f32 v[130:131], v[130:131], v[46:47]
 v_cvt_pk_bf16_f32 v248, v128, v129
 v_cvt_pk_bf16_f32 v249, v130, v131
 v_pk_add_f32 v[132:133], v[132:133], v[140:141]
 v_pk_add_f32 v[134:135], v[134:135], v[142:143]
 v_pk_fma_f32 v[132:133], v[132:133], v[38:39], v[38:39] op_sel:[0,0,1] op_sel_hi:[1,0,1]
 v_pk_fma_f32 v[134:135], v[134:135], v[38:39], v[38:39] op_sel:[0,0,1] op_sel_hi:[1,0,1]
 v_lshlrev_b32 v44, 16, v250
 v_and_b32 v45, 0xffff0000, v250
 v_lshlrev_b32 v46, 16, v251
 v_and_b32 v47, 0xffff0000, v251
 v_pk_mul_f32 v[132:133], v[132:133], v[44:45]
 v_pk_mul_f32 v[134:135], v[134:135], v[46:47]
 v_cvt_pk_bf16_f32 v250, v132, v133
 v_cvt_pk_bf16_f32 v251, v134, v135
 s_nop 1
 v_permlane16_swap_b32 v248, v250
 v_permlane16_swap_b32 v249, v251
 buffer_store_dwordx4 v[248:251], v21, s[20:23], 0 offen sc1
 s_branch L_fz_p5a2
L_fz_p5a1:
 s_waitcnt lgkmcnt(0)
 s_barrier
 ds_read_b128 v[144:147], v8 offset:0
 ds_read_b64_tr_b16 v[160:161], v10 offset:0
 ds_read_b64_tr_b16 v[162:163], v11 offset:0
 ds_read_b128 v[148:151], v8 offset:2048
 ds_read_b128 v[152:155], v8 offset:4096
 ds_read_b128 v[156:159], v8 offset:6144
 ds_read_b64_tr_b16 v[164:165], v10 offset:512
 ds_read_b64_tr_b16 v[166:167], v11 offset:512
 ds_read_b64_tr_b16 v[168:169], v10 offset:2048
 ds_read_b64_tr_b16 v[170:171], v11 offset:2048
 ds_read_b64_tr_b16 v[172:173], v10 offset:2560
 ds_read_b64_tr_b16 v[174:175], v11 offset:2560
 s_waitcnt lgkmcnt(6)
 v_mfma_f32_16x16x32_bf16 v[64:67], v[160:163], v[144:147], 0
 v_mfma_f32_16x16x32_bf16 v[68:71], v[160:163], v[148:151], 0
 v_mfma_f32_16x16x32_bf16 v[72:75], v[160:163], v[152:155], 0
 v_mfma_f32_16x16x32_bf16 v[76:79], v[160:163], v[156:159], 0
 s_waitcnt lgkmcnt(0)
 v_mfma_f32_16x16x32_bf16 v[80:83], v[164:167], v[144:147], 0
 ds_read_b128 v[180:183], v9 offset:0
 v_mfma_f32_16x16x32_bf16 v[84:87], v[164:167], v[148:151], 0
 ds_read_b64_tr_b16 v[196:197], v10 offset:9216
 v_mfma_f32_16x16x32_bf16 v[88:91], v[164:167], v[152:155], 0
 ds_read_b64_tr_b16 v[198:199], v11 offset:9216
 v_mfma_f32_16x16x32_bf16 v[92:95], v[164:167], v[156:159], 0
 ds_read_b128 v[184:187], v9 offset:2048
 v_mfma_f32_16x16x32_bf16 v[96:99], v[168:171], v[144:147], 0
 ds_read_b128 v[188:191], v9 offset:4096
 v_mfma_f32_16x16x32_bf16 v[100:103], v[168:171], v[148:151], 0
 ds_read_b128 v[192:195], v9 offset:6144
 v_mfma_f32_16x16x32_bf16 v[104:107], v[168:171], v[152:155], 0
 ds_read_b64_tr_b16 v[200:201], v10 offset:9728
 v_mfma_f32_16x16x32_bf16 v[108:111], v[168:171], v[156:159], 0
 ds_read_b64_tr_b16 v[202:203], v11 offset:9728
 v_mfma_f32_16x16x32_bf16 v[112:115], v[172:175], v[144:147], 0
 ds_read_b64_tr_b16 v[204:205], v10 offset:11264
 v_mfma_f32_16x16x32_bf16 v[116:119], v[172:175], v[148:151], 0
 ds_read_b64_tr_b16 v[206:207], v11 offset:11264
 v_mfma_f32_16x16x32_bf16 v[120:123], v[172:175], v[152:155], 0
 ds_read_b64_tr_b16 v[208:209], v10 offset:11776
 v_mfma_f32_16x16x32_bf16 v[124:127], v[172:175], v[156:159], 0
 ds_read_b64_tr_b16 v[210:211], v11 offset:11776
 ds_read_b64_tr_b16 v[212:213], v12 offset:9216
 ds_read_b64_tr_b16 v[214:215], v13 offset:9216
 v_add_u32 v8, 49152, v2
 v_add_u32 v9, 49152, v3
 v_add_u32 v10, 125952, v4
 v_add_u32 v11, 125952, v5
 v_add_u32 v12, 125952, v6
 v_add_u32 v13, 125952, v7
 s_waitcnt lgkmcnt(8)
 v_mfma_f32_16x16x32_bf16 v[64:67], v[196:199], v[180:183], v[64:67]
 v_mfma_f32_16x16x32_bf16 v[68:71], v[196:199], v[184:187], v[68:71]
 v_mfma_f32_16x16x32_bf16 v[72:75], v[196:199], v[188:191], v[72:75]
 v_mfma_f32_16x16x32_bf16 v[76:79], v[196:199], v[192:195], v[76:79]
 s_waitcnt lgkmcnt(0)
 s_barrier
 v_mfma_f32_16x16x32_bf16 v[128:131], v[212:215], v[180:183], v[128:131]
 ds_read_b128 v[144:147], v8 offset:0
 v_mfma_f32_16x16x32_bf16 v[132:135], v[212:215], v[184:187], v[132:135]
 ds_read_b64_tr_b16 v[160:161], v10 offset:0
 v_mfma_f32_16x16x32_bf16 v[136:139], v[212:215], v[188:191], v[136:139]
 ds_read_b64_tr_b16 v[162:163], v11 offset:0
 v_mfma_f32_16x16x32_bf16 v[140:143], v[212:215], v[192:195], v[140:143]
 ds_read_b128 v[148:151], v8 offset:2048
 v_mfma_f32_16x16x32_bf16 v[80:83], v[200:203], v[180:183], v[80:83]
 ds_read_b128 v[152:155], v8 offset:4096
 v_mfma_f32_16x16x32_bf16 v[84:87], v[200:203], v[184:187], v[84:87]
 ds_read_b128 v[156:159], v8 offset:6144
 v_mfma_f32_16x16x32_bf16 v[88:91], v[200:203], v[188:191], v[88:91]
 ds_read_b64_tr_b16 v[164:165], v10 offset:512
 v_mfma_f32_16x16x32_bf16 v[92:95], v[200:203], v[192:195], v[92:95]
 ds_read_b64_tr_b16 v[166:167], v11 offset:512
 v_mfma_f32_16x16x32_bf16 v[96:99], v[204:207], v[180:183], v[96:99]
 ds_read_b64_tr_b16 v[168:169], v10 offset:2048
 v_mfma_f32_16x16x32_bf16 v[100:103], v[204:207], v[184:187], v[100:103]
 ds_read_b64_tr_b16 v[170:171], v11 offset:2048
 v_mfma_f32_16x16x32_bf16 v[104:107], v[204:207], v[188:191], v[104:107]
 ds_read_b64_tr_b16 v[172:173], v10 offset:2560
 v_mfma_f32_16x16x32_bf16 v[108:111], v[204:207], v[192:195], v[108:111]
 ds_read_b64_tr_b16 v[174:175], v11 offset:2560
 v_mfma_f32_16x16x32_bf16 v[112:115], v[208:211], v[180:183], v[112:115]
 v_mfma_f32_16x16x32_bf16 v[116:119], v[208:211], v[184:187], v[116:119]
 v_mfma_f32_16x16x32_bf16 v[120:123], v[208:211], v[188:191], v[120:123]
 v_mfma_f32_16x16x32_bf16 v[124:127], v[208:211], v[192:195], v[124:127]
 s_waitcnt lgkmcnt(6)
 v_mfma_f32_16x16x32_bf16 v[64:67], v[160:163], v[144:147], v[64:67]
 v_mfma_f32_16x16x32_bf16 v[68:71], v[160:163], v[148:151], v[68:71]
 v_mfma_f32_16x16x32_bf16 v[72:75], v[160:163], v[152:155], v[72:75]
 v_mfma_f32_16x16x32_bf16 v[76:79], v[160:163], v[156:159], v[76:79]
 s_waitcnt lgkmcnt(0)
 v_mfma_f32_16x16x32_bf16 v[80:83], v[164:167], v[144:147], v[80:83]
 ds_read_b128 v[180:183], v9 offset:0
 v_mfma_f32_16x16x32_bf16 v[84:87], v[164:167], v[148:151], v[84:87]
 ds_read_b64_tr_b16 v[196:197], v10 offset:9216
 v_mfma_f32_16x16x32_bf16 v[88:91], v[164:167], v[152:155], v[88:91]
 ds_read_b64_tr_b16 v[198:199], v11 offset:9216
 v_mfma_f32_16x16x32_bf16 v[92:95], v[164:167], v[156:159], v[92:95]
 ds_read_b128 v[184:187], v9 offset:2048
 v_mfma_f32_16x16x32_bf16 v[96:99], v[168:171], v[144:147], v[96:99]
 ds_read_b128 v[188:191], v9 offset:4096
 v_mfma_f32_16x16x32_bf16 v[100:103], v[168:171], v[148:151], v[100:103]
 ds_read_b128 v[192:195], v9 offset:6144
 v_mfma_f32_16x16x32_bf16 v[104:107], v[168:171], v[152:155], v[104:107]
 ds_read_b64_tr_b16 v[200:201], v10 offset:9728
 v_mfma_f32_16x16x32_bf16 v[108:111], v[168:171], v[156:159], v[108:111]
 ds_read_b64_tr_b16 v[202:203], v11 offset:9728
 v_mfma_f32_16x16x32_bf16 v[112:115], v[172:175], v[144:147], v[112:115]
 ds_read_b64_tr_b16 v[204:205], v10 offset:11264
 v_mfma_f32_16x16x32_bf16 v[116:119], v[172:175], v[148:151], v[116:119]
 ds_read_b64_tr_b16 v[206:207], v11 offset:11264
 v_mfma_f32_16x16x32_bf16 v[120:123], v[172:175], v[152:155], v[120:123]
 ds_read_b64_tr_b16 v[208:209], v10 offset:11776
 v_mfma_f32_16x16x32_bf16 v[124:127], v[172:175], v[156:159], v[124:127]
 ds_read_b64_tr_b16 v[210:211], v11 offset:11776
 ds_read_b64_tr_b16 v[212:213], v12 offset:9216
 ds_read_b64_tr_b16 v[214:215], v13 offset:9216
 v_mov_b32 v8, v2
 v_mov_b32 v9, v3
 v_add_u32 v10, 70656, v4
 v_add_u32 v11, 70656, v5
 v_add_u32 v12, 70656, v6
 v_add_u32 v13, 70656, v7
 s_waitcnt lgkmcnt(8)
 v_mfma_f32_16x16x32_bf16 v[64:67], v[196:199], v[180:183], v[64:67]
 v_mfma_f32_16x16x32_bf16 v[68:71], v[196:199], v[184:187], v[68:71]
 v_mfma_f32_16x16x32_bf16 v[72:75], v[196:199], v[188:191], v[72:75]
 v_mfma_f32_16x16x32_bf16 v[76:79], v[196:199], v[192:195], v[76:79]
 s_waitcnt lgkmcnt(0)
 s_barrier
 v_mfma_f32_16x16x32_bf16 v[128:131], v[212:215], v[180:183], v[128:131]
 ds_read_b128 v[144:147], v8 offset:0
 v_mfma_f32_16x16x32_bf16 v[132:135], v[212:215], v[184:187], v[132:135]
 ds_read_b64_tr_b16 v[160:161], v10 offset:0
 v_mfma_f32_16x16x32_bf16 v[136:139], v[212:215], v[188:191], v[136:139]
 ds_read_b64_tr_b16 v[162:163], v11 offset:0
 v_mfma_f32_16x16x32_bf16 v[140:143], v[212:215], v[192:195], v[140:143]
 ds_read_b128 v[148:151], v8 offset:2048
 v_mfma_f32_16x16x32_bf16 v[80:83], v[200:203], v[180:183], v[80:83]
 ds_read_b128 v[152:155], v8 offset:4096
 v_mfma_f32_16x16x32_bf16 v[84:87], v[200:203], v[184:187], v[84:87]
 ds_read_b128 v[156:159], v8 offset:6144
 v_mfma_f32_16x16x32_bf16 v[88:91], v[200:203], v[188:191], v[88:91]
 ds_read_b64_tr_b16 v[164:165], v10 offset:512
 v_mfma_f32_16x16x32_bf16 v[92:95], v[200:203], v[192:195], v[92:95]
 ds_read_b64_tr_b16 v[166:167], v11 offset:512
 v_mfma_f32_16x16x32_bf16 v[96:99], v[204:207], v[180:183], v[96:99]
 ds_read_b64_tr_b16 v[168:169], v10 offset:2048
 v_mfma_f32_16x16x32_bf16 v[100:103], v[204:207], v[184:187], v[100:103]
 ds_read_b64_tr_b16 v[170:171], v11 offset:2048
 v_mfma_f32_16x16x32_bf16 v[104:107], v[204:207], v[188:191], v[104:107]
 ds_read_b64_tr_b16 v[172:173], v10 offset:2560
 v_mfma_f32_16x16x32_bf16 v[108:111], v[204:207], v[192:195], v[108:111]
 ds_read_b64_tr_b16 v[174:175], v11 offset:2560
 v_mfma_f32_16x16x32_bf16 v[112:115], v[208:211], v[180:183], v[112:115]
 v_mfma_f32_16x16x32_bf16 v[116:119], v[208:211], v[184:187], v[116:119]
 v_mfma_f32_16x16x32_bf16 v[120:123], v[208:211], v[188:191], v[120:123]
 v_mfma_f32_16x16x32_bf16 v[124:127], v[208:211], v[192:195], v[124:127]
 s_waitcnt lgkmcnt(6)
 v_mfma_f32_16x16x32_bf16 v[64:67], v[160:163], v[144:147], v[64:67]
 v_mfma_f32_16x16x32_bf16 v[68:71], v[160:163], v[148:151], v[68:71]
 v_mfma_f32_16x16x32_bf16 v[72:75], v[160:163], v[152:155], v[72:75]
 v_mfma_f32_16x16x32_bf16 v[76:79], v[160:163], v[156:159], v[76:79]
 s_waitcnt lgkmcnt(0)
 v_mfma_f32_16x16x32_bf16 v[80:83], v[164:167], v[144:147], v[80:83]
 ds_read_b128 v[180:183], v9 offset:0
 v_mfma_f32_16x16x32_bf16 v[84:87], v[164:167], v[148:151], v[84:87]
 ds_read_b64_tr_b16 v[196:197], v10 offset:9216
 v_mfma_f32_16x16x32_bf16 v[88:91], v[164:167], v[152:155], v[88:91]
 ds_read_b64_tr_b16 v[198:199], v11 offset:9216
 v_mfma_f32_16x16x32_bf16 v[92:95], v[164:167], v[156:159], v[92:95]
 ds_read_b128 v[184:187], v9 offset:2048
 v_mfma_f32_16x16x32_bf16 v[96:99], v[168:171], v[144:147], v[96:99]
 ds_read_b128 v[188:191], v9 offset:4096
 v_mfma_f32_16x16x32_bf16 v[100:103], v[168:171], v[148:151], v[100:103]
 ds_read_b128 v[192:195], v9 offset:6144
 v_mfma_f32_16x16x32_bf16 v[104:107], v[168:171], v[152:155], v[104:107]
 ds_read_b64_tr_b16 v[200:201], v10 offset:9728
 v_mfma_f32_16x16x32_bf16 v[108:111], v[168:171], v[156:159], v[108:111]
 ds_read_b64_tr_b16 v[202:203], v11 offset:9728
 v_mfma_f32_16x16x32_bf16 v[112:115], v[172:175], v[144:147], v[112:115]
 ds_read_b64_tr_b16 v[204:205], v10 offset:11264
 v_mfma_f32_16x16x32_bf16 v[116:119], v[172:175], v[148:151], v[116:119]
 ds_read_b64_tr_b16 v[206:207], v11 offset:11264
 v_mfma_f32_16x16x32_bf16 v[120:123], v[172:175], v[152:155], v[120:123]
 ds_read_b64_tr_b16 v[208:209], v10 offset:11776
 v_mfma_f32_16x16x32_bf16 v[124:127], v[172:175], v[156:159], v[124:127]
 ds_read_b64_tr_b16 v[210:211], v11 offset:11776
 ds_read_b64_tr_b16 v[212:213], v12 offset:9216
 ds_read_b64_tr_b16 v[214:215], v13 offset:9216
 v_add_u32 v8, 16384, v2
 v_add_u32 v9, 16384, v3
 v_add_u32 v10, 89088, v4
 v_add_u32 v11, 89088, v5
 v_add_u32 v12, 89088, v6
 v_add_u32 v13, 89088, v7
 s_waitcnt lgkmcnt(8)
 v_mfma_f32_16x16x32_bf16 v[64:67], v[196:199], v[180:183], v[64:67]
 v_mfma_f32_16x16x32_bf16 v[68:71], v[196:199], v[184:187], v[68:71]
 v_mfma_f32_16x16x32_bf16 v[72:75], v[196:199], v[188:191], v[72:75]
 v_mfma_f32_16x16x32_bf16 v[76:79], v[196:199], v[192:195], v[76:79]
 s_waitcnt lgkmcnt(0)
 s_barrier
 v_mfma_f32_16x16x32_bf16 v[128:131], v[212:215], v[180:183], v[128:131]
 ds_read_b128 v[144:147], v8 offset:0
 v_mfma_f32_16x16x32_bf16 v[132:135], v[212:215], v[184:187], v[132:135]
 ds_read_b64_tr_b16 v[160:161], v10 offset:0
 v_mfma_f32_16x16x32_bf16 v[136:139], v[212:215], v[188:191], v[136:139]
 ds_read_b64_tr_b16 v[162:163], v11 offset:0
 v_mfma_f32_16x16x32_bf16 v[140:143], v[212:215], v[192:195], v[140:143]
 ds_read_b128 v[148:151], v8 offset:2048
 v_mfma_f32_16x16x32_bf16 v[80:83], v[200:203], v[180:183], v[80:83]
 ds_read_b128 v[152:155], v8 offset:4096
 v_mfma_f32_16x16x32_bf16 v[84:87], v[200:203], v[184:187], v[84:87]
 ds_read_b128 v[156:159], v8 offset:6144
 v_mfma_f32_16x16x32_bf16 v[88:91], v[200:203], v[188:191], v[88:91]
 ds_read_b64_tr_b16 v[164:165], v10 offset:512
 v_mfma_f32_16x16x32_bf16 v[92:95], v[200:203], v[192:195], v[92:95]
 ds_read_b64_tr_b16 v[166:167], v11 offset:512
 v_mfma_f32_16x16x32_bf16 v[96:99], v[204:207], v[180:183], v[96:99]
 ds_read_b64_tr_b16 v[168:169], v10 offset:2048
 v_mfma_f32_16x16x32_bf16 v[100:103], v[204:207], v[184:187], v[100:103]
 ds_read_b64_tr_b16 v[170:171], v11 offset:2048
 v_mfma_f32_16x16x32_bf16 v[104:107], v[204:207], v[188:191], v[104:107]
 ds_read_b64_tr_b16 v[172:173], v10 offset:2560
 v_mfma_f32_16x16x32_bf16 v[108:111], v[204:207], v[192:195], v[108:111]
 ds_read_b64_tr_b16 v[174:175], v11 offset:2560
 v_mfma_f32_16x16x32_bf16 v[112:115], v[208:211], v[180:183], v[112:115]
 v_mfma_f32_16x16x32_bf16 v[116:119], v[208:211], v[184:187], v[116:119]
 v_mfma_f32_16x16x32_bf16 v[120:123], v[208:211], v[188:191], v[120:123]
 v_mfma_f32_16x16x32_bf16 v[124:127], v[208:211], v[192:195], v[124:127]
 s_waitcnt lgkmcnt(6)
 v_mfma_f32_16x16x32_bf16 v[64:67], v[160:163], v[144:147], v[64:67]
 v_mfma_f32_16x16x32_bf16 v[68:71], v[160:163], v[148:151], v[68:71]
 v_mfma_f32_16x16x32_bf16 v[72:75], v[160:163], v[152:155], v[72:75]
 v_mfma_f32_16x16x32_bf16 v[76:79], v[160:163], v[156:159], v[76:79]
 s_waitcnt lgkmcnt(0)
 v_mfma_f32_16x16x32_bf16 v[80:83], v[164:167], v[144:147], v[80:83]
 ds_read_b128 v[180:183], v9 offset:0
 v_mfma_f32_16x16x32_bf16 v[84:87], v[164:167], v[148:151], v[84:87]
 ds_read_b64_tr_b16 v[196:197], v10 offset:9216
 v_mfma_f32_16x16x32_bf16 v[88:91], v[164:167], v[152:155], v[88:91]
 ds_read_b64_tr_b16 v[198:199], v11 offset:9216
 v_mfma_f32_16x16x32_bf16 v[92:95], v[164:167], v[156:159], v[92:95]
 ds_read_b128 v[184:187], v9 offset:2048
 v_mfma_f32_16x16x32_bf16 v[96:99], v[168:171], v[144:147], v[96:99]
 ds_read_b128 v[188:191], v9 offset:4096
 v_mfma_f32_16x16x32_bf16 v[100:103], v[168:171], v[148:151], v[100:103]
 ds_read_b128 v[192:195], v9 offset:6144
 v_mfma_f32_16x16x32_bf16 v[104:107], v[168:171], v[152:155], v[104:107]
 ds_read_b64_tr_b16 v[200:201], v10 offset:9728
 v_mfma_f32_16x16x32_bf16 v[108:111], v[168:171], v[156:159], v[108:111]
 ds_read_b64_tr_b16 v[202:203], v11 offset:9728
 v_mfma_f32_16x16x32_bf16 v[112:115], v[172:175], v[144:147], v[112:115]
 ds_read_b64_tr_b16 v[204:205], v10 offset:11264
 v_mfma_f32_16x16x32_bf16 v[116:119], v[172:175], v[148:151], v[116:119]
 ds_read_b64_tr_b16 v[206:207], v11 offset:11264
 v_mfma_f32_16x16x32_bf16 v[120:123], v[172:175], v[152:155], v[120:123]
 ds_read_b64_tr_b16 v[208:209], v10 offset:11776
 v_mfma_f32_16x16x32_bf16 v[124:127], v[172:175], v[156:159], v[124:127]
 ds_read_b64_tr_b16 v[210:211], v11 offset:11776
 ds_read_b64_tr_b16 v[212:213], v12 offset:9216
 ds_read_b64_tr_b16 v[214:215], v13 offset:9216
 v_add_u32 v8, 32768, v2
 v_add_u32 v9, 32768, v3
 v_add_u32 v10, 107520, v4
 v_add_u32 v11, 107520, v5
 v_add_u32 v12, 107520, v6
 v_add_u32 v13, 107520, v7
 s_mov_b32 s40, 4
L_fz_p5c1:
 s_waitcnt lgkmcnt(8)
 v_mfma_f32_16x16x32_bf16 v[64:67], v[196:199], v[180:183], v[64:67]
 v_mfma_f32_16x16x32_bf16 v[68:71], v[196:199], v[184:187], v[68:71]
 v_mfma_f32_16x16x32_bf16 v[72:75], v[196:199], v[188:191], v[72:75]
 v_mfma_f32_16x16x32_bf16 v[76:79], v[196:199], v[192:195], v[76:79]
 s_waitcnt lgkmcnt(0)
 s_barrier
 v_mfma_f32_16x16x32_bf16 v[128:131], v[212:215], v[180:183], v[128:131]
 ds_read_b128 v[144:147], v8 offset:0
 v_mfma_f32_16x16x32_bf16 v[132:135], v[212:215], v[184:187], v[132:135]
 ds_read_b64_tr_b16 v[160:161], v10 offset:0
 v_mfma_f32_16x16x32_bf16 v[136:139], v[212:215], v[188:191], v[136:139]
 ds_read_b64_tr_b16 v[162:163], v11 offset:0
 v_mfma_f32_16x16x32_bf16 v[140:143], v[212:215], v[192:195], v[140:143]
 ds_read_b128 v[148:151], v8 offset:2048
 v_mfma_f32_16x16x32_bf16 v[80:83], v[200:203], v[180:183], v[80:83]
 ds_read_b128 v[152:155], v8 offset:4096
 v_mfma_f32_16x16x32_bf16 v[84:87], v[200:203], v[184:187], v[84:87]
 ds_read_b128 v[156:159], v8 offset:6144
 v_mfma_f32_16x16x32_bf16 v[88:91], v[200:203], v[188:191], v[88:91]
 ds_read_b64_tr_b16 v[164:165], v10 offset:512
 v_mfma_f32_16x16x32_bf16 v[92:95], v[200:203], v[192:195], v[92:95]
 ds_read_b64_tr_b16 v[166:167], v11 offset:512
 v_mfma_f32_16x16x32_bf16 v[96:99], v[204:207], v[180:183], v[96:99]
 ds_read_b64_tr_b16 v[168:169], v10 offset:2048
 v_mfma_f32_16x16x32_bf16 v[100:103], v[204:207], v[184:187], v[100:103]
 ds_read_b64_tr_b16 v[170:171], v11 offset:2048
 v_mfma_f32_16x16x32_bf16 v[104:107], v[204:207], v[188:191], v[104:107]
 ds_read_b64_tr_b16 v[172:173], v10 offset:2560
 v_mfma_f32_16x16x32_bf16 v[108:111], v[204:207], v[192:195], v[108:111]
 ds_read_b64_tr_b16 v[174:175], v11 offset:2560
 v_mfma_f32_16x16x32_bf16 v[112:115], v[208:211], v[180:183], v[112:115]
 v_mfma_f32_16x16x32_bf16 v[116:119], v[208:211], v[184:187], v[116:119]
 v_mfma_f32_16x16x32_bf16 v[120:123], v[208:211], v[188:191], v[120:123]
 v_mfma_f32_16x16x32_bf16 v[124:127], v[208:211], v[192:195], v[124:127]
 s_waitcnt lgkmcnt(6)
 v_mfma_f32_16x16x32_bf16 v[64:67], v[160:163], v[144:147], v[64:67]
 v_mfma_f32_16x16x32_bf16 v[68:71], v[160:163], v[148:151], v[68:71]
 v_mfma_f32_16x16x32_bf16 v[72:75], v[160:163], v[152:155], v[72:75]
 v_mfma_f32_16x16x32_bf16 v[76:79], v[160:163], v[156:159], v[76:79]
 s_waitcnt lgkmcnt(0)
 v_mfma_f32_16x16x32_bf16 v[80:83], v[164:167], v[144:147], v[80:83]
 ds_read_b128 v[180:183], v9 offset:0
 v_mfma_f32_16x16x32_bf16 v[84:87], v[164:167], v[148:151], v[84:87]
 ds_read_b64_tr_b16 v[196:197], v10 offset:9216
 v_mfma_f32_16x16x32_bf16 v[88:91], v[164:167], v[152:155], v[88:91]
 ds_read_b64_tr_b16 v[198:199], v11 offset:9216
 v_mfma_f32_16x16x32_bf16 v[92:95], v[164:167], v[156:159], v[92:95]
 ds_read_b128 v[184:187], v9 offset:2048
 v_mfma_f32_16x16x32_bf16 v[96:99], v[168:171], v[144:147], v[96:99]
 ds_read_b128 v[188:191], v9 offset:4096
 v_mfma_f32_16x16x32_bf16 v[100:103], v[168:171], v[148:151], v[100:103]
 ds_read_b128 v[192:195], v9 offset:6144
 v_mfma_f32_16x16x32_bf16 v[104:107], v[168:171], v[152:155], v[104:107]
 ds_read_b64_tr_b16 v[200:201], v10 offset:9728
 v_mfma_f32_16x16x32_bf16 v[108:111], v[168:171], v[156:159], v[108:111]
 ds_read_b64_tr_b16 v[202:203], v11 offset:9728
 v_mfma_f32_16x16x32_bf16 v[112:115], v[172:175], v[144:147], v[112:115]
 ds_read_b64_tr_b16 v[204:205], v10 offset:11264
 v_mfma_f32_16x16x32_bf16 v[116:119], v[172:175], v[148:151], v[116:119]
 ds_read_b64_tr_b16 v[206:207], v11 offset:11264
 v_mfma_f32_16x16x32_bf16 v[120:123], v[172:175], v[152:155], v[120:123]
 ds_read_b64_tr_b16 v[208:209], v10 offset:11776
 v_mfma_f32_16x16x32_bf16 v[124:127], v[172:175], v[156:159], v[124:127]
 ds_read_b64_tr_b16 v[210:211], v11 offset:11776
 ds_read_b64_tr_b16 v[212:213], v12 offset:9216
 ds_read_b64_tr_b16 v[214:215], v13 offset:9216
 v_add_u32 v8, 49152, v2
 v_add_u32 v9, 49152, v3
 v_add_u32 v10, 125952, v4
 v_add_u32 v11, 125952, v5
 v_add_u32 v12, 125952, v6
 v_add_u32 v13, 125952, v7
 s_waitcnt lgkmcnt(8)
 v_mfma_f32_16x16x32_bf16 v[64:67], v[196:199], v[180:183], v[64:67]
 v_mfma_f32_16x16x32_bf16 v[68:71], v[196:199], v[184:187], v[68:71]
 v_mfma_f32_16x16x32_bf16 v[72:75], v[196:199], v[188:191], v[72:75]
 v_mfma_f32_16x16x32_bf16 v[76:79], v[196:199], v[192:195], v[76:79]
 s_waitcnt lgkmcnt(0)
 s_barrier
 v_mfma_f32_16x16x32_bf16 v[128:131], v[212:215], v[180:183], v[128:131]
 ds_read_b128 v[144:147], v8 offset:0
 v_mfma_f32_16x16x32_bf16 v[132:135], v[212:215], v[184:187], v[132:135]
 ds_read_b64_tr_b16 v[160:161], v10 offset:0
 v_mfma_f32_16x16x32_bf16 v[136:139], v[212:215], v[188:191], v[136:139]
 ds_read_b64_tr_b16 v[162:163], v11 offset:0
 v_mfma_f32_16x16x32_bf16 v[140:143], v[212:215], v[192:195], v[140:143]
 ds_read_b128 v[148:151], v8 offset:2048
 v_mfma_f32_16x16x32_bf16 v[80:83], v[200:203], v[180:183], v[80:83]
 ds_read_b128 v[152:155], v8 offset:4096
 v_mfma_f32_16x16x32_bf16 v[84:87], v[200:203], v[184:187], v[84:87]
 ds_read_b128 v[156:159], v8 offset:6144
 v_mfma_f32_16x16x32_bf16 v[88:91], v[200:203], v[188:191], v[88:91]
 ds_read_b64_tr_b16 v[164:165], v10 offset:512
 v_mfma_f32_16x16x32_bf16 v[92:95], v[200:203], v[192:195], v[92:95]
 ds_read_b64_tr_b16 v[166:167], v11 offset:512
 v_mfma_f32_16x16x32_bf16 v[96:99], v[204:207], v[180:183], v[96:99]
 ds_read_b64_tr_b16 v[168:169], v10 offset:2048
 v_mfma_f32_16x16x32_bf16 v[100:103], v[204:207], v[184:187], v[100:103]
 ds_read_b64_tr_b16 v[170:171], v11 offset:2048
 v_mfma_f32_16x16x32_bf16 v[104:107], v[204:207], v[188:191], v[104:107]
 ds_read_b64_tr_b16 v[172:173], v10 offset:2560
 v_mfma_f32_16x16x32_bf16 v[108:111], v[204:207], v[192:195], v[108:111]
 ds_read_b64_tr_b16 v[174:175], v11 offset:2560
 v_mfma_f32_16x16x32_bf16 v[112:115], v[208:211], v[180:183], v[112:115]
 v_mfma_f32_16x16x32_bf16 v[116:119], v[208:211], v[184:187], v[116:119]
 v_mfma_f32_16x16x32_bf16 v[120:123], v[208:211], v[188:191], v[120:123]
 v_mfma_f32_16x16x32_bf16 v[124:127], v[208:211], v[192:195], v[124:127]
 s_waitcnt lgkmcnt(6)
 v_mfma_f32_16x16x32_bf16 v[64:67], v[160:163], v[144:147], v[64:67]
 v_mfma_f32_16x16x32_bf16 v[68:71], v[160:163], v[148:151], v[68:71]
 v_mfma_f32_16x16x32_bf16 v[72:75], v[160:163], v[152:155], v[72:75]
 v_mfma_f32_16x16x32_bf16 v[76:79], v[160:163], v[156:159], v[76:79]
 s_waitcnt lgkmcnt(0)
 v_mfma_f32_16x16x32_bf16 v[80:83], v[164:167], v[144:147], v[80:83]
 ds_read_b128 v[180:183], v9 offset:0
 v_mfma_f32_16x16x32_bf16 v[84:87], v[164:167], v[148:151], v[84:87]
 ds_read_b64_tr_b16 v[196:197], v10 offset:9216
 v_mfma_f32_16x16x32_bf16 v[88:91], v[164:167], v[152:155], v[88:91]
 ds_read_b64_tr_b16 v[198:199], v11 offset:9216
 v_mfma_f32_16x16x32_bf16 v[92:95], v[164:167], v[156:159], v[92:95]
 ds_read_b128 v[184:187], v9 offset:2048
 v_mfma_f32_16x16x32_bf16 v[96:99], v[168:171], v[144:147], v[96:99]
 ds_read_b128 v[188:191], v9 offset:4096
 v_mfma_f32_16x16x32_bf16 v[100:103], v[168:171], v[148:151], v[100:103]
 ds_read_b128 v[192:195], v9 offset:6144
 v_mfma_f32_16x16x32_bf16 v[104:107], v[168:171], v[152:155], v[104:107]
 ds_read_b64_tr_b16 v[200:201], v10 offset:9728
 v_mfma_f32_16x16x32_bf16 v[108:111], v[168:171], v[156:159], v[108:111]
 ds_read_b64_tr_b16 v[202:203], v11 offset:9728
 v_mfma_f32_16x16x32_bf16 v[112:115], v[172:175], v[144:147], v[112:115]
 ds_read_b64_tr_b16 v[204:205], v10 offset:11264
 v_mfma_f32_16x16x32_bf16 v[116:119], v[172:175], v[148:151], v[116:119]
 ds_read_b64_tr_b16 v[206:207], v11 offset:11264
 v_mfma_f32_16x16x32_bf16 v[120:123], v[172:175], v[152:155], v[120:123]
 ds_read_b64_tr_b16 v[208:209], v10 offset:11776
 v_mfma_f32_16x16x32_bf16 v[124:127], v[172:175], v[156:159], v[124:127]
 ds_read_b64_tr_b16 v[210:211], v11 offset:11776
 ds_read_b64_tr_b16 v[212:213], v12 offset:9216
 ds_read_b64_tr_b16 v[214:215], v13 offset:9216
 v_mov_b32 v8, v2
 v_mov_b32 v9, v3
 v_add_u32 v10, 70656, v4
 v_add_u32 v11, 70656, v5
 v_add_u32 v12, 70656, v6
 v_add_u32 v13, 70656, v7
 s_waitcnt lgkmcnt(8)
 v_mfma_f32_16x16x32_bf16 v[64:67], v[196:199], v[180:183], v[64:67]
 v_mfma_f32_16x16x32_bf16 v[68:71], v[196:199], v[184:187], v[68:71]
 v_mfma_f32_16x16x32_bf16 v[72:75], v[196:199], v[188:191], v[72:75]
 v_mfma_f32_16x16x32_bf16 v[76:79], v[196:199], v[192:195], v[76:79]
 s_waitcnt lgkmcnt(0)
 s_barrier
 v_mfma_f32_16x16x32_bf16 v[128:131], v[212:215], v[180:183], v[128:131]
 ds_read_b128 v[144:147], v8 offset:0
 v_mfma_f32_16x16x32_bf16 v[132:135], v[212:215], v[184:187], v[132:135]
 ds_read_b64_tr_b16 v[160:161], v10 offset:0
 v_mfma_f32_16x16x32_bf16 v[136:139], v[212:215], v[188:191], v[136:139]
 ds_read_b64_tr_b16 v[162:163], v11 offset:0
 v_mfma_f32_16x16x32_bf16 v[140:143], v[212:215], v[192:195], v[140:143]
 ds_read_b128 v[148:151], v8 offset:2048
 v_mfma_f32_16x16x32_bf16 v[80:83], v[200:203], v[180:183], v[80:83]
 ds_read_b128 v[152:155], v8 offset:4096
 v_mfma_f32_16x16x32_bf16 v[84:87], v[200:203], v[184:187], v[84:87]
 ds_read_b128 v[156:159], v8 offset:6144
 v_mfma_f32_16x16x32_bf16 v[88:91], v[200:203], v[188:191], v[88:91]
 ds_read_b64_tr_b16 v[164:165], v10 offset:512
 v_mfma_f32_16x16x32_bf16 v[92:95], v[200:203], v[192:195], v[92:95]
 ds_read_b64_tr_b16 v[166:167], v11 offset:512
 v_mfma_f32_16x16x32_bf16 v[96:99], v[204:207], v[180:183], v[96:99]
 ds_read_b64_tr_b16 v[168:169], v10 offset:2048
 v_mfma_f32_16x16x32_bf16 v[100:103], v[204:207], v[184:187], v[100:103]
 ds_read_b64_tr_b16 v[170:171], v11 offset:2048
 v_mfma_f32_16x16x32_bf16 v[104:107], v[204:207], v[188:191], v[104:107]
 ds_read_b64_tr_b16 v[172:173], v10 offset:2560
 v_mfma_f32_16x16x32_bf16 v[108:111], v[204:207], v[192:195], v[108:111]
 ds_read_b64_tr_b16 v[174:175], v11 offset:2560
 v_mfma_f32_16x16x32_bf16 v[112:115], v[208:211], v[180:183], v[112:115]
 v_mfma_f32_16x16x32_bf16 v[116:119], v[208:211], v[184:187], v[116:119]
 v_mfma_f32_16x16x32_bf16 v[120:123], v[208:211], v[188:191], v[120:123]
 v_mfma_f32_16x16x32_bf16 v[124:127], v[208:211], v[192:195], v[124:127]
 s_waitcnt lgkmcnt(6)
 v_mfma_f32_16x16x32_bf16 v[64:67], v[160:163], v[144:147], v[64:67]
 v_mfma_f32_16x16x32_bf16 v[68:71], v[160:163], v[148:151], v[68:71]
 v_mfma_f32_16x16x32_bf16 v[72:75], v[160:163], v[152:155], v[72:75]
 v_mfma_f32_16x16x32_bf16 v[76:79], v[160:163], v[156:159], v[76:79]
 s_waitcnt lgkmcnt(0)
 v_mfma_f32_16x16x32_bf16 v[80:83], v[164:167], v[144:147], v[80:83]
 ds_read_b128 v[180:183], v9 offset:0
 v_mfma_f32_16x16x32_bf16 v[84:87], v[164:167], v[148:151], v[84:87]
 ds_read_b64_tr_b16 v[196:197], v10 offset:9216
 v_mfma_f32_16x16x32_bf16 v[88:91], v[164:167], v[152:155], v[88:91]
 ds_read_b64_tr_b16 v[198:199], v11 offset:9216
 v_mfma_f32_16x16x32_bf16 v[92:95], v[164:167], v[156:159], v[92:95]
 ds_read_b128 v[184:187], v9 offset:2048
 v_mfma_f32_16x16x32_bf16 v[96:99], v[168:171], v[144:147], v[96:99]
 ds_read_b128 v[188:191], v9 offset:4096
 v_mfma_f32_16x16x32_bf16 v[100:103], v[168:171], v[148:151], v[100:103]
 ds_read_b128 v[192:195], v9 offset:6144
 v_mfma_f32_16x16x32_bf16 v[104:107], v[168:171], v[152:155], v[104:107]
 ds_read_b64_tr_b16 v[200:201], v10 offset:9728
 v_mfma_f32_16x16x32_bf16 v[108:111], v[168:171], v[156:159], v[108:111]
 ds_read_b64_tr_b16 v[202:203], v11 offset:9728
 v_mfma_f32_16x16x32_bf16 v[112:115], v[172:175], v[144:147], v[112:115]
 ds_read_b64_tr_b16 v[204:205], v10 offset:11264
 v_mfma_f32_16x16x32_bf16 v[116:119], v[172:175], v[148:151], v[116:119]
 ds_read_b64_tr_b16 v[206:207], v11 offset:11264
 v_mfma_f32_16x16x32_bf16 v[120:123], v[172:175], v[152:155], v[120:123]
 ds_read_b64_tr_b16 v[208:209], v10 offset:11776
 v_mfma_f32_16x16x32_bf16 v[124:127], v[172:175], v[156:159], v[124:127]
 ds_read_b64_tr_b16 v[210:211], v11 offset:11776
 ds_read_b64_tr_b16 v[212:213], v12 offset:9216
 ds_read_b64_tr_b16 v[214:215], v13 offset:9216
 v_add_u32 v8, 16384, v2
 v_add_u32 v9, 16384, v3
 v_add_u32 v10, 89088, v4
 v_add_u32 v11, 89088, v5
 v_add_u32 v12, 89088, v6
 v_add_u32 v13, 89088, v7
 s_waitcnt lgkmcnt(8)
 v_mfma_f32_16x16x32_bf16 v[64:67], v[196:199], v[180:183], v[64:67]
 v_mfma_f32_16x16x32_bf16 v[68:71], v[196:199], v[184:187], v[68:71]
 v_mfma_f32_16x16x32_bf16 v[72:75], v[196:199], v[188:191], v[72:75]
 v_mfma_f32_16x16x32_bf16 v[76:79], v[196:199], v[192:195], v[76:79]
 s_waitcnt lgkmcnt(0)
 s_barrier
 v_mfma_f32_16x16x32_bf16 v[128:131], v[212:215], v[180:183], v[128:131]
 ds_read_b128 v[144:147], v8 offset:0
 v_mfma_f32_16x16x32_bf16 v[132:135], v[212:215], v[184:187], v[132:135]
 ds_read_b64_tr_b16 v[160:161], v10 offset:0
 v_mfma_f32_16x16x32_bf16 v[136:139], v[212:215], v[188:191], v[136:139]
 ds_read_b64_tr_b16 v[162:163], v11 offset:0
 v_mfma_f32_16x16x32_bf16 v[140:143], v[212:215], v[192:195], v[140:143]
 ds_read_b128 v[148:151], v8 offset:2048
 v_mfma_f32_16x16x32_bf16 v[80:83], v[200:203], v[180:183], v[80:83]
 ds_read_b128 v[152:155], v8 offset:4096
 v_mfma_f32_16x16x32_bf16 v[84:87], v[200:203], v[184:187], v[84:87]
 ds_read_b128 v[156:159], v8 offset:6144
 v_mfma_f32_16x16x32_bf16 v[88:91], v[200:203], v[188:191], v[88:91]
 ds_read_b64_tr_b16 v[164:165], v10 offset:512
 v_mfma_f32_16x16x32_bf16 v[92:95], v[200:203], v[192:195], v[92:95]
 ds_read_b64_tr_b16 v[166:167], v11 offset:512
 v_mfma_f32_16x16x32_bf16 v[96:99], v[204:207], v[180:183], v[96:99]
 ds_read_b64_tr_b16 v[168:169], v10 offset:2048
 v_mfma_f32_16x16x32_bf16 v[100:103], v[204:207], v[184:187], v[100:103]
 ds_read_b64_tr_b16 v[170:171], v11 offset:2048
 v_mfma_f32_16x16x32_bf16 v[104:107], v[204:207], v[188:191], v[104:107]
 ds_read_b64_tr_b16 v[172:173], v10 offset:2560
 v_mfma_f32_16x16x32_bf16 v[108:111], v[204:207], v[192:195], v[108:111]
 ds_read_b64_tr_b16 v[174:175], v11 offset:2560
 v_mfma_f32_16x16x32_bf16 v[112:115], v[208:211], v[180:183], v[112:115]
 v_mfma_f32_16x16x32_bf16 v[116:119], v[208:211], v[184:187], v[116:119]
 v_mfma_f32_16x16x32_bf16 v[120:123], v[208:211], v[188:191], v[120:123]
 v_mfma_f32_16x16x32_bf16 v[124:127], v[208:211], v[192:195], v[124:127]
 s_waitcnt lgkmcnt(6)
 v_mfma_f32_16x16x32_bf16 v[64:67], v[160:163], v[144:147], v[64:67]
 v_mfma_f32_16x16x32_bf16 v[68:71], v[160:163], v[148:151], v[68:71]
 v_mfma_f32_16x16x32_bf16 v[72:75], v[160:163], v[152:155], v[72:75]
 v_mfma_f32_16x16x32_bf16 v[76:79], v[160:163], v[156:159], v[76:79]
 s_waitcnt lgkmcnt(0)
 v_mfma_f32_16x16x32_bf16 v[80:83], v[164:167], v[144:147], v[80:83]
 ds_read_b128 v[180:183], v9 offset:0
 v_mfma_f32_16x16x32_bf16 v[84:87], v[164:167], v[148:151], v[84:87]
 ds_read_b64_tr_b16 v[196:197], v10 offset:9216
 v_mfma_f32_16x16x32_bf16 v[88:91], v[164:167], v[152:155], v[88:91]
 ds_read_b64_tr_b16 v[198:199], v11 offset:9216
 v_mfma_f32_16x16x32_bf16 v[92:95], v[164:167], v[156:159], v[92:95]
 ds_read_b128 v[184:187], v9 offset:2048
 v_mfma_f32_16x16x32_bf16 v[96:99], v[168:171], v[144:147], v[96:99]
 ds_read_b128 v[188:191], v9 offset:4096
 v_mfma_f32_16x16x32_bf16 v[100:103], v[168:171], v[148:151], v[100:103]
 ds_read_b128 v[192:195], v9 offset:6144
 v_mfma_f32_16x16x32_bf16 v[104:107], v[168:171], v[152:155], v[104:107]
 ds_read_b64_tr_b16 v[200:201], v10 offset:9728
 v_mfma_f32_16x16x32_bf16 v[108:111], v[168:171], v[156:159], v[108:111]
 ds_read_b64_tr_b16 v[202:203], v11 offset:9728
 v_mfma_f32_16x16x32_bf16 v[112:115], v[172:175], v[144:147], v[112:115]
 ds_read_b64_tr_b16 v[204:205], v10 offset:11264
 v_mfma_f32_16x16x32_bf16 v[116:119], v[172:175], v[148:151], v[116:119]
 ds_read_b64_tr_b16 v[206:207], v11 offset:11264
 v_mfma_f32_16x16x32_bf16 v[120:123], v[172:175], v[152:155], v[120:123]
 ds_read_b64_tr_b16 v[208:209], v10 offset:11776
 v_mfma_f32_16x16x32_bf16 v[124:127], v[172:175], v[156:159], v[124:127]
 ds_read_b64_tr_b16 v[210:211], v11 offset:11776
 ds_read_b64_tr_b16 v[212:213], v12 offset:9216
 ds_read_b64_tr_b16 v[214:215], v13 offset:9216
 v_add_u32 v8, 32768, v2
 v_add_u32 v9, 32768, v3
 v_add_u32 v10, 107520, v4
 v_add_u32 v11, 107520, v5
 v_add_u32 v12, 107520, v6
 v_add_u32 v13, 107520, v7
 s_add_u32 s40, s40, 4
 s_cmp_lt_u32 s40, 32
 s_cbranch_scc1 L_fz_p5c1
 s_waitcnt lgkmcnt(0)
 v_mfma_f32_16x16x32_bf16 v[64:67], v[196:199], v[180:183], v[64:67]
 v_mfma_f32_16x16x32_bf16 v[68:71], v[196:199], v[184:187], v[68:71]
 v_mfma_f32_16x16x32_bf16 v[72:75], v[196:199], v[188:191], v[72:75]
 v_mfma_f32_16x16x32_bf16 v[76:79], v[196:199], v[192:195], v[76:79]
 v_mfma_f32_16x16x32_bf16 v[128:131], v[212:215], v[180:183], v[128:131]
 v_mfma_f32_16x16x32_bf16 v[132:135], v[212:215], v[184:187], v[132:135]
 v_mfma_f32_16x16x32_bf16 v[136:139], v[212:215], v[188:191], v[136:139]
 v_mfma_f32_16x16x32_bf16 v[140:143], v[212:215], v[192:195], v[140:143]
 v_mfma_f32_16x16x32_bf16 v[80:83], v[200:203], v[180:183], v[80:83]
 v_mfma_f32_16x16x32_bf16 v[84:87], v[200:203], v[184:187], v[84:87]
 v_mfma_f32_16x16x32_bf16 v[88:91], v[200:203], v[188:191], v[88:91]
 v_mfma_f32_16x16x32_bf16 v[92:95], v[200:203], v[192:195], v[92:95]
 v_mfma_f32_16x16x32_bf16 v[96:99], v[204:207], v[180:183], v[96:99]
 v_mfma_f32_16x16x32_bf16 v[100:103], v[204:207], v[184:187], v[100:103]
 v_mfma_f32_16x16x32_bf16 v[104:107], v[204:207], v[188:191], v[104:107]
 v_mfma_f32_16x16x32_bf16 v[108:111], v[204:207], v[192:195], v[108:111]
 v_mfma_f32_16x16x32_bf16 v[112:115], v[208:211], v[180:183], v[112:115]
 v_mfma_f32_16x16x32_bf16 v[116:119], v[208:211], v[184:187], v[116:119]
 v_mfma_f32_16x16x32_bf16 v[120:123], v[208:211], v[188:191], v[120:123]
 v_mfma_f32_16x16x32_bf16 v[124:127], v[208:211], v[192:195], v[124:127]
 ds_read_b128 v[216:219], v14 offset:0
 ds_read_b128 v[220:223], v14 offset:1024
 ds_read_b128 v[224:227], v14 offset:2048
 ds_read_b128 v[228:231], v14 offset:3072
 ds_read_b128 v[232:235], v14 offset:4096
 ds_read_b128 v[236:239], v14 offset:5120
 ds_read_b128 v[240:243], v14 offset:6144
 ds_read_b128 v[244:247], v14 offset:7168
 ds_write_b128 v25, v[128:131] offset:0
 ds_write_b128 v25, v[132:135] offset:1024
 ds_read_b128 v[248:251], v14 offset:8192
 s_waitcnt lgkmcnt(0)
 s_barrier
 ds_read_b128 v[128:131], v26 offset:0
 ds_read_b128 v[132:135], v26 offset:1024
 v_pk_fma_f32 v[64:65], v[64:65], v[36:37], v[36:37] op_sel:[0,0,1] op_sel_hi:[1,0,1]
 v_pk_fma_f32 v[66:67], v[66:67], v[36:37], v[36:37] op_sel:[0,0,1] op_sel_hi:[1,0,1]
 v_pk_fma_f32 v[80:81], v[80:81], v[36:37], v[36:37] op_sel:[0,0,1] op_sel_hi:[1,0,1]
 v_pk_fma_f32 v[82:83], v[82:83], v[36:37], v[36:37] op_sel:[0,0,1] op_sel_hi:[1,0,1]
 v_lshlrev_b32 v44, 16, v216
 v_and_b32 v45, 0xffff0000, v216
 v_lshlrev_b32 v46, 16, v217
 v_and_b32 v47, 0xffff0000, v217
 v_lshlrev_b32 v48, 16, v218
 v_and_b32 v49, 0xffff0000, v218
 v_lshlrev_b32 v50, 16, v219
 v_and_b32 v51, 0xffff0000, v219
 v_pk_mul_f32 v[64:65], v[64:65], v[44:45]
 v_pk_mul_f32 v[66:67], v[66:67], v[46:47]
 v_pk_mul_f32 v[80:81], v[80:81], v[48:49]
 v_pk_mul_f32 v[82:83], v[82:83], v[50:51]
 v_cvt_pk_bf16_f32 v216, v64, v65
 v_cvt_pk_bf16_f32 v218, v80, v81
 v_cvt_pk_bf16_f32 v217, v66, v67
 v_cvt_pk_bf16_f32 v219, v82, v83
 s_nop 0
 v_permlane16_swap_b32 v216, v218
 v_permlane16_swap_b32 v217, v219
 buffer_store_dwordx4 v[216:219], v20, s[20:23], 0 offen offset:0 sc1
 v_pk_fma_f32 v[96:97], v[96:97], v[36:37], v[36:37] op_sel:[0,0,1] op_sel_hi:[1,0,1]
 v_pk_fma_f32 v[98:99], v[98:99], v[36:37], v[36:37] op_sel:[0,0,1] op_sel_hi:[1,0,1]
 v_pk_fma_f32 v[112:113], v[112:113], v[36:37], v[36:37] op_sel:[0,0,1] op_sel_hi:[1,0,1]
 v_pk_fma_f32 v[114:115], v[114:115], v[36:37], v[36:37] op_sel:[0,0,1] op_sel_hi:[1,0,1]
 v_lshlrev_b32 v44, 16, v220
 v_and_b32 v45, 0xffff0000, v220
 v_lshlrev_b32 v46, 16, v221
 v_and_b32 v47, 0xffff0000, v221
 v_lshlrev_b32 v48, 16, v222
 v_and_b32 v49, 0xffff0000, v222
 v_lshlrev_b32 v50, 16, v223
 v_and_b32 v51, 0xffff0000, v223
 v_pk_mul_f32 v[96:97], v[96:97], v[44:45]
 v_pk_mul_f32 v[98:99], v[98:99], v[46:47]
 v_pk_mul_f32 v[112:113], v[112:113], v[48:49]
 v_pk_mul_f32 v[114:115], v[114:115], v[50:51]
 v_cvt_pk_bf16_f32 v220, v96, v97
 v_cvt_pk_bf16_f32 v222, v112, v113
 v_cvt_pk_bf16_f32 v221, v98, v99
 v_cvt_pk_bf16_f32 v223, v114, v115
 s_nop 0
 v_permlane16_swap_b32 v220, v222
 v_permlane16_swap_b32 v221, v223
 buffer_store_dwordx4 v[220:223], v20, s[20:23], 0 offen offset:1024 sc1
 v_pk_fma_f32 v[68:69], v[68:69], v[38:39], v[38:39] op_sel:[0,0,1] op_sel_hi:[1,0,1]
 v_pk_fma_f32 v[70:71], v[70:71], v[38:39], v[38:39] op_sel:[0,0,1] op_sel_hi:[1,0,1]
 v_pk_fma_f32 v[84:85], v[84:85], v[38:39], v[38:39] op_sel:[0,0,1] op_sel_hi:[1,0,1]
 v_pk_fma_f32 v[86:87], v[86:87], v[38:39], v[38:39] op_sel:[0,0,1] op_sel_hi:[1,0,1]
 v_lshlrev_b32 v44, 16, v224
 v_and_b32 v45, 0xffff0000, v224
 v_lshlrev_b32 v46, 16, v225
 v_and_b32 v47, 0xffff0000, v225
 v_lshlrev_b32 v48, 16, v226
 v_and_b32 v49, 0xffff0000, v226
 v_lshlrev_b32 v50, 16, v227
 v_and_b32 v51, 0xffff0000, v227
 v_pk_mul_f32 v[68:69], v[68:69], v[44:45]
 v_pk_mul_f32 v[70:71], v[70:71], v[46:47]
 v_pk_mul_f32 v[84:85], v[84:85], v[48:49]
 v_pk_mul_f32 v[86:87], v[86:87], v[50:51]
 v_cvt_pk_bf16_f32 v224, v68, v69
 v_cvt_pk_bf16_f32 v226, v84, v85
 v_cvt_pk_bf16_f32 v225, v70, v71
 v_cvt_pk_bf16_f32 v227, v86, v87
 s_nop 0
 v_permlane16_swap_b32 v224, v226
 v_permlane16_swap_b32 v225, v227
 buffer_store_dwordx4 v[224:227], v20, s[20:23], s50 offen offset:0 sc1
 v_pk_fma_f32 v[100:101], v[100:101], v[38:39], v[38:39] op_sel:[0,0,1] op_sel_hi:[1,0,1]
 v_pk_fma_f32 v[102:103], v[102:103], v[38:39], v[38:39] op_sel:[0,0,1] op_sel_hi:[1,0,1]
 v_pk_fma_f32 v[116:117], v[116:117], v[38:39], v[38:39] op_sel:[0,0,1] op_sel_hi:[1,0,1]
 v_pk_fma_f32 v[118:119], v[118:119], v[38:39], v[38:39] op_sel:[0,0,1] op_sel_hi:[1,0,1]
 v_lshlrev_b32 v44, 16, v228
 v_and_b32 v45, 0xffff0000, v228
 v_lshlrev_b32 v46, 16, v229
 v_and_b32 v47, 0xffff0000, v229
 v_lshlrev_b32 v48, 16, v230
 v_and_b32 v49, 0xffff0000, v230
 v_lshlrev_b32 v50, 16, v231
 v_and_b32 v51, 0xffff0000, v231
 v_pk_mul_f32 v[100:101], v[100:101], v[44:45]
 v_pk_mul_f32 v[102:103], v[102:103], v[46:47]
 v_pk_mul_f32 v[116:117], v[116:117], v[48:49]
 v_pk_mul_f32 v[118:119], v[118:119], v[50:51]
 v_cvt_pk_bf16_f32 v228, v100, v101
 v_cvt_pk_bf16_f32 v230, v116, v117
 v_cvt_pk_bf16_f32 v229, v102, v103
 v_cvt_pk_bf16_f32 v231, v118, v119
 s_nop 0
 v_permlane16_swap_b32 v228, v230
 v_permlane16_swap_b32 v229, v231
 buffer_store_dwordx4 v[228:231], v20, s[20:23], s50 offen offset:1024 sc1
 v_pk_fma_f32 v[72:73], v[72:73], v[40:41], v[40:41] op_sel:[0,0,1] op_sel_hi:[1,0,1]
 v_pk_fma_f32 v[74:75], v[74:75], v[40:41], v[40:41] op_sel:[0,0,1] op_sel_hi:[1,0,1]
 v_pk_fma_f32 v[88:89], v[88:89], v[40:41], v[40:41] op_sel:[0,0,1] op_sel_hi:[1,0,1]
 v_pk_fma_f32 v[90:91], v[90:91], v[40:41], v[40:41] op_sel:[0,0,1] op_sel_hi:[1,0,1]
 v_lshlrev_b32 v44, 16, v232
 v_and_b32 v45, 0xffff0000, v232
 v_lshlrev_b32 v46, 16, v233
 v_and_b32 v47, 0xffff0000, v233
 v_lshlrev_b32 v48, 16, v234
 v_and_b32 v49, 0xffff0000, v234
 v_lshlrev_b32 v50, 16, v235
 v_and_b32 v51, 0xffff0000, v235
 v_pk_mul_f32 v[72:73], v[72:73], v[44:45]
 v_pk_mul_f32 v[74:75], v[74:75], v[46:47]
 v_pk_mul_f32 v[88:89], v[88:89], v[48:49]
 v_pk_mul_f32 v[90:91], v[90:91], v[50:51]
 v_cvt_pk_bf16_f32 v232, v72, v73
 v_cvt_pk_bf16_f32 v234, v88, v89
 v_cvt_pk_bf16_f32 v233, v74, v75
 v_cvt_pk_bf16_f32 v235, v90, v91
 s_nop 0
 v_permlane16_swap_b32 v232, v234
 v_permlane16_swap_b32 v233, v235
 buffer_store_dwordx4 v[232:235], v20, s[20:23], s51 offen offset:0 sc1
 v_pk_fma_f32 v[104:105], v[104:105], v[40:41], v[40:41] op_sel:[0,0,1] op_sel_hi:[1,0,1]
 v_pk_fma_f32 v[106:107], v[106:107], v[40:41], v[40:41] op_sel:[0,0,1] op_sel_hi:[1,0,1]
 v_pk_fma_f32 v[120:121], v[120:121], v[40:41], v[40:41] op_sel:[0,0,1] op_sel_hi:[1,0,1]
 v_pk_fma_f32 v[122:123], v[122:123], v[40:41], v[40:41] op_sel:[0,0,1] op_sel_hi:[1,0,1]
 v_lshlrev_b32 v44, 16, v236
 v_and_b32 v45, 0xffff0000, v236
 v_lshlrev_b32 v46, 16, v237
 v_and_b32 v47, 0xffff0000, v237
 v_lshlrev_b32 v48, 16, v238
 v_and_b32 v49, 0xffff0000, v238
 v_lshlrev_b32 v50, 16, v239
 v_and_b32 v51, 0xffff0000, v239
 v_pk_mul_f32 v[104:105], v[104:105], v[44:45]
 v_pk_mul_f32 v[106:107], v[106:107], v[46:47]
 v_pk_mul_f32 v[120:121], v[120:121], v[48:49]
 v_pk_mul_f32 v[122:123], v[122:123], v[50:51]
 v_cvt_pk_bf16_f32 v236, v104, v105
 v_cvt_pk_bf16_f32 v238, v120, v121
 v_cvt_pk_bf16_f32 v237, v106, v107
 v_cvt_pk_bf16_f32 v239, v122, v123
 s_nop 0
 v_permlane16_swap_b32 v236, v238
 v_permlane16_swap_b32 v237, v239
 buffer_store_dwordx4 v[236:239], v20, s[20:23], s51 offen offset:1024 sc1
 v_pk_fma_f32 v[76:77], v[76:77], v[42:43], v[42:43] op_sel:[0,0,1] op_sel_hi:[1,0,1]
 v_pk_fma_f32 v[78:79], v[78:79], v[42:43], v[42:43] op_sel:[0,0,1] op_sel_hi:[1,0,1]
 v_pk_fma_f32 v[92:93], v[92:93], v[42:43], v[42:43] op_sel:[0,0,1] op_sel_hi:[1,0,1]
 v_pk_fma_f32 v[94:95], v[94:95], v[42:43], v[42:43] op_sel:[0,0,1] op_sel_hi:[1,0,1]
 v_lshlrev_b32 v44, 16, v240
 v_and_b32 v45, 0xffff0000, v240
 v_lshlrev_b32 v46, 16, v241
 v_and_b32 v47, 0xffff0000, v241
 v_lshlrev_b32 v48, 16, v242
 v_and_b32 v49, 0xffff0000, v242
 v_lshlrev_b32 v50, 16, v243
 v_and_b32 v51, 0xffff0000, v243
 v_pk_mul_f32 v[76:77], v[76:77], v[44:45]
 v_pk_mul_f32 v[78:79], v[78:79], v[46:47]
 v_pk_mul_f32 v[92:93], v[92:93], v[48:49]
 v_pk_mul_f32 v[94:95], v[94:95], v[50:51]
 v_cvt_pk_bf16_f32 v240, v76, v77
 v_cvt_pk_bf16_f32 v242, v92, v93
 v_cvt_pk_bf16_f32 v241, v78, v79
 v_cvt_pk_bf16_f32 v243, v94, v95
 s_nop 0
 v_permlane16_swap_b32 v240, v242
 v_permlane16_swap_b32 v241, v243
 buffer_store_dwordx4 v[240:243], v20, s[20:23], s52 offen offset:0 sc1
 v_pk_fma_f32 v[108:109], v[108:109], v[42:43], v[42:43] op_sel:[0,0,1] op_sel_hi:[1,0,1]
 v_pk_fma_f32 v[110:111], v[110:111], v[42:43], v[42:43] op_sel:[0,0,1] op_sel_hi:[1,0,1]
 v_pk_fma_f32 v[124:125], v[124:125], v[42:43], v[42:43] op_sel:[0,0,1] op_sel_hi:[1,0,1]
 v_pk_fma_f32 v[126:127], v[126:127], v[42:43], v[42:43] op_sel:[0,0,1] op_sel_hi:[1,0,1]
 v_lshlrev_b32 v44, 16, v244
 v_and_b32 v45, 0xffff0000, v244
 v_lshlrev_b32 v46, 16, v245
 v_and_b32 v47, 0xffff0000, v245
 v_lshlrev_b32 v48, 16, v246
 v_and_b32 v49, 0xffff0000, v246
 v_lshlrev_b32 v50, 16, v247
 v_and_b32 v51, 0xffff0000, v247
 v_pk_mul_f32 v[108:109], v[108:109], v[44:45]
 v_pk_mul_f32 v[110:111], v[110:111], v[46:47]
 v_pk_mul_f32 v[124:125], v[124:125], v[48:49]
 v_pk_mul_f32 v[126:127], v[126:127], v[50:51]
 v_cvt_pk_bf16_f32 v244, v108, v109
 v_cvt_pk_bf16_f32 v246, v124, v125
 v_cvt_pk_bf16_f32 v245, v110, v111
 v_cvt_pk_bf16_f32 v247, v126, v127
 s_nop 0
 v_permlane16_swap_b32 v244, v246
 v_permlane16_swap_b32 v245, v247
 buffer_store_dwordx4 v[244:247], v20, s[20:23], s52 offen offset:1024 sc1
 s_waitcnt lgkmcnt(0)
 v_pk_add_f32 v[136:137], v[136:137], v[128:129]
 v_pk_add_f32 v[138:139], v[138:139], v[130:131]
 v_pk_fma_f32 v[136:137], v[136:137], v[40:41], v[40:41] op_sel:[0,0,1] op_sel_hi:[1,0,1]
 v_pk_fma_f32 v[138:139], v[138:139], v[40:41], v[40:41] op_sel:[0,0,1] op_sel_hi:[1,0,1]
 v_lshlrev_b32 v44, 16, v248
 v_and_b32 v45, 0xffff0000, v248
 v_lshlrev_b32 v46, 16, v249
 v_and_b32 v47, 0xffff0000, v249
 v_pk_mul_f32 v[136:137], v[136:137], v[44:45]
 v_pk_mul_f32 v[138:139], v[138:139], v[46:47]
 v_cvt_pk_bf16_f32 v248, v136, v137
 v_cvt_pk_bf16_f32 v249, v138, v139
 v_pk_add_f32 v[140:141], v[140:141], v[132:133]
 v_pk_add_f32 v[142:143], v[142:143], v[134:135]
 v_pk_fma_f32 v[140:141], v[140:141], v[42:43], v[42:43] op_sel:[0,0,1] op_sel_hi:[1,0,1]
 v_pk_fma_f32 v[142:143], v[142:143], v[42:43], v[42:43] op_sel:[0,0,1] op_sel_hi:[1,0,1]
 v_lshlrev_b32 v44, 16, v250
 v_and_b32 v45, 0xffff0000, v250
 v_lshlrev_b32 v46, 16, v251
 v_and_b32 v47, 0xffff0000, v251
 v_pk_mul_f32 v[140:141], v[140:141], v[44:45]
 v_pk_mul_f32 v[142:143], v[142:143], v[46:47]
 v_cvt_pk_bf16_f32 v250, v140, v141
 v_cvt_pk_bf16_f32 v251, v142, v143
 s_nop 1
 v_permlane16_swap_b32 v248, v250
 v_permlane16_swap_b32 v249, v251
 buffer_store_dwordx4 v[248:251], v21, s[20:23], 0 offen sc1
L_fz_p5a2:
 s_lshl_b32 s55, s33, 4
 s_add_u32 s55, s55, s34
 s_cmp_ge_u32 s62, 26
 s_cbranch_scc1 L_fz_p6p1
 s_cmp_eq_u32 s3, 3
 s_cbranch_scc1 L_fz_p6p2
 s_mov_b32 s32, s3
 v_bfe_u32 v3, v0, 1, 2
 v_bfe_u32 v4, v0, 4, 2
 v_xor_b32 v3, v3, v4
 v_and_b32 v4, 1, v0
 v_lshlrev_b32 v4, 4, v4
 v_lshl_add_u32 v3, v3, 5, v4
 s_lshl_b32 s36, s63, 7
 v_add_u32 v3, s36, v3
 v_lshrrev_b32 v4, 5, v0
 v_bfe_u32 v5, v0, 3, 2
 v_lshl_add_u32 v4, v4, 3, v5
 v_mul_u32_u24 v4, 1152, v4
 s_mul_i32 s36, s32, 73728
 v_add3_u32 v8, v4, v3, s36
 s_mul_i32 s54, s32, 8192
 s_add_u32 s54, s54, 87040
 v_add_u32 v9, 18432, v8
 v_add_u32 v10, 4608, v8
 v_add_u32 v11, 23040, v8
 s_mov_b32 s12, s78
 s_mov_b32 s13, s79
 s_mov_b32 s14, 2654208
 s_mov_b32 s15, 0x20000
 s_branch L_fz_p6p1
L_fz_p6p2:
 s_mov_b32 s32, 4
 s_mul_i32 s46, s62, 5
 s_add_u32 s46, s46, s32
 s_cmp_lt_u32 s46, 128
 s_cselect_b32 s37, 18432, 0
 s_cselect_b32 s38, 73728, 0
 s_mul_i32 s36, s46, 18432
 s_add_u32 s36, s36, 11534336
 v_and_b32 v5, 15, v0
 v_lshrrev_b32 v6, 5, v0
 v_bfe_u32 v7, v0, 4, 1
 v_lshlrev_b32 v27, 4, v5
 v_lshl_add_u32 v27, v6, 8, v27
 v_lshl_add_u32 v27, v7, 3, v27
 s_add_u32 s28, s8, s36
 s_addc_u32 s29, s9, 0
 s_mov_b32 s30, s37
 s_mov_b32 s31, 0x20000
 s_lshl_b32 s36, s63, 11
 buffer_load_dwordx2 v[208:209], v27, s[28:31], s36 offen offset:0 sc1
 buffer_load_dwordx2 v[210:211], v27, s[28:31], s36 offen offset:512 sc1
 buffer_load_dwordx2 v[212:213], v27, s[28:31], s36 offen offset:1024 sc1
 buffer_load_dwordx2 v[214:215], v27, s[28:31], s36 offen offset:1536 sc1
 s_mul_i32 s36, s46, 73728
 s_add_u32 s36, s36, 16777216
 s_add_u32 s16, s8, s36
 s_addc_u32 s17, s9, 0
 s_mov_b32 s18, s38
 s_mov_b32 s19, 0x20000
 v_lshrrev_b32 v3, 2, v0
 v_bfe_u32 v4, v0, 3, 2
 v_lshlrev_b32 v3, 7, v3
 v_lshl_add_u32 v3, v4, 5, v3
 v_and_b32 v4, 3, v0
 v_lshl_add_u32 v21, v4, 3, v3
 v_add_u32 v21, 87040, v21
 v_xor_b32 v22, 32, v21
 v_xor_b32 v23, 64, v21
 v_xor_b32 v24, 96, v21
 v_lshlrev_b32 v16, 4, v0
 s_mul_i32 s36, s32, 2304
 v_mul_u32_u24 v28, 144, v5
 v_lshl_add_u32 v7, v7, 1, v6
 v_lshlrev_b32 v7, 4, v7
 v_add3_u32 v28, v28, v7, s36
 v_lshrrev_b32 v3, 3, v0
 v_and_b32 v4, 7, v0
 v_mul_u32_u24 v29, 144, v3
 v_lshlrev_b32 v4, 4, v4
 v_add3_u32 v29, v29, v4, s36
 v_mul_u32_u24 v30, 1152, v3
 s_mul_i32 s47, s46, 18432
 s_lshl_b32 s36, s63, 7
 s_add_u32 s47, s47, s36
 v_add3_u32 v30, v30, v4, s47
 s_mov_b32 s20, s4
 s_mov_b32 s21, s5
 s_mov_b32 s22, 2359296
 s_mov_b32 s23, 0x20000
L_fz_p6p1:
 s_branch L_fz_p5pub
L_fz_p4g1:
 s_cmp_lg_u32 s3, 5
 s_cbranch_scc1 L_fz_p4w
 s_add_u32 s56, s8, 16351232
 s_addc_u32 s57, s9, 0
 s_mov_b32 s58, 32768
 s_mov_b32 s59, 0x20000
 s_sub_u32 s60, s52, 1
 v_min_u32 v18, s60, v0
 v_add_lshl_u32 v18, v18, s53, 7
 s_mov_b32 s61, 40000
L_fz_wf3:
 buffer_load_dword v19, v18, s[56:59], 0 offen sc1
 s_waitcnt vmcnt(0)
 v_cmp_ne_u32 vcc, s100, v19
 s_sub_u32 s61, s61, 1
 s_cbranch_vccz L_fz_wd3
 s_cmp_lg_u32 s61, 0
 s_cbranch_scc1 L_fz_wf3
L_fz_wd3:
L_fz_p4w:
 s_barrier
 s_cmp_eq_u32 s45, 0
 s_cbranch_scc0 L_fz_p4b1
 s_add_u32 m0, s48, 0
 s_mov_b32 s43, 0
 buffer_load_dwordx4 v16, s[12:15], s43 offen sc1 lds
 buffer_load_dwordx4 v16, s[12:15], s43 offen offset:1024 sc1 lds
 buffer_load_dwordx4 v17, s[12:15], s43 offen offset:2048 sc1 lds
 buffer_load_dwordx4 v17, s[12:15], s43 offen offset:3072 sc1 lds
 s_add_u32 m0, s48, 16384
 s_mov_b32 s43, 2048
 buffer_load_dwordx4 v16, s[12:15], s43 offen sc1 lds
 buffer_load_dwordx4 v16, s[12:15], s43 offen offset:1024 sc1 lds
 buffer_load_dwordx4 v17, s[12:15], s43 offen offset:2048 sc1 lds
 buffer_load_dwordx4 v17, s[12:15], s43 offen offset:3072 sc1 lds
 s_waitcnt vmcnt(4)
 s_barrier
 s_add_u32 m0, s48, 32768
 s_mov_b32 s43, 4096
 buffer_load_dwordx4 v16, s[12:15], s43 offen sc1 lds
 buffer_load_dwordx4 v16, s[12:15], s43 offen offset:1024 sc1 lds
 buffer_load_dwordx4 v17, s[12:15], s43 offen offset:2048 sc1 lds
 buffer_load_dwordx4 v17, s[12:15], s43 offen offset:3072 sc1 lds
 s_add_u32 m0, s48, 49152
 s_mov_b32 s43, 6144
 buffer_load_dwordx4 v16, s[12:15], s43 offen sc1 lds
 buffer_load_dwordx4 v16, s[12:15], s43 offen offset:1024 sc1 lds
 buffer_load_dwordx4 v17, s[12:15], s43 offen offset:2048 sc1 lds
 buffer_load_dwordx4 v17, s[12:15], s43 offen offset:3072 sc1 lds
 s_waitcnt vmcnt(8)
 s_barrier
 s_add_u32 m0, s48, 0
 s_mov_b32 s43, 8192
 buffer_load_dwordx4 v16, s[12:15], s43 offen sc1 lds
 buffer_load_dwordx4 v16, s[12:15], s43 offen offset:1024 sc1 lds
 buffer_load_dwordx4 v17, s[12:15], s43 offen offset:2048 sc1 lds
 buffer_load_dwordx4 v17, s[12:15], s43 offen offset:3072 sc1 lds
 s_add_u32 m0, s48, 87040
 s_mov_b32 s42, 2363904
 buffer_load_dwordx4 v232, s[16:19], s42 offen lds
 s_add_u32 m0, s48, 88064
 s_nop 0
 buffer_load_dwordx4 v233, s[16:19], s42 offen lds
 s_add_u32 m0, s48, 89088
 s_nop 0
 buffer_load_dwordx4 v234, s[16:19], s42 offen lds
 s_add_u32 m0, s48, 90112
 s_nop 0
 buffer_load_dwordx4 v235, s[16:19], s42 offen lds
 s_add_u32 m0, s49, 103424
 s_nop 0
 buffer_load_dwordx4 v236, s[16:19], s42 offen lds
 v_bfe_u32 v18, v0, 4, 1
 v_bfe_u32 v19, v0, 1, 1
 v_lshlrev_b32 v3, 2, v19
 v_and_b32 v19, 1, v0
 v_lshl_add_u32 v3, v19, 1, v3
 v_add_u32 v3, v3, v18
 v_lshrrev_b32 v19, 5, v0
 v_bfe_u32 v20, v0, 2, 2
 v_lshl_add_u32 v20, v20, 1, v19
 v_mul_u32_u24 v20, 288, v20
 v_lshl_add_u32 v3, v3, 3, v20
 s_lshl_b32 s36, s45, 2
 s_add_u32 s36, s36, s39
 s_lshl_b32 s36, s36, 5
 s_add_u32 s36, s36, 16384
 v_add_u32 v3, s36, v3
 v_and_b32 v20, 15, v0
 v_lshlrev_b32 v20, 4, v20
 v_lshl_add_u32 v20, v19, 8, v20
 v_lshl_add_u32 v5, v18, 11, v20
 s_lshl_b32 s36, s44, 13
 v_add_u32 v5, s36, v5
 s_waitcnt vmcnt(13)
 s_barrier
 s_add_u32 m0, s48, 16384
 s_mov_b32 s43, 10240
 buffer_load_dwordx4 v16, s[12:15], s43 offen sc1 lds
 buffer_load_dwordx4 v16, s[12:15], s43 offen offset:1024 sc1 lds
 buffer_load_dwordx4 v17, s[12:15], s43 offen offset:2048 sc1 lds
 buffer_load_dwordx4 v17, s[12:15], s43 offen offset:3072 sc1 lds
 s_add_u32 m0, s48, 105472
 s_mov_b32 s42, 2953728
 buffer_load_dwordx4 v232, s[16:19], s42 offen lds
 s_add_u32 m0, s48, 106496
 s_nop 0
 buffer_load_dwordx4 v233, s[16:19], s42 offen lds
 s_add_u32 m0, s48, 107520
 s_nop 0
 buffer_load_dwordx4 v234, s[16:19], s42 offen lds
 s_add_u32 m0, s48, 108544
 s_nop 0
 buffer_load_dwordx4 v235, s[16:19], s42 offen lds
 s_add_u32 m0, s49, 121856
 s_nop 0
 buffer_load_dwordx4 v236, s[16:19], s42 offen lds
 s_lshl_b32 s36, s33, 1
 s_add_u32 s36, s36, s44
 s_lshl_b32 s36, s36, 9
 v_lshlrev_b32 v18, 3, v0
 s_add_u32 s24, s8, 14680064
 s_addc_u32 s25, s9, 0
 s_mov_b32 s26, 147456
 s_mov_b32 s27, 0x20000
 buffer_load_dwordx2 v[144:145], v18, s[24:27], s36 offen sc1
 s_add_u32 s36, s36, 16384
 buffer_load_dwordx2 v[146:147], v18, s[24:27], s36 offen sc1
 s_add_u32 s36, s36, 16384
 buffer_load_dwordx2 v[148:149], v18, s[24:27], s36 offen sc1
 s_add_u32 s36, s36, 16384
 buffer_load_dwordx2 v[150:151], v18, s[24:27], s36 offen sc1
 s_add_u32 s36, s36, 16384
 buffer_load_dwordx2 v[152:153], v18, s[24:27], s36 offen sc1
 s_add_u32 s36, s36, 16384
 buffer_load_dwordx2 v[154:155], v18, s[24:27], s36 offen sc1
 s_add_u32 s36, s36, 16384
 buffer_load_dwordx2 v[156:157], v18, s[24:27], s36 offen sc1
 s_add_u32 s36, s36, 16384
 buffer_load_dwordx2 v[158:159], v18, s[24:27], s36 offen sc1
 s_add_u32 s36, s36, 16384
 buffer_load_dwordx2 v[160:161], v18, s[24:27], s36 offen sc1
 s_mul_i32 s36, s34, 576
 s_add_u32 s36, s36, 14942208
 v_lshrrev_b32 v18, 5, v0
 v_lshlrev_b32 v18, 5, v18
 v_lshrrev_b32 v19, 4, v0
 v_lshlrev_b32 v19, 4, v19
 s_lshl_b32 s37, s45, 2
 s_add_u32 s37, s37, s39
 s_lshl_b32 s37, s37, 6
 s_cmp_eq_u32 s39, 0
 s_cselect_b32 s46, 512, 0
 s_add_u32 s24, s8, s36
 s_addc_u32 s25, s9, 0
 s_mov_b32 s26, 576
 s_mov_b32 s27, 0x20000
 buffer_load_dwordx4 v[196:199], v18, s[24:27], s37 offen offset:0 sc1
 buffer_load_dwordx4 v[200:203], v18, s[24:27], s37 offen offset:64 sc1
 buffer_load_dwordx4 v[204:207], v18, s[24:27], s37 offen offset:16 sc1
 buffer_load_dwordx4 v[208:211], v18, s[24:27], s37 offen offset:80 sc1
 buffer_load_dwordx4 v[212:215], v18, s[24:27], s37 offen offset:128 sc1
 buffer_load_dwordx4 v[216:219], v18, s[24:27], s37 offen offset:192 sc1
 buffer_load_dwordx4 v[220:223], v18, s[24:27], s37 offen offset:144 sc1
 buffer_load_dwordx4 v[224:227], v18, s[24:27], s37 offen offset:208 sc1
 buffer_load_dwordx4 v[60:63], v19, s[24:27], s46 offen sc1
 s_waitcnt vmcnt(36)
 s_barrier
 s_add_u32 m0, s48, 32768
 s_mov_b32 s43, 12288
 buffer_load_dwordx4 v16, s[12:15], s43 offen sc1 lds
 buffer_load_dwordx4 v16, s[12:15], s43 offen offset:1024 sc1 lds
 buffer_load_dwordx4 v17, s[12:15], s43 offen offset:2048 sc1 lds
 buffer_load_dwordx4 v17, s[12:15], s43 offen offset:3072 sc1 lds
 s_add_u32 m0, s48, 123904
 s_mov_b32 s42, 3543552
 buffer_load_dwordx4 v232, s[16:19], s42 offen lds
 s_add_u32 m0, s48, 124928
 s_nop 0
 buffer_load_dwordx4 v233, s[16:19], s42 offen lds
 s_add_u32 m0, s48, 125952
 s_nop 0
 buffer_load_dwordx4 v234, s[16:19], s42 offen lds
 s_add_u32 m0, s48, 126976
 s_nop 0
 buffer_load_dwordx4 v235, s[16:19], s42 offen lds
 s_add_u32 m0, s49, 140288
 s_nop 0
 buffer_load_dwordx4 v236, s[16:19], s42 offen lds
 s_waitcnt vmcnt(36)
 s_barrier
 s_add_u32 m0, s48, 49152
 s_mov_b32 s43, 14336
 buffer_load_dwordx4 v16, s[12:15], s43 offen sc1 lds
 buffer_load_dwordx4 v16, s[12:15], s43 offen offset:1024 sc1 lds
 buffer_load_dwordx4 v17, s[12:15], s43 offen offset:2048 sc1 lds
 buffer_load_dwordx4 v17, s[12:15], s43 offen offset:3072 sc1 lds
 s_add_u32 m0, s48, 142336
 s_mov_b32 s42, 4133376
 buffer_load_dwordx4 v232, s[16:19], s42 offen lds
 s_add_u32 m0, s48, 143360
 s_nop 0
 buffer_load_dwordx4 v233, s[16:19], s42 offen lds
 s_add_u32 m0, s48, 144384
 s_nop 0
 buffer_load_dwordx4 v234, s[16:19], s42 offen lds
 s_add_u32 m0, s48, 145408
 s_nop 0
 buffer_load_dwordx4 v235, s[16:19], s42 offen lds
 s_add_u32 m0, s49, 158720
 s_nop 0
 buffer_load_dwordx4 v236, s[16:19], s42 offen lds
 s_waitcnt vmcnt(18)
 v_pk_add_f32 v[144:145], v[144:145], v[146:147]
 v_pk_add_f32 v[144:145], v[144:145], v[148:149]
 v_pk_add_f32 v[144:145], v[144:145], v[150:151]
 v_pk_add_f32 v[144:145], v[144:145], v[152:153]
 v_pk_add_f32 v[144:145], v[144:145], v[154:155]
 v_pk_add_f32 v[144:145], v[144:145], v[156:157]
 v_pk_add_f32 v[144:145], v[144:145], v[158:159]
 v_pk_add_f32 v[144:145], v[144:145], v[160:161]
 v_mul_f32 v144, 0.001736111111111111, v144
 v_mul_f32 v145, 0.001736111111111111, v145
 v_fma_f32 v145, -v144, v144, v145
 v_max_f32 v145, 0, v145
 v_add_f32 v145, 0x3727c5ac, v145
 v_rsq_f32 v145, v145
 s_lshl_b32 s36, s44, 8
 s_add_u32 s36, s36, 78848
 v_lshl_add_u32 v19, v0, 2, s36
 ds_write_b32 v19, v144
 ds_write_b32 v19, v145 offset:512
 s_waitcnt lgkmcnt(0)
 s_waitcnt vmcnt(18)
 s_barrier
 s_add_u32 m0, s48, 0
 s_mov_b32 s43, 16384
 buffer_load_dwordx4 v16, s[12:15], s43 offen sc1 lds
 buffer_load_dwordx4 v16, s[12:15], s43 offen offset:1024 sc1 lds
 buffer_load_dwordx4 v17, s[12:15], s43 offen offset:2048 sc1 lds
 buffer_load_dwordx4 v17, s[12:15], s43 offen offset:3072 sc1 lds
 s_add_u32 m0, s48, 87040
 s_mov_b32 s42, 4723200
 buffer_load_dwordx4 v232, s[16:19], s42 offen lds
 s_add_u32 m0, s48, 88064
 s_nop 0
 buffer_load_dwordx4 v233, s[16:19], s42 offen lds
 s_add_u32 m0, s48, 89088
 s_nop 0
 buffer_load_dwordx4 v234, s[16:19], s42 offen lds
 s_add_u32 m0, s48, 90112
 s_nop 0
 buffer_load_dwordx4 v235, s[16:19], s42 offen lds
 s_add_u32 m0, s49, 103424
 s_nop 0
 buffer_load_dwordx4 v236, s[16:19], s42 offen lds
 s_lshl_b32 s36, s44, 8
 s_add_u32 s36, s36, 78848
 v_and_b32 v19, 15, v0
 v_lshl_add_u32 v19, v19, 2, s36
 ds_read_b32 v28, v19 offset:0
 ds_read_b32 v32, v19 offset:512
 ds_read_b32 v29, v19 offset:64
 ds_read_b32 v33, v19 offset:576
 ds_read_b32 v30, v19 offset:128
 ds_read_b32 v34, v19 offset:640
 ds_read_b32 v31, v19 offset:192
 ds_read_b32 v35, v19 offset:704
 v_and_b32 v19, 31, v0
 v_lshl_add_u32 v19, v19, 2, s36
 ds_read_b32 v48, v19 offset:0
 ds_read_b32 v50, v19 offset:512
 ds_read_b32 v49, v19 offset:128
 ds_read_b32 v51, v19 offset:640
 s_waitcnt vmcnt(18)
 s_barrier
 s_add_u32 m0, s48, 105472
 s_mov_b32 s42, 2949120
 buffer_load_dwordx4 v232, s[16:19], s42 offen lds
 s_add_u32 m0, s48, 106496
 s_nop 0
 buffer_load_dwordx4 v233, s[16:19], s42 offen lds
 s_add_u32 m0, s48, 107520
 s_nop 0
 buffer_load_dwordx4 v234, s[16:19], s42 offen lds
 s_add_u32 m0, s48, 108544
 s_nop 0
 buffer_load_dwordx4 v235, s[16:19], s42 offen lds
 s_add_u32 m0, s49, 121856
 s_nop 0
 buffer_load_dwordx4 v236, s[16:19], s42 offen lds
 s_waitcnt lgkmcnt(0)
 v_mul_f32 v36, -2.302208198144325, v32
 v_mul_f32 v37, v32, v32
 v_mul_f32 v37, v37, v36
 v_mul_f32 v37, 0.044715, v37
 v_mul_f32 v38, -2.302208198144325, v33
 v_mul_f32 v39, v33, v33
 v_mul_f32 v39, v39, v38
 v_mul_f32 v39, 0.044715, v39
 v_mul_f32 v40, -2.302208198144325, v34
 v_mul_f32 v41, v34, v34
 v_mul_f32 v41, v41, v40
 v_mul_f32 v41, 0.044715, v41
 v_mul_f32 v42, -2.302208198144325, v35
 v_mul_f32 v43, v35, v35
 v_mul_f32 v43, v43, v42
 v_mul_f32 v43, 0.044715, v43
 v_mul_f32 v52, -2.302208198144325, v50
 v_mul_f32 v53, v50, v50
 v_mul_f32 v53, v53, v52
 v_mul_f32 v53, 0.044715, v53
 v_mul_f32 v54, -2.302208198144325, v51
 v_mul_f32 v55, v51, v51
 v_mul_f32 v55, v55, v54
 v_mul_f32 v55, 0.044715, v55
 s_waitcnt vmcnt(14)
 s_barrier
 s_add_u32 m0, s48, 123904
 s_mov_b32 s42, 3538944
 buffer_load_dwordx4 v232, s[16:19], s42 offen lds
 s_add_u32 m0, s48, 124928
 s_nop 0
 buffer_load_dwordx4 v233, s[16:19], s42 offen lds
 s_add_u32 m0, s48, 125952
 s_nop 0
 buffer_load_dwordx4 v234, s[16:19], s42 offen lds
 s_add_u32 m0, s48, 126976
 s_nop 0
 buffer_load_dwordx4 v235, s[16:19], s42 offen lds
 s_add_u32 m0, s49, 140288
 s_nop 0
 buffer_load_dwordx4 v236, s[16:19], s42 offen lds
 s_waitcnt vmcnt(10)
 s_barrier
 s_add_u32 m0, s48, 142336
 s_mov_b32 s42, 4128768
 buffer_load_dwordx4 v232, s[16:19], s42 offen lds
 s_add_u32 m0, s48, 143360
 s_nop 0
 buffer_load_dwordx4 v233, s[16:19], s42 offen lds
 s_add_u32 m0, s48, 144384
 s_nop 0
 buffer_load_dwordx4 v234, s[16:19], s42 offen lds
 s_add_u32 m0, s48, 145408
 s_nop 0
 buffer_load_dwordx4 v235, s[16:19], s42 offen lds
 s_add_u32 m0, s49, 158720
 s_nop 0
 buffer_load_dwordx4 v236, s[16:19], s42 offen lds
 s_lshl_b32 s36, s32, 2
 s_add_u32 s36, s36, 80000
 v_mov_b32 v23, s36
 v_mov_b32 v24, 80000
 v_add_u32 v11, 16384, v5
 v_add_u32 v9, 89088, v3
 v_add_u32 v8, 16384, v2
 v_add_u32 v10, 89088, v4
 s_waitcnt vmcnt(10) lgkmcnt(0)
 s_barrier
 ds_read_b128 v[144:147], v11 offset:0
 ds_read_b64_tr_b16 v[152:153], v9 offset:0
 ds_read_b64_tr_b16 v[154:155], v9 offset:2304
 ds_read_b128 v[148:151], v11 offset:4096
 ds_read_b64_tr_b16 v[156:157], v9 offset:64
 ds_read_b64_tr_b16 v[158:159], v9 offset:2368
 s_waitcnt lgkmcnt(3)
 v_mfma_f32_32x32x16_bf16 v[64:79], v[152:155], v[144:147], 0
 ds_read_b128 v[160:163], v11 offset:512
 ds_read_b64_tr_b16 v[168:169], v9 offset:4608
 s_add_u32 m0, s48, 87040
 s_mov_b32 s42, 4718592
 buffer_load_dwordx4 v232, s[16:19], s42 offen lds
 s_waitcnt lgkmcnt(4)
 v_mfma_f32_32x32x16_bf16 v[80:95], v[152:155], v[148:151], 0
 ds_read_b64_tr_b16 v[170:171], v9 offset:6912
 ds_read_b128 v[164:167], v11 offset:4608
 s_add_u32 m0, s48, 88064
 s_nop 0
 buffer_load_dwordx4 v233, s[16:19], s42 offen lds
 s_waitcnt lgkmcnt(4)
 v_mfma_f32_32x32x16_bf16 v[96:111], v[156:159], v[144:147], 0
 ds_read_b64_tr_b16 v[172:173], v9 offset:4672
 ds_read_b64_tr_b16 v[174:175], v9 offset:6976
 s_add_u32 m0, s48, 89088
 s_nop 0
 buffer_load_dwordx4 v234, s[16:19], s42 offen lds
 v_mfma_f32_32x32x16_bf16 v[112:127], v[156:159], v[148:151], 0
 ds_read_b64_tr_b16 v[192:193], v10 offset:0
 ds_read_b64_tr_b16 v[194:195], v10 offset:2304
 ds_read_b128 v[176:179], v8 offset:0
 ds_read_b128 v[180:183], v8 offset:2048
 ds_read_b128 v[184:187], v8 offset:4096
 ds_read_b128 v[188:191], v8 offset:6144
 s_waitcnt lgkmcnt(9)
 v_mfma_f32_32x32x16_bf16 v[64:79], v[168:171], v[160:163], v[64:79]
 ds_read_b128 v[144:147], v11 offset:1024
 ds_read_b64_tr_b16 v[152:153], v9 offset:9216
 s_add_u32 m0, s48, 90112
 s_nop 0
 buffer_load_dwordx4 v235, s[16:19], s42 offen lds
 s_waitcnt lgkmcnt(10)
 v_mfma_f32_32x32x16_bf16 v[80:95], v[168:171], v[164:167], v[80:95]
 ds_read_b64_tr_b16 v[154:155], v9 offset:11520
 ds_read_b128 v[148:151], v11 offset:5120
 s_add_u32 m0, s49, 103424
 s_nop 0
 buffer_load_dwordx4 v236, s[16:19], s42 offen lds
 s_waitcnt lgkmcnt(10)
 v_mfma_f32_32x32x16_bf16 v[96:111], v[172:175], v[160:163], v[96:111]
 ds_read_b64_tr_b16 v[156:157], v9 offset:9280
 ds_read_b64_tr_b16 v[158:159], v9 offset:11584
 v_mfma_f32_32x32x16_bf16 v[112:127], v[172:175], v[164:167], v[112:127]
 s_waitcnt lgkmcnt(6)
 v_mfma_f32_16x16x32_bf16 v[128:131], v[192:195], v[176:179], v[128:131]
 v_mfma_f32_16x16x32_bf16 v[132:135], v[192:195], v[180:183], v[132:135]
 v_mfma_f32_16x16x32_bf16 v[136:139], v[192:195], v[184:187], v[136:139]
 v_mfma_f32_16x16x32_bf16 v[140:143], v[192:195], v[188:191], v[140:143]
 s_waitcnt lgkmcnt(3)
 v_mfma_f32_32x32x16_bf16 v[64:79], v[152:155], v[144:147], v[64:79]
 ds_read_b128 v[160:163], v11 offset:1536
 ds_read_b64_tr_b16 v[168:169], v9 offset:13824
 s_waitcnt lgkmcnt(4)
 v_mfma_f32_32x32x16_bf16 v[80:95], v[152:155], v[148:151], v[80:95]
 ds_read_b64_tr_b16 v[170:171], v9 offset:16128
 ds_read_b128 v[164:167], v11 offset:5632
 s_waitcnt lgkmcnt(4)
 v_mfma_f32_32x32x16_bf16 v[96:111], v[156:159], v[144:147], v[96:111]
 ds_read_b64_tr_b16 v[172:173], v9 offset:13888
 ds_read_b64_tr_b16 v[174:175], v9 offset:16192
 v_mfma_f32_32x32x16_bf16 v[112:127], v[156:159], v[148:151], v[112:127]
 v_mov_b32 v18, 10
 s_waitcnt vmcnt(10) lgkmcnt(0)
 ds_write_b32 v23, v18
 v_mfma_f32_32x32x16_bf16 v[64:79], v[168:171], v[160:163], v[64:79]
 ds_read_b128 v[18:21], v24
 v_add_u32 v11, 32768, v5
 v_add_u32 v9, 107520, v3
 v_add_u32 v8, 32768, v2
 v_add_u32 v10, 107520, v4
 v_mfma_f32_32x32x16_bf16 v[80:95], v[168:171], v[164:167], v[80:95]
 s_waitcnt lgkmcnt(0)
 v_min3_u32 v18, v18, v19, v20
 v_min_u32 v18, v18, v21
 v_cmp_gt_u32 vcc, 10, v18
 s_nop 0
 s_cbranch_vccnz L_fz_p4gb0_10s
L_fz_p4gb0_10r:
 ds_read_b128 v[144:147], v11 offset:0
 ds_read_b64_tr_b16 v[152:153], v9 offset:0
 ds_read_b64_tr_b16 v[154:155], v9 offset:2304
 v_mfma_f32_32x32x16_bf16 v[96:111], v[172:175], v[160:163], v[96:111]
 ds_read_b128 v[148:151], v11 offset:4096
 ds_read_b64_tr_b16 v[156:157], v9 offset:64
 ds_read_b64_tr_b16 v[158:159], v9 offset:2368
 v_mfma_f32_32x32x16_bf16 v[112:127], v[172:175], v[164:167], v[112:127]
 s_waitcnt lgkmcnt(3)
 v_mfma_f32_32x32x16_bf16 v[64:79], v[152:155], v[144:147], v[64:79]
 ds_read_b128 v[160:163], v11 offset:512
 ds_read_b64_tr_b16 v[168:169], v9 offset:4608
 s_add_u32 m0, s48, 16384
 s_mov_b32 s43, 0
 buffer_load_dwordx4 v16, s[12:15], s43 offen sc1 lds
 s_waitcnt lgkmcnt(4)
 v_mfma_f32_32x32x16_bf16 v[80:95], v[152:155], v[148:151], v[80:95]
 ds_read_b64_tr_b16 v[170:171], v9 offset:6912
 ds_read_b128 v[164:167], v11 offset:4608
 buffer_load_dwordx4 v16, s[12:15], s43 offen offset:1024 sc1 lds
 s_waitcnt lgkmcnt(4)
 v_mfma_f32_32x32x16_bf16 v[96:111], v[156:159], v[144:147], v[96:111]
 ds_read_b64_tr_b16 v[172:173], v9 offset:4672
 ds_read_b64_tr_b16 v[174:175], v9 offset:6976
 buffer_load_dwordx4 v17, s[12:15], s43 offen offset:2048 sc1 lds
 v_mfma_f32_32x32x16_bf16 v[112:127], v[156:159], v[148:151], v[112:127]
 ds_read_b64_tr_b16 v[192:193], v10 offset:0
 ds_read_b64_tr_b16 v[194:195], v10 offset:2304
 ds_read_b128 v[176:179], v8 offset:0
 ds_read_b128 v[180:183], v8 offset:2048
 ds_read_b128 v[184:187], v8 offset:4096
 ds_read_b128 v[188:191], v8 offset:6144
 s_waitcnt lgkmcnt(9)
 v_mfma_f32_32x32x16_bf16 v[64:79], v[168:171], v[160:163], v[64:79]
 ds_read_b128 v[144:147], v11 offset:1024
 ds_read_b64_tr_b16 v[152:153], v9 offset:9216
 buffer_load_dwordx4 v17, s[12:15], s43 offen offset:3072 sc1 lds
 s_waitcnt lgkmcnt(10)
 v_mfma_f32_32x32x16_bf16 v[80:95], v[168:171], v[164:167], v[80:95]
 ds_read_b64_tr_b16 v[154:155], v9 offset:11520
 ds_read_b128 v[148:151], v11 offset:5120
 s_add_u32 m0, s48, 105472
 s_mov_b32 s42, 0
 buffer_load_dwordx4 v232, s[16:19], s42 offen lds
 s_waitcnt lgkmcnt(10)
 v_mfma_f32_32x32x16_bf16 v[96:111], v[172:175], v[160:163], v[96:111]
 ds_read_b64_tr_b16 v[156:157], v9 offset:9280
 ds_read_b64_tr_b16 v[158:159], v9 offset:11584
 s_add_u32 m0, s48, 106496
 s_nop 0
 buffer_load_dwordx4 v233, s[16:19], s42 offen lds
 v_mfma_f32_32x32x16_bf16 v[112:127], v[172:175], v[164:167], v[112:127]
 s_waitcnt lgkmcnt(6)
 v_mfma_f32_16x16x32_bf16 v[128:131], v[192:195], v[176:179], v[128:131]
 v_mfma_f32_16x16x32_bf16 v[132:135], v[192:195], v[180:183], v[132:135]
 v_mfma_f32_16x16x32_bf16 v[136:139], v[192:195], v[184:187], v[136:139]
 v_mfma_f32_16x16x32_bf16 v[140:143], v[192:195], v[188:191], v[140:143]
 s_waitcnt lgkmcnt(3)
 v_mfma_f32_32x32x16_bf16 v[64:79], v[152:155], v[144:147], v[64:79]
 ds_read_b128 v[160:163], v11 offset:1536
 ds_read_b64_tr_b16 v[168:169], v9 offset:13824
 s_add_u32 m0, s48, 107520
 s_nop 0
 buffer_load_dwordx4 v234, s[16:19], s42 offen lds
 s_waitcnt lgkmcnt(4)
 v_mfma_f32_32x32x16_bf16 v[80:95], v[152:155], v[148:151], v[80:95]
 ds_read_b64_tr_b16 v[170:171], v9 offset:16128
 ds_read_b128 v[164:167], v11 offset:5632
 s_add_u32 m0, s48, 108544
 s_nop 0
 buffer_load_dwordx4 v235, s[16:19], s42 offen lds
 s_waitcnt lgkmcnt(4)
 v_mfma_f32_32x32x16_bf16 v[96:111], v[156:159], v[144:147], v[96:111]
 ds_read_b64_tr_b16 v[172:173], v9 offset:13888
 ds_read_b64_tr_b16 v[174:175], v9 offset:16192
 s_add_u32 m0, s49, 121856
 s_nop 0
 buffer_load_dwordx4 v236, s[16:19], s42 offen lds
 v_mfma_f32_32x32x16_bf16 v[112:127], v[156:159], v[148:151], v[112:127]
 v_mov_b32 v18, 11
 s_waitcnt vmcnt(14) lgkmcnt(0)
 ds_write_b32 v23, v18
 v_mfma_f32_32x32x16_bf16 v[64:79], v[168:171], v[160:163], v[64:79]
 ds_read_b128 v[18:21], v24
 v_add_u32 v11, 49152, v5
 v_add_u32 v9, 125952, v3
 v_add_u32 v8, 49152, v2
 v_add_u32 v10, 125952, v4
 v_mfma_f32_32x32x16_bf16 v[80:95], v[168:171], v[164:167], v[80:95]
 s_waitcnt lgkmcnt(0)
 v_min3_u32 v18, v18, v19, v20
 v_min_u32 v18, v18, v21
 v_cmp_gt_u32 vcc, 11, v18
 s_nop 0
 s_cbranch_vccnz L_fz_p4gb0_11s
L_fz_p4gb0_11r:
 ds_read_b128 v[144:147], v11 offset:0
 ds_read_b64_tr_b16 v[152:153], v9 offset:0
 ds_read_b64_tr_b16 v[154:155], v9 offset:2304
 v_mfma_f32_32x32x16_bf16 v[96:111], v[172:175], v[160:163], v[96:111]
 ds_read_b128 v[148:151], v11 offset:4096
 ds_read_b64_tr_b16 v[156:157], v9 offset:64
 ds_read_b64_tr_b16 v[158:159], v9 offset:2368
 v_mfma_f32_32x32x16_bf16 v[112:127], v[172:175], v[164:167], v[112:127]
 s_waitcnt lgkmcnt(3)
 v_mfma_f32_32x32x16_bf16 v[64:79], v[152:155], v[144:147], v[64:79]
 ds_read_b128 v[160:163], v11 offset:512
 ds_read_b64_tr_b16 v[168:169], v9 offset:4608
 s_add_u32 m0, s48, 32768
 s_mov_b32 s43, 2048
 buffer_load_dwordx4 v16, s[12:15], s43 offen sc1 lds
 s_waitcnt lgkmcnt(4)
 v_mfma_f32_32x32x16_bf16 v[80:95], v[152:155], v[148:151], v[80:95]
 ds_read_b64_tr_b16 v[170:171], v9 offset:6912
 ds_read_b128 v[164:167], v11 offset:4608
 buffer_load_dwordx4 v16, s[12:15], s43 offen offset:1024 sc1 lds
 s_waitcnt lgkmcnt(4)
 v_mfma_f32_32x32x16_bf16 v[96:111], v[156:159], v[144:147], v[96:111]
 ds_read_b64_tr_b16 v[172:173], v9 offset:4672
 ds_read_b64_tr_b16 v[174:175], v9 offset:6976
 buffer_load_dwordx4 v17, s[12:15], s43 offen offset:2048 sc1 lds
 v_mfma_f32_32x32x16_bf16 v[112:127], v[156:159], v[148:151], v[112:127]
 ds_read_b64_tr_b16 v[192:193], v10 offset:0
 ds_read_b64_tr_b16 v[194:195], v10 offset:2304
 ds_read_b128 v[176:179], v8 offset:0
 ds_read_b128 v[180:183], v8 offset:2048
 ds_read_b128 v[184:187], v8 offset:4096
 ds_read_b128 v[188:191], v8 offset:6144
 s_waitcnt lgkmcnt(9)
 v_mfma_f32_32x32x16_bf16 v[64:79], v[168:171], v[160:163], v[64:79]
 ds_read_b128 v[144:147], v11 offset:1024
 ds_read_b64_tr_b16 v[152:153], v9 offset:9216
 buffer_load_dwordx4 v17, s[12:15], s43 offen offset:3072 sc1 lds
 s_waitcnt lgkmcnt(10)
 v_mfma_f32_32x32x16_bf16 v[80:95], v[168:171], v[164:167], v[80:95]
 ds_read_b64_tr_b16 v[154:155], v9 offset:11520
 ds_read_b128 v[148:151], v11 offset:5120
 s_add_u32 m0, s48, 123904
 s_mov_b32 s42, 589824
 buffer_load_dwordx4 v232, s[16:19], s42 offen lds
 s_waitcnt lgkmcnt(10)
 v_mfma_f32_32x32x16_bf16 v[96:111], v[172:175], v[160:163], v[96:111]
 ds_read_b64_tr_b16 v[156:157], v9 offset:9280
 ds_read_b64_tr_b16 v[158:159], v9 offset:11584
 s_add_u32 m0, s48, 124928
 s_nop 0
 buffer_load_dwordx4 v233, s[16:19], s42 offen lds
 v_mfma_f32_32x32x16_bf16 v[112:127], v[172:175], v[164:167], v[112:127]
 s_waitcnt lgkmcnt(6)
 v_mfma_f32_16x16x32_bf16 v[128:131], v[192:195], v[176:179], v[128:131]
 v_mfma_f32_16x16x32_bf16 v[132:135], v[192:195], v[180:183], v[132:135]
 v_mfma_f32_16x16x32_bf16 v[136:139], v[192:195], v[184:187], v[136:139]
 v_mfma_f32_16x16x32_bf16 v[140:143], v[192:195], v[188:191], v[140:143]
 s_waitcnt lgkmcnt(3)
 v_mfma_f32_32x32x16_bf16 v[64:79], v[152:155], v[144:147], v[64:79]
 ds_read_b128 v[160:163], v11 offset:1536
 ds_read_b64_tr_b16 v[168:169], v9 offset:13824
 s_add_u32 m0, s48, 125952
 s_nop 0
 buffer_load_dwordx4 v234, s[16:19], s42 offen lds
 s_waitcnt lgkmcnt(4)
 v_mfma_f32_32x32x16_bf16 v[80:95], v[152:155], v[148:151], v[80:95]
 ds_read_b64_tr_b16 v[170:171], v9 offset:16128
 ds_read_b128 v[164:167], v11 offset:5632
 s_add_u32 m0, s48, 126976
 s_nop 0
 buffer_load_dwordx4 v235, s[16:19], s42 offen lds
 s_waitcnt lgkmcnt(4)
 v_mfma_f32_32x32x16_bf16 v[96:111], v[156:159], v[144:147], v[96:111]
 ds_read_b64_tr_b16 v[172:173], v9 offset:13888
 ds_read_b64_tr_b16 v[174:175], v9 offset:16192
 s_add_u32 m0, s49, 140288
 s_nop 0
 buffer_load_dwordx4 v236, s[16:19], s42 offen lds
 v_mfma_f32_32x32x16_bf16 v[112:127], v[156:159], v[148:151], v[112:127]
 v_mov_b32 v18, 12
 s_waitcnt vmcnt(18) lgkmcnt(0)
 ds_write_b32 v23, v18
 v_mfma_f32_32x32x16_bf16 v[64:79], v[168:171], v[160:163], v[64:79]
 ds_read_b128 v[18:21], v24
 v_mov_b32 v11, v5
 v_add_u32 v9, 70656, v3
 v_mov_b32 v8, v2
 v_add_u32 v10, 70656, v4
 v_mfma_f32_32x32x16_bf16 v[80:95], v[168:171], v[164:167], v[80:95]
 s_waitcnt lgkmcnt(0)
 v_min3_u32 v18, v18, v19, v20
 v_min_u32 v18, v18, v21
 v_cmp_gt_u32 vcc, 12, v18
 s_nop 0
 s_cbranch_vccnz L_fz_p4gb0_12s
L_fz_p4gb0_12r:
 ds_read_b128 v[144:147], v11 offset:0
 ds_read_b64_tr_b16 v[152:153], v9 offset:0
 ds_read_b64_tr_b16 v[154:155], v9 offset:2304
 v_mfma_f32_32x32x16_bf16 v[96:111], v[172:175], v[160:163], v[96:111]
 ds_read_b128 v[148:151], v11 offset:4096
 ds_read_b64_tr_b16 v[156:157], v9 offset:64
 ds_read_b64_tr_b16 v[158:159], v9 offset:2368
 v_mfma_f32_32x32x16_bf16 v[112:127], v[172:175], v[164:167], v[112:127]
 s_waitcnt lgkmcnt(3)
 v_mfma_f32_32x32x16_bf16 v[64:79], v[152:155], v[144:147], v[64:79]
 ds_read_b128 v[160:163], v11 offset:512
 ds_read_b64_tr_b16 v[168:169], v9 offset:4608
 s_add_u32 m0, s48, 49152
 s_mov_b32 s43, 4096
 buffer_load_dwordx4 v16, s[12:15], s43 offen sc1 lds
 s_waitcnt lgkmcnt(4)
 v_mfma_f32_32x32x16_bf16 v[80:95], v[152:155], v[148:151], v[80:95]
 ds_read_b64_tr_b16 v[170:171], v9 offset:6912
 ds_read_b128 v[164:167], v11 offset:4608
 buffer_load_dwordx4 v16, s[12:15], s43 offen offset:1024 sc1 lds
 s_waitcnt lgkmcnt(4)
 v_mfma_f32_32x32x16_bf16 v[96:111], v[156:159], v[144:147], v[96:111]
 ds_read_b64_tr_b16 v[172:173], v9 offset:4672
 ds_read_b64_tr_b16 v[174:175], v9 offset:6976
 buffer_load_dwordx4 v17, s[12:15], s43 offen offset:2048 sc1 lds
 v_mfma_f32_32x32x16_bf16 v[112:127], v[156:159], v[148:151], v[112:127]
 ds_read_b64_tr_b16 v[192:193], v10 offset:0
 ds_read_b64_tr_b16 v[194:195], v10 offset:2304
 ds_read_b128 v[176:179], v8 offset:0
 ds_read_b128 v[180:183], v8 offset:2048
 ds_read_b128 v[184:187], v8 offset:4096
 ds_read_b128 v[188:191], v8 offset:6144
 s_waitcnt lgkmcnt(9)
 v_mfma_f32_32x32x16_bf16 v[64:79], v[168:171], v[160:163], v[64:79]
 ds_read_b128 v[144:147], v11 offset:1024
 ds_read_b64_tr_b16 v[152:153], v9 offset:9216
 buffer_load_dwordx4 v17, s[12:15], s43 offen offset:3072 sc1 lds
 s_waitcnt lgkmcnt(10)
 v_mfma_f32_32x32x16_bf16 v[80:95], v[168:171], v[164:167], v[80:95]
 ds_read_b64_tr_b16 v[154:155], v9 offset:11520
 ds_read_b128 v[148:151], v11 offset:5120
 s_add_u32 m0, s48, 142336
 s_mov_b32 s42, 1179648
 buffer_load_dwordx4 v232, s[16:19], s42 offen lds
 s_waitcnt lgkmcnt(10)
 v_mfma_f32_32x32x16_bf16 v[96:111], v[172:175], v[160:163], v[96:111]
 ds_read_b64_tr_b16 v[156:157], v9 offset:9280
 ds_read_b64_tr_b16 v[158:159], v9 offset:11584
 s_add_u32 m0, s48, 143360
 s_nop 0
 buffer_load_dwordx4 v233, s[16:19], s42 offen lds
 v_mfma_f32_32x32x16_bf16 v[112:127], v[172:175], v[164:167], v[112:127]
 s_waitcnt lgkmcnt(6)
 v_mfma_f32_16x16x32_bf16 v[128:131], v[192:195], v[176:179], v[128:131]
 v_mfma_f32_16x16x32_bf16 v[132:135], v[192:195], v[180:183], v[132:135]
 v_mfma_f32_16x16x32_bf16 v[136:139], v[192:195], v[184:187], v[136:139]
 v_mfma_f32_16x16x32_bf16 v[140:143], v[192:195], v[188:191], v[140:143]
 s_waitcnt lgkmcnt(3)
 v_mfma_f32_32x32x16_bf16 v[64:79], v[152:155], v[144:147], v[64:79]
 ds_read_b128 v[160:163], v11 offset:1536
 ds_read_b64_tr_b16 v[168:169], v9 offset:13824
 s_add_u32 m0, s48, 144384
 s_nop 0
 buffer_load_dwordx4 v234, s[16:19], s42 offen lds
 s_waitcnt lgkmcnt(4)
 v_mfma_f32_32x32x16_bf16 v[80:95], v[152:155], v[148:151], v[80:95]
 ds_read_b64_tr_b16 v[170:171], v9 offset:16128
 ds_read_b128 v[164:167], v11 offset:5632
 s_add_u32 m0, s48, 145408
 s_nop 0
 buffer_load_dwordx4 v235, s[16:19], s42 offen lds
 s_waitcnt lgkmcnt(4)
 v_mfma_f32_32x32x16_bf16 v[96:111], v[156:159], v[144:147], v[96:111]
 ds_read_b64_tr_b16 v[172:173], v9 offset:13888
 ds_read_b64_tr_b16 v[174:175], v9 offset:16192
 s_add_u32 m0, s49, 158720
 s_nop 0
 buffer_load_dwordx4 v236, s[16:19], s42 offen lds
 v_mfma_f32_32x32x16_bf16 v[112:127], v[156:159], v[148:151], v[112:127]
 v_mov_b32 v18, 13
 s_waitcnt vmcnt(18) lgkmcnt(0)
 ds_write_b32 v23, v18
 v_mfma_f32_32x32x16_bf16 v[64:79], v[168:171], v[160:163], v[64:79]
 ds_read_b128 v[18:21], v24
 v_add_u32 v11, 16384, v5
 v_add_u32 v9, 89088, v3
 v_add_u32 v8, 16384, v2
 v_add_u32 v10, 89088, v4
 v_mfma_f32_32x32x16_bf16 v[80:95], v[168:171], v[164:167], v[80:95]
 s_waitcnt lgkmcnt(0)
 v_min3_u32 v18, v18, v19, v20
 v_min_u32 v18, v18, v21
 v_cmp_gt_u32 vcc, 13, v18
 s_nop 0
 s_cbranch_vccnz L_fz_p4gb0_13s
L_fz_p4gb0_13r:
 ds_read_b128 v[144:147], v11 offset:0
 ds_read_b64_tr_b16 v[152:153], v9 offset:0
 ds_read_b64_tr_b16 v[154:155], v9 offset:2304
 v_mfma_f32_32x32x16_bf16 v[96:111], v[172:175], v[160:163], v[96:111]
 ds_read_b128 v[148:151], v11 offset:4096
 ds_read_b64_tr_b16 v[156:157], v9 offset:64
 ds_read_b64_tr_b16 v[158:159], v9 offset:2368
 v_mfma_f32_32x32x16_bf16 v[112:127], v[172:175], v[164:167], v[112:127]
 s_waitcnt lgkmcnt(3)
 v_mfma_f32_32x32x16_bf16 v[64:79], v[152:155], v[144:147], v[64:79]
 ds_read_b128 v[160:163], v11 offset:512
 ds_read_b64_tr_b16 v[168:169], v9 offset:4608
 s_add_u32 m0, s48, 0
 s_mov_b32 s43, 6144
 buffer_load_dwordx4 v16, s[12:15], s43 offen sc1 lds
 s_waitcnt lgkmcnt(4)
 v_mfma_f32_32x32x16_bf16 v[80:95], v[152:155], v[148:151], v[80:95]
 ds_read_b64_tr_b16 v[170:171], v9 offset:6912
 ds_read_b128 v[164:167], v11 offset:4608
 buffer_load_dwordx4 v16, s[12:15], s43 offen offset:1024 sc1 lds
 s_waitcnt lgkmcnt(4)
 v_mfma_f32_32x32x16_bf16 v[96:111], v[156:159], v[144:147], v[96:111]
 ds_read_b64_tr_b16 v[172:173], v9 offset:4672
 ds_read_b64_tr_b16 v[174:175], v9 offset:6976
 buffer_load_dwordx4 v17, s[12:15], s43 offen offset:2048 sc1 lds
 v_mfma_f32_32x32x16_bf16 v[112:127], v[156:159], v[148:151], v[112:127]
 ds_read_b64_tr_b16 v[192:193], v10 offset:0
 ds_read_b64_tr_b16 v[194:195], v10 offset:2304
 ds_read_b128 v[176:179], v8 offset:0
 ds_read_b128 v[180:183], v8 offset:2048
 ds_read_b128 v[184:187], v8 offset:4096
 ds_read_b128 v[188:191], v8 offset:6144
 s_waitcnt lgkmcnt(9)
 v_mfma_f32_32x32x16_bf16 v[64:79], v[168:171], v[160:163], v[64:79]
 ds_read_b128 v[144:147], v11 offset:1024
 ds_read_b64_tr_b16 v[152:153], v9 offset:9216
 buffer_load_dwordx4 v17, s[12:15], s43 offen offset:3072 sc1 lds
 s_waitcnt lgkmcnt(10)
 v_mfma_f32_32x32x16_bf16 v[80:95], v[168:171], v[164:167], v[80:95]
 ds_read_b64_tr_b16 v[154:155], v9 offset:11520
 ds_read_b128 v[148:151], v11 offset:5120
 s_add_u32 m0, s48, 87040
 s_mov_b32 s42, 1769472
 buffer_load_dwordx4 v232, s[16:19], s42 offen lds
 s_waitcnt lgkmcnt(10)
 v_mfma_f32_32x32x16_bf16 v[96:111], v[172:175], v[160:163], v[96:111]
 ds_read_b64_tr_b16 v[156:157], v9 offset:9280
 ds_read_b64_tr_b16 v[158:159], v9 offset:11584
 s_add_u32 m0, s48, 88064
 s_nop 0
 buffer_load_dwordx4 v233, s[16:19], s42 offen lds
 v_mfma_f32_32x32x16_bf16 v[112:127], v[172:175], v[164:167], v[112:127]
 s_waitcnt lgkmcnt(6)
 v_mfma_f32_16x16x32_bf16 v[128:131], v[192:195], v[176:179], v[128:131]
 v_mfma_f32_16x16x32_bf16 v[132:135], v[192:195], v[180:183], v[132:135]
 v_mfma_f32_16x16x32_bf16 v[136:139], v[192:195], v[184:187], v[136:139]
 v_mfma_f32_16x16x32_bf16 v[140:143], v[192:195], v[188:191], v[140:143]
 s_waitcnt lgkmcnt(3)
 v_mfma_f32_32x32x16_bf16 v[64:79], v[152:155], v[144:147], v[64:79]
 ds_read_b128 v[160:163], v11 offset:1536
 ds_read_b64_tr_b16 v[168:169], v9 offset:13824
 s_add_u32 m0, s48, 89088
 s_nop 0
 buffer_load_dwordx4 v234, s[16:19], s42 offen lds
 s_waitcnt lgkmcnt(4)
 v_mfma_f32_32x32x16_bf16 v[80:95], v[152:155], v[148:151], v[80:95]
 ds_read_b64_tr_b16 v[170:171], v9 offset:16128
 ds_read_b128 v[164:167], v11 offset:5632
 s_add_u32 m0, s48, 90112
 s_nop 0
 buffer_load_dwordx4 v235, s[16:19], s42 offen lds
 s_waitcnt lgkmcnt(4)
 v_mfma_f32_32x32x16_bf16 v[96:111], v[156:159], v[144:147], v[96:111]
 ds_read_b64_tr_b16 v[172:173], v9 offset:13888
 ds_read_b64_tr_b16 v[174:175], v9 offset:16192
 s_add_u32 m0, s49, 103424
 s_nop 0
 buffer_load_dwordx4 v236, s[16:19], s42 offen lds
 v_mfma_f32_32x32x16_bf16 v[112:127], v[156:159], v[148:151], v[112:127]
 v_mov_b32 v18, 14
 s_waitcnt vmcnt(18) lgkmcnt(0)
 ds_write_b32 v23, v18
 v_mfma_f32_32x32x16_bf16 v[64:79], v[168:171], v[160:163], v[64:79]
 ds_read_b128 v[18:21], v24
 v_add_u32 v11, 32768, v5
 v_add_u32 v9, 107520, v3
 v_add_u32 v8, 32768, v2
 v_add_u32 v10, 107520, v4
 v_mfma_f32_32x32x16_bf16 v[80:95], v[168:171], v[164:167], v[80:95]
 s_waitcnt lgkmcnt(0)
 v_min3_u32 v18, v18, v19, v20
 v_min_u32 v18, v18, v21
 v_cmp_gt_u32 vcc, 14, v18
 s_nop 0
 s_cbranch_vccnz L_fz_p4gb0_14s
L_fz_p4gb0_14r:
 ds_read_b128 v[144:147], v11 offset:0
 ds_read_b64_tr_b16 v[152:153], v9 offset:0
 ds_read_b64_tr_b16 v[154:155], v9 offset:2304
 v_mfma_f32_32x32x16_bf16 v[96:111], v[172:175], v[160:163], v[96:111]
 ds_read_b128 v[148:151], v11 offset:4096
 ds_read_b64_tr_b16 v[156:157], v9 offset:64
 ds_read_b64_tr_b16 v[158:159], v9 offset:2368
 v_mfma_f32_32x32x16_bf16 v[112:127], v[172:175], v[164:167], v[112:127]
 s_waitcnt lgkmcnt(3)
 v_mfma_f32_32x32x16_bf16 v[64:79], v[152:155], v[144:147], v[64:79]
 ds_read_b128 v[160:163], v11 offset:512
 ds_read_b64_tr_b16 v[168:169], v9 offset:4608
 s_add_u32 m0, s48, 16384
 s_mov_b32 s43, 8192
 buffer_load_dwordx4 v16, s[12:15], s43 offen sc1 lds
 s_waitcnt lgkmcnt(4)
 v_mfma_f32_32x32x16_bf16 v[80:95], v[152:155], v[148:151], v[80:95]
 ds_read_b64_tr_b16 v[170:171], v9 offset:6912
 ds_read_b128 v[164:167], v11 offset:4608
 buffer_load_dwordx4 v16, s[12:15], s43 offen offset:1024 sc1 lds
 s_waitcnt lgkmcnt(4)
 v_mfma_f32_32x32x16_bf16 v[96:111], v[156:159], v[144:147], v[96:111]
 ds_read_b64_tr_b16 v[172:173], v9 offset:4672
 ds_read_b64_tr_b16 v[174:175], v9 offset:6976
 buffer_load_dwordx4 v17, s[12:15], s43 offen offset:2048 sc1 lds
 v_mfma_f32_32x32x16_bf16 v[112:127], v[156:159], v[148:151], v[112:127]
 ds_read_b64_tr_b16 v[192:193], v10 offset:0
 ds_read_b64_tr_b16 v[194:195], v10 offset:2304
 ds_read_b128 v[176:179], v8 offset:0
 ds_read_b128 v[180:183], v8 offset:2048
 ds_read_b128 v[184:187], v8 offset:4096
 ds_read_b128 v[188:191], v8 offset:6144
 s_waitcnt lgkmcnt(9)
 v_mfma_f32_32x32x16_bf16 v[64:79], v[168:171], v[160:163], v[64:79]
 ds_read_b128 v[144:147], v11 offset:1024
 ds_read_b64_tr_b16 v[152:153], v9 offset:9216
 buffer_load_dwordx4 v17, s[12:15], s43 offen offset:3072 sc1 lds
 s_waitcnt lgkmcnt(10)
 v_mfma_f32_32x32x16_bf16 v[80:95], v[168:171], v[164:167], v[80:95]
 ds_read_b64_tr_b16 v[154:155], v9 offset:11520
 ds_read_b128 v[148:151], v11 offset:5120
 s_add_u32 m0, s48, 105472
 s_mov_b32 s42, 2359296
 buffer_load_dwordx4 v232, s[16:19], s42 offen lds
 s_waitcnt lgkmcnt(10)
 v_mfma_f32_32x32x16_bf16 v[96:111], v[172:175], v[160:163], v[96:111]
 ds_read_b64_tr_b16 v[156:157], v9 offset:9280
 ds_read_b64_tr_b16 v[158:159], v9 offset:11584
 s_add_u32 m0, s48, 106496
 s_nop 0
 buffer_load_dwordx4 v233, s[16:19], s42 offen lds
 v_mfma_f32_32x32x16_bf16 v[112:127], v[172:175], v[164:167], v[112:127]
 s_waitcnt lgkmcnt(6)
 v_mfma_f32_16x16x32_bf16 v[128:131], v[192:195], v[176:179], v[128:131]
 v_mfma_f32_16x16x32_bf16 v[132:135], v[192:195], v[180:183], v[132:135]
 v_mfma_f32_16x16x32_bf16 v[136:139], v[192:195], v[184:187], v[136:139]
 v_mfma_f32_16x16x32_bf16 v[140:143], v[192:195], v[188:191], v[140:143]
 s_waitcnt lgkmcnt(3)
 v_mfma_f32_32x32x16_bf16 v[64:79], v[152:155], v[144:147], v[64:79]
 ds_read_b128 v[160:163], v11 offset:1536
 ds_read_b64_tr_b16 v[168:169], v9 offset:13824
 s_add_u32 m0, s48, 107520
 s_nop 0
 buffer_load_dwordx4 v234, s[16:19], s42 offen lds
 s_waitcnt lgkmcnt(4)
 v_mfma_f32_32x32x16_bf16 v[80:95], v[152:155], v[148:151], v[80:95]
 ds_read_b64_tr_b16 v[170:171], v9 offset:16128
 ds_read_b128 v[164:167], v11 offset:5632
 s_add_u32 m0, s48, 108544
 s_nop 0
 buffer_load_dwordx4 v235, s[16:19], s42 offen lds
 s_waitcnt lgkmcnt(4)
 v_mfma_f32_32x32x16_bf16 v[96:111], v[156:159], v[144:147], v[96:111]
 ds_read_b64_tr_b16 v[172:173], v9 offset:13888
 ds_read_b64_tr_b16 v[174:175], v9 offset:16192
 s_add_u32 m0, s49, 121856
 s_nop 0
 buffer_load_dwordx4 v236, s[16:19], s42 offen lds
 v_mfma_f32_32x32x16_bf16 v[112:127], v[156:159], v[148:151], v[112:127]
 v_mov_b32 v18, 15
 s_waitcnt vmcnt(18) lgkmcnt(0)
 ds_write_b32 v23, v18
 v_mfma_f32_32x32x16_bf16 v[64:79], v[168:171], v[160:163], v[64:79]
 ds_read_b128 v[18:21], v24
 v_add_u32 v11, 49152, v5
 v_add_u32 v9, 125952, v3
 v_add_u32 v8, 49152, v2
 v_add_u32 v10, 125952, v4
 v_mfma_f32_32x32x16_bf16 v[80:95], v[168:171], v[164:167], v[80:95]
 s_waitcnt lgkmcnt(0)
 v_min3_u32 v18, v18, v19, v20
 v_min_u32 v18, v18, v21
 v_cmp_gt_u32 vcc, 15, v18
 s_nop 0
 s_cbranch_vccnz L_fz_p4gb0_15s
L_fz_p4gb0_15r:
 ds_read_b128 v[144:147], v11 offset:0
 ds_read_b64_tr_b16 v[152:153], v9 offset:0
 ds_read_b64_tr_b16 v[154:155], v9 offset:2304
 v_mfma_f32_32x32x16_bf16 v[96:111], v[172:175], v[160:163], v[96:111]
 ds_read_b128 v[148:151], v11 offset:4096
 ds_read_b64_tr_b16 v[156:157], v9 offset:64
 ds_read_b64_tr_b16 v[158:159], v9 offset:2368
 v_mfma_f32_32x32x16_bf16 v[112:127], v[172:175], v[164:167], v[112:127]
 s_waitcnt lgkmcnt(3)
 v_mfma_f32_32x32x16_bf16 v[64:79], v[152:155], v[144:147], v[64:79]
 ds_read_b128 v[160:163], v11 offset:512
 ds_read_b64_tr_b16 v[168:169], v9 offset:4608
 s_waitcnt lgkmcnt(4)
 v_mfma_f32_32x32x16_bf16 v[80:95], v[152:155], v[148:151], v[80:95]
 ds_read_b64_tr_b16 v[170:171], v9 offset:6912
 ds_read_b128 v[164:167], v11 offset:4608
 s_waitcnt lgkmcnt(4)
 v_mfma_f32_32x32x16_bf16 v[96:111], v[156:159], v[144:147], v[96:111]
 ds_read_b64_tr_b16 v[172:173], v9 offset:4672
 ds_read_b64_tr_b16 v[174:175], v9 offset:6976
 v_mfma_f32_32x32x16_bf16 v[112:127], v[156:159], v[148:151], v[112:127]
 ds_read_b64_tr_b16 v[192:193], v10 offset:0
 ds_read_b64_tr_b16 v[194:195], v10 offset:2304
 ds_read_b128 v[176:179], v8 offset:0
 ds_read_b128 v[180:183], v8 offset:2048
 ds_read_b128 v[184:187], v8 offset:4096
 ds_read_b128 v[188:191], v8 offset:6144
 s_waitcnt lgkmcnt(9)
 v_mfma_f32_32x32x16_bf16 v[64:79], v[168:171], v[160:163], v[64:79]
 ds_read_b128 v[144:147], v11 offset:1024
 ds_read_b64_tr_b16 v[152:153], v9 offset:9216
 s_waitcnt lgkmcnt(10)
 v_mfma_f32_32x32x16_bf16 v[80:95], v[168:171], v[164:167], v[80:95]
 ds_read_b64_tr_b16 v[154:155], v9 offset:11520
 ds_read_b128 v[148:151], v11 offset:5120
 s_waitcnt lgkmcnt(10)
 v_mfma_f32_32x32x16_bf16 v[96:111], v[172:175], v[160:163], v[96:111]
 ds_read_b64_tr_b16 v[156:157], v9 offset:9280
 ds_read_b64_tr_b16 v[158:159], v9 offset:11584
 v_mfma_f32_32x32x16_bf16 v[112:127], v[172:175], v[164:167], v[112:127]
 s_waitcnt lgkmcnt(6)
 v_mfma_f32_16x16x32_bf16 v[128:131], v[192:195], v[176:179], v[128:131]
 v_mfma_f32_16x16x32_bf16 v[132:135], v[192:195], v[180:183], v[132:135]
 v_mfma_f32_16x16x32_bf16 v[136:139], v[192:195], v[184:187], v[136:139]
 v_mfma_f32_16x16x32_bf16 v[140:143], v[192:195], v[188:191], v[140:143]
 s_waitcnt lgkmcnt(3)
 v_mfma_f32_32x32x16_bf16 v[64:79], v[152:155], v[144:147], v[64:79]
 ds_read_b128 v[160:163], v11 offset:1536
 ds_read_b64_tr_b16 v[168:169], v9 offset:13824
 s_waitcnt lgkmcnt(4)
 v_mfma_f32_32x32x16_bf16 v[80:95], v[152:155], v[148:151], v[80:95]
 ds_read_b64_tr_b16 v[170:171], v9 offset:16128
 ds_read_b128 v[164:167], v11 offset:5632
 s_waitcnt lgkmcnt(4)
 v_mfma_f32_32x32x16_bf16 v[96:111], v[156:159], v[144:147], v[96:111]
 ds_read_b64_tr_b16 v[172:173], v9 offset:13888
 ds_read_b64_tr_b16 v[174:175], v9 offset:16192
 v_mfma_f32_32x32x16_bf16 v[112:127], v[156:159], v[148:151], v[112:127]
 v_mov_b32 v18, 16
 s_waitcnt vmcnt(9) lgkmcnt(0)
 ds_write_b32 v23, v18
 v_mfma_f32_32x32x16_bf16 v[64:79], v[168:171], v[160:163], v[64:79]
 ds_read_b128 v[18:21], v24
 v_mov_b32 v11, v5
 v_add_u32 v9, 70656, v3
 v_mov_b32 v8, v2
 v_add_u32 v10, 70656, v4
 v_mfma_f32_32x32x16_bf16 v[80:95], v[168:171], v[164:167], v[80:95]
 s_waitcnt lgkmcnt(0)
 v_min3_u32 v18, v18, v19, v20
 v_min_u32 v18, v18, v21
 v_cmp_gt_u32 vcc, 16, v18
 s_nop 0
 s_cbranch_vccnz L_fz_p4gb0_16s
L_fz_p4gb0_16r:
 ds_read_b128 v[144:147], v11 offset:0
 ds_read_b64_tr_b16 v[152:153], v9 offset:0
 ds_read_b64_tr_b16 v[154:155], v9 offset:2304
 v_mfma_f32_32x32x16_bf16 v[96:111], v[172:175], v[160:163], v[96:111]
 ds_read_b128 v[148:151], v11 offset:4096
 ds_read_b64_tr_b16 v[156:157], v9 offset:64
 ds_read_b64_tr_b16 v[158:159], v9 offset:2368
 v_mfma_f32_32x32x16_bf16 v[112:127], v[172:175], v[164:167], v[112:127]
 s_waitcnt lgkmcnt(3)
 v_mfma_f32_32x32x16_bf16 v[64:79], v[152:155], v[144:147], v[64:79]
 ds_read_b128 v[160:163], v11 offset:512
 ds_read_b64_tr_b16 v[168:169], v9 offset:4608
 s_waitcnt lgkmcnt(4)
 v_mfma_f32_32x32x16_bf16 v[80:95], v[152:155], v[148:151], v[80:95]
 ds_read_b64_tr_b16 v[170:171], v9 offset:6912
 ds_read_b128 v[164:167], v11 offset:4608
 s_waitcnt lgkmcnt(4)
 v_mfma_f32_32x32x16_bf16 v[96:111], v[156:159], v[144:147], v[96:111]
 ds_read_b64_tr_b16 v[172:173], v9 offset:4672
 ds_read_b64_tr_b16 v[174:175], v9 offset:6976
 v_mfma_f32_32x32x16_bf16 v[112:127], v[156:159], v[148:151], v[112:127]
 ds_read_b64_tr_b16 v[192:193], v10 offset:0
 ds_read_b64_tr_b16 v[194:195], v10 offset:2304
 ds_read_b128 v[176:179], v8 offset:0
 ds_read_b128 v[180:183], v8 offset:2048
 ds_read_b128 v[184:187], v8 offset:4096
 ds_read_b128 v[188:191], v8 offset:6144
 s_waitcnt lgkmcnt(9)
 v_mfma_f32_32x32x16_bf16 v[64:79], v[168:171], v[160:163], v[64:79]
 ds_read_b128 v[144:147], v11 offset:1024
 ds_read_b64_tr_b16 v[152:153], v9 offset:9216
 s_waitcnt lgkmcnt(10)
 v_mfma_f32_32x32x16_bf16 v[80:95], v[168:171], v[164:167], v[80:95]
 ds_read_b64_tr_b16 v[154:155], v9 offset:11520
 ds_read_b128 v[148:151], v11 offset:5120
 s_waitcnt lgkmcnt(10)
 v_mfma_f32_32x32x16_bf16 v[96:111], v[172:175], v[160:163], v[96:111]
 ds_read_b64_tr_b16 v[156:157], v9 offset:9280
 ds_read_b64_tr_b16 v[158:159], v9 offset:11584
 v_mfma_f32_32x32x16_bf16 v[112:127], v[172:175], v[164:167], v[112:127]
 s_waitcnt lgkmcnt(6)
 v_mfma_f32_16x16x32_bf16 v[128:131], v[192:195], v[176:179], v[128:131]
 v_mfma_f32_16x16x32_bf16 v[132:135], v[192:195], v[180:183], v[132:135]
 v_mfma_f32_16x16x32_bf16 v[136:139], v[192:195], v[184:187], v[136:139]
 v_mfma_f32_16x16x32_bf16 v[140:143], v[192:195], v[188:191], v[140:143]
 s_waitcnt lgkmcnt(3)
 v_mfma_f32_32x32x16_bf16 v[64:79], v[152:155], v[144:147], v[64:79]
 ds_read_b128 v[160:163], v11 offset:1536
 ds_read_b64_tr_b16 v[168:169], v9 offset:13824
 s_waitcnt lgkmcnt(4)
 v_mfma_f32_32x32x16_bf16 v[80:95], v[152:155], v[148:151], v[80:95]
 ds_read_b64_tr_b16 v[170:171], v9 offset:16128
 ds_read_b128 v[164:167], v11 offset:5632
 s_waitcnt lgkmcnt(4)
 v_mfma_f32_32x32x16_bf16 v[96:111], v[156:159], v[144:147], v[96:111]
 ds_read_b64_tr_b16 v[172:173], v9 offset:13888
 ds_read_b64_tr_b16 v[174:175], v9 offset:16192
 v_mfma_f32_32x32x16_bf16 v[112:127], v[156:159], v[148:151], v[112:127]
 v_mov_b32 v18, 17
 s_waitcnt vmcnt(0) lgkmcnt(0)
 ds_write_b32 v23, v18
 v_mfma_f32_32x32x16_bf16 v[64:79], v[168:171], v[160:163], v[64:79]
 ds_read_b128 v[18:21], v24
 v_add_u32 v11, 16384, v5
 v_add_u32 v9, 89088, v3
 v_add_u32 v8, 16384, v2
 v_add_u32 v10, 89088, v4
 v_mfma_f32_32x32x16_bf16 v[80:95], v[168:171], v[164:167], v[80:95]
 s_waitcnt lgkmcnt(0)
 v_min3_u32 v18, v18, v19, v20
 v_min_u32 v18, v18, v21
 v_cmp_gt_u32 vcc, 17, v18
 s_nop 0
 s_cbranch_vccnz L_fz_p4gb0_17s
L_fz_p4gb0_17r:
 ds_read_b128 v[144:147], v11 offset:0
 ds_read_b64_tr_b16 v[152:153], v9 offset:0
 ds_read_b64_tr_b16 v[154:155], v9 offset:2304
 v_mfma_f32_32x32x16_bf16 v[96:111], v[172:175], v[160:163], v[96:111]
 ds_read_b128 v[148:151], v11 offset:4096
 ds_read_b64_tr_b16 v[156:157], v9 offset:64
 ds_read_b64_tr_b16 v[158:159], v9 offset:2368
 v_mfma_f32_32x32x16_bf16 v[112:127], v[172:175], v[164:167], v[112:127]
 s_waitcnt lgkmcnt(3)
 v_mfma_f32_32x32x16_bf16 v[64:79], v[152:155], v[144:147], v[64:79]
 ds_read_b128 v[160:163], v11 offset:512
 ds_read_b64_tr_b16 v[168:169], v9 offset:4608
 s_waitcnt lgkmcnt(4)
 v_mfma_f32_32x32x16_bf16 v[80:95], v[152:155], v[148:151], v[80:95]
 ds_read_b64_tr_b16 v[170:171], v9 offset:6912
 ds_read_b128 v[164:167], v11 offset:4608
 s_waitcnt lgkmcnt(4)
 v_mfma_f32_32x32x16_bf16 v[96:111], v[156:159], v[144:147], v[96:111]
 ds_read_b64_tr_b16 v[172:173], v9 offset:4672
 ds_read_b64_tr_b16 v[174:175], v9 offset:6976
 v_mfma_f32_32x32x16_bf16 v[112:127], v[156:159], v[148:151], v[112:127]
 ds_read_b64_tr_b16 v[192:193], v10 offset:0
 ds_read_b64_tr_b16 v[194:195], v10 offset:2304
 ds_read_b128 v[176:179], v8 offset:0
 ds_read_b128 v[180:183], v8 offset:2048
 ds_read_b128 v[184:187], v8 offset:4096
 ds_read_b128 v[188:191], v8 offset:6144
 s_waitcnt lgkmcnt(9)
 v_mfma_f32_32x32x16_bf16 v[64:79], v[168:171], v[160:163], v[64:79]
 ds_read_b128 v[144:147], v11 offset:1024
 ds_read_b64_tr_b16 v[152:153], v9 offset:9216
 s_waitcnt lgkmcnt(10)
 v_mfma_f32_32x32x16_bf16 v[80:95], v[168:171], v[164:167], v[80:95]
 ds_read_b64_tr_b16 v[154:155], v9 offset:11520
 ds_read_b128 v[148:151], v11 offset:5120
 s_waitcnt lgkmcnt(10)
 v_mfma_f32_32x32x16_bf16 v[96:111], v[172:175], v[160:163], v[96:111]
 ds_read_b64_tr_b16 v[156:157], v9 offset:9280
 ds_read_b64_tr_b16 v[158:159], v9 offset:11584
 v_mfma_f32_32x32x16_bf16 v[112:127], v[172:175], v[164:167], v[112:127]
 s_waitcnt lgkmcnt(6)
 v_mfma_f32_16x16x32_bf16 v[128:131], v[192:195], v[176:179], v[128:131]
 v_mfma_f32_16x16x32_bf16 v[132:135], v[192:195], v[180:183], v[132:135]
 v_mfma_f32_16x16x32_bf16 v[136:139], v[192:195], v[184:187], v[136:139]
 v_mfma_f32_16x16x32_bf16 v[140:143], v[192:195], v[188:191], v[140:143]
 s_waitcnt lgkmcnt(3)
 v_mfma_f32_32x32x16_bf16 v[64:79], v[152:155], v[144:147], v[64:79]
 ds_read_b128 v[160:163], v11 offset:1536
 ds_read_b64_tr_b16 v[168:169], v9 offset:13824
 s_waitcnt lgkmcnt(4)
 v_mfma_f32_32x32x16_bf16 v[80:95], v[152:155], v[148:151], v[80:95]
 ds_read_b64_tr_b16 v[170:171], v9 offset:16128
 ds_read_b128 v[164:167], v11 offset:5632
 s_waitcnt lgkmcnt(4)
 v_mfma_f32_32x32x16_bf16 v[96:111], v[156:159], v[144:147], v[96:111]
 ds_read_b64_tr_b16 v[172:173], v9 offset:13888
 ds_read_b64_tr_b16 v[174:175], v9 offset:16192
 v_mfma_f32_32x32x16_bf16 v[112:127], v[156:159], v[148:151], v[112:127]
 s_waitcnt lgkmcnt(0)
 v_mfma_f32_32x32x16_bf16 v[64:79], v[168:171], v[160:163], v[64:79]
 v_mfma_f32_32x32x16_bf16 v[80:95], v[168:171], v[164:167], v[80:95]
 v_mfma_f32_32x32x16_bf16 v[96:111], v[172:175], v[160:163], v[96:111]
 v_mfma_f32_32x32x16_bf16 v[112:127], v[172:175], v[164:167], v[112:127]
 v_lshrrev_b32 v14, 3, v0
 v_and_b32 v15, 7, v0
 v_xor_b32 v15, v15, v14
 v_lshlrev_b32 v15, 4, v15
 v_lshl_add_u32 v2, v14, 12, v15
 s_lshl_b32 s46, s32, 17
 v_add_u32 v4, s46, v2
 v_add_u32 v5, 0x8000, v4
 v_add_u32 v6, 0x10000, v4
 v_add_u32 v7, 0x18000, v4
 s_lshl_b32 s46, s33, 19
 s_add_u32 s12, s74, s46
 s_addc_u32 s13, s75, 0
 s_mov_b32 s14, 524288
 s_mov_b32 s15, 0x20000
 s_movk_i32 s42, 0
 s_add_u32 m0, s48, 32768
 s_nop 0
 buffer_load_dwordx4 v4, s[12:15], s42 offen lds
 s_add_u32 m0, s48, 33792
 s_nop 0
 buffer_load_dwordx4 v5, s[12:15], s42 offen lds
 s_add_u32 m0, s48, 34816
 s_nop 0
 buffer_load_dwordx4 v6, s[12:15], s42 offen lds
 s_add_u32 m0, s48, 35840
 s_nop 0
 buffer_load_dwordx4 v7, s[12:15], s42 offen lds
 s_add_u32 s46, s32, s39
 s_lshl_b32 s46, s46, 17
 v_add_u32 v8, s46, v1
 v_lshrrev_b32 v14, 5, v0
 v_and_b32 v15, 31, v0
 v_lshlrev_b32 v15, 4, v15
 v_lshl_add_u32 v9, v14, 10, v15
 s_movk_i32 s47, 512
 s_cmp_eq_u32 s39, 0
 s_cselect_b32 s46, 524288, s47
 s_lshl_b32 s47, s44, 11
 s_add_u32 s46, s46, s47
 v_add_u32 v9, s46, v9
 s_lshl_b32 s46, s38, 17
 s_add_u32 s46, s46, 27262976
 s_add_u32 s16, s8, s46
 s_addc_u32 s17, s9, 0
 s_mov_b32 s18, 655360
 s_mov_b32 s19, 0x20000
 s_lshl_b32 s49, s32, 11
 s_add_u32 s49, s49, 16384
 s_mul_i32 s53, s44, 9216
 s_add_u32 s53, s53, 24576
 s_lshl_b32 s36, s44, 14
 s_add_u32 s36, s36, 65536
 v_add_u32 v25, s36, v1
 v_xor_b32 v26, 2048, v25
 s_mul_i32 s46, s32, 9216
 s_add_u32 s46, s46, 123904
 v_add_u32 v22, s46, v1
 v_bfe_u32 v16, v0, 4, 1
 v_and_b32 v17, 15, v0
 v_lshlrev_b32 v17, 4, v17
 v_lshl_add_u32 v17, v16, 11, v17
 v_lshl_add_u32 v17, v14, 9, v17
 v_add_u32 v27, s46, v17
 v_mov_b32 v10, 79872
 v_mov_b32 v18, 18
 ds_write_b128 v25, v[136:139] offset:0
 ds_write_b128 v25, v[140:143] offset:1024
 ds_write_b32 v23, v18
 v_pk_fma_f32 v[64:65], v[48:49], v[196:197], v[64:65] op_sel_hi:[0,1,1] neg_lo:[1,0,0] neg_hi:[1,0,0]
 v_pk_fma_f32 v[66:67], v[48:49], v[198:199], v[66:67] op_sel_hi:[0,1,1] neg_lo:[1,0,0] neg_hi:[1,0,0]
 v_pk_fma_f32 v[68:69], v[48:49], v[200:201], v[68:69] op_sel_hi:[0,1,1] neg_lo:[1,0,0] neg_hi:[1,0,0]
 v_pk_fma_f32 v[70:71], v[48:49], v[202:203], v[70:71] op_sel_hi:[0,1,1] neg_lo:[1,0,0] neg_hi:[1,0,0]
 v_pk_fma_f32 v[72:73], v[48:49], v[204:205], v[72:73] op_sel_hi:[0,1,1] neg_lo:[1,0,0] neg_hi:[1,0,0]
 v_pk_fma_f32 v[74:75], v[48:49], v[206:207], v[74:75] op_sel_hi:[0,1,1] neg_lo:[1,0,0] neg_hi:[1,0,0]
 v_pk_fma_f32 v[76:77], v[48:49], v[208:209], v[76:77] op_sel_hi:[0,1,1] neg_lo:[1,0,0] neg_hi:[1,0,0]
 v_pk_fma_f32 v[78:79], v[48:49], v[210:211], v[78:79] op_sel_hi:[0,1,1] neg_lo:[1,0,0] neg_hi:[1,0,0]
 v_pk_mul_f32 v[144:145], v[64:65], v[64:65]
 v_pk_mul_f32 v[146:147], v[66:67], v[66:67]
 v_pk_mul_f32 v[148:149], v[68:69], v[68:69]
 v_pk_mul_f32 v[150:151], v[70:71], v[70:71]
 v_pk_mul_f32 v[152:153], v[72:73], v[72:73]
 v_pk_mul_f32 v[154:155], v[74:75], v[74:75]
 v_pk_mul_f32 v[156:157], v[76:77], v[76:77]
 v_pk_mul_f32 v[158:159], v[78:79], v[78:79]
 v_pk_fma_f32 v[144:145], v[144:145], v[52:53], v[52:53] op_sel:[0,1,0] op_sel_hi:[1,1,0]
 v_pk_fma_f32 v[146:147], v[146:147], v[52:53], v[52:53] op_sel:[0,1,0] op_sel_hi:[1,1,0]
 v_pk_fma_f32 v[148:149], v[148:149], v[52:53], v[52:53] op_sel:[0,1,0] op_sel_hi:[1,1,0]
 v_pk_fma_f32 v[150:151], v[150:151], v[52:53], v[52:53] op_sel:[0,1,0] op_sel_hi:[1,1,0]
 v_pk_fma_f32 v[152:153], v[152:153], v[52:53], v[52:53] op_sel:[0,1,0] op_sel_hi:[1,1,0]
 v_pk_fma_f32 v[154:155], v[154:155], v[52:53], v[52:53] op_sel:[0,1,0] op_sel_hi:[1,1,0]
 v_pk_fma_f32 v[156:157], v[156:157], v[52:53], v[52:53] op_sel:[0,1,0] op_sel_hi:[1,1,0]
 v_pk_fma_f32 v[158:159], v[158:159], v[52:53], v[52:53] op_sel:[0,1,0] op_sel_hi:[1,1,0]
 v_pk_mul_f32 v[144:145], v[144:145], v[64:65]
 v_pk_mul_f32 v[146:147], v[146:147], v[66:67]
 v_pk_mul_f32 v[148:149], v[148:149], v[68:69]
 v_pk_mul_f32 v[150:151], v[150:151], v[70:71]
 v_pk_mul_f32 v[152:153], v[152:153], v[72:73]
 v_pk_mul_f32 v[154:155], v[154:155], v[74:75]
 v_pk_mul_f32 v[156:157], v[156:157], v[76:77]
 v_pk_mul_f32 v[158:159], v[158:159], v[78:79]
 v_exp_f32 v144, v144
 v_exp_f32 v145, v145
 v_exp_f32 v146, v146
 v_exp_f32 v147, v147
 v_exp_f32 v148, v148
 v_exp_f32 v149, v149
 v_exp_f32 v150, v150
 v_exp_f32 v151, v151
 v_exp_f32 v152, v152
 v_exp_f32 v153, v153
 v_exp_f32 v154, v154
 v_exp_f32 v155, v155
 v_exp_f32 v156, v156
 v_exp_f32 v157, v157
 v_exp_f32 v158, v158
 v_exp_f32 v159, v159
 v_pk_add_f32 v[144:145], v[144:145], 1.0 op_sel_hi:[1,0]
 v_pk_add_f32 v[146:147], v[146:147], 1.0 op_sel_hi:[1,0]
 v_pk_add_f32 v[148:149], v[148:149], 1.0 op_sel_hi:[1,0]
 v_pk_add_f32 v[150:151], v[150:151], 1.0 op_sel_hi:[1,0]
 v_pk_add_f32 v[152:153], v[152:153], 1.0 op_sel_hi:[1,0]
 v_pk_add_f32 v[154:155], v[154:155], 1.0 op_sel_hi:[1,0]
 v_pk_add_f32 v[156:157], v[156:157], 1.0 op_sel_hi:[1,0]
 v_pk_add_f32 v[158:159], v[158:159], 1.0 op_sel_hi:[1,0]
 v_rcp_f32 v144, v144
 v_rcp_f32 v145, v145
 v_rcp_f32 v146, v146
 v_rcp_f32 v147, v147
 v_rcp_f32 v148, v148
 v_rcp_f32 v149, v149
 v_rcp_f32 v150, v150
 v_rcp_f32 v151, v151
 v_rcp_f32 v152, v152
 v_rcp_f32 v153, v153
 v_rcp_f32 v154, v154
 v_rcp_f32 v155, v155
 v_rcp_f32 v156, v156
 v_rcp_f32 v157, v157
 v_rcp_f32 v158, v158
 v_rcp_f32 v159, v159
 v_pk_mul_f32 v[64:65], v[64:65], v[144:145]
 v_pk_mul_f32 v[66:67], v[66:67], v[146:147]
 v_pk_mul_f32 v[68:69], v[68:69], v[148:149]
 v_pk_mul_f32 v[70:71], v[70:71], v[150:151]
 v_pk_mul_f32 v[72:73], v[72:73], v[152:153]
 v_pk_mul_f32 v[74:75], v[74:75], v[154:155]
 v_pk_mul_f32 v[76:77], v[76:77], v[156:157]
 v_pk_mul_f32 v[78:79], v[78:79], v[158:159]
 v_cvt_pk_bf16_f32 v64, v64, v65
 v_cvt_pk_bf16_f32 v65, v66, v67
 v_cvt_pk_bf16_f32 v66, v68, v69
 v_cvt_pk_bf16_f32 v67, v70, v71
 v_cvt_pk_bf16_f32 v68, v72, v73
 v_cvt_pk_bf16_f32 v69, v74, v75
 v_cvt_pk_bf16_f32 v70, v76, v77
 v_cvt_pk_bf16_f32 v71, v78, v79
 v_pk_fma_f32 v[80:81], v[48:49], v[196:197], v[80:81] op_sel:[1,0,0] op_sel_hi:[1,1,1] neg_lo:[1,0,0] neg_hi:[1,0,0]
 v_pk_fma_f32 v[82:83], v[48:49], v[198:199], v[82:83] op_sel:[1,0,0] op_sel_hi:[1,1,1] neg_lo:[1,0,0] neg_hi:[1,0,0]
 v_pk_fma_f32 v[84:85], v[48:49], v[200:201], v[84:85] op_sel:[1,0,0] op_sel_hi:[1,1,1] neg_lo:[1,0,0] neg_hi:[1,0,0]
 v_pk_fma_f32 v[86:87], v[48:49], v[202:203], v[86:87] op_sel:[1,0,0] op_sel_hi:[1,1,1] neg_lo:[1,0,0] neg_hi:[1,0,0]
 v_pk_fma_f32 v[88:89], v[48:49], v[204:205], v[88:89] op_sel:[1,0,0] op_sel_hi:[1,1,1] neg_lo:[1,0,0] neg_hi:[1,0,0]
 v_pk_fma_f32 v[90:91], v[48:49], v[206:207], v[90:91] op_sel:[1,0,0] op_sel_hi:[1,1,1] neg_lo:[1,0,0] neg_hi:[1,0,0]
 v_pk_fma_f32 v[92:93], v[48:49], v[208:209], v[92:93] op_sel:[1,0,0] op_sel_hi:[1,1,1] neg_lo:[1,0,0] neg_hi:[1,0,0]
 v_pk_fma_f32 v[94:95], v[48:49], v[210:211], v[94:95] op_sel:[1,0,0] op_sel_hi:[1,1,1] neg_lo:[1,0,0] neg_hi:[1,0,0]
 v_pk_mul_f32 v[144:145], v[80:81], v[80:81]
 v_pk_mul_f32 v[146:147], v[82:83], v[82:83]
 v_pk_mul_f32 v[148:149], v[84:85], v[84:85]
 v_pk_mul_f32 v[150:151], v[86:87], v[86:87]
 v_pk_mul_f32 v[152:153], v[88:89], v[88:89]
 v_pk_mul_f32 v[154:155], v[90:91], v[90:91]
 v_pk_mul_f32 v[156:157], v[92:93], v[92:93]
 v_pk_mul_f32 v[158:159], v[94:95], v[94:95]
 v_pk_fma_f32 v[144:145], v[144:145], v[54:55], v[54:55] op_sel:[0,1,0] op_sel_hi:[1,1,0]
 v_pk_fma_f32 v[146:147], v[146:147], v[54:55], v[54:55] op_sel:[0,1,0] op_sel_hi:[1,1,0]
 v_pk_fma_f32 v[148:149], v[148:149], v[54:55], v[54:55] op_sel:[0,1,0] op_sel_hi:[1,1,0]
 v_pk_fma_f32 v[150:151], v[150:151], v[54:55], v[54:55] op_sel:[0,1,0] op_sel_hi:[1,1,0]
 v_pk_fma_f32 v[152:153], v[152:153], v[54:55], v[54:55] op_sel:[0,1,0] op_sel_hi:[1,1,0]
 v_pk_fma_f32 v[154:155], v[154:155], v[54:55], v[54:55] op_sel:[0,1,0] op_sel_hi:[1,1,0]
 v_pk_fma_f32 v[156:157], v[156:157], v[54:55], v[54:55] op_sel:[0,1,0] op_sel_hi:[1,1,0]
 v_pk_fma_f32 v[158:159], v[158:159], v[54:55], v[54:55] op_sel:[0,1,0] op_sel_hi:[1,1,0]
 v_pk_mul_f32 v[144:145], v[144:145], v[80:81]
 v_pk_mul_f32 v[146:147], v[146:147], v[82:83]
 v_pk_mul_f32 v[148:149], v[148:149], v[84:85]
 v_pk_mul_f32 v[150:151], v[150:151], v[86:87]
 v_pk_mul_f32 v[152:153], v[152:153], v[88:89]
 v_pk_mul_f32 v[154:155], v[154:155], v[90:91]
 v_pk_mul_f32 v[156:157], v[156:157], v[92:93]
 v_pk_mul_f32 v[158:159], v[158:159], v[94:95]
 v_exp_f32 v144, v144
 v_exp_f32 v145, v145
 v_exp_f32 v146, v146
 v_exp_f32 v147, v147
 v_exp_f32 v148, v148
 v_exp_f32 v149, v149
 v_exp_f32 v150, v150
 v_exp_f32 v151, v151
 v_exp_f32 v152, v152
 v_exp_f32 v153, v153
 v_exp_f32 v154, v154
 v_exp_f32 v155, v155
 v_exp_f32 v156, v156
 v_exp_f32 v157, v157
 v_exp_f32 v158, v158
 v_exp_f32 v159, v159
 v_pk_add_f32 v[144:145], v[144:145], 1.0 op_sel_hi:[1,0]
 v_pk_add_f32 v[146:147], v[146:147], 1.0 op_sel_hi:[1,0]
 v_pk_add_f32 v[148:149], v[148:149], 1.0 op_sel_hi:[1,0]
 v_pk_add_f32 v[150:151], v[150:151], 1.0 op_sel_hi:[1,0]
 v_pk_add_f32 v[152:153], v[152:153], 1.0 op_sel_hi:[1,0]
 v_pk_add_f32 v[154:155], v[154:155], 1.0 op_sel_hi:[1,0]
 v_pk_add_f32 v[156:157], v[156:157], 1.0 op_sel_hi:[1,0]
 v_pk_add_f32 v[158:159], v[158:159], 1.0 op_sel_hi:[1,0]
 v_rcp_f32 v144, v144
 v_rcp_f32 v145, v145
 v_rcp_f32 v146, v146
 v_rcp_f32 v147, v147
 v_rcp_f32 v148, v148
 v_rcp_f32 v149, v149
 v_rcp_f32 v150, v150
 v_rcp_f32 v151, v151
 v_rcp_f32 v152, v152
 v_rcp_f32 v153, v153
 v_rcp_f32 v154, v154
 v_rcp_f32 v155, v155
 v_rcp_f32 v156, v156
 v_rcp_f32 v157, v157
 v_rcp_f32 v158, v158
 v_rcp_f32 v159, v159
 v_pk_mul_f32 v[80:81], v[80:81], v[144:145]
 v_pk_mul_f32 v[82:83], v[82:83], v[146:147]
 v_pk_mul_f32 v[84:85], v[84:85], v[148:149]
 v_pk_mul_f32 v[86:87], v[86:87], v[150:151]
 v_pk_mul_f32 v[88:89], v[88:89], v[152:153]
 v_pk_mul_f32 v[90:91], v[90:91], v[154:155]
 v_pk_mul_f32 v[92:93], v[92:93], v[156:157]
 v_pk_mul_f32 v[94:95], v[94:95], v[158:159]
 v_cvt_pk_bf16_f32 v80, v80, v81
 v_cvt_pk_bf16_f32 v81, v82, v83
 v_cvt_pk_bf16_f32 v82, v84, v85
 v_cvt_pk_bf16_f32 v83, v86, v87
 v_cvt_pk_bf16_f32 v84, v88, v89
 v_cvt_pk_bf16_f32 v85, v90, v91
 v_cvt_pk_bf16_f32 v86, v92, v93
 v_cvt_pk_bf16_f32 v87, v94, v95
 v_pk_fma_f32 v[96:97], v[48:49], v[212:213], v[96:97] op_sel_hi:[0,1,1] neg_lo:[1,0,0] neg_hi:[1,0,0]
 v_pk_fma_f32 v[98:99], v[48:49], v[214:215], v[98:99] op_sel_hi:[0,1,1] neg_lo:[1,0,0] neg_hi:[1,0,0]
 v_pk_fma_f32 v[100:101], v[48:49], v[216:217], v[100:101] op_sel_hi:[0,1,1] neg_lo:[1,0,0] neg_hi:[1,0,0]
 v_pk_fma_f32 v[102:103], v[48:49], v[218:219], v[102:103] op_sel_hi:[0,1,1] neg_lo:[1,0,0] neg_hi:[1,0,0]
 v_pk_fma_f32 v[104:105], v[48:49], v[220:221], v[104:105] op_sel_hi:[0,1,1] neg_lo:[1,0,0] neg_hi:[1,0,0]
 v_pk_fma_f32 v[106:107], v[48:49], v[222:223], v[106:107] op_sel_hi:[0,1,1] neg_lo:[1,0,0] neg_hi:[1,0,0]
 v_pk_fma_f32 v[108:109], v[48:49], v[224:225], v[108:109] op_sel_hi:[0,1,1] neg_lo:[1,0,0] neg_hi:[1,0,0]
 v_pk_fma_f32 v[110:111], v[48:49], v[226:227], v[110:111] op_sel_hi:[0,1,1] neg_lo:[1,0,0] neg_hi:[1,0,0]
 v_pk_mul_f32 v[144:145], v[96:97], v[96:97]
 v_pk_mul_f32 v[146:147], v[98:99], v[98:99]
 v_pk_mul_f32 v[148:149], v[100:101], v[100:101]
 v_pk_mul_f32 v[150:151], v[102:103], v[102:103]
 v_pk_mul_f32 v[152:153], v[104:105], v[104:105]
 v_pk_mul_f32 v[154:155], v[106:107], v[106:107]
 v_pk_mul_f32 v[156:157], v[108:109], v[108:109]
 v_pk_mul_f32 v[158:159], v[110:111], v[110:111]
 v_pk_fma_f32 v[144:145], v[144:145], v[52:53], v[52:53] op_sel:[0,1,0] op_sel_hi:[1,1,0]
 v_pk_fma_f32 v[146:147], v[146:147], v[52:53], v[52:53] op_sel:[0,1,0] op_sel_hi:[1,1,0]
 v_pk_fma_f32 v[148:149], v[148:149], v[52:53], v[52:53] op_sel:[0,1,0] op_sel_hi:[1,1,0]
 v_pk_fma_f32 v[150:151], v[150:151], v[52:53], v[52:53] op_sel:[0,1,0] op_sel_hi:[1,1,0]
 v_pk_fma_f32 v[152:153], v[152:153], v[52:53], v[52:53] op_sel:[0,1,0] op_sel_hi:[1,1,0]
 v_pk_fma_f32 v[154:155], v[154:155], v[52:53], v[52:53] op_sel:[0,1,0] op_sel_hi:[1,1,0]
 v_pk_fma_f32 v[156:157], v[156:157], v[52:53], v[52:53] op_sel:[0,1,0] op_sel_hi:[1,1,0]
 v_pk_fma_f32 v[158:159], v[158:159], v[52:53], v[52:53] op_sel:[0,1,0] op_sel_hi:[1,1,0]
 v_pk_mul_f32 v[144:145], v[144:145], v[96:97]
 v_pk_mul_f32 v[146:147], v[146:147], v[98:99]
 v_pk_mul_f32 v[148:149], v[148:149], v[100:101]
 v_pk_mul_f32 v[150:151], v[150:151], v[102:103]
 v_pk_mul_f32 v[152:153], v[152:153], v[104:105]
 v_pk_mul_f32 v[154:155], v[154:155], v[106:107]
 v_pk_mul_f32 v[156:157], v[156:157], v[108:109]
 v_pk_mul_f32 v[158:159], v[158:159], v[110:111]
 v_exp_f32 v144, v144
 v_exp_f32 v145, v145
 v_exp_f32 v146, v146
 v_exp_f32 v147, v147
 v_exp_f32 v148, v148
 v_exp_f32 v149, v149
 v_exp_f32 v150, v150
 v_exp_f32 v151, v151
 v_exp_f32 v152, v152
 v_exp_f32 v153, v153
 v_exp_f32 v154, v154
 v_exp_f32 v155, v155
 v_exp_f32 v156, v156
 v_exp_f32 v157, v157
 v_exp_f32 v158, v158
 v_exp_f32 v159, v159
 v_pk_add_f32 v[144:145], v[144:145], 1.0 op_sel_hi:[1,0]
 v_pk_add_f32 v[146:147], v[146:147], 1.0 op_sel_hi:[1,0]
 v_pk_add_f32 v[148:149], v[148:149], 1.0 op_sel_hi:[1,0]
 v_pk_add_f32 v[150:151], v[150:151], 1.0 op_sel_hi:[1,0]
 v_pk_add_f32 v[152:153], v[152:153], 1.0 op_sel_hi:[1,0]
 v_pk_add_f32 v[154:155], v[154:155], 1.0 op_sel_hi:[1,0]
 v_pk_add_f32 v[156:157], v[156:157], 1.0 op_sel_hi:[1,0]
 v_pk_add_f32 v[158:159], v[158:159], 1.0 op_sel_hi:[1,0]
 v_rcp_f32 v144, v144
 v_rcp_f32 v145, v145
 v_rcp_f32 v146, v146
 v_rcp_f32 v147, v147
 v_rcp_f32 v148, v148
 v_rcp_f32 v149, v149
 v_rcp_f32 v150, v150
 v_rcp_f32 v151, v151
 v_rcp_f32 v152, v152
 v_rcp_f32 v153, v153
 v_rcp_f32 v154, v154
 v_rcp_f32 v155, v155
 v_rcp_f32 v156, v156
 v_rcp_f32 v157, v157
 v_rcp_f32 v158, v158
 v_rcp_f32 v159, v159
 v_pk_mul_f32 v[96:97], v[96:97], v[144:145]
 v_pk_mul_f32 v[98:99], v[98:99], v[146:147]
 v_pk_mul_f32 v[100:101], v[100:101], v[148:149]
 v_pk_mul_f32 v[102:103], v[102:103], v[150:151]
 v_pk_mul_f32 v[104:105], v[104:105], v[152:153]
 v_pk_mul_f32 v[106:107], v[106:107], v[154:155]
 v_pk_mul_f32 v[108:109], v[108:109], v[156:157]
 v_pk_mul_f32 v[110:111], v[110:111], v[158:159]
 v_cvt_pk_bf16_f32 v96, v96, v97
 v_cvt_pk_bf16_f32 v97, v98, v99
 v_cvt_pk_bf16_f32 v98, v100, v101
 v_cvt_pk_bf16_f32 v99, v102, v103
 v_cvt_pk_bf16_f32 v100, v104, v105
 v_cvt_pk_bf16_f32 v101, v106, v107
 v_cvt_pk_bf16_f32 v102, v108, v109
 v_cvt_pk_bf16_f32 v103, v110, v111
 v_pk_fma_f32 v[112:113], v[48:49], v[212:213], v[112:113] op_sel:[1,0,0] op_sel_hi:[1,1,1] neg_lo:[1,0,0] neg_hi:[1,0,0]
 v_pk_fma_f32 v[114:115], v[48:49], v[214:215], v[114:115] op_sel:[1,0,0] op_sel_hi:[1,1,1] neg_lo:[1,0,0] neg_hi:[1,0,0]
 v_pk_fma_f32 v[116:117], v[48:49], v[216:217], v[116:117] op_sel:[1,0,0] op_sel_hi:[1,1,1] neg_lo:[1,0,0] neg_hi:[1,0,0]
 v_pk_fma_f32 v[118:119], v[48:49], v[218:219], v[118:119] op_sel:[1,0,0] op_sel_hi:[1,1,1] neg_lo:[1,0,0] neg_hi:[1,0,0]
 v_pk_fma_f32 v[120:121], v[48:49], v[220:221], v[120:121] op_sel:[1,0,0] op_sel_hi:[1,1,1] neg_lo:[1,0,0] neg_hi:[1,0,0]
 v_pk_fma_f32 v[122:123], v[48:49], v[222:223], v[122:123] op_sel:[1,0,0] op_sel_hi:[1,1,1] neg_lo:[1,0,0] neg_hi:[1,0,0]
 v_pk_fma_f32 v[124:125], v[48:49], v[224:225], v[124:125] op_sel:[1,0,0] op_sel_hi:[1,1,1] neg_lo:[1,0,0] neg_hi:[1,0,0]
 v_pk_fma_f32 v[126:127], v[48:49], v[226:227], v[126:127] op_sel:[1,0,0] op_sel_hi:[1,1,1] neg_lo:[1,0,0] neg_hi:[1,0,0]
 v_pk_mul_f32 v[144:145], v[112:113], v[112:113]
 v_pk_mul_f32 v[146:147], v[114:115], v[114:115]
 v_pk_mul_f32 v[148:149], v[116:117], v[116:117]
 v_pk_mul_f32 v[150:151], v[118:119], v[118:119]
 v_pk_mul_f32 v[152:153], v[120:121], v[120:121]
 v_pk_mul_f32 v[154:155], v[122:123], v[122:123]
 v_pk_mul_f32 v[156:157], v[124:125], v[124:125]
 v_pk_mul_f32 v[158:159], v[126:127], v[126:127]
 v_pk_fma_f32 v[144:145], v[144:145], v[54:55], v[54:55] op_sel:[0,1,0] op_sel_hi:[1,1,0]
 v_pk_fma_f32 v[146:147], v[146:147], v[54:55], v[54:55] op_sel:[0,1,0] op_sel_hi:[1,1,0]
 v_pk_fma_f32 v[148:149], v[148:149], v[54:55], v[54:55] op_sel:[0,1,0] op_sel_hi:[1,1,0]
 v_pk_fma_f32 v[150:151], v[150:151], v[54:55], v[54:55] op_sel:[0,1,0] op_sel_hi:[1,1,0]
 v_pk_fma_f32 v[152:153], v[152:153], v[54:55], v[54:55] op_sel:[0,1,0] op_sel_hi:[1,1,0]
 v_pk_fma_f32 v[154:155], v[154:155], v[54:55], v[54:55] op_sel:[0,1,0] op_sel_hi:[1,1,0]
 v_pk_fma_f32 v[156:157], v[156:157], v[54:55], v[54:55] op_sel:[0,1,0] op_sel_hi:[1,1,0]
 v_pk_fma_f32 v[158:159], v[158:159], v[54:55], v[54:55] op_sel:[0,1,0] op_sel_hi:[1,1,0]
 v_pk_mul_f32 v[144:145], v[144:145], v[112:113]
 v_pk_mul_f32 v[146:147], v[146:147], v[114:115]
 v_pk_mul_f32 v[148:149], v[148:149], v[116:117]
 v_pk_mul_f32 v[150:151], v[150:151], v[118:119]
 v_pk_mul_f32 v[152:153], v[152:153], v[120:121]
 v_pk_mul_f32 v[154:155], v[154:155], v[122:123]
 v_pk_mul_f32 v[156:157], v[156:157], v[124:125]
 v_pk_mul_f32 v[158:159], v[158:159], v[126:127]
 v_exp_f32 v144, v144
 v_exp_f32 v145, v145
 v_exp_f32 v146, v146
 v_exp_f32 v147, v147
 v_exp_f32 v148, v148
 v_exp_f32 v149, v149
 v_exp_f32 v150, v150
 v_exp_f32 v151, v151
 v_exp_f32 v152, v152
 v_exp_f32 v153, v153
 v_exp_f32 v154, v154
 v_exp_f32 v155, v155
 v_exp_f32 v156, v156
 v_exp_f32 v157, v157
 v_exp_f32 v158, v158
 v_exp_f32 v159, v159
 v_pk_add_f32 v[144:145], v[144:145], 1.0 op_sel_hi:[1,0]
 v_pk_add_f32 v[146:147], v[146:147], 1.0 op_sel_hi:[1,0]
 v_pk_add_f32 v[148:149], v[148:149], 1.0 op_sel_hi:[1,0]
 v_pk_add_f32 v[150:151], v[150:151], 1.0 op_sel_hi:[1,0]
 v_pk_add_f32 v[152:153], v[152:153], 1.0 op_sel_hi:[1,0]
 v_pk_add_f32 v[154:155], v[154:155], 1.0 op_sel_hi:[1,0]
 v_pk_add_f32 v[156:157], v[156:157], 1.0 op_sel_hi:[1,0]
 v_pk_add_f32 v[158:159], v[158:159], 1.0 op_sel_hi:[1,0]
 v_rcp_f32 v144, v144
 v_rcp_f32 v145, v145
 v_rcp_f32 v146, v146
 v_rcp_f32 v147, v147
 v_rcp_f32 v148, v148
 v_rcp_f32 v149, v149
 v_rcp_f32 v150, v150
 v_rcp_f32 v151, v151
 v_rcp_f32 v152, v152
 v_rcp_f32 v153, v153
 v_rcp_f32 v154, v154
 v_rcp_f32 v155, v155
 v_rcp_f32 v156, v156
 v_rcp_f32 v157, v157
 v_rcp_f32 v158, v158
 v_rcp_f32 v159, v159
 v_pk_mul_f32 v[112:113], v[112:113], v[144:145]
 v_pk_mul_f32 v[114:115], v[114:115], v[146:147]
 v_pk_mul_f32 v[116:117], v[116:117], v[148:149]
 v_pk_mul_f32 v[118:119], v[118:119], v[150:151]
 v_pk_mul_f32 v[120:121], v[120:121], v[152:153]
 v_pk_mul_f32 v[122:123], v[122:123], v[154:155]
 v_pk_mul_f32 v[124:125], v[124:125], v[156:157]
 v_pk_mul_f32 v[126:127], v[126:127], v[158:159]
 v_cvt_pk_bf16_f32 v112, v112, v113
 v_cvt_pk_bf16_f32 v113, v114, v115
 v_cvt_pk_bf16_f32 v114, v116, v117
 v_cvt_pk_bf16_f32 v115, v118, v119
 v_cvt_pk_bf16_f32 v116, v120, v121
 v_cvt_pk_bf16_f32 v117, v122, v123
 v_cvt_pk_bf16_f32 v118, v124, v125
 v_cvt_pk_bf16_f32 v119, v126, v127
 s_branch L_fz_p4gz0s
L_fz_p4gz0r:
 ds_read_b128 v[136:139], v26 offset:0
 ds_read_b128 v[140:143], v26 offset:1024
 s_waitcnt lgkmcnt(0)
 v_pk_add_f32 v[128:129], v[128:129], v[136:137]
 v_pk_add_f32 v[130:131], v[130:131], v[138:139]
 v_pk_add_f32 v[132:133], v[132:133], v[140:141]
 v_pk_add_f32 v[134:135], v[134:135], v[142:143]
 v_pk_fma_f32 v[128:129], v[28:29], v[60:61], v[128:129] op_sel_hi:[0,1,1] neg_lo:[1,0,0] neg_hi:[1,0,0]
 v_pk_fma_f32 v[130:131], v[28:29], v[62:63], v[130:131] op_sel_hi:[0,1,1] neg_lo:[1,0,0] neg_hi:[1,0,0]
 v_pk_fma_f32 v[132:133], v[28:29], v[60:61], v[132:133] op_sel:[1,0,0] op_sel_hi:[1,1,1] neg_lo:[1,0,0] neg_hi:[1,0,0]
 v_pk_fma_f32 v[134:135], v[28:29], v[62:63], v[134:135] op_sel:[1,0,0] op_sel_hi:[1,1,1] neg_lo:[1,0,0] neg_hi:[1,0,0]
 v_pk_mul_f32 v[144:145], v[128:129], v[128:129]
 v_pk_mul_f32 v[146:147], v[130:131], v[130:131]
 v_pk_mul_f32 v[148:149], v[132:133], v[132:133]
 v_pk_mul_f32 v[150:151], v[134:135], v[134:135]
 v_pk_fma_f32 v[144:145], v[144:145], v[36:37], v[36:37] op_sel:[0,1,0] op_sel_hi:[1,1,0]
 v_pk_fma_f32 v[146:147], v[146:147], v[36:37], v[36:37] op_sel:[0,1,0] op_sel_hi:[1,1,0]
 v_pk_fma_f32 v[148:149], v[148:149], v[38:39], v[38:39] op_sel:[0,1,0] op_sel_hi:[1,1,0]
 v_pk_fma_f32 v[150:151], v[150:151], v[38:39], v[38:39] op_sel:[0,1,0] op_sel_hi:[1,1,0]
 v_pk_mul_f32 v[144:145], v[144:145], v[128:129]
 v_pk_mul_f32 v[146:147], v[146:147], v[130:131]
 v_pk_mul_f32 v[148:149], v[148:149], v[132:133]
 v_pk_mul_f32 v[150:151], v[150:151], v[134:135]
 v_exp_f32 v144, v144
 v_exp_f32 v145, v145
 v_exp_f32 v146, v146
 v_exp_f32 v147, v147
 v_exp_f32 v148, v148
 v_exp_f32 v149, v149
 v_exp_f32 v150, v150
 v_exp_f32 v151, v151
 v_pk_add_f32 v[144:145], v[144:145], 1.0 op_sel_hi:[1,0]
 v_pk_add_f32 v[146:147], v[146:147], 1.0 op_sel_hi:[1,0]
 v_pk_add_f32 v[148:149], v[148:149], 1.0 op_sel_hi:[1,0]
 v_pk_add_f32 v[150:151], v[150:151], 1.0 op_sel_hi:[1,0]
 v_rcp_f32 v144, v144
 v_rcp_f32 v145, v145
 v_rcp_f32 v146, v146
 v_rcp_f32 v147, v147
 v_rcp_f32 v148, v148
 v_rcp_f32 v149, v149
 v_rcp_f32 v150, v150
 v_rcp_f32 v151, v151
 v_pk_mul_f32 v[128:129], v[128:129], v[144:145]
 v_pk_mul_f32 v[130:131], v[130:131], v[146:147]
 v_pk_mul_f32 v[132:133], v[132:133], v[148:149]
 v_pk_mul_f32 v[134:135], v[134:135], v[150:151]
 v_cvt_pk_bf16_f32 v248, v128, v129
 v_cvt_pk_bf16_f32 v249, v130, v131
 v_cvt_pk_bf16_f32 v250, v132, v133
 v_cvt_pk_bf16_f32 v251, v134, v135
 s_cmp_lg_u32 s3, 4
 s_cbranch_scc1 L_fz_p4np
 s_lshl_b32 s36, s34, 6
 s_add_u32 s56, s8, 16515072
 s_addc_u32 s57, s9, 0
 s_mov_b32 s58, 131072
 s_mov_b32 s59, 0x20000
 s_sub_u32 s60, 64, 1
 v_min_u32 v12, s60, v0
 v_add_lshl_u32 v12, v12, s36, 7
 s_mov_b32 s61, 40000
L_fz_wf8:
 buffer_load_dword v13, v12, s[56:59], 0 offen sc1
 s_waitcnt vmcnt(0)
 v_cmp_ne_u32 vcc, s100, v13
 s_sub_u32 s61, s61, 1
 s_cbranch_vccz L_fz_wd8
 s_cmp_lg_u32 s61, 0
 s_cbranch_scc1 L_fz_wf8
L_fz_wd8:
 v_mov_b32 v11, 1
 ds_write_b32 v10, v11
 s_branch L_fz_p4go
L_fz_p4np:
 s_mov_b32 s46, 200000
L_fz_p4gs0:
 s_sleep 1
 ds_read_b32 v11, v10
 s_waitcnt lgkmcnt(0)
 v_cmp_ne_u32 vcc, 1, v11
 s_sub_u32 s46, s46, 1
 s_cbranch_vccz L_fz_p4gs0r
 s_cmp_lg_u32 s46, 0
 s_cbranch_scc1 L_fz_p4gs0
L_fz_p4gs0r:
L_fz_p4go:
 s_mov_b32 s43, 0
 s_add_u32 m0, s49, 107520
 s_nop 0
 buffer_load_dwordx4 v8, s[16:19], s43 offen sc1 lds
 buffer_load_dwordx4 v8, s[16:19], s43 offen offset:1024 sc1 lds
 s_add_u32 m0, s49, 114688
 s_nop 0
 buffer_load_dwordx4 v8, s[16:19], s43 offen offset:2048 sc1 lds
 buffer_load_dwordx4 v8, s[16:19], s43 offen offset:3072 sc1 lds
 s_add_u32 m0, s53, 107520
 s_nop 0
 buffer_load_dwordx4 v9, s[16:19], s43 offen sc1 lds
 s_movk_i32 s42, 128
 s_mov_b32 s43, 4096
 s_add_u32 m0, s48, 49152
 s_nop 0
 buffer_load_dwordx4 v4, s[12:15], s42 offen lds
 s_add_u32 m0, s48, 50176
 s_nop 0
 buffer_load_dwordx4 v5, s[12:15], s42 offen lds
 s_add_u32 m0, s48, 51200
 s_nop 0
 buffer_load_dwordx4 v6, s[12:15], s42 offen lds
 s_add_u32 m0, s48, 52224
 s_nop 0
 buffer_load_dwordx4 v7, s[12:15], s42 offen lds
 s_add_u32 m0, s49, 125952
 s_nop 0
 buffer_load_dwordx4 v8, s[16:19], s43 offen sc1 lds
 buffer_load_dwordx4 v8, s[16:19], s43 offen offset:1024 sc1 lds
 s_add_u32 m0, s49, 133120
 s_nop 0
 buffer_load_dwordx4 v8, s[16:19], s43 offen offset:2048 sc1 lds
 buffer_load_dwordx4 v8, s[16:19], s43 offen offset:3072 sc1 lds
 s_add_u32 m0, s53, 125952
 s_nop 0
 buffer_load_dwordx4 v9, s[16:19], s43 offen sc1 lds
 s_waitcnt vmcnt(9) lgkmcnt(0)
 s_barrier
 s_movk_i32 s42, 256
 s_mov_b32 s43, 8192
 s_add_u32 m0, s48, 0
 s_nop 0
 buffer_load_dwordx4 v4, s[12:15], s42 offen lds
 s_add_u32 m0, s48, 1024
 s_nop 0
 buffer_load_dwordx4 v5, s[12:15], s42 offen lds
 s_add_u32 m0, s48, 2048
 s_nop 0
 buffer_load_dwordx4 v6, s[12:15], s42 offen lds
 s_add_u32 m0, s48, 3072
 s_nop 0
 buffer_load_dwordx4 v7, s[12:15], s42 offen lds
 s_add_u32 m0, s49, 70656
 s_nop 0
 buffer_load_dwordx4 v8, s[16:19], s43 offen sc1 lds
 buffer_load_dwordx4 v8, s[16:19], s43 offen offset:1024 sc1 lds
 s_add_u32 m0, s49, 77824
 s_nop 0
 buffer_load_dwordx4 v8, s[16:19], s43 offen offset:2048 sc1 lds
 buffer_load_dwordx4 v8, s[16:19], s43 offen offset:3072 sc1 lds
 s_add_u32 m0, s53, 70656
 s_nop 0
 buffer_load_dwordx4 v9, s[16:19], s43 offen sc1 lds
 s_movk_i32 s42, 384
 s_mov_b32 s43, 12288
 s_add_u32 m0, s48, 16384
 s_nop 0
 buffer_load_dwordx4 v4, s[12:15], s42 offen lds
 s_add_u32 m0, s48, 17408
 s_nop 0
 buffer_load_dwordx4 v5, s[12:15], s42 offen lds
 s_add_u32 m0, s48, 18432
 s_nop 0
 buffer_load_dwordx4 v6, s[12:15], s42 offen lds
 s_add_u32 m0, s48, 19456
 s_nop 0
 buffer_load_dwordx4 v7, s[12:15], s42 offen lds
 s_add_u32 m0, s49, 89088
 s_nop 0
 buffer_load_dwordx4 v8, s[16:19], s43 offen sc1 lds
 buffer_load_dwordx4 v8, s[16:19], s43 offen offset:1024 sc1 lds
 s_add_u32 m0, s49, 96256
 s_nop 0
 buffer_load_dwordx4 v8, s[16:19], s43 offen offset:2048 sc1 lds
 buffer_load_dwordx4 v8, s[16:19], s43 offen offset:3072 sc1 lds
 s_add_u32 m0, s53, 89088
 s_nop 0
 buffer_load_dwordx4 v9, s[16:19], s43 offen sc1 lds
 s_movk_i32 s42, 512
 s_mov_b32 s43, 16384
 s_waitcnt vmcnt(18) lgkmcnt(0)
 s_barrier
 s_add_u32 m0, s48, 32768
 s_nop 0
 buffer_load_dwordx4 v4, s[12:15], s42 offen lds
 s_add_u32 m0, s48, 33792
 s_nop 0
 buffer_load_dwordx4 v5, s[12:15], s42 offen lds
 s_add_u32 m0, s48, 34816
 s_nop 0
 buffer_load_dwordx4 v6, s[12:15], s42 offen lds
 s_add_u32 m0, s48, 35840
 s_nop 0
 buffer_load_dwordx4 v7, s[12:15], s42 offen lds
 s_add_u32 m0, s49, 107520
 s_nop 0
 buffer_load_dwordx4 v8, s[16:19], s43 offen sc1 lds
 buffer_load_dwordx4 v8, s[16:19], s43 offen offset:1024 sc1 lds
 s_add_u32 m0, s49, 114688
 s_nop 0
 buffer_load_dwordx4 v8, s[16:19], s43 offen offset:2048 sc1 lds
 buffer_load_dwordx4 v8, s[16:19], s43 offen offset:3072 sc1 lds
 s_add_u32 m0, s53, 107520
 s_nop 0
 buffer_load_dwordx4 v9, s[16:19], s43 offen sc1 lds
 s_add_u32 s42, s42, 128
 s_add_u32 s43, s43, 4096
 s_mov_b32 s20, s78
 s_mov_b32 s21, s79
 s_mov_b32 s22, 2654208
 s_mov_b32 s23, 0x20000
 s_mov_b32 s24, s74
 s_mov_b32 s25, s75
 s_mov_b32 s26, 8388608
 s_mov_b32 s27, 0x20000
 s_lshl_b32 s36, s2, 2
 s_add_u32 s36, s36, s32
 s_lshl_b32 s37, s36, 13
 s_add_u32 s47, s37, 4096
 s_mul_i32 s36, s36, 3072
 v_lshrrev_b32 v12, 3, v0
 v_and_b32 v13, 7, v0
 v_min_u32 v12, 1, v12
 v_lshlrev_b32 v12, 12, v12
 v_lshl_add_u32 v12, v13, 7, v12
 v_min_u32 v13, 23, v0
 v_lshlrev_b32 v13, 7, v13
 s_waitcnt vmcnt(18) lgkmcnt(0)
 s_barrier
 s_add_u32 m0, s48, 49152
 s_nop 0
 buffer_load_dwordx4 v4, s[12:15], s42 offen lds
 s_add_u32 m0, s48, 50176
 s_nop 0
 buffer_load_dwordx4 v5, s[12:15], s42 offen lds
 s_add_u32 m0, s48, 51200
 s_nop 0
 buffer_load_dwordx4 v6, s[12:15], s42 offen lds
 s_add_u32 m0, s48, 52224
 s_nop 0
 buffer_load_dwordx4 v7, s[12:15], s42 offen lds
 s_add_u32 m0, s49, 125952
 s_nop 0
 buffer_load_dwordx4 v8, s[16:19], s43 offen sc1 lds
 buffer_load_dwordx4 v8, s[16:19], s43 offen offset:1024 sc1 lds
 s_add_u32 m0, s49, 133120
 s_nop 0
 buffer_load_dwordx4 v8, s[16:19], s43 offen offset:2048 sc1 lds
 buffer_load_dwordx4 v8, s[16:19], s43 offen offset:3072 sc1 lds
 s_add_u32 m0, s53, 125952
 s_nop 0
 buffer_load_dwordx4 v9, s[16:19], s43 offen sc1 lds
 s_add_u32 s42, s42, 128
 s_add_u32 s43, s43, 4096
 s_waitcnt vmcnt(18) lgkmcnt(0)
 s_barrier
 s_add_u32 m0, s48, 0
 s_nop 0
 buffer_load_dwordx4 v4, s[12:15], s42 offen lds
 s_add_u32 m0, s48, 1024
 s_nop 0
 buffer_load_dwordx4 v5, s[12:15], s42 offen lds
 s_add_u32 m0, s48, 2048
 s_nop 0
 buffer_load_dwordx4 v6, s[12:15], s42 offen lds
 s_add_u32 m0, s48, 3072
 s_nop 0
 buffer_load_dwordx4 v7, s[12:15], s42 offen lds
 s_add_u32 m0, s49, 70656
 s_nop 0
 buffer_load_dwordx4 v8, s[16:19], s43 offen sc1 lds
 buffer_load_dwordx4 v8, s[16:19], s43 offen offset:1024 sc1 lds
 s_add_u32 m0, s49, 77824
 s_nop 0
 buffer_load_dwordx4 v8, s[16:19], s43 offen offset:2048 sc1 lds
 buffer_load_dwordx4 v8, s[16:19], s43 offen offset:3072 sc1 lds
 s_add_u32 m0, s53, 70656
 s_nop 0
 buffer_load_dwordx4 v9, s[16:19], s43 offen sc1 lds
 s_add_u32 s42, s42, 128
 s_add_u32 s43, s43, 4096
 s_waitcnt vmcnt(18) lgkmcnt(0)
 s_barrier
 s_add_u32 m0, s48, 16384
 s_nop 0
 buffer_load_dwordx4 v4, s[12:15], s42 offen lds
 s_add_u32 m0, s48, 17408
 s_nop 0
 buffer_load_dwordx4 v5, s[12:15], s42 offen lds
 s_add_u32 m0, s48, 18432
 s_nop 0
 buffer_load_dwordx4 v6, s[12:15], s42 offen lds
 s_add_u32 m0, s48, 19456
 s_nop 0
 buffer_load_dwordx4 v7, s[12:15], s42 offen lds
 s_add_u32 m0, s49, 89088
 s_nop 0
 buffer_load_dwordx4 v8, s[16:19], s43 offen sc1 lds
 buffer_load_dwordx4 v8, s[16:19], s43 offen offset:1024 sc1 lds
 s_add_u32 m0, s49, 96256
 s_nop 0
 buffer_load_dwordx4 v8, s[16:19], s43 offen offset:2048 sc1 lds
 buffer_load_dwordx4 v8, s[16:19], s43 offen offset:3072 sc1 lds
 s_add_u32 m0, s53, 89088
 s_nop 0
 buffer_load_dwordx4 v9, s[16:19], s43 offen sc1 lds
 s_add_u32 s42, s42, 128
 s_add_u32 s43, s43, 4096
 buffer_load_dword v196, v12, s[24:27], s37 offen offset:3072
 s_waitcnt vmcnt(19) lgkmcnt(0)
 s_barrier
 s_add_u32 m0, s48, 32768
 s_nop 0
 buffer_load_dwordx4 v4, s[12:15], s42 offen lds
 s_add_u32 m0, s48, 33792
 s_nop 0
 buffer_load_dwordx4 v5, s[12:15], s42 offen lds
 s_add_u32 m0, s48, 34816
 s_nop 0
 buffer_load_dwordx4 v6, s[12:15], s42 offen lds
 s_add_u32 m0, s48, 35840
 s_nop 0
 buffer_load_dwordx4 v7, s[12:15], s42 offen lds
 s_add_u32 m0, s49, 107520
 s_nop 0
 buffer_load_dwordx4 v8, s[16:19], s43 offen sc1 lds
 buffer_load_dwordx4 v8, s[16:19], s43 offen offset:1024 sc1 lds
 s_add_u32 m0, s49, 114688
 s_nop 0
 buffer_load_dwordx4 v8, s[16:19], s43 offen offset:2048 sc1 lds
 buffer_load_dwordx4 v8, s[16:19], s43 offen offset:3072 sc1 lds
 s_add_u32 m0, s53, 107520
 s_nop 0
 buffer_load_dwordx4 v9, s[16:19], s43 offen sc1 lds
 s_add_u32 s42, s42, 128
 s_add_u32 s43, s43, 4096
 s_waitcnt vmcnt(19) lgkmcnt(0)
 s_barrier
 s_add_u32 m0, s48, 49152
 s_nop 0
 buffer_load_dwordx4 v4, s[12:15], s42 offen lds
 s_add_u32 m0, s48, 50176
 s_nop 0
 buffer_load_dwordx4 v5, s[12:15], s42 offen lds
 s_add_u32 m0, s48, 51200
 s_nop 0
 buffer_load_dwordx4 v6, s[12:15], s42 offen lds
 s_add_u32 m0, s48, 52224
 s_nop 0
 buffer_load_dwordx4 v7, s[12:15], s42 offen lds
 s_add_u32 m0, s49, 125952
 s_nop 0
 buffer_load_dwordx4 v8, s[16:19], s43 offen sc1 lds
 buffer_load_dwordx4 v8, s[16:19], s43 offen offset:1024 sc1 lds
 s_add_u32 m0, s49, 133120
 s_nop 0
 buffer_load_dwordx4 v8, s[16:19], s43 offen offset:2048 sc1 lds
 buffer_load_dwordx4 v8, s[16:19], s43 offen offset:3072 sc1 lds
 s_add_u32 m0, s53, 125952
 s_nop 0
 buffer_load_dwordx4 v9, s[16:19], s43 offen sc1 lds
 s_add_u32 s42, s42, 128
 s_add_u32 s43, s43, 4096
 s_waitcnt vmcnt(19) lgkmcnt(0)
 s_barrier
 s_add_u32 m0, s48, 0
 s_nop 0
 buffer_load_dwordx4 v4, s[12:15], s42 offen lds
 s_add_u32 m0, s48, 1024
 s_nop 0
 buffer_load_dwordx4 v5, s[12:15], s42 offen lds
 s_add_u32 m0, s48, 2048
 s_nop 0
 buffer_load_dwordx4 v6, s[12:15], s42 offen lds
 s_add_u32 m0, s48, 3072
 s_nop 0
 buffer_load_dwordx4 v7, s[12:15], s42 offen lds
 s_add_u32 m0, s49, 70656
 s_nop 0
 buffer_load_dwordx4 v8, s[16:19], s43 offen sc1 lds
 buffer_load_dwordx4 v8, s[16:19], s43 offen offset:1024 sc1 lds
 s_add_u32 m0, s49, 77824
 s_nop 0
 buffer_load_dwordx4 v8, s[16:19], s43 offen offset:2048 sc1 lds
 buffer_load_dwordx4 v8, s[16:19], s43 offen offset:3072 sc1 lds
 s_add_u32 m0, s53, 70656
 s_nop 0
 buffer_load_dwordx4 v9, s[16:19], s43 offen sc1 lds
 s_add_u32 s42, s42, 128
 s_add_u32 s43, s43, 4096
 s_waitcnt vmcnt(18) lgkmcnt(0)
 s_barrier
 s_add_u32 m0, s48, 16384
 s_nop 0
 buffer_load_dwordx4 v4, s[12:15], s42 offen lds
 s_add_u32 m0, s48, 17408
 s_nop 0
 buffer_load_dwordx4 v5, s[12:15], s42 offen lds
 s_add_u32 m0, s48, 18432
 s_nop 0
 buffer_load_dwordx4 v6, s[12:15], s42 offen lds
 s_add_u32 m0, s48, 19456
 s_nop 0
 buffer_load_dwordx4 v7, s[12:15], s42 offen lds
 s_add_u32 m0, s49, 89088
 s_nop 0
 buffer_load_dwordx4 v8, s[16:19], s43 offen sc1 lds
 buffer_load_dwordx4 v8, s[16:19], s43 offen offset:1024 sc1 lds
 s_add_u32 m0, s49, 96256
 s_nop 0
 buffer_load_dwordx4 v8, s[16:19], s43 offen offset:2048 sc1 lds
 buffer_load_dwordx4 v8, s[16:19], s43 offen offset:3072 sc1 lds
 s_add_u32 m0, s53, 89088
 s_nop 0
 buffer_load_dwordx4 v9, s[16:19], s43 offen sc1 lds
 s_add_u32 s42, s42, 128
 s_add_u32 s43, s43, 4096
 s_waitcnt vmcnt(18) lgkmcnt(0)
 s_barrier
 s_add_u32 m0, s48, 32768
 s_nop 0
 buffer_load_dwordx4 v4, s[12:15], s42 offen lds
 s_add_u32 m0, s48, 33792
 s_nop 0
 buffer_load_dwordx4 v5, s[12:15], s42 offen lds
 s_add_u32 m0, s48, 34816
 s_nop 0
 buffer_load_dwordx4 v6, s[12:15], s42 offen lds
 s_add_u32 m0, s48, 35840
 s_nop 0
 buffer_load_dwordx4 v7, s[12:15], s42 offen lds
 s_add_u32 m0, s49, 107520
 s_nop 0
 buffer_load_dwordx4 v8, s[16:19], s43 offen sc1 lds
 buffer_load_dwordx4 v8, s[16:19], s43 offen offset:1024 sc1 lds
 s_add_u32 m0, s49, 114688
 s_nop 0
 buffer_load_dwordx4 v8, s[16:19], s43 offen offset:2048 sc1 lds
 buffer_load_dwordx4 v8, s[16:19], s43 offen offset:3072 sc1 lds
 s_add_u32 m0, s53, 107520
 s_nop 0
 buffer_load_dwordx4 v9, s[16:19], s43 offen sc1 lds
 s_add_u32 s42, s42, 128
 s_add_u32 s43, s43, 4096
 s_waitcnt vmcnt(18) lgkmcnt(0)
 s_barrier
 s_add_u32 m0, s48, 49152
 s_nop 0
 buffer_load_dwordx4 v4, s[12:15], s42 offen lds
 s_add_u32 m0, s48, 50176
 s_nop 0
 buffer_load_dwordx4 v5, s[12:15], s42 offen lds
 s_add_u32 m0, s48, 51200
 s_nop 0
 buffer_load_dwordx4 v6, s[12:15], s42 offen lds
 s_add_u32 m0, s48, 52224
 s_nop 0
 buffer_load_dwordx4 v7, s[12:15], s42 offen lds
 s_add_u32 m0, s49, 125952
 s_nop 0
 buffer_load_dwordx4 v8, s[16:19], s43 offen sc1 lds
 buffer_load_dwordx4 v8, s[16:19], s43 offen offset:1024 sc1 lds
 s_add_u32 m0, s49, 133120
 s_nop 0
 buffer_load_dwordx4 v8, s[16:19], s43 offen offset:2048 sc1 lds
 buffer_load_dwordx4 v8, s[16:19], s43 offen offset:3072 sc1 lds
 s_add_u32 m0, s53, 125952
 s_nop 0
 buffer_load_dwordx4 v9, s[16:19], s43 offen sc1 lds
 s_add_u32 s42, s42, 128
 s_add_u32 s43, s43, 4096
 s_waitcnt vmcnt(18) lgkmcnt(0)
 s_barrier
 s_add_u32 m0, s48, 0
 s_nop 0
 buffer_load_dwordx4 v4, s[12:15], s42 offen lds
 s_add_u32 m0, s48, 1024
 s_nop 0
 buffer_load_dwordx4 v5, s[12:15], s42 offen lds
 s_add_u32 m0, s48, 2048
 s_nop 0
 buffer_load_dwordx4 v6, s[12:15], s42 offen lds
 s_add_u32 m0, s48, 3072
 s_nop 0
 buffer_load_dwordx4 v7, s[12:15], s42 offen lds
 s_add_u32 m0, s49, 70656
 s_nop 0
 buffer_load_dwordx4 v8, s[16:19], s43 offen sc1 lds
 buffer_load_dwordx4 v8, s[16:19], s43 offen offset:1024 sc1 lds
 s_add_u32 m0, s49, 77824
 s_nop 0
 buffer_load_dwordx4 v8, s[16:19], s43 offen offset:2048 sc1 lds
 buffer_load_dwordx4 v8, s[16:19], s43 offen offset:3072 sc1 lds
 s_add_u32 m0, s53, 70656
 s_nop 0
 buffer_load_dwordx4 v9, s[16:19], s43 offen sc1 lds
 s_add_u32 s42, s42, 128
 s_add_u32 s43, s43, 4096
 s_waitcnt vmcnt(18) lgkmcnt(0)
 s_barrier
 s_add_u32 m0, s48, 16384
 s_nop 0
 buffer_load_dwordx4 v4, s[12:15], s42 offen lds
 s_add_u32 m0, s48, 17408
 s_nop 0
 buffer_load_dwordx4 v5, s[12:15], s42 offen lds
 s_add_u32 m0, s48, 18432
 s_nop 0
 buffer_load_dwordx4 v6, s[12:15], s42 offen lds
 s_add_u32 m0, s48, 19456
 s_nop 0
 buffer_load_dwordx4 v7, s[12:15], s42 offen lds
 s_add_u32 m0, s49, 89088
 s_nop 0
 buffer_load_dwordx4 v8, s[16:19], s43 offen sc1 lds
 buffer_load_dwordx4 v8, s[16:19], s43 offen offset:1024 sc1 lds
 s_add_u32 m0, s49, 96256
 s_nop 0
 buffer_load_dwordx4 v8, s[16:19], s43 offen offset:2048 sc1 lds
 buffer_load_dwordx4 v8, s[16:19], s43 offen offset:3072 sc1 lds
 s_add_u32 m0, s53, 89088
 s_nop 0
 buffer_load_dwordx4 v9, s[16:19], s43 offen sc1 lds
 s_add_u32 s42, s42, 128
 s_add_u32 s43, s43, 4096
 buffer_load_dword v196, v13, s[20:23], s36 offen
 s_waitcnt vmcnt(19) lgkmcnt(0)
 s_barrier
 s_add_u32 m0, s48, 32768
 s_nop 0
 buffer_load_dwordx4 v4, s[12:15], s42 offen lds
 s_add_u32 m0, s48, 33792
 s_nop 0
 buffer_load_dwordx4 v5, s[12:15], s42 offen lds
 s_add_u32 m0, s48, 34816
 s_nop 0
 buffer_load_dwordx4 v6, s[12:15], s42 offen lds
 s_add_u32 m0, s48, 35840
 s_nop 0
 buffer_load_dwordx4 v7, s[12:15], s42 offen lds
 s_add_u32 m0, s49, 107520
 s_nop 0
 buffer_load_dwordx4 v8, s[16:19], s43 offen sc1 lds
 buffer_load_dwordx4 v8, s[16:19], s43 offen offset:1024 sc1 lds
 s_add_u32 m0, s49, 114688
 s_nop 0
 buffer_load_dwordx4 v8, s[16:19], s43 offen offset:2048 sc1 lds
 buffer_load_dwordx4 v8, s[16:19], s43 offen offset:3072 sc1 lds
 s_add_u32 m0, s53, 107520
 s_nop 0
 buffer_load_dwordx4 v9, s[16:19], s43 offen sc1 lds
 s_add_u32 s42, s42, 128
 s_add_u32 s43, s43, 4096
 s_waitcnt vmcnt(19) lgkmcnt(0)
 s_barrier
 s_add_u32 m0, s48, 49152
 s_nop 0
 buffer_load_dwordx4 v4, s[12:15], s42 offen lds
 s_add_u32 m0, s48, 50176
 s_nop 0
 buffer_load_dwordx4 v5, s[12:15], s42 offen lds
 s_add_u32 m0, s48, 51200
 s_nop 0
 buffer_load_dwordx4 v6, s[12:15], s42 offen lds
 s_add_u32 m0, s48, 52224
 s_nop 0
 buffer_load_dwordx4 v7, s[12:15], s42 offen lds
 s_add_u32 m0, s49, 125952
 s_nop 0
 buffer_load_dwordx4 v8, s[16:19], s43 offen sc1 lds
 buffer_load_dwordx4 v8, s[16:19], s43 offen offset:1024 sc1 lds
 s_add_u32 m0, s49, 133120
 s_nop 0
 buffer_load_dwordx4 v8, s[16:19], s43 offen offset:2048 sc1 lds
 buffer_load_dwordx4 v8, s[16:19], s43 offen offset:3072 sc1 lds
 s_add_u32 m0, s53, 125952
 s_nop 0
 buffer_load_dwordx4 v9, s[16:19], s43 offen sc1 lds
 s_add_u32 s42, s42, 128
 s_add_u32 s43, s43, 4096
 s_waitcnt vmcnt(19) lgkmcnt(0)
 s_barrier
 s_add_u32 m0, s48, 0
 s_nop 0
 buffer_load_dwordx4 v4, s[12:15], s42 offen lds
 s_add_u32 m0, s48, 1024
 s_nop 0
 buffer_load_dwordx4 v5, s[12:15], s42 offen lds
 s_add_u32 m0, s48, 2048
 s_nop 0
 buffer_load_dwordx4 v6, s[12:15], s42 offen lds
 s_add_u32 m0, s48, 3072
 s_nop 0
 buffer_load_dwordx4 v7, s[12:15], s42 offen lds
 s_add_u32 m0, s49, 70656
 s_nop 0
 buffer_load_dwordx4 v8, s[16:19], s43 offen sc1 lds
 buffer_load_dwordx4 v8, s[16:19], s43 offen offset:1024 sc1 lds
 s_add_u32 m0, s49, 77824
 s_nop 0
 buffer_load_dwordx4 v8, s[16:19], s43 offen offset:2048 sc1 lds
 buffer_load_dwordx4 v8, s[16:19], s43 offen offset:3072 sc1 lds
 s_add_u32 m0, s53, 70656
 s_nop 0
 buffer_load_dwordx4 v9, s[16:19], s43 offen sc1 lds
 s_add_u32 s42, s42, 128
 s_add_u32 s43, s43, 4096
 s_waitcnt vmcnt(18) lgkmcnt(0)
 s_barrier
 s_add_u32 m0, s48, 16384
 s_nop 0
 buffer_load_dwordx4 v4, s[12:15], s42 offen lds
 s_add_u32 m0, s48, 17408
 s_nop 0
 buffer_load_dwordx4 v5, s[12:15], s42 offen lds
 s_add_u32 m0, s48, 18432
 s_nop 0
 buffer_load_dwordx4 v6, s[12:15], s42 offen lds
 s_add_u32 m0, s48, 19456
 s_nop 0
 buffer_load_dwordx4 v7, s[12:15], s42 offen lds
 s_add_u32 m0, s49, 89088
 s_nop 0
 buffer_load_dwordx4 v8, s[16:19], s43 offen sc1 lds
 buffer_load_dwordx4 v8, s[16:19], s43 offen offset:1024 sc1 lds
 s_add_u32 m0, s49, 96256
 s_nop 0
 buffer_load_dwordx4 v8, s[16:19], s43 offen offset:2048 sc1 lds
 buffer_load_dwordx4 v8, s[16:19], s43 offen offset:3072 sc1 lds
 s_add_u32 m0, s53, 89088
 s_nop 0
 buffer_load_dwordx4 v9, s[16:19], s43 offen sc1 lds
 s_add_u32 s42, s42, 128
 s_add_u32 s43, s43, 4096
 s_waitcnt vmcnt(18) lgkmcnt(0)
 s_barrier
 s_add_u32 m0, s48, 32768
 s_nop 0
 buffer_load_dwordx4 v4, s[12:15], s42 offen lds
 s_add_u32 m0, s48, 33792
 s_nop 0
 buffer_load_dwordx4 v5, s[12:15], s42 offen lds
 s_add_u32 m0, s48, 34816
 s_nop 0
 buffer_load_dwordx4 v6, s[12:15], s42 offen lds
 s_add_u32 m0, s48, 35840
 s_nop 0
 buffer_load_dwordx4 v7, s[12:15], s42 offen lds
 s_add_u32 m0, s49, 107520
 s_nop 0
 buffer_load_dwordx4 v8, s[16:19], s43 offen sc1 lds
 buffer_load_dwordx4 v8, s[16:19], s43 offen offset:1024 sc1 lds
 s_add_u32 m0, s49, 114688
 s_nop 0
 buffer_load_dwordx4 v8, s[16:19], s43 offen offset:2048 sc1 lds
 buffer_load_dwordx4 v8, s[16:19], s43 offen offset:3072 sc1 lds
 s_add_u32 m0, s53, 107520
 s_nop 0
 buffer_load_dwordx4 v9, s[16:19], s43 offen sc1 lds
 s_add_u32 s42, s42, 128
 s_add_u32 s43, s43, 4096
 s_mov_b32 s40, 18
L_fz_p5ll0:
 s_waitcnt vmcnt(18) lgkmcnt(0)
 s_barrier
 s_add_u32 m0, s48, 49152
 s_nop 0
 buffer_load_dwordx4 v4, s[12:15], s42 offen lds
 s_add_u32 m0, s48, 50176
 s_nop 0
 buffer_load_dwordx4 v5, s[12:15], s42 offen lds
 s_add_u32 m0, s48, 51200
 s_nop 0
 buffer_load_dwordx4 v6, s[12:15], s42 offen lds
 s_add_u32 m0, s48, 52224
 s_nop 0
 buffer_load_dwordx4 v7, s[12:15], s42 offen lds
 s_add_u32 m0, s49, 125952
 s_nop 0
 buffer_load_dwordx4 v8, s[16:19], s43 offen sc1 lds
 buffer_load_dwordx4 v8, s[16:19], s43 offen offset:1024 sc1 lds
 s_add_u32 m0, s49, 133120
 s_nop 0
 buffer_load_dwordx4 v8, s[16:19], s43 offen offset:2048 sc1 lds
 buffer_load_dwordx4 v8, s[16:19], s43 offen offset:3072 sc1 lds
 s_add_u32 m0, s53, 125952
 s_nop 0
 buffer_load_dwordx4 v9, s[16:19], s43 offen sc1 lds
 s_add_u32 s42, s42, 128
 s_add_u32 s43, s43, 4096
 s_waitcnt vmcnt(18) lgkmcnt(0)
 s_barrier
 s_add_u32 m0, s48, 0
 s_nop 0
 buffer_load_dwordx4 v4, s[12:15], s42 offen lds
 s_add_u32 m0, s48, 1024
 s_nop 0
 buffer_load_dwordx4 v5, s[12:15], s42 offen lds
 s_add_u32 m0, s48, 2048
 s_nop 0
 buffer_load_dwordx4 v6, s[12:15], s42 offen lds
 s_add_u32 m0, s48, 3072
 s_nop 0
 buffer_load_dwordx4 v7, s[12:15], s42 offen lds
 s_add_u32 m0, s49, 70656
 s_nop 0
 buffer_load_dwordx4 v8, s[16:19], s43 offen sc1 lds
 buffer_load_dwordx4 v8, s[16:19], s43 offen offset:1024 sc1 lds
 s_add_u32 m0, s49, 77824
 s_nop 0
 buffer_load_dwordx4 v8, s[16:19], s43 offen offset:2048 sc1 lds
 buffer_load_dwordx4 v8, s[16:19], s43 offen offset:3072 sc1 lds
 s_add_u32 m0, s53, 70656
 s_nop 0
 buffer_load_dwordx4 v9, s[16:19], s43 offen sc1 lds
 s_add_u32 s42, s42, 128
 s_add_u32 s43, s43, 4096
 s_waitcnt vmcnt(18) lgkmcnt(0)
 s_barrier
 s_add_u32 m0, s48, 16384
 s_nop 0
 buffer_load_dwordx4 v4, s[12:15], s42 offen lds
 s_add_u32 m0, s48, 17408
 s_nop 0
 buffer_load_dwordx4 v5, s[12:15], s42 offen lds
 s_add_u32 m0, s48, 18432
 s_nop 0
 buffer_load_dwordx4 v6, s[12:15], s42 offen lds
 s_add_u32 m0, s48, 19456
 s_nop 0
 buffer_load_dwordx4 v7, s[12:15], s42 offen lds
 s_add_u32 m0, s49, 89088
 s_nop 0
 buffer_load_dwordx4 v8, s[16:19], s43 offen sc1 lds
 buffer_load_dwordx4 v8, s[16:19], s43 offen offset:1024 sc1 lds
 s_add_u32 m0, s49, 96256
 s_nop 0
 buffer_load_dwordx4 v8, s[16:19], s43 offen offset:2048 sc1 lds
 buffer_load_dwordx4 v8, s[16:19], s43 offen offset:3072 sc1 lds
 s_add_u32 m0, s53, 89088
 s_nop 0
 buffer_load_dwordx4 v9, s[16:19], s43 offen sc1 lds
 s_add_u32 s42, s42, 128
 s_add_u32 s43, s43, 4096
 s_waitcnt vmcnt(18) lgkmcnt(0)
 s_barrier
 s_add_u32 m0, s48, 32768
 s_nop 0
 buffer_load_dwordx4 v4, s[12:15], s42 offen lds
 s_add_u32 m0, s48, 33792
 s_nop 0
 buffer_load_dwordx4 v5, s[12:15], s42 offen lds
 s_add_u32 m0, s48, 34816
 s_nop 0
 buffer_load_dwordx4 v6, s[12:15], s42 offen lds
 s_add_u32 m0, s48, 35840
 s_nop 0
 buffer_load_dwordx4 v7, s[12:15], s42 offen lds
 s_add_u32 m0, s49, 107520
 s_nop 0
 buffer_load_dwordx4 v8, s[16:19], s43 offen sc1 lds
 buffer_load_dwordx4 v8, s[16:19], s43 offen offset:1024 sc1 lds
 s_add_u32 m0, s49, 114688
 s_nop 0
 buffer_load_dwordx4 v8, s[16:19], s43 offen offset:2048 sc1 lds
 buffer_load_dwordx4 v8, s[16:19], s43 offen offset:3072 sc1 lds
 s_add_u32 m0, s53, 107520
 s_nop 0
 buffer_load_dwordx4 v9, s[16:19], s43 offen sc1 lds
 s_add_u32 s42, s42, 128
 s_add_u32 s43, s43, 4096
 s_add_u32 s40, s40, 4
 s_cmp_lt_u32 s40, 26
 s_cbranch_scc1 L_fz_p5ll0
 s_waitcnt vmcnt(18) lgkmcnt(0)
 s_barrier
 s_add_u32 m0, s48, 49152
 s_nop 0
 buffer_load_dwordx4 v4, s[12:15], s42 offen lds
 s_add_u32 m0, s48, 50176
 s_nop 0
 buffer_load_dwordx4 v5, s[12:15], s42 offen lds
 s_add_u32 m0, s48, 51200
 s_nop 0
 buffer_load_dwordx4 v6, s[12:15], s42 offen lds
 s_add_u32 m0, s48, 52224
 s_nop 0
 buffer_load_dwordx4 v7, s[12:15], s42 offen lds
 s_add_u32 m0, s49, 125952
 s_nop 0
 buffer_load_dwordx4 v8, s[16:19], s43 offen sc1 lds
 buffer_load_dwordx4 v8, s[16:19], s43 offen offset:1024 sc1 lds
 s_add_u32 m0, s49, 133120
 s_nop 0
 buffer_load_dwordx4 v8, s[16:19], s43 offen offset:2048 sc1 lds
 buffer_load_dwordx4 v8, s[16:19], s43 offen offset:3072 sc1 lds
 s_add_u32 m0, s53, 125952
 s_nop 0
 buffer_load_dwordx4 v9, s[16:19], s43 offen sc1 lds
 s_add_u32 s42, s42, 128
 s_add_u32 s43, s43, 4096
 s_waitcnt vmcnt(18) lgkmcnt(0)
 s_barrier
 s_add_u32 m0, s48, 0
 s_nop 0
 buffer_load_dwordx4 v4, s[12:15], s42 offen lds
 s_add_u32 m0, s48, 1024
 s_nop 0
 buffer_load_dwordx4 v5, s[12:15], s42 offen lds
 s_add_u32 m0, s48, 2048
 s_nop 0
 buffer_load_dwordx4 v6, s[12:15], s42 offen lds
 s_add_u32 m0, s48, 3072
 s_nop 0
 buffer_load_dwordx4 v7, s[12:15], s42 offen lds
 s_add_u32 m0, s49, 70656
 s_nop 0
 buffer_load_dwordx4 v8, s[16:19], s43 offen sc1 lds
 buffer_load_dwordx4 v8, s[16:19], s43 offen offset:1024 sc1 lds
 s_add_u32 m0, s49, 77824
 s_nop 0
 buffer_load_dwordx4 v8, s[16:19], s43 offen offset:2048 sc1 lds
 buffer_load_dwordx4 v8, s[16:19], s43 offen offset:3072 sc1 lds
 s_add_u32 m0, s53, 70656
 s_nop 0
 buffer_load_dwordx4 v9, s[16:19], s43 offen sc1 lds
 s_add_u32 s42, s42, 128
 s_add_u32 s43, s43, 4096
 s_waitcnt vmcnt(18) lgkmcnt(0)
 s_barrier
 s_add_u32 m0, s48, 16384
 s_nop 0
 buffer_load_dwordx4 v4, s[12:15], s42 offen lds
 s_add_u32 m0, s48, 17408
 s_nop 0
 buffer_load_dwordx4 v5, s[12:15], s42 offen lds
 s_add_u32 m0, s48, 18432
 s_nop 0
 buffer_load_dwordx4 v6, s[12:15], s42 offen lds
 s_add_u32 m0, s48, 19456
 s_nop 0
 buffer_load_dwordx4 v7, s[12:15], s42 offen lds
 s_add_u32 m0, s49, 89088
 s_nop 0
 buffer_load_dwordx4 v8, s[16:19], s43 offen sc1 lds
 buffer_load_dwordx4 v8, s[16:19], s43 offen offset:1024 sc1 lds
 s_add_u32 m0, s49, 96256
 s_nop 0
 buffer_load_dwordx4 v8, s[16:19], s43 offen offset:2048 sc1 lds
 buffer_load_dwordx4 v8, s[16:19], s43 offen offset:3072 sc1 lds
 s_add_u32 m0, s53, 89088
 s_nop 0
 buffer_load_dwordx4 v9, s[16:19], s43 offen sc1 lds
 s_add_u32 s42, s42, 128
 s_add_u32 s43, s43, 4096
 s_waitcnt vmcnt(18)
 s_barrier
 s_waitcnt vmcnt(9)
 s_barrier
 ds_write_b128 v27, v[64:67] offset:0
 ds_write_b128 v27, v[68:71] offset:256
 ds_write_b128 v27, v[80:83] offset:4096
 ds_write_b128 v27, v[84:87] offset:4352
 ds_write_b128 v27, v[96:99] offset:1024
 ds_write_b128 v27, v[100:103] offset:1280
 ds_write_b128 v27, v[112:115] offset:5120
 ds_write_b128 v27, v[116:119] offset:5376
 ds_write_b128 v22, v[248:251] offset:8192
 s_waitcnt vmcnt(0) lgkmcnt(0)
 s_barrier
 s_branch L_fz_p5g0
L_fz_p4b1:
 s_add_u32 m0, s48, 0
 s_mov_b32 s43, 0
 buffer_load_dwordx4 v16, s[12:15], s43 offen sc1 lds
 buffer_load_dwordx4 v16, s[12:15], s43 offen offset:1024 sc1 lds
 buffer_load_dwordx4 v17, s[12:15], s43 offen offset:2048 sc1 lds
 buffer_load_dwordx4 v17, s[12:15], s43 offen offset:3072 sc1 lds
 s_add_u32 m0, s48, 16384
 s_mov_b32 s43, 2048
 buffer_load_dwordx4 v16, s[12:15], s43 offen sc1 lds
 buffer_load_dwordx4 v16, s[12:15], s43 offen offset:1024 sc1 lds
 buffer_load_dwordx4 v17, s[12:15], s43 offen offset:2048 sc1 lds
 buffer_load_dwordx4 v17, s[12:15], s43 offen offset:3072 sc1 lds
 s_waitcnt vmcnt(4)
 s_barrier
 s_add_u32 m0, s48, 32768
 s_mov_b32 s43, 4096
 buffer_load_dwordx4 v16, s[12:15], s43 offen sc1 lds
 buffer_load_dwordx4 v16, s[12:15], s43 offen offset:1024 sc1 lds
 buffer_load_dwordx4 v17, s[12:15], s43 offen offset:2048 sc1 lds
 buffer_load_dwordx4 v17, s[12:15], s43 offen offset:3072 sc1 lds
 s_add_u32 m0, s48, 49152
 s_mov_b32 s43, 6144
 buffer_load_dwordx4 v16, s[12:15], s43 offen sc1 lds
 buffer_load_dwordx4 v16, s[12:15], s43 offen offset:1024 sc1 lds
 buffer_load_dwordx4 v17, s[12:15], s43 offen offset:2048 sc1 lds
 buffer_load_dwordx4 v17, s[12:15], s43 offen offset:3072 sc1 lds
 s_waitcnt vmcnt(8)
 s_barrier
 s_add_u32 m0, s48, 0
 s_mov_b32 s43, 8192
 buffer_load_dwordx4 v16, s[12:15], s43 offen sc1 lds
 buffer_load_dwordx4 v16, s[12:15], s43 offen offset:1024 sc1 lds
 buffer_load_dwordx4 v17, s[12:15], s43 offen offset:2048 sc1 lds
 buffer_load_dwordx4 v17, s[12:15], s43 offen offset:3072 sc1 lds
 s_add_u32 m0, s48, 87040
 s_mov_b32 s42, 2363904
 buffer_load_dwordx4 v232, s[16:19], s42 offen lds
 s_add_u32 m0, s48, 88064
 s_nop 0
 buffer_load_dwordx4 v233, s[16:19], s42 offen lds
 s_add_u32 m0, s48, 89088
 s_nop 0
 buffer_load_dwordx4 v234, s[16:19], s42 offen lds
 s_add_u32 m0, s48, 90112
 s_nop 0
 buffer_load_dwordx4 v235, s[16:19], s42 offen lds
 v_bfe_u32 v18, v0, 4, 1
 v_bfe_u32 v19, v0, 1, 1
 v_lshlrev_b32 v3, 2, v19
 v_and_b32 v19, 1, v0
 v_lshl_add_u32 v3, v19, 1, v3
 v_add_u32 v3, v3, v18
 v_lshrrev_b32 v19, 5, v0
 v_bfe_u32 v20, v0, 2, 2
 v_lshl_add_u32 v20, v20, 1, v19
 v_mul_u32_u24 v20, 288, v20
 v_lshl_add_u32 v3, v3, 3, v20
 s_lshl_b32 s36, s45, 2
 s_add_u32 s36, s36, s39
 s_lshl_b32 s36, s36, 5
 s_add_u32 s36, s36, 16384
 v_add_u32 v3, s36, v3
 v_and_b32 v20, 15, v0
 v_lshlrev_b32 v20, 4, v20
 v_lshl_add_u32 v20, v19, 8, v20
 v_lshl_add_u32 v5, v18, 11, v20
 s_lshl_b32 s36, s44, 13
 v_add_u32 v5, s36, v5
 s_waitcnt vmcnt(12)
 s_barrier
 s_add_u32 m0, s48, 16384
 s_mov_b32 s43, 10240
 buffer_load_dwordx4 v16, s[12:15], s43 offen sc1 lds
 buffer_load_dwordx4 v16, s[12:15], s43 offen offset:1024 sc1 lds
 buffer_load_dwordx4 v17, s[12:15], s43 offen offset:2048 sc1 lds
 buffer_load_dwordx4 v17, s[12:15], s43 offen offset:3072 sc1 lds
 s_add_u32 m0, s48, 105472
 s_mov_b32 s42, 2953728
 buffer_load_dwordx4 v232, s[16:19], s42 offen lds
 s_add_u32 m0, s48, 106496
 s_nop 0
 buffer_load_dwordx4 v233, s[16:19], s42 offen lds
 s_add_u32 m0, s48, 107520
 s_nop 0
 buffer_load_dwordx4 v234, s[16:19], s42 offen lds
 s_add_u32 m0, s48, 108544
 s_nop 0
 buffer_load_dwordx4 v235, s[16:19], s42 offen lds
 s_mul_i32 s36, s34, 576
 s_add_u32 s36, s36, 14942208
 v_lshrrev_b32 v18, 5, v0
 v_lshlrev_b32 v18, 5, v18
 v_lshrrev_b32 v19, 4, v0
 v_lshlrev_b32 v19, 4, v19
 s_lshl_b32 s37, s45, 2
 s_add_u32 s37, s37, s39
 s_lshl_b32 s37, s37, 6
 s_cmp_eq_u32 s39, 0
 s_cselect_b32 s46, 512, 0
 s_add_u32 s24, s8, s36
 s_addc_u32 s25, s9, 0
 s_mov_b32 s26, 576
 s_mov_b32 s27, 0x20000
 buffer_load_dwordx4 v[196:199], v18, s[24:27], s37 offen offset:0 sc1
 buffer_load_dwordx4 v[200:203], v18, s[24:27], s37 offen offset:64 sc1
 buffer_load_dwordx4 v[204:207], v18, s[24:27], s37 offen offset:16 sc1
 buffer_load_dwordx4 v[208:211], v18, s[24:27], s37 offen offset:80 sc1
 buffer_load_dwordx4 v[212:215], v18, s[24:27], s37 offen offset:128 sc1
 buffer_load_dwordx4 v[216:219], v18, s[24:27], s37 offen offset:192 sc1
 buffer_load_dwordx4 v[220:223], v18, s[24:27], s37 offen offset:144 sc1
 buffer_load_dwordx4 v[224:227], v18, s[24:27], s37 offen offset:208 sc1
 buffer_load_dwordx4 v[60:63], v19, s[24:27], s46 offen sc1
 s_waitcnt vmcnt(25)
 s_barrier
 s_add_u32 m0, s48, 32768
 s_mov_b32 s43, 12288
 buffer_load_dwordx4 v16, s[12:15], s43 offen sc1 lds
 buffer_load_dwordx4 v16, s[12:15], s43 offen offset:1024 sc1 lds
 buffer_load_dwordx4 v17, s[12:15], s43 offen offset:2048 sc1 lds
 buffer_load_dwordx4 v17, s[12:15], s43 offen offset:3072 sc1 lds
 s_add_u32 m0, s48, 123904
 s_mov_b32 s42, 3543552
 buffer_load_dwordx4 v232, s[16:19], s42 offen lds
 s_add_u32 m0, s48, 124928
 s_nop 0
 buffer_load_dwordx4 v233, s[16:19], s42 offen lds
 s_add_u32 m0, s48, 125952
 s_nop 0
 buffer_load_dwordx4 v234, s[16:19], s42 offen lds
 s_add_u32 m0, s48, 126976
 s_nop 0
 buffer_load_dwordx4 v235, s[16:19], s42 offen lds
 s_waitcnt vmcnt(25)
 s_barrier
 s_add_u32 m0, s48, 49152
 s_mov_b32 s43, 14336
 buffer_load_dwordx4 v16, s[12:15], s43 offen sc1 lds
 buffer_load_dwordx4 v16, s[12:15], s43 offen offset:1024 sc1 lds
 buffer_load_dwordx4 v17, s[12:15], s43 offen offset:2048 sc1 lds
 buffer_load_dwordx4 v17, s[12:15], s43 offen offset:3072 sc1 lds
 s_add_u32 m0, s48, 142336
 s_mov_b32 s42, 4133376
 buffer_load_dwordx4 v232, s[16:19], s42 offen lds
 s_add_u32 m0, s48, 143360
 s_nop 0
 buffer_load_dwordx4 v233, s[16:19], s42 offen lds
 s_add_u32 m0, s48, 144384
 s_nop 0
 buffer_load_dwordx4 v234, s[16:19], s42 offen lds
 s_add_u32 m0, s48, 145408
 s_nop 0
 buffer_load_dwordx4 v235, s[16:19], s42 offen lds
 s_waitcnt vmcnt(16)
 s_barrier
 s_add_u32 m0, s48, 0
 s_mov_b32 s43, 16384
 buffer_load_dwordx4 v16, s[12:15], s43 offen sc1 lds
 buffer_load_dwordx4 v16, s[12:15], s43 offen offset:1024 sc1 lds
 buffer_load_dwordx4 v17, s[12:15], s43 offen offset:2048 sc1 lds
 buffer_load_dwordx4 v17, s[12:15], s43 offen offset:3072 sc1 lds
 s_add_u32 m0, s48, 87040
 s_mov_b32 s42, 4723200
 buffer_load_dwordx4 v232, s[16:19], s42 offen lds
 s_add_u32 m0, s48, 88064
 s_nop 0
 buffer_load_dwordx4 v233, s[16:19], s42 offen lds
 s_add_u32 m0, s48, 89088
 s_nop 0
 buffer_load_dwordx4 v234, s[16:19], s42 offen lds
 s_add_u32 m0, s48, 90112
 s_nop 0
 buffer_load_dwordx4 v235, s[16:19], s42 offen lds
 s_lshl_b32 s36, s44, 8
 s_add_u32 s36, s36, 78848
 v_and_b32 v19, 15, v0
 v_lshl_add_u32 v19, v19, 2, s36
 ds_read_b32 v28, v19 offset:0
 ds_read_b32 v32, v19 offset:512
 ds_read_b32 v29, v19 offset:64
 ds_read_b32 v33, v19 offset:576
 ds_read_b32 v30, v19 offset:128
 ds_read_b32 v34, v19 offset:640
 ds_read_b32 v31, v19 offset:192
 ds_read_b32 v35, v19 offset:704
 v_and_b32 v19, 31, v0
 v_lshl_add_u32 v19, v19, 2, s36
 ds_read_b32 v48, v19 offset:0
 ds_read_b32 v50, v19 offset:512
 ds_read_b32 v49, v19 offset:128
 ds_read_b32 v51, v19 offset:640
 s_waitcnt vmcnt(16)
 s_barrier
 s_add_u32 m0, s48, 105472
 s_mov_b32 s42, 2949120
 buffer_load_dwordx4 v232, s[16:19], s42 offen lds
 s_add_u32 m0, s48, 106496
 s_nop 0
 buffer_load_dwordx4 v233, s[16:19], s42 offen lds
 s_add_u32 m0, s48, 107520
 s_nop 0
 buffer_load_dwordx4 v234, s[16:19], s42 offen lds
 s_add_u32 m0, s48, 108544
 s_nop 0
 buffer_load_dwordx4 v235, s[16:19], s42 offen lds
 s_waitcnt lgkmcnt(0)
 v_mul_f32 v36, -2.302208198144325, v32
 v_mul_f32 v37, v32, v32
 v_mul_f32 v37, v37, v36
 v_mul_f32 v37, 0.044715, v37
 v_mul_f32 v38, -2.302208198144325, v33
 v_mul_f32 v39, v33, v33
 v_mul_f32 v39, v39, v38
 v_mul_f32 v39, 0.044715, v39
 v_mul_f32 v40, -2.302208198144325, v34
 v_mul_f32 v41, v34, v34
 v_mul_f32 v41, v41, v40
 v_mul_f32 v41, 0.044715, v41
 v_mul_f32 v42, -2.302208198144325, v35
 v_mul_f32 v43, v35, v35
 v_mul_f32 v43, v43, v42
 v_mul_f32 v43, 0.044715, v43
 v_mul_f32 v52, -2.302208198144325, v50
 v_mul_f32 v53, v50, v50
 v_mul_f32 v53, v53, v52
 v_mul_f32 v53, 0.044715, v53
 v_mul_f32 v54, -2.302208198144325, v51
 v_mul_f32 v55, v51, v51
 v_mul_f32 v55, v55, v54
 v_mul_f32 v55, 0.044715, v55
 s_waitcnt vmcnt(12)
 s_barrier
 s_add_u32 m0, s48, 123904
 s_mov_b32 s42, 3538944
 buffer_load_dwordx4 v232, s[16:19], s42 offen lds
 s_add_u32 m0, s48, 124928
 s_nop 0
 buffer_load_dwordx4 v233, s[16:19], s42 offen lds
 s_add_u32 m0, s48, 125952
 s_nop 0
 buffer_load_dwordx4 v234, s[16:19], s42 offen lds
 s_add_u32 m0, s48, 126976
 s_nop 0
 buffer_load_dwordx4 v235, s[16:19], s42 offen lds
 s_waitcnt vmcnt(8)
 s_barrier
 s_add_u32 m0, s48, 142336
 s_mov_b32 s42, 4128768
 buffer_load_dwordx4 v232, s[16:19], s42 offen lds
 s_add_u32 m0, s48, 143360
 s_nop 0
 buffer_load_dwordx4 v233, s[16:19], s42 offen lds
 s_add_u32 m0, s48, 144384
 s_nop 0
 buffer_load_dwordx4 v234, s[16:19], s42 offen lds
 s_add_u32 m0, s48, 145408
 s_nop 0
 buffer_load_dwordx4 v235, s[16:19], s42 offen lds
 s_lshl_b32 s36, s32, 2
 s_add_u32 s36, s36, 80000
 v_mov_b32 v23, s36
 v_mov_b32 v24, 80000
 v_add_u32 v11, 16384, v5
 v_add_u32 v9, 89088, v3
 v_add_u32 v8, 16384, v2
 v_add_u32 v10, 89088, v4
 s_waitcnt vmcnt(8) lgkmcnt(0)
 s_barrier
 ds_read_b128 v[144:147], v11 offset:0
 ds_read_b64_tr_b16 v[152:153], v9 offset:0
 ds_read_b64_tr_b16 v[154:155], v9 offset:2304
 ds_read_b128 v[148:151], v11 offset:4096
 ds_read_b64_tr_b16 v[156:157], v9 offset:64
 ds_read_b64_tr_b16 v[158:159], v9 offset:2368
 s_waitcnt lgkmcnt(3)
 v_mfma_f32_32x32x16_bf16 v[64:79], v[152:155], v[144:147], 0
 ds_read_b128 v[160:163], v11 offset:512
 ds_read_b64_tr_b16 v[168:169], v9 offset:4608
 s_add_u32 m0, s48, 87040
 s_mov_b32 s42, 4718592
 buffer_load_dwordx4 v232, s[16:19], s42 offen lds
 s_waitcnt lgkmcnt(4)
 v_mfma_f32_32x32x16_bf16 v[80:95], v[152:155], v[148:151], 0
 ds_read_b64_tr_b16 v[170:171], v9 offset:6912
 ds_read_b128 v[164:167], v11 offset:4608
 s_add_u32 m0, s48, 88064
 s_nop 0
 buffer_load_dwordx4 v233, s[16:19], s42 offen lds
 s_waitcnt lgkmcnt(4)
 v_mfma_f32_32x32x16_bf16 v[96:111], v[156:159], v[144:147], 0
 ds_read_b64_tr_b16 v[172:173], v9 offset:4672
 ds_read_b64_tr_b16 v[174:175], v9 offset:6976
 s_add_u32 m0, s48, 89088
 s_nop 0
 buffer_load_dwordx4 v234, s[16:19], s42 offen lds
 v_mfma_f32_32x32x16_bf16 v[112:127], v[156:159], v[148:151], 0
 s_waitcnt lgkmcnt(3)
 v_mfma_f32_32x32x16_bf16 v[64:79], v[168:171], v[160:163], v[64:79]
 ds_read_b128 v[144:147], v11 offset:1024
 ds_read_b64_tr_b16 v[152:153], v9 offset:9216
 s_add_u32 m0, s48, 90112
 s_nop 0
 buffer_load_dwordx4 v235, s[16:19], s42 offen lds
 s_waitcnt lgkmcnt(4)
 v_mfma_f32_32x32x16_bf16 v[80:95], v[168:171], v[164:167], v[80:95]
 ds_read_b64_tr_b16 v[154:155], v9 offset:11520
 ds_read_b128 v[148:151], v11 offset:5120
 s_waitcnt lgkmcnt(4)
 v_mfma_f32_32x32x16_bf16 v[96:111], v[172:175], v[160:163], v[96:111]
 ds_read_b64_tr_b16 v[156:157], v9 offset:9280
 ds_read_b64_tr_b16 v[158:159], v9 offset:11584
 v_mfma_f32_32x32x16_bf16 v[112:127], v[172:175], v[164:167], v[112:127]
 ds_read_b64_tr_b16 v[192:193], v10 offset:9216
 ds_read_b64_tr_b16 v[194:195], v10 offset:11520
 ds_read_b128 v[176:179], v8 offset:1024
 ds_read_b128 v[180:183], v8 offset:3072
 ds_read_b128 v[184:187], v8 offset:5120
 ds_read_b128 v[188:191], v8 offset:7168
 s_waitcnt lgkmcnt(9)
 v_mfma_f32_32x32x16_bf16 v[64:79], v[152:155], v[144:147], v[64:79]
 ds_read_b128 v[160:163], v11 offset:1536
 ds_read_b64_tr_b16 v[168:169], v9 offset:13824
 s_waitcnt lgkmcnt(10)
 v_mfma_f32_32x32x16_bf16 v[80:95], v[152:155], v[148:151], v[80:95]
 ds_read_b64_tr_b16 v[170:171], v9 offset:16128
 ds_read_b128 v[164:167], v11 offset:5632
 s_waitcnt lgkmcnt(10)
 v_mfma_f32_32x32x16_bf16 v[96:111], v[156:159], v[144:147], v[96:111]
 ds_read_b64_tr_b16 v[172:173], v9 offset:13888
 ds_read_b64_tr_b16 v[174:175], v9 offset:16192
 v_mfma_f32_32x32x16_bf16 v[112:127], v[156:159], v[148:151], v[112:127]
 s_waitcnt lgkmcnt(6)
 v_mfma_f32_16x16x32_bf16 v[128:131], v[192:195], v[176:179], v[128:131]
 v_mfma_f32_16x16x32_bf16 v[132:135], v[192:195], v[180:183], v[132:135]
 v_mfma_f32_16x16x32_bf16 v[136:139], v[192:195], v[184:187], v[136:139]
 v_mfma_f32_16x16x32_bf16 v[140:143], v[192:195], v[188:191], v[140:143]
 v_mov_b32 v18, 10
 s_waitcnt vmcnt(8) lgkmcnt(0)
 ds_write_b32 v23, v18
 v_mfma_f32_32x32x16_bf16 v[64:79], v[168:171], v[160:163], v[64:79]
 ds_read_b128 v[18:21], v24
 v_add_u32 v11, 32768, v5
 v_add_u32 v9, 107520, v3
 v_add_u32 v8, 32768, v2
 v_add_u32 v10, 107520, v4
 v_mfma_f32_32x32x16_bf16 v[80:95], v[168:171], v[164:167], v[80:95]
 s_waitcnt lgkmcnt(0)
 v_min3_u32 v18, v18, v19, v20
 v_min_u32 v18, v18, v21
 v_cmp_gt_u32 vcc, 10, v18
 s_nop 0
 s_cbranch_vccnz L_fz_p4gb1_10s
L_fz_p4gb1_10r:
 ds_read_b128 v[144:147], v11 offset:0
 ds_read_b64_tr_b16 v[152:153], v9 offset:0
 ds_read_b64_tr_b16 v[154:155], v9 offset:2304
 v_mfma_f32_32x32x16_bf16 v[96:111], v[172:175], v[160:163], v[96:111]
 ds_read_b128 v[148:151], v11 offset:4096
 ds_read_b64_tr_b16 v[156:157], v9 offset:64
 ds_read_b64_tr_b16 v[158:159], v9 offset:2368
 v_mfma_f32_32x32x16_bf16 v[112:127], v[172:175], v[164:167], v[112:127]
 s_waitcnt lgkmcnt(3)
 v_mfma_f32_32x32x16_bf16 v[64:79], v[152:155], v[144:147], v[64:79]
 ds_read_b128 v[160:163], v11 offset:512
 ds_read_b64_tr_b16 v[168:169], v9 offset:4608
 s_add_u32 m0, s48, 16384
 s_mov_b32 s43, 0
 buffer_load_dwordx4 v16, s[12:15], s43 offen sc1 lds
 s_waitcnt lgkmcnt(4)
 v_mfma_f32_32x32x16_bf16 v[80:95], v[152:155], v[148:151], v[80:95]
 ds_read_b64_tr_b16 v[170:171], v9 offset:6912
 ds_read_b128 v[164:167], v11 offset:4608
 buffer_load_dwordx4 v16, s[12:15], s43 offen offset:1024 sc1 lds
 s_waitcnt lgkmcnt(4)
 v_mfma_f32_32x32x16_bf16 v[96:111], v[156:159], v[144:147], v[96:111]
 ds_read_b64_tr_b16 v[172:173], v9 offset:4672
 ds_read_b64_tr_b16 v[174:175], v9 offset:6976
 buffer_load_dwordx4 v17, s[12:15], s43 offen offset:2048 sc1 lds
 v_mfma_f32_32x32x16_bf16 v[112:127], v[156:159], v[148:151], v[112:127]
 s_waitcnt lgkmcnt(3)
 v_mfma_f32_32x32x16_bf16 v[64:79], v[168:171], v[160:163], v[64:79]
 ds_read_b128 v[144:147], v11 offset:1024
 ds_read_b64_tr_b16 v[152:153], v9 offset:9216
 buffer_load_dwordx4 v17, s[12:15], s43 offen offset:3072 sc1 lds
 s_waitcnt lgkmcnt(4)
 v_mfma_f32_32x32x16_bf16 v[80:95], v[168:171], v[164:167], v[80:95]
 ds_read_b64_tr_b16 v[154:155], v9 offset:11520
 ds_read_b128 v[148:151], v11 offset:5120
 s_add_u32 m0, s48, 105472
 s_mov_b32 s42, 0
 buffer_load_dwordx4 v232, s[16:19], s42 offen lds
 s_waitcnt lgkmcnt(4)
 v_mfma_f32_32x32x16_bf16 v[96:111], v[172:175], v[160:163], v[96:111]
 ds_read_b64_tr_b16 v[156:157], v9 offset:9280
 ds_read_b64_tr_b16 v[158:159], v9 offset:11584
 s_add_u32 m0, s48, 106496
 s_nop 0
 buffer_load_dwordx4 v233, s[16:19], s42 offen lds
 v_mfma_f32_32x32x16_bf16 v[112:127], v[172:175], v[164:167], v[112:127]
 ds_read_b64_tr_b16 v[192:193], v10 offset:9216
 ds_read_b64_tr_b16 v[194:195], v10 offset:11520
 ds_read_b128 v[176:179], v8 offset:1024
 ds_read_b128 v[180:183], v8 offset:3072
 ds_read_b128 v[184:187], v8 offset:5120
 ds_read_b128 v[188:191], v8 offset:7168
 s_waitcnt lgkmcnt(9)
 v_mfma_f32_32x32x16_bf16 v[64:79], v[152:155], v[144:147], v[64:79]
 ds_read_b128 v[160:163], v11 offset:1536
 ds_read_b64_tr_b16 v[168:169], v9 offset:13824
 s_add_u32 m0, s48, 107520
 s_nop 0
 buffer_load_dwordx4 v234, s[16:19], s42 offen lds
 s_waitcnt lgkmcnt(10)
 v_mfma_f32_32x32x16_bf16 v[80:95], v[152:155], v[148:151], v[80:95]
 ds_read_b64_tr_b16 v[170:171], v9 offset:16128
 ds_read_b128 v[164:167], v11 offset:5632
 s_add_u32 m0, s48, 108544
 s_nop 0
 buffer_load_dwordx4 v235, s[16:19], s42 offen lds
 s_waitcnt lgkmcnt(10)
 v_mfma_f32_32x32x16_bf16 v[96:111], v[156:159], v[144:147], v[96:111]
 ds_read_b64_tr_b16 v[172:173], v9 offset:13888
 ds_read_b64_tr_b16 v[174:175], v9 offset:16192
 v_mfma_f32_32x32x16_bf16 v[112:127], v[156:159], v[148:151], v[112:127]
 s_waitcnt lgkmcnt(6)
 v_mfma_f32_16x16x32_bf16 v[128:131], v[192:195], v[176:179], v[128:131]
 v_mfma_f32_16x16x32_bf16 v[132:135], v[192:195], v[180:183], v[132:135]
 v_mfma_f32_16x16x32_bf16 v[136:139], v[192:195], v[184:187], v[136:139]
 v_mfma_f32_16x16x32_bf16 v[140:143], v[192:195], v[188:191], v[140:143]
 v_mov_b32 v18, 11
 s_waitcnt vmcnt(12) lgkmcnt(0)
 ds_write_b32 v23, v18
 v_mfma_f32_32x32x16_bf16 v[64:79], v[168:171], v[160:163], v[64:79]
 ds_read_b128 v[18:21], v24
 v_add_u32 v11, 49152, v5
 v_add_u32 v9, 125952, v3
 v_add_u32 v8, 49152, v2
 v_add_u32 v10, 125952, v4
 v_mfma_f32_32x32x16_bf16 v[80:95], v[168:171], v[164:167], v[80:95]
 s_waitcnt lgkmcnt(0)
 v_min3_u32 v18, v18, v19, v20
 v_min_u32 v18, v18, v21
 v_cmp_gt_u32 vcc, 11, v18
 s_nop 0
 s_cbranch_vccnz L_fz_p4gb1_11s
L_fz_p4gb1_11r:
 ds_read_b128 v[144:147], v11 offset:0
 ds_read_b64_tr_b16 v[152:153], v9 offset:0
 ds_read_b64_tr_b16 v[154:155], v9 offset:2304
 v_mfma_f32_32x32x16_bf16 v[96:111], v[172:175], v[160:163], v[96:111]
 ds_read_b128 v[148:151], v11 offset:4096
 ds_read_b64_tr_b16 v[156:157], v9 offset:64
 ds_read_b64_tr_b16 v[158:159], v9 offset:2368
 v_mfma_f32_32x32x16_bf16 v[112:127], v[172:175], v[164:167], v[112:127]
 s_waitcnt lgkmcnt(3)
 v_mfma_f32_32x32x16_bf16 v[64:79], v[152:155], v[144:147], v[64:79]
 ds_read_b128 v[160:163], v11 offset:512
 ds_read_b64_tr_b16 v[168:169], v9 offset:4608
 s_add_u32 m0, s48, 32768
 s_mov_b32 s43, 2048
 buffer_load_dwordx4 v16, s[12:15], s43 offen sc1 lds
 s_waitcnt lgkmcnt(4)
 v_mfma_f32_32x32x16_bf16 v[80:95], v[152:155], v[148:151], v[80:95]
 ds_read_b64_tr_b16 v[170:171], v9 offset:6912
 ds_read_b128 v[164:167], v11 offset:4608
 buffer_load_dwordx4 v16, s[12:15], s43 offen offset:1024 sc1 lds
 s_waitcnt lgkmcnt(4)
 v_mfma_f32_32x32x16_bf16 v[96:111], v[156:159], v[144:147], v[96:111]
 ds_read_b64_tr_b16 v[172:173], v9 offset:4672
 ds_read_b64_tr_b16 v[174:175], v9 offset:6976
 buffer_load_dwordx4 v17, s[12:15], s43 offen offset:2048 sc1 lds
 v_mfma_f32_32x32x16_bf16 v[112:127], v[156:159], v[148:151], v[112:127]
 s_waitcnt lgkmcnt(3)
 v_mfma_f32_32x32x16_bf16 v[64:79], v[168:171], v[160:163], v[64:79]
 ds_read_b128 v[144:147], v11 offset:1024
 ds_read_b64_tr_b16 v[152:153], v9 offset:9216
 buffer_load_dwordx4 v17, s[12:15], s43 offen offset:3072 sc1 lds
 s_waitcnt lgkmcnt(4)
 v_mfma_f32_32x32x16_bf16 v[80:95], v[168:171], v[164:167], v[80:95]
 ds_read_b64_tr_b16 v[154:155], v9 offset:11520
 ds_read_b128 v[148:151], v11 offset:5120
 s_add_u32 m0, s48, 123904
 s_mov_b32 s42, 589824
 buffer_load_dwordx4 v232, s[16:19], s42 offen lds
 s_waitcnt lgkmcnt(4)
 v_mfma_f32_32x32x16_bf16 v[96:111], v[172:175], v[160:163], v[96:111]
 ds_read_b64_tr_b16 v[156:157], v9 offset:9280
 ds_read_b64_tr_b16 v[158:159], v9 offset:11584
 s_add_u32 m0, s48, 124928
 s_nop 0
 buffer_load_dwordx4 v233, s[16:19], s42 offen lds
 v_mfma_f32_32x32x16_bf16 v[112:127], v[172:175], v[164:167], v[112:127]
 ds_read_b64_tr_b16 v[192:193], v10 offset:9216
 ds_read_b64_tr_b16 v[194:195], v10 offset:11520
 ds_read_b128 v[176:179], v8 offset:1024
 ds_read_b128 v[180:183], v8 offset:3072
 ds_read_b128 v[184:187], v8 offset:5120
 ds_read_b128 v[188:191], v8 offset:7168
 s_waitcnt lgkmcnt(9)
 v_mfma_f32_32x32x16_bf16 v[64:79], v[152:155], v[144:147], v[64:79]
 ds_read_b128 v[160:163], v11 offset:1536
 ds_read_b64_tr_b16 v[168:169], v9 offset:13824
 s_add_u32 m0, s48, 125952
 s_nop 0
 buffer_load_dwordx4 v234, s[16:19], s42 offen lds
 s_waitcnt lgkmcnt(10)
 v_mfma_f32_32x32x16_bf16 v[80:95], v[152:155], v[148:151], v[80:95]
 ds_read_b64_tr_b16 v[170:171], v9 offset:16128
 ds_read_b128 v[164:167], v11 offset:5632
 s_add_u32 m0, s48, 126976
 s_nop 0
 buffer_load_dwordx4 v235, s[16:19], s42 offen lds
 s_waitcnt lgkmcnt(10)
 v_mfma_f32_32x32x16_bf16 v[96:111], v[156:159], v[144:147], v[96:111]
 ds_read_b64_tr_b16 v[172:173], v9 offset:13888
 ds_read_b64_tr_b16 v[174:175], v9 offset:16192
 v_mfma_f32_32x32x16_bf16 v[112:127], v[156:159], v[148:151], v[112:127]
 s_waitcnt lgkmcnt(6)
 v_mfma_f32_16x16x32_bf16 v[128:131], v[192:195], v[176:179], v[128:131]
 v_mfma_f32_16x16x32_bf16 v[132:135], v[192:195], v[180:183], v[132:135]
 v_mfma_f32_16x16x32_bf16 v[136:139], v[192:195], v[184:187], v[136:139]
 v_mfma_f32_16x16x32_bf16 v[140:143], v[192:195], v[188:191], v[140:143]
 v_mov_b32 v18, 12
 s_waitcnt vmcnt(16) lgkmcnt(0)
 ds_write_b32 v23, v18
 v_mfma_f32_32x32x16_bf16 v[64:79], v[168:171], v[160:163], v[64:79]
 ds_read_b128 v[18:21], v24
 v_mov_b32 v11, v5
 v_add_u32 v9, 70656, v3
 v_mov_b32 v8, v2
 v_add_u32 v10, 70656, v4
 v_mfma_f32_32x32x16_bf16 v[80:95], v[168:171], v[164:167], v[80:95]
 s_waitcnt lgkmcnt(0)
 v_min3_u32 v18, v18, v19, v20
 v_min_u32 v18, v18, v21
 v_cmp_gt_u32 vcc, 12, v18
 s_nop 0
 s_cbranch_vccnz L_fz_p4gb1_12s
L_fz_p4gb1_12r:
 ds_read_b128 v[144:147], v11 offset:0
 ds_read_b64_tr_b16 v[152:153], v9 offset:0
 ds_read_b64_tr_b16 v[154:155], v9 offset:2304
 v_mfma_f32_32x32x16_bf16 v[96:111], v[172:175], v[160:163], v[96:111]
 ds_read_b128 v[148:151], v11 offset:4096
 ds_read_b64_tr_b16 v[156:157], v9 offset:64
 ds_read_b64_tr_b16 v[158:159], v9 offset:2368
 v_mfma_f32_32x32x16_bf16 v[112:127], v[172:175], v[164:167], v[112:127]
 s_waitcnt lgkmcnt(3)
 v_mfma_f32_32x32x16_bf16 v[64:79], v[152:155], v[144:147], v[64:79]
 ds_read_b128 v[160:163], v11 offset:512
 ds_read_b64_tr_b16 v[168:169], v9 offset:4608
 s_add_u32 m0, s48, 49152
 s_mov_b32 s43, 4096
 buffer_load_dwordx4 v16, s[12:15], s43 offen sc1 lds
 s_waitcnt lgkmcnt(4)
 v_mfma_f32_32x32x16_bf16 v[80:95], v[152:155], v[148:151], v[80:95]
 ds_read_b64_tr_b16 v[170:171], v9 offset:6912
 ds_read_b128 v[164:167], v11 offset:4608
 buffer_load_dwordx4 v16, s[12:15], s43 offen offset:1024 sc1 lds
 s_waitcnt lgkmcnt(4)
 v_mfma_f32_32x32x16_bf16 v[96:111], v[156:159], v[144:147], v[96:111]
 ds_read_b64_tr_b16 v[172:173], v9 offset:4672
 ds_read_b64_tr_b16 v[174:175], v9 offset:6976
 buffer_load_dwordx4 v17, s[12:15], s43 offen offset:2048 sc1 lds
 v_mfma_f32_32x32x16_bf16 v[112:127], v[156:159], v[148:151], v[112:127]
 s_waitcnt lgkmcnt(3)
 v_mfma_f32_32x32x16_bf16 v[64:79], v[168:171], v[160:163], v[64:79]
 ds_read_b128 v[144:147], v11 offset:1024
 ds_read_b64_tr_b16 v[152:153], v9 offset:9216
 buffer_load_dwordx4 v17, s[12:15], s43 offen offset:3072 sc1 lds
 s_waitcnt lgkmcnt(4)
 v_mfma_f32_32x32x16_bf16 v[80:95], v[168:171], v[164:167], v[80:95]
 ds_read_b64_tr_b16 v[154:155], v9 offset:11520
 ds_read_b128 v[148:151], v11 offset:5120
 s_add_u32 m0, s48, 142336
 s_mov_b32 s42, 1179648
 buffer_load_dwordx4 v232, s[16:19], s42 offen lds
 s_waitcnt lgkmcnt(4)
 v_mfma_f32_32x32x16_bf16 v[96:111], v[172:175], v[160:163], v[96:111]
 ds_read_b64_tr_b16 v[156:157], v9 offset:9280
 ds_read_b64_tr_b16 v[158:159], v9 offset:11584
 s_add_u32 m0, s48, 143360
 s_nop 0
 buffer_load_dwordx4 v233, s[16:19], s42 offen lds
 v_mfma_f32_32x32x16_bf16 v[112:127], v[172:175], v[164:167], v[112:127]
 ds_read_b64_tr_b16 v[192:193], v10 offset:9216
 ds_read_b64_tr_b16 v[194:195], v10 offset:11520
 ds_read_b128 v[176:179], v8 offset:1024
 ds_read_b128 v[180:183], v8 offset:3072
 ds_read_b128 v[184:187], v8 offset:5120
 ds_read_b128 v[188:191], v8 offset:7168
 s_waitcnt lgkmcnt(9)
 v_mfma_f32_32x32x16_bf16 v[64:79], v[152:155], v[144:147], v[64:79]
 ds_read_b128 v[160:163], v11 offset:1536
 ds_read_b64_tr_b16 v[168:169], v9 offset:13824
 s_add_u32 m0, s48, 144384
 s_nop 0
 buffer_load_dwordx4 v234, s[16:19], s42 offen lds
 s_waitcnt lgkmcnt(10)
 v_mfma_f32_32x32x16_bf16 v[80:95], v[152:155], v[148:151], v[80:95]
 ds_read_b64_tr_b16 v[170:171], v9 offset:16128
 ds_read_b128 v[164:167], v11 offset:5632
 s_add_u32 m0, s48, 145408
 s_nop 0
 buffer_load_dwordx4 v235, s[16:19], s42 offen lds
 s_waitcnt lgkmcnt(10)
 v_mfma_f32_32x32x16_bf16 v[96:111], v[156:159], v[144:147], v[96:111]
 ds_read_b64_tr_b16 v[172:173], v9 offset:13888
 ds_read_b64_tr_b16 v[174:175], v9 offset:16192
 v_mfma_f32_32x32x16_bf16 v[112:127], v[156:159], v[148:151], v[112:127]
 s_waitcnt lgkmcnt(6)
 v_mfma_f32_16x16x32_bf16 v[128:131], v[192:195], v[176:179], v[128:131]
 v_mfma_f32_16x16x32_bf16 v[132:135], v[192:195], v[180:183], v[132:135]
 v_mfma_f32_16x16x32_bf16 v[136:139], v[192:195], v[184:187], v[136:139]
 v_mfma_f32_16x16x32_bf16 v[140:143], v[192:195], v[188:191], v[140:143]
 v_mov_b32 v18, 13
 s_waitcnt vmcnt(16) lgkmcnt(0)
 ds_write_b32 v23, v18
 v_mfma_f32_32x32x16_bf16 v[64:79], v[168:171], v[160:163], v[64:79]
 ds_read_b128 v[18:21], v24
 v_add_u32 v11, 16384, v5
 v_add_u32 v9, 89088, v3
 v_add_u32 v8, 16384, v2
 v_add_u32 v10, 89088, v4
 v_mfma_f32_32x32x16_bf16 v[80:95], v[168:171], v[164:167], v[80:95]
 s_waitcnt lgkmcnt(0)
 v_min3_u32 v18, v18, v19, v20
 v_min_u32 v18, v18, v21
 v_cmp_gt_u32 vcc, 13, v18
 s_nop 0
 s_cbranch_vccnz L_fz_p4gb1_13s
L_fz_p4gb1_13r:
 ds_read_b128 v[144:147], v11 offset:0
 ds_read_b64_tr_b16 v[152:153], v9 offset:0
 ds_read_b64_tr_b16 v[154:155], v9 offset:2304
 v_mfma_f32_32x32x16_bf16 v[96:111], v[172:175], v[160:163], v[96:111]
 ds_read_b128 v[148:151], v11 offset:4096
 ds_read_b64_tr_b16 v[156:157], v9 offset:64
 ds_read_b64_tr_b16 v[158:159], v9 offset:2368
 v_mfma_f32_32x32x16_bf16 v[112:127], v[172:175], v[164:167], v[112:127]
 s_waitcnt lgkmcnt(3)
 v_mfma_f32_32x32x16_bf16 v[64:79], v[152:155], v[144:147], v[64:79]
 ds_read_b128 v[160:163], v11 offset:512
 ds_read_b64_tr_b16 v[168:169], v9 offset:4608
 s_add_u32 m0, s48, 0
 s_mov_b32 s43, 6144
 buffer_load_dwordx4 v16, s[12:15], s43 offen sc1 lds
 s_waitcnt lgkmcnt(4)
 v_mfma_f32_32x32x16_bf16 v[80:95], v[152:155], v[148:151], v[80:95]
 ds_read_b64_tr_b16 v[170:171], v9 offset:6912
 ds_read_b128 v[164:167], v11 offset:4608
 buffer_load_dwordx4 v16, s[12:15], s43 offen offset:1024 sc1 lds
 s_waitcnt lgkmcnt(4)
 v_mfma_f32_32x32x16_bf16 v[96:111], v[156:159], v[144:147], v[96:111]
 ds_read_b64_tr_b16 v[172:173], v9 offset:4672
 ds_read_b64_tr_b16 v[174:175], v9 offset:6976
 buffer_load_dwordx4 v17, s[12:15], s43 offen offset:2048 sc1 lds
 v_mfma_f32_32x32x16_bf16 v[112:127], v[156:159], v[148:151], v[112:127]
 s_waitcnt lgkmcnt(3)
 v_mfma_f32_32x32x16_bf16 v[64:79], v[168:171], v[160:163], v[64:79]
 ds_read_b128 v[144:147], v11 offset:1024
 ds_read_b64_tr_b16 v[152:153], v9 offset:9216
 buffer_load_dwordx4 v17, s[12:15], s43 offen offset:3072 sc1 lds
 s_waitcnt lgkmcnt(4)
 v_mfma_f32_32x32x16_bf16 v[80:95], v[168:171], v[164:167], v[80:95]
 ds_read_b64_tr_b16 v[154:155], v9 offset:11520
 ds_read_b128 v[148:151], v11 offset:5120
 s_add_u32 m0, s48, 87040
 s_mov_b32 s42, 1769472
 buffer_load_dwordx4 v232, s[16:19], s42 offen lds
 s_waitcnt lgkmcnt(4)
 v_mfma_f32_32x32x16_bf16 v[96:111], v[172:175], v[160:163], v[96:111]
 ds_read_b64_tr_b16 v[156:157], v9 offset:9280
 ds_read_b64_tr_b16 v[158:159], v9 offset:11584
 s_add_u32 m0, s48, 88064
 s_nop 0
 buffer_load_dwordx4 v233, s[16:19], s42 offen lds
 v_mfma_f32_32x32x16_bf16 v[112:127], v[172:175], v[164:167], v[112:127]
 ds_read_b64_tr_b16 v[192:193], v10 offset:9216
 ds_read_b64_tr_b16 v[194:195], v10 offset:11520
 ds_read_b128 v[176:179], v8 offset:1024
 ds_read_b128 v[180:183], v8 offset:3072
 ds_read_b128 v[184:187], v8 offset:5120
 ds_read_b128 v[188:191], v8 offset:7168
 s_waitcnt lgkmcnt(9)
 v_mfma_f32_32x32x16_bf16 v[64:79], v[152:155], v[144:147], v[64:79]
 ds_read_b128 v[160:163], v11 offset:1536
 ds_read_b64_tr_b16 v[168:169], v9 offset:13824
 s_add_u32 m0, s48, 89088
 s_nop 0
 buffer_load_dwordx4 v234, s[16:19], s42 offen lds
 s_waitcnt lgkmcnt(10)
 v_mfma_f32_32x32x16_bf16 v[80:95], v[152:155], v[148:151], v[80:95]
 ds_read_b64_tr_b16 v[170:171], v9 offset:16128
 ds_read_b128 v[164:167], v11 offset:5632
 s_add_u32 m0, s48, 90112
 s_nop 0
 buffer_load_dwordx4 v235, s[16:19], s42 offen lds
 s_waitcnt lgkmcnt(10)
 v_mfma_f32_32x32x16_bf16 v[96:111], v[156:159], v[144:147], v[96:111]
 ds_read_b64_tr_b16 v[172:173], v9 offset:13888
 ds_read_b64_tr_b16 v[174:175], v9 offset:16192
 v_mfma_f32_32x32x16_bf16 v[112:127], v[156:159], v[148:151], v[112:127]
 s_waitcnt lgkmcnt(6)
 v_mfma_f32_16x16x32_bf16 v[128:131], v[192:195], v[176:179], v[128:131]
 v_mfma_f32_16x16x32_bf16 v[132:135], v[192:195], v[180:183], v[132:135]
 v_mfma_f32_16x16x32_bf16 v[136:139], v[192:195], v[184:187], v[136:139]
 v_mfma_f32_16x16x32_bf16 v[140:143], v[192:195], v[188:191], v[140:143]
 v_mov_b32 v18, 14
 s_waitcnt vmcnt(16) lgkmcnt(0)
 ds_write_b32 v23, v18
 v_mfma_f32_32x32x16_bf16 v[64:79], v[168:171], v[160:163], v[64:79]
 ds_read_b128 v[18:21], v24
 v_add_u32 v11, 32768, v5
 v_add_u32 v9, 107520, v3
 v_add_u32 v8, 32768, v2
 v_add_u32 v10, 107520, v4
 v_mfma_f32_32x32x16_bf16 v[80:95], v[168:171], v[164:167], v[80:95]
 s_waitcnt lgkmcnt(0)
 v_min3_u32 v18, v18, v19, v20
 v_min_u32 v18, v18, v21
 v_cmp_gt_u32 vcc, 14, v18
 s_nop 0
 s_cbranch_vccnz L_fz_p4gb1_14s
L_fz_p4gb1_14r:
 ds_read_b128 v[144:147], v11 offset:0
 ds_read_b64_tr_b16 v[152:153], v9 offset:0
 ds_read_b64_tr_b16 v[154:155], v9 offset:2304
 v_mfma_f32_32x32x16_bf16 v[96:111], v[172:175], v[160:163], v[96:111]
 ds_read_b128 v[148:151], v11 offset:4096
 ds_read_b64_tr_b16 v[156:157], v9 offset:64
 ds_read_b64_tr_b16 v[158:159], v9 offset:2368
 v_mfma_f32_32x32x16_bf16 v[112:127], v[172:175], v[164:167], v[112:127]
 s_waitcnt lgkmcnt(3)
 v_mfma_f32_32x32x16_bf16 v[64:79], v[152:155], v[144:147], v[64:79]
 ds_read_b128 v[160:163], v11 offset:512
 ds_read_b64_tr_b16 v[168:169], v9 offset:4608
 s_add_u32 m0, s48, 16384
 s_mov_b32 s43, 8192
 buffer_load_dwordx4 v16, s[12:15], s43 offen sc1 lds
 s_waitcnt lgkmcnt(4)
 v_mfma_f32_32x32x16_bf16 v[80:95], v[152:155], v[148:151], v[80:95]
 ds_read_b64_tr_b16 v[170:171], v9 offset:6912
 ds_read_b128 v[164:167], v11 offset:4608
 buffer_load_dwordx4 v16, s[12:15], s43 offen offset:1024 sc1 lds
 s_waitcnt lgkmcnt(4)
 v_mfma_f32_32x32x16_bf16 v[96:111], v[156:159], v[144:147], v[96:111]
 ds_read_b64_tr_b16 v[172:173], v9 offset:4672
 ds_read_b64_tr_b16 v[174:175], v9 offset:6976
 buffer_load_dwordx4 v17, s[12:15], s43 offen offset:2048 sc1 lds
 v_mfma_f32_32x32x16_bf16 v[112:127], v[156:159], v[148:151], v[112:127]
 s_waitcnt lgkmcnt(3)
 v_mfma_f32_32x32x16_bf16 v[64:79], v[168:171], v[160:163], v[64:79]
 ds_read_b128 v[144:147], v11 offset:1024
 ds_read_b64_tr_b16 v[152:153], v9 offset:9216
 buffer_load_dwordx4 v17, s[12:15], s43 offen offset:3072 sc1 lds
 s_waitcnt lgkmcnt(4)
 v_mfma_f32_32x32x16_bf16 v[80:95], v[168:171], v[164:167], v[80:95]
 ds_read_b64_tr_b16 v[154:155], v9 offset:11520
 ds_read_b128 v[148:151], v11 offset:5120
 s_add_u32 m0, s48, 105472
 s_mov_b32 s42, 2359296
 buffer_load_dwordx4 v232, s[16:19], s42 offen lds
 s_waitcnt lgkmcnt(4)
 v_mfma_f32_32x32x16_bf16 v[96:111], v[172:175], v[160:163], v[96:111]
 ds_read_b64_tr_b16 v[156:157], v9 offset:9280
 ds_read_b64_tr_b16 v[158:159], v9 offset:11584
 s_add_u32 m0, s48, 106496
 s_nop 0
 buffer_load_dwordx4 v233, s[16:19], s42 offen lds
 v_mfma_f32_32x32x16_bf16 v[112:127], v[172:175], v[164:167], v[112:127]
 ds_read_b64_tr_b16 v[192:193], v10 offset:9216
 ds_read_b64_tr_b16 v[194:195], v10 offset:11520
 ds_read_b128 v[176:179], v8 offset:1024
 ds_read_b128 v[180:183], v8 offset:3072
 ds_read_b128 v[184:187], v8 offset:5120
 ds_read_b128 v[188:191], v8 offset:7168
 s_waitcnt lgkmcnt(9)
 v_mfma_f32_32x32x16_bf16 v[64:79], v[152:155], v[144:147], v[64:79]
 ds_read_b128 v[160:163], v11 offset:1536
 ds_read_b64_tr_b16 v[168:169], v9 offset:13824
 s_add_u32 m0, s48, 107520
 s_nop 0
 buffer_load_dwordx4 v234, s[16:19], s42 offen lds
 s_waitcnt lgkmcnt(10)
 v_mfma_f32_32x32x16_bf16 v[80:95], v[152:155], v[148:151], v[80:95]
 ds_read_b64_tr_b16 v[170:171], v9 offset:16128
 ds_read_b128 v[164:167], v11 offset:5632
 s_add_u32 m0, s48, 108544
 s_nop 0
 buffer_load_dwordx4 v235, s[16:19], s42 offen lds
 s_waitcnt lgkmcnt(10)
 v_mfma_f32_32x32x16_bf16 v[96:111], v[156:159], v[144:147], v[96:111]
 ds_read_b64_tr_b16 v[172:173], v9 offset:13888
 ds_read_b64_tr_b16 v[174:175], v9 offset:16192
 v_mfma_f32_32x32x16_bf16 v[112:127], v[156:159], v[148:151], v[112:127]
 s_waitcnt lgkmcnt(6)
 v_mfma_f32_16x16x32_bf16 v[128:131], v[192:195], v[176:179], v[128:131]
 v_mfma_f32_16x16x32_bf16 v[132:135], v[192:195], v[180:183], v[132:135]
 v_mfma_f32_16x16x32_bf16 v[136:139], v[192:195], v[184:187], v[136:139]
 v_mfma_f32_16x16x32_bf16 v[140:143], v[192:195], v[188:191], v[140:143]
 v_mov_b32 v18, 15
 s_waitcnt vmcnt(16) lgkmcnt(0)
 ds_write_b32 v23, v18
 v_mfma_f32_32x32x16_bf16 v[64:79], v[168:171], v[160:163], v[64:79]
 ds_read_b128 v[18:21], v24
 v_add_u32 v11, 49152, v5
 v_add_u32 v9, 125952, v3
 v_add_u32 v8, 49152, v2
 v_add_u32 v10, 125952, v4
 v_mfma_f32_32x32x16_bf16 v[80:95], v[168:171], v[164:167], v[80:95]
 s_waitcnt lgkmcnt(0)
 v_min3_u32 v18, v18, v19, v20
 v_min_u32 v18, v18, v21
 v_cmp_gt_u32 vcc, 15, v18
 s_nop 0
 s_cbranch_vccnz L_fz_p4gb1_15s
L_fz_p4gb1_15r:
 ds_read_b128 v[144:147], v11 offset:0
 ds_read_b64_tr_b16 v[152:153], v9 offset:0
 ds_read_b64_tr_b16 v[154:155], v9 offset:2304
 v_mfma_f32_32x32x16_bf16 v[96:111], v[172:175], v[160:163], v[96:111]
 ds_read_b128 v[148:151], v11 offset:4096
 ds_read_b64_tr_b16 v[156:157], v9 offset:64
 ds_read_b64_tr_b16 v[158:159], v9 offset:2368
 v_mfma_f32_32x32x16_bf16 v[112:127], v[172:175], v[164:167], v[112:127]
 s_waitcnt lgkmcnt(3)
 v_mfma_f32_32x32x16_bf16 v[64:79], v[152:155], v[144:147], v[64:79]
 ds_read_b128 v[160:163], v11 offset:512
 ds_read_b64_tr_b16 v[168:169], v9 offset:4608
 s_waitcnt lgkmcnt(4)
 v_mfma_f32_32x32x16_bf16 v[80:95], v[152:155], v[148:151], v[80:95]
 ds_read_b64_tr_b16 v[170:171], v9 offset:6912
 ds_read_b128 v[164:167], v11 offset:4608
 s_waitcnt lgkmcnt(4)
 v_mfma_f32_32x32x16_bf16 v[96:111], v[156:159], v[144:147], v[96:111]
 ds_read_b64_tr_b16 v[172:173], v9 offset:4672
 ds_read_b64_tr_b16 v[174:175], v9 offset:6976
 v_mfma_f32_32x32x16_bf16 v[112:127], v[156:159], v[148:151], v[112:127]
 s_waitcnt lgkmcnt(3)
 v_mfma_f32_32x32x16_bf16 v[64:79], v[168:171], v[160:163], v[64:79]
 ds_read_b128 v[144:147], v11 offset:1024
 ds_read_b64_tr_b16 v[152:153], v9 offset:9216
 s_waitcnt lgkmcnt(4)
 v_mfma_f32_32x32x16_bf16 v[80:95], v[168:171], v[164:167], v[80:95]
 ds_read_b64_tr_b16 v[154:155], v9 offset:11520
 ds_read_b128 v[148:151], v11 offset:5120
 s_waitcnt lgkmcnt(4)
 v_mfma_f32_32x32x16_bf16 v[96:111], v[172:175], v[160:163], v[96:111]
 ds_read_b64_tr_b16 v[156:157], v9 offset:9280
 ds_read_b64_tr_b16 v[158:159], v9 offset:11584
 v_mfma_f32_32x32x16_bf16 v[112:127], v[172:175], v[164:167], v[112:127]
 ds_read_b64_tr_b16 v[192:193], v10 offset:9216
 ds_read_b64_tr_b16 v[194:195], v10 offset:11520
 ds_read_b128 v[176:179], v8 offset:1024
 ds_read_b128 v[180:183], v8 offset:3072
 ds_read_b128 v[184:187], v8 offset:5120
 ds_read_b128 v[188:191], v8 offset:7168
 s_waitcnt lgkmcnt(9)
 v_mfma_f32_32x32x16_bf16 v[64:79], v[152:155], v[144:147], v[64:79]
 ds_read_b128 v[160:163], v11 offset:1536
 ds_read_b64_tr_b16 v[168:169], v9 offset:13824
 s_waitcnt lgkmcnt(10)
 v_mfma_f32_32x32x16_bf16 v[80:95], v[152:155], v[148:151], v[80:95]
 ds_read_b64_tr_b16 v[170:171], v9 offset:16128
 ds_read_b128 v[164:167], v11 offset:5632
 s_waitcnt lgkmcnt(10)
 v_mfma_f32_32x32x16_bf16 v[96:111], v[156:159], v[144:147], v[96:111]
 ds_read_b64_tr_b16 v[172:173], v9 offset:13888
 ds_read_b64_tr_b16 v[174:175], v9 offset:16192
 v_mfma_f32_32x32x16_bf16 v[112:127], v[156:159], v[148:151], v[112:127]
 s_waitcnt lgkmcnt(6)
 v_mfma_f32_16x16x32_bf16 v[128:131], v[192:195], v[176:179], v[128:131]
 v_mfma_f32_16x16x32_bf16 v[132:135], v[192:195], v[180:183], v[132:135]
 v_mfma_f32_16x16x32_bf16 v[136:139], v[192:195], v[184:187], v[136:139]
 v_mfma_f32_16x16x32_bf16 v[140:143], v[192:195], v[188:191], v[140:143]
 v_mov_b32 v18, 16
 s_waitcnt vmcnt(8) lgkmcnt(0)
 ds_write_b32 v23, v18
 v_mfma_f32_32x32x16_bf16 v[64:79], v[168:171], v[160:163], v[64:79]
 ds_read_b128 v[18:21], v24
 v_mov_b32 v11, v5
 v_add_u32 v9, 70656, v3
 v_mov_b32 v8, v2
 v_add_u32 v10, 70656, v4
 v_mfma_f32_32x32x16_bf16 v[80:95], v[168:171], v[164:167], v[80:95]
 s_waitcnt lgkmcnt(0)
 v_min3_u32 v18, v18, v19, v20
 v_min_u32 v18, v18, v21
 v_cmp_gt_u32 vcc, 16, v18
 s_nop 0
 s_cbranch_vccnz L_fz_p4gb1_16s
L_fz_p4gb1_16r:
 ds_read_b128 v[144:147], v11 offset:0
 ds_read_b64_tr_b16 v[152:153], v9 offset:0
 ds_read_b64_tr_b16 v[154:155], v9 offset:2304
 v_mfma_f32_32x32x16_bf16 v[96:111], v[172:175], v[160:163], v[96:111]
 ds_read_b128 v[148:151], v11 offset:4096
 ds_read_b64_tr_b16 v[156:157], v9 offset:64
 ds_read_b64_tr_b16 v[158:159], v9 offset:2368
 v_mfma_f32_32x32x16_bf16 v[112:127], v[172:175], v[164:167], v[112:127]
 s_waitcnt lgkmcnt(3)
 v_mfma_f32_32x32x16_bf16 v[64:79], v[152:155], v[144:147], v[64:79]
 ds_read_b128 v[160:163], v11 offset:512
 ds_read_b64_tr_b16 v[168:169], v9 offset:4608
 s_waitcnt lgkmcnt(4)
 v_mfma_f32_32x32x16_bf16 v[80:95], v[152:155], v[148:151], v[80:95]
 ds_read_b64_tr_b16 v[170:171], v9 offset:6912
 ds_read_b128 v[164:167], v11 offset:4608
 s_waitcnt lgkmcnt(4)
 v_mfma_f32_32x32x16_bf16 v[96:111], v[156:159], v[144:147], v[96:111]
 ds_read_b64_tr_b16 v[172:173], v9 offset:4672
 ds_read_b64_tr_b16 v[174:175], v9 offset:6976
 v_mfma_f32_32x32x16_bf16 v[112:127], v[156:159], v[148:151], v[112:127]
 s_waitcnt lgkmcnt(3)
 v_mfma_f32_32x32x16_bf16 v[64:79], v[168:171], v[160:163], v[64:79]
 ds_read_b128 v[144:147], v11 offset:1024
 ds_read_b64_tr_b16 v[152:153], v9 offset:9216
 s_waitcnt lgkmcnt(4)
 v_mfma_f32_32x32x16_bf16 v[80:95], v[168:171], v[164:167], v[80:95]
 ds_read_b64_tr_b16 v[154:155], v9 offset:11520
 ds_read_b128 v[148:151], v11 offset:5120
 s_waitcnt lgkmcnt(4)
 v_mfma_f32_32x32x16_bf16 v[96:111], v[172:175], v[160:163], v[96:111]
 ds_read_b64_tr_b16 v[156:157], v9 offset:9280
 ds_read_b64_tr_b16 v[158:159], v9 offset:11584
 v_mfma_f32_32x32x16_bf16 v[112:127], v[172:175], v[164:167], v[112:127]
 ds_read_b64_tr_b16 v[192:193], v10 offset:9216
 ds_read_b64_tr_b16 v[194:195], v10 offset:11520
 ds_read_b128 v[176:179], v8 offset:1024
 ds_read_b128 v[180:183], v8 offset:3072
 ds_read_b128 v[184:187], v8 offset:5120
 ds_read_b128 v[188:191], v8 offset:7168
 s_waitcnt lgkmcnt(9)
 v_mfma_f32_32x32x16_bf16 v[64:79], v[152:155], v[144:147], v[64:79]
 ds_read_b128 v[160:163], v11 offset:1536
 ds_read_b64_tr_b16 v[168:169], v9 offset:13824
 s_waitcnt lgkmcnt(10)
 v_mfma_f32_32x32x16_bf16 v[80:95], v[152:155], v[148:151], v[80:95]
 ds_read_b64_tr_b16 v[170:171], v9 offset:16128
 ds_read_b128 v[164:167], v11 offset:5632
 s_waitcnt lgkmcnt(10)
 v_mfma_f32_32x32x16_bf16 v[96:111], v[156:159], v[144:147], v[96:111]
 ds_read_b64_tr_b16 v[172:173], v9 offset:13888
 ds_read_b64_tr_b16 v[174:175], v9 offset:16192
 v_mfma_f32_32x32x16_bf16 v[112:127], v[156:159], v[148:151], v[112:127]
 s_waitcnt lgkmcnt(6)
 v_mfma_f32_16x16x32_bf16 v[128:131], v[192:195], v[176:179], v[128:131]
 v_mfma_f32_16x16x32_bf16 v[132:135], v[192:195], v[180:183], v[132:135]
 v_mfma_f32_16x16x32_bf16 v[136:139], v[192:195], v[184:187], v[136:139]
 v_mfma_f32_16x16x32_bf16 v[140:143], v[192:195], v[188:191], v[140:143]
 v_mov_b32 v18, 17
 s_waitcnt vmcnt(0) lgkmcnt(0)
 ds_write_b32 v23, v18
 v_mfma_f32_32x32x16_bf16 v[64:79], v[168:171], v[160:163], v[64:79]
 ds_read_b128 v[18:21], v24
 v_add_u32 v11, 16384, v5
 v_add_u32 v9, 89088, v3
 v_add_u32 v8, 16384, v2
 v_add_u32 v10, 89088, v4
 v_mfma_f32_32x32x16_bf16 v[80:95], v[168:171], v[164:167], v[80:95]
 s_waitcnt lgkmcnt(0)
 v_min3_u32 v18, v18, v19, v20
 v_min_u32 v18, v18, v21
 v_cmp_gt_u32 vcc, 17, v18
 s_nop 0
 s_cbranch_vccnz L_fz_p4gb1_17s
L_fz_p4gb1_17r:
 ds_read_b128 v[144:147], v11 offset:0
 ds_read_b64_tr_b16 v[152:153], v9 offset:0
 ds_read_b64_tr_b16 v[154:155], v9 offset:2304
 v_mfma_f32_32x32x16_bf16 v[96:111], v[172:175], v[160:163], v[96:111]
 ds_read_b128 v[148:151], v11 offset:4096
 ds_read_b64_tr_b16 v[156:157], v9 offset:64
 ds_read_b64_tr_b16 v[158:159], v9 offset:2368
 v_mfma_f32_32x32x16_bf16 v[112:127], v[172:175], v[164:167], v[112:127]
 s_waitcnt lgkmcnt(3)
 v_mfma_f32_32x32x16_bf16 v[64:79], v[152:155], v[144:147], v[64:79]
 ds_read_b128 v[160:163], v11 offset:512
 ds_read_b64_tr_b16 v[168:169], v9 offset:4608
 s_waitcnt lgkmcnt(4)
 v_mfma_f32_32x32x16_bf16 v[80:95], v[152:155], v[148:151], v[80:95]
 ds_read_b64_tr_b16 v[170:171], v9 offset:6912
 ds_read_b128 v[164:167], v11 offset:4608
 s_waitcnt lgkmcnt(4)
 v_mfma_f32_32x32x16_bf16 v[96:111], v[156:159], v[144:147], v[96:111]
 ds_read_b64_tr_b16 v[172:173], v9 offset:4672
 ds_read_b64_tr_b16 v[174:175], v9 offset:6976
 v_mfma_f32_32x32x16_bf16 v[112:127], v[156:159], v[148:151], v[112:127]
 s_waitcnt lgkmcnt(3)
 v_mfma_f32_32x32x16_bf16 v[64:79], v[168:171], v[160:163], v[64:79]
 ds_read_b128 v[144:147], v11 offset:1024
 ds_read_b64_tr_b16 v[152:153], v9 offset:9216
 s_waitcnt lgkmcnt(4)
 v_mfma_f32_32x32x16_bf16 v[80:95], v[168:171], v[164:167], v[80:95]
 ds_read_b64_tr_b16 v[154:155], v9 offset:11520
 ds_read_b128 v[148:151], v11 offset:5120
 s_waitcnt lgkmcnt(4)
 v_mfma_f32_32x32x16_bf16 v[96:111], v[172:175], v[160:163], v[96:111]
 ds_read_b64_tr_b16 v[156:157], v9 offset:9280
 ds_read_b64_tr_b16 v[158:159], v9 offset:11584
 v_mfma_f32_32x32x16_bf16 v[112:127], v[172:175], v[164:167], v[112:127]
 ds_read_b64_tr_b16 v[192:193], v10 offset:9216
 ds_read_b64_tr_b16 v[194:195], v10 offset:11520
 ds_read_b128 v[176:179], v8 offset:1024
 ds_read_b128 v[180:183], v8 offset:3072
 ds_read_b128 v[184:187], v8 offset:5120
 ds_read_b128 v[188:191], v8 offset:7168
 s_waitcnt lgkmcnt(9)
 v_mfma_f32_32x32x16_bf16 v[64:79], v[152:155], v[144:147], v[64:79]
 ds_read_b128 v[160:163], v11 offset:1536
 ds_read_b64_tr_b16 v[168:169], v9 offset:13824
 s_waitcnt lgkmcnt(10)
 v_mfma_f32_32x32x16_bf16 v[80:95], v[152:155], v[148:151], v[80:95]
 ds_read_b64_tr_b16 v[170:171], v9 offset:16128
 ds_read_b128 v[164:167], v11 offset:5632
 s_waitcnt lgkmcnt(10)
 v_mfma_f32_32x32x16_bf16 v[96:111], v[156:159], v[144:147], v[96:111]
 ds_read_b64_tr_b16 v[172:173], v9 offset:13888
 ds_read_b64_tr_b16 v[174:175], v9 offset:16192
 v_mfma_f32_32x32x16_bf16 v[112:127], v[156:159], v[148:151], v[112:127]
 s_waitcnt lgkmcnt(6)
 v_mfma_f32_16x16x32_bf16 v[128:131], v[192:195], v[176:179], v[128:131]
 v_mfma_f32_16x16x32_bf16 v[132:135], v[192:195], v[180:183], v[132:135]
 v_mfma_f32_16x16x32_bf16 v[136:139], v[192:195], v[184:187], v[136:139]
 v_mfma_f32_16x16x32_bf16 v[140:143], v[192:195], v[188:191], v[140:143]
 s_waitcnt lgkmcnt(0)
 v_mfma_f32_32x32x16_bf16 v[64:79], v[168:171], v[160:163], v[64:79]
 v_mfma_f32_32x32x16_bf16 v[80:95], v[168:171], v[164:167], v[80:95]
 v_mfma_f32_32x32x16_bf16 v[96:111], v[172:175], v[160:163], v[96:111]
 v_mfma_f32_32x32x16_bf16 v[112:127], v[172:175], v[164:167], v[112:127]
 v_lshrrev_b32 v14, 3, v0
 v_and_b32 v15, 7, v0
 v_xor_b32 v15, v15, v14
 v_lshlrev_b32 v15, 4, v15
 v_lshl_add_u32 v2, v14, 12, v15
 s_lshl_b32 s46, s32, 17
 v_add_u32 v4, s46, v2
 v_add_u32 v5, 0x8000, v4
 v_add_u32 v6, 0x10000, v4
 v_add_u32 v7, 0x18000, v4
 s_lshl_b32 s46, s33, 19
 s_add_u32 s12, s74, s46
 s_addc_u32 s13, s75, 0
 s_mov_b32 s14, 524288
 s_mov_b32 s15, 0x20000
 s_movk_i32 s42, 0
 s_add_u32 m0, s48, 32768
 s_nop 0
 buffer_load_dwordx4 v4, s[12:15], s42 offen lds
 s_add_u32 m0, s48, 33792
 s_nop 0
 buffer_load_dwordx4 v5, s[12:15], s42 offen lds
 s_add_u32 m0, s48, 34816
 s_nop 0
 buffer_load_dwordx4 v6, s[12:15], s42 offen lds
 s_add_u32 m0, s48, 35840
 s_nop 0
 buffer_load_dwordx4 v7, s[12:15], s42 offen lds
 s_add_u32 s46, s32, s39
 s_lshl_b32 s46, s46, 17
 v_add_u32 v8, s46, v1
 v_lshrrev_b32 v14, 5, v0
 v_and_b32 v15, 31, v0
 v_lshlrev_b32 v15, 4, v15
 v_lshl_add_u32 v9, v14, 10, v15
 s_movk_i32 s47, 512
 s_cmp_eq_u32 s39, 0
 s_cselect_b32 s46, 524288, s47
 s_lshl_b32 s47, s44, 11
 s_add_u32 s46, s46, s47
 v_add_u32 v9, s46, v9
 s_lshl_b32 s46, s38, 17
 s_add_u32 s46, s46, 27262976
 s_add_u32 s16, s8, s46
 s_addc_u32 s17, s9, 0
 s_mov_b32 s18, 655360
 s_mov_b32 s19, 0x20000
 s_lshl_b32 s49, s32, 11
 s_add_u32 s49, s49, 16384
 s_mul_i32 s53, s44, 9216
 s_add_u32 s53, s53, 24576
 s_lshl_b32 s36, s44, 14
 s_add_u32 s36, s36, 67584
 v_add_u32 v25, s36, v1
 v_xor_b32 v26, 2048, v25
 s_mul_i32 s46, s32, 9216
 s_add_u32 s46, s46, 123904
 v_add_u32 v22, s46, v1
 v_bfe_u32 v16, v0, 4, 1
 v_and_b32 v17, 15, v0
 v_lshlrev_b32 v17, 4, v17
 v_lshl_add_u32 v17, v16, 11, v17
 v_lshl_add_u32 v17, v14, 9, v17
 v_add_u32 v27, s46, v17
 v_mov_b32 v10, 79872
 v_mov_b32 v18, 18
 ds_write_b128 v25, v[128:131] offset:0
 ds_write_b128 v25, v[132:135] offset:1024
 ds_write_b32 v23, v18
 v_pk_fma_f32 v[64:65], v[48:49], v[196:197], v[64:65] op_sel_hi:[0,1,1] neg_lo:[1,0,0] neg_hi:[1,0,0]
 v_pk_fma_f32 v[66:67], v[48:49], v[198:199], v[66:67] op_sel_hi:[0,1,1] neg_lo:[1,0,0] neg_hi:[1,0,0]
 v_pk_fma_f32 v[68:69], v[48:49], v[200:201], v[68:69] op_sel_hi:[0,1,1] neg_lo:[1,0,0] neg_hi:[1,0,0]
 v_pk_fma_f32 v[70:71], v[48:49], v[202:203], v[70:71] op_sel_hi:[0,1,1] neg_lo:[1,0,0] neg_hi:[1,0,0]
 v_pk_fma_f32 v[72:73], v[48:49], v[204:205], v[72:73] op_sel_hi:[0,1,1] neg_lo:[1,0,0] neg_hi:[1,0,0]
 v_pk_fma_f32 v[74:75], v[48:49], v[206:207], v[74:75] op_sel_hi:[0,1,1] neg_lo:[1,0,0] neg_hi:[1,0,0]
 v_pk_fma_f32 v[76:77], v[48:49], v[208:209], v[76:77] op_sel_hi:[0,1,1] neg_lo:[1,0,0] neg_hi:[1,0,0]
 v_pk_fma_f32 v[78:79], v[48:49], v[210:211], v[78:79] op_sel_hi:[0,1,1] neg_lo:[1,0,0] neg_hi:[1,0,0]
 v_pk_mul_f32 v[144:145], v[64:65], v[64:65]
 v_pk_mul_f32 v[146:147], v[66:67], v[66:67]
 v_pk_mul_f32 v[148:149], v[68:69], v[68:69]
 v_pk_mul_f32 v[150:151], v[70:71], v[70:71]
 v_pk_mul_f32 v[152:153], v[72:73], v[72:73]
 v_pk_mul_f32 v[154:155], v[74:75], v[74:75]
 v_pk_mul_f32 v[156:157], v[76:77], v[76:77]
 v_pk_mul_f32 v[158:159], v[78:79], v[78:79]
 v_pk_fma_f32 v[144:145], v[144:145], v[52:53], v[52:53] op_sel:[0,1,0] op_sel_hi:[1,1,0]
 v_pk_fma_f32 v[146:147], v[146:147], v[52:53], v[52:53] op_sel:[0,1,0] op_sel_hi:[1,1,0]
 v_pk_fma_f32 v[148:149], v[148:149], v[52:53], v[52:53] op_sel:[0,1,0] op_sel_hi:[1,1,0]
 v_pk_fma_f32 v[150:151], v[150:151], v[52:53], v[52:53] op_sel:[0,1,0] op_sel_hi:[1,1,0]
 v_pk_fma_f32 v[152:153], v[152:153], v[52:53], v[52:53] op_sel:[0,1,0] op_sel_hi:[1,1,0]
 v_pk_fma_f32 v[154:155], v[154:155], v[52:53], v[52:53] op_sel:[0,1,0] op_sel_hi:[1,1,0]
 v_pk_fma_f32 v[156:157], v[156:157], v[52:53], v[52:53] op_sel:[0,1,0] op_sel_hi:[1,1,0]
 v_pk_fma_f32 v[158:159], v[158:159], v[52:53], v[52:53] op_sel:[0,1,0] op_sel_hi:[1,1,0]
 v_pk_mul_f32 v[144:145], v[144:145], v[64:65]
 v_pk_mul_f32 v[146:147], v[146:147], v[66:67]
 v_pk_mul_f32 v[148:149], v[148:149], v[68:69]
 v_pk_mul_f32 v[150:151], v[150:151], v[70:71]
 v_pk_mul_f32 v[152:153], v[152:153], v[72:73]
 v_pk_mul_f32 v[154:155], v[154:155], v[74:75]
 v_pk_mul_f32 v[156:157], v[156:157], v[76:77]
 v_pk_mul_f32 v[158:159], v[158:159], v[78:79]
 v_exp_f32 v144, v144
 v_exp_f32 v145, v145
 v_exp_f32 v146, v146
 v_exp_f32 v147, v147
 v_exp_f32 v148, v148
 v_exp_f32 v149, v149
 v_exp_f32 v150, v150
 v_exp_f32 v151, v151
 v_exp_f32 v152, v152
 v_exp_f32 v153, v153
 v_exp_f32 v154, v154
 v_exp_f32 v155, v155
 v_exp_f32 v156, v156
 v_exp_f32 v157, v157
 v_exp_f32 v158, v158
 v_exp_f32 v159, v159
 v_pk_add_f32 v[144:145], v[144:145], 1.0 op_sel_hi:[1,0]
 v_pk_add_f32 v[146:147], v[146:147], 1.0 op_sel_hi:[1,0]
 v_pk_add_f32 v[148:149], v[148:149], 1.0 op_sel_hi:[1,0]
 v_pk_add_f32 v[150:151], v[150:151], 1.0 op_sel_hi:[1,0]
 v_pk_add_f32 v[152:153], v[152:153], 1.0 op_sel_hi:[1,0]
 v_pk_add_f32 v[154:155], v[154:155], 1.0 op_sel_hi:[1,0]
 v_pk_add_f32 v[156:157], v[156:157], 1.0 op_sel_hi:[1,0]
 v_pk_add_f32 v[158:159], v[158:159], 1.0 op_sel_hi:[1,0]
 v_rcp_f32 v144, v144
 v_rcp_f32 v145, v145
 v_rcp_f32 v146, v146
 v_rcp_f32 v147, v147
 v_rcp_f32 v148, v148
 v_rcp_f32 v149, v149
 v_rcp_f32 v150, v150
 v_rcp_f32 v151, v151
 v_rcp_f32 v152, v152
 v_rcp_f32 v153, v153
 v_rcp_f32 v154, v154
 v_rcp_f32 v155, v155
 v_rcp_f32 v156, v156
 v_rcp_f32 v157, v157
 v_rcp_f32 v158, v158
 v_rcp_f32 v159, v159
 v_pk_mul_f32 v[64:65], v[64:65], v[144:145]
 v_pk_mul_f32 v[66:67], v[66:67], v[146:147]
 v_pk_mul_f32 v[68:69], v[68:69], v[148:149]
 v_pk_mul_f32 v[70:71], v[70:71], v[150:151]
 v_pk_mul_f32 v[72:73], v[72:73], v[152:153]
 v_pk_mul_f32 v[74:75], v[74:75], v[154:155]
 v_pk_mul_f32 v[76:77], v[76:77], v[156:157]
 v_pk_mul_f32 v[78:79], v[78:79], v[158:159]
 v_cvt_pk_bf16_f32 v64, v64, v65
 v_cvt_pk_bf16_f32 v65, v66, v67
 v_cvt_pk_bf16_f32 v66, v68, v69
 v_cvt_pk_bf16_f32 v67, v70, v71
 v_cvt_pk_bf16_f32 v68, v72, v73
 v_cvt_pk_bf16_f32 v69, v74, v75
 v_cvt_pk_bf16_f32 v70, v76, v77
 v_cvt_pk_bf16_f32 v71, v78, v79
 v_pk_fma_f32 v[80:81], v[48:49], v[196:197], v[80:81] op_sel:[1,0,0] op_sel_hi:[1,1,1] neg_lo:[1,0,0] neg_hi:[1,0,0]
 v_pk_fma_f32 v[82:83], v[48:49], v[198:199], v[82:83] op_sel:[1,0,0] op_sel_hi:[1,1,1] neg_lo:[1,0,0] neg_hi:[1,0,0]
 v_pk_fma_f32 v[84:85], v[48:49], v[200:201], v[84:85] op_sel:[1,0,0] op_sel_hi:[1,1,1] neg_lo:[1,0,0] neg_hi:[1,0,0]
 v_pk_fma_f32 v[86:87], v[48:49], v[202:203], v[86:87] op_sel:[1,0,0] op_sel_hi:[1,1,1] neg_lo:[1,0,0] neg_hi:[1,0,0]
 v_pk_fma_f32 v[88:89], v[48:49], v[204:205], v[88:89] op_sel:[1,0,0] op_sel_hi:[1,1,1] neg_lo:[1,0,0] neg_hi:[1,0,0]
 v_pk_fma_f32 v[90:91], v[48:49], v[206:207], v[90:91] op_sel:[1,0,0] op_sel_hi:[1,1,1] neg_lo:[1,0,0] neg_hi:[1,0,0]
 v_pk_fma_f32 v[92:93], v[48:49], v[208:209], v[92:93] op_sel:[1,0,0] op_sel_hi:[1,1,1] neg_lo:[1,0,0] neg_hi:[1,0,0]
 v_pk_fma_f32 v[94:95], v[48:49], v[210:211], v[94:95] op_sel:[1,0,0] op_sel_hi:[1,1,1] neg_lo:[1,0,0] neg_hi:[1,0,0]
 v_pk_mul_f32 v[144:145], v[80:81], v[80:81]
 v_pk_mul_f32 v[146:147], v[82:83], v[82:83]
 v_pk_mul_f32 v[148:149], v[84:85], v[84:85]
 v_pk_mul_f32 v[150:151], v[86:87], v[86:87]
 v_pk_mul_f32 v[152:153], v[88:89], v[88:89]
 v_pk_mul_f32 v[154:155], v[90:91], v[90:91]
 v_pk_mul_f32 v[156:157], v[92:93], v[92:93]
 v_pk_mul_f32 v[158:159], v[94:95], v[94:95]
 v_pk_fma_f32 v[144:145], v[144:145], v[54:55], v[54:55] op_sel:[0,1,0] op_sel_hi:[1,1,0]
 v_pk_fma_f32 v[146:147], v[146:147], v[54:55], v[54:55] op_sel:[0,1,0] op_sel_hi:[1,1,0]
 v_pk_fma_f32 v[148:149], v[148:149], v[54:55], v[54:55] op_sel:[0,1,0] op_sel_hi:[1,1,0]
 v_pk_fma_f32 v[150:151], v[150:151], v[54:55], v[54:55] op_sel:[0,1,0] op_sel_hi:[1,1,0]
 v_pk_fma_f32 v[152:153], v[152:153], v[54:55], v[54:55] op_sel:[0,1,0] op_sel_hi:[1,1,0]
 v_pk_fma_f32 v[154:155], v[154:155], v[54:55], v[54:55] op_sel:[0,1,0] op_sel_hi:[1,1,0]
 v_pk_fma_f32 v[156:157], v[156:157], v[54:55], v[54:55] op_sel:[0,1,0] op_sel_hi:[1,1,0]
 v_pk_fma_f32 v[158:159], v[158:159], v[54:55], v[54:55] op_sel:[0,1,0] op_sel_hi:[1,1,0]
 v_pk_mul_f32 v[144:145], v[144:145], v[80:81]
 v_pk_mul_f32 v[146:147], v[146:147], v[82:83]
 v_pk_mul_f32 v[148:149], v[148:149], v[84:85]
 v_pk_mul_f32 v[150:151], v[150:151], v[86:87]
 v_pk_mul_f32 v[152:153], v[152:153], v[88:89]
 v_pk_mul_f32 v[154:155], v[154:155], v[90:91]
 v_pk_mul_f32 v[156:157], v[156:157], v[92:93]
 v_pk_mul_f32 v[158:159], v[158:159], v[94:95]
 v_exp_f32 v144, v144
 v_exp_f32 v145, v145
 v_exp_f32 v146, v146
 v_exp_f32 v147, v147
 v_exp_f32 v148, v148
 v_exp_f32 v149, v149
 v_exp_f32 v150, v150
 v_exp_f32 v151, v151
 v_exp_f32 v152, v152
 v_exp_f32 v153, v153
 v_exp_f32 v154, v154
 v_exp_f32 v155, v155
 v_exp_f32 v156, v156
 v_exp_f32 v157, v157
 v_exp_f32 v158, v158
 v_exp_f32 v159, v159
 v_pk_add_f32 v[144:145], v[144:145], 1.0 op_sel_hi:[1,0]
 v_pk_add_f32 v[146:147], v[146:147], 1.0 op_sel_hi:[1,0]
 v_pk_add_f32 v[148:149], v[148:149], 1.0 op_sel_hi:[1,0]
 v_pk_add_f32 v[150:151], v[150:151], 1.0 op_sel_hi:[1,0]
 v_pk_add_f32 v[152:153], v[152:153], 1.0 op_sel_hi:[1,0]
 v_pk_add_f32 v[154:155], v[154:155], 1.0 op_sel_hi:[1,0]
 v_pk_add_f32 v[156:157], v[156:157], 1.0 op_sel_hi:[1,0]
 v_pk_add_f32 v[158:159], v[158:159], 1.0 op_sel_hi:[1,0]
 v_rcp_f32 v144, v144
 v_rcp_f32 v145, v145
 v_rcp_f32 v146, v146
 v_rcp_f32 v147, v147
 v_rcp_f32 v148, v148
 v_rcp_f32 v149, v149
 v_rcp_f32 v150, v150
 v_rcp_f32 v151, v151
 v_rcp_f32 v152, v152
 v_rcp_f32 v153, v153
 v_rcp_f32 v154, v154
 v_rcp_f32 v155, v155
 v_rcp_f32 v156, v156
 v_rcp_f32 v157, v157
 v_rcp_f32 v158, v158
 v_rcp_f32 v159, v159
 v_pk_mul_f32 v[80:81], v[80:81], v[144:145]
 v_pk_mul_f32 v[82:83], v[82:83], v[146:147]
 v_pk_mul_f32 v[84:85], v[84:85], v[148:149]
 v_pk_mul_f32 v[86:87], v[86:87], v[150:151]
 v_pk_mul_f32 v[88:89], v[88:89], v[152:153]
 v_pk_mul_f32 v[90:91], v[90:91], v[154:155]
 v_pk_mul_f32 v[92:93], v[92:93], v[156:157]
 v_pk_mul_f32 v[94:95], v[94:95], v[158:159]
 v_cvt_pk_bf16_f32 v80, v80, v81
 v_cvt_pk_bf16_f32 v81, v82, v83
 v_cvt_pk_bf16_f32 v82, v84, v85
 v_cvt_pk_bf16_f32 v83, v86, v87
 v_cvt_pk_bf16_f32 v84, v88, v89
 v_cvt_pk_bf16_f32 v85, v90, v91
 v_cvt_pk_bf16_f32 v86, v92, v93
 v_cvt_pk_bf16_f32 v87, v94, v95
 v_pk_fma_f32 v[96:97], v[48:49], v[212:213], v[96:97] op_sel_hi:[0,1,1] neg_lo:[1,0,0] neg_hi:[1,0,0]
 v_pk_fma_f32 v[98:99], v[48:49], v[214:215], v[98:99] op_sel_hi:[0,1,1] neg_lo:[1,0,0] neg_hi:[1,0,0]
 v_pk_fma_f32 v[100:101], v[48:49], v[216:217], v[100:101] op_sel_hi:[0,1,1] neg_lo:[1,0,0] neg_hi:[1,0,0]
 v_pk_fma_f32 v[102:103], v[48:49], v[218:219], v[102:103] op_sel_hi:[0,1,1] neg_lo:[1,0,0] neg_hi:[1,0,0]
 v_pk_fma_f32 v[104:105], v[48:49], v[220:221], v[104:105] op_sel_hi:[0,1,1] neg_lo:[1,0,0] neg_hi:[1,0,0]
 v_pk_fma_f32 v[106:107], v[48:49], v[222:223], v[106:107] op_sel_hi:[0,1,1] neg_lo:[1,0,0] neg_hi:[1,0,0]
 v_pk_fma_f32 v[108:109], v[48:49], v[224:225], v[108:109] op_sel_hi:[0,1,1] neg_lo:[1,0,0] neg_hi:[1,0,0]
 v_pk_fma_f32 v[110:111], v[48:49], v[226:227], v[110:111] op_sel_hi:[0,1,1] neg_lo:[1,0,0] neg_hi:[1,0,0]
 v_pk_mul_f32 v[144:145], v[96:97], v[96:97]
 v_pk_mul_f32 v[146:147], v[98:99], v[98:99]
 v_pk_mul_f32 v[148:149], v[100:101], v[100:101]
 v_pk_mul_f32 v[150:151], v[102:103], v[102:103]
 v_pk_mul_f32 v[152:153], v[104:105], v[104:105]
 v_pk_mul_f32 v[154:155], v[106:107], v[106:107]
 v_pk_mul_f32 v[156:157], v[108:109], v[108:109]
 v_pk_mul_f32 v[158:159], v[110:111], v[110:111]
 v_pk_fma_f32 v[144:145], v[144:145], v[52:53], v[52:53] op_sel:[0,1,0] op_sel_hi:[1,1,0]
 v_pk_fma_f32 v[146:147], v[146:147], v[52:53], v[52:53] op_sel:[0,1,0] op_sel_hi:[1,1,0]
 v_pk_fma_f32 v[148:149], v[148:149], v[52:53], v[52:53] op_sel:[0,1,0] op_sel_hi:[1,1,0]
 v_pk_fma_f32 v[150:151], v[150:151], v[52:53], v[52:53] op_sel:[0,1,0] op_sel_hi:[1,1,0]
 v_pk_fma_f32 v[152:153], v[152:153], v[52:53], v[52:53] op_sel:[0,1,0] op_sel_hi:[1,1,0]
 v_pk_fma_f32 v[154:155], v[154:155], v[52:53], v[52:53] op_sel:[0,1,0] op_sel_hi:[1,1,0]
 v_pk_fma_f32 v[156:157], v[156:157], v[52:53], v[52:53] op_sel:[0,1,0] op_sel_hi:[1,1,0]
 v_pk_fma_f32 v[158:159], v[158:159], v[52:53], v[52:53] op_sel:[0,1,0] op_sel_hi:[1,1,0]
 v_pk_mul_f32 v[144:145], v[144:145], v[96:97]
 v_pk_mul_f32 v[146:147], v[146:147], v[98:99]
 v_pk_mul_f32 v[148:149], v[148:149], v[100:101]
 v_pk_mul_f32 v[150:151], v[150:151], v[102:103]
 v_pk_mul_f32 v[152:153], v[152:153], v[104:105]
 v_pk_mul_f32 v[154:155], v[154:155], v[106:107]
 v_pk_mul_f32 v[156:157], v[156:157], v[108:109]
 v_pk_mul_f32 v[158:159], v[158:159], v[110:111]
 v_exp_f32 v144, v144
 v_exp_f32 v145, v145
 v_exp_f32 v146, v146
 v_exp_f32 v147, v147
 v_exp_f32 v148, v148
 v_exp_f32 v149, v149
 v_exp_f32 v150, v150
 v_exp_f32 v151, v151
 v_exp_f32 v152, v152
 v_exp_f32 v153, v153
 v_exp_f32 v154, v154
 v_exp_f32 v155, v155
 v_exp_f32 v156, v156
 v_exp_f32 v157, v157
 v_exp_f32 v158, v158
 v_exp_f32 v159, v159
 v_pk_add_f32 v[144:145], v[144:145], 1.0 op_sel_hi:[1,0]
 v_pk_add_f32 v[146:147], v[146:147], 1.0 op_sel_hi:[1,0]
 v_pk_add_f32 v[148:149], v[148:149], 1.0 op_sel_hi:[1,0]
 v_pk_add_f32 v[150:151], v[150:151], 1.0 op_sel_hi:[1,0]
 v_pk_add_f32 v[152:153], v[152:153], 1.0 op_sel_hi:[1,0]
 v_pk_add_f32 v[154:155], v[154:155], 1.0 op_sel_hi:[1,0]
 v_pk_add_f32 v[156:157], v[156:157], 1.0 op_sel_hi:[1,0]
 v_pk_add_f32 v[158:159], v[158:159], 1.0 op_sel_hi:[1,0]
 v_rcp_f32 v144, v144
 v_rcp_f32 v145, v145
 v_rcp_f32 v146, v146
 v_rcp_f32 v147, v147
 v_rcp_f32 v148, v148
 v_rcp_f32 v149, v149
 v_rcp_f32 v150, v150
 v_rcp_f32 v151, v151
 v_rcp_f32 v152, v152
 v_rcp_f32 v153, v153
 v_rcp_f32 v154, v154
 v_rcp_f32 v155, v155
 v_rcp_f32 v156, v156
 v_rcp_f32 v157, v157
 v_rcp_f32 v158, v158
 v_rcp_f32 v159, v159
 v_pk_mul_f32 v[96:97], v[96:97], v[144:145]
 v_pk_mul_f32 v[98:99], v[98:99], v[146:147]
 v_pk_mul_f32 v[100:101], v[100:101], v[148:149]
 v_pk_mul_f32 v[102:103], v[102:103], v[150:151]
 v_pk_mul_f32 v[104:105], v[104:105], v[152:153]
 v_pk_mul_f32 v[106:107], v[106:107], v[154:155]
 v_pk_mul_f32 v[108:109], v[108:109], v[156:157]
 v_pk_mul_f32 v[110:111], v[110:111], v[158:159]
 v_cvt_pk_bf16_f32 v96, v96, v97
 v_cvt_pk_bf16_f32 v97, v98, v99
 v_cvt_pk_bf16_f32 v98, v100, v101
 v_cvt_pk_bf16_f32 v99, v102, v103
 v_cvt_pk_bf16_f32 v100, v104, v105
 v_cvt_pk_bf16_f32 v101, v106, v107
 v_cvt_pk_bf16_f32 v102, v108, v109
 v_cvt_pk_bf16_f32 v103, v110, v111
 v_pk_fma_f32 v[112:113], v[48:49], v[212:213], v[112:113] op_sel:[1,0,0] op_sel_hi:[1,1,1] neg_lo:[1,0,0] neg_hi:[1,0,0]
 v_pk_fma_f32 v[114:115], v[48:49], v[214:215], v[114:115] op_sel:[1,0,0] op_sel_hi:[1,1,1] neg_lo:[1,0,0] neg_hi:[1,0,0]
 v_pk_fma_f32 v[116:117], v[48:49], v[216:217], v[116:117] op_sel:[1,0,0] op_sel_hi:[1,1,1] neg_lo:[1,0,0] neg_hi:[1,0,0]
 v_pk_fma_f32 v[118:119], v[48:49], v[218:219], v[118:119] op_sel:[1,0,0] op_sel_hi:[1,1,1] neg_lo:[1,0,0] neg_hi:[1,0,0]
 v_pk_fma_f32 v[120:121], v[48:49], v[220:221], v[120:121] op_sel:[1,0,0] op_sel_hi:[1,1,1] neg_lo:[1,0,0] neg_hi:[1,0,0]
 v_pk_fma_f32 v[122:123], v[48:49], v[222:223], v[122:123] op_sel:[1,0,0] op_sel_hi:[1,1,1] neg_lo:[1,0,0] neg_hi:[1,0,0]
 v_pk_fma_f32 v[124:125], v[48:49], v[224:225], v[124:125] op_sel:[1,0,0] op_sel_hi:[1,1,1] neg_lo:[1,0,0] neg_hi:[1,0,0]
 v_pk_fma_f32 v[126:127], v[48:49], v[226:227], v[126:127] op_sel:[1,0,0] op_sel_hi:[1,1,1] neg_lo:[1,0,0] neg_hi:[1,0,0]
 v_pk_mul_f32 v[144:145], v[112:113], v[112:113]
 v_pk_mul_f32 v[146:147], v[114:115], v[114:115]
 v_pk_mul_f32 v[148:149], v[116:117], v[116:117]
 v_pk_mul_f32 v[150:151], v[118:119], v[118:119]
 v_pk_mul_f32 v[152:153], v[120:121], v[120:121]
 v_pk_mul_f32 v[154:155], v[122:123], v[122:123]
 v_pk_mul_f32 v[156:157], v[124:125], v[124:125]
 v_pk_mul_f32 v[158:159], v[126:127], v[126:127]
 v_pk_fma_f32 v[144:145], v[144:145], v[54:55], v[54:55] op_sel:[0,1,0] op_sel_hi:[1,1,0]
 v_pk_fma_f32 v[146:147], v[146:147], v[54:55], v[54:55] op_sel:[0,1,0] op_sel_hi:[1,1,0]
 v_pk_fma_f32 v[148:149], v[148:149], v[54:55], v[54:55] op_sel:[0,1,0] op_sel_hi:[1,1,0]
 v_pk_fma_f32 v[150:151], v[150:151], v[54:55], v[54:55] op_sel:[0,1,0] op_sel_hi:[1,1,0]
 v_pk_fma_f32 v[152:153], v[152:153], v[54:55], v[54:55] op_sel:[0,1,0] op_sel_hi:[1,1,0]
 v_pk_fma_f32 v[154:155], v[154:155], v[54:55], v[54:55] op_sel:[0,1,0] op_sel_hi:[1,1,0]
 v_pk_fma_f32 v[156:157], v[156:157], v[54:55], v[54:55] op_sel:[0,1,0] op_sel_hi:[1,1,0]
 v_pk_fma_f32 v[158:159], v[158:159], v[54:55], v[54:55] op_sel:[0,1,0] op_sel_hi:[1,1,0]
 v_pk_mul_f32 v[144:145], v[144:145], v[112:113]
 v_pk_mul_f32 v[146:147], v[146:147], v[114:115]
 v_pk_mul_f32 v[148:149], v[148:149], v[116:117]
 v_pk_mul_f32 v[150:151], v[150:151], v[118:119]
 v_pk_mul_f32 v[152:153], v[152:153], v[120:121]
 v_pk_mul_f32 v[154:155], v[154:155], v[122:123]
 v_pk_mul_f32 v[156:157], v[156:157], v[124:125]
 v_pk_mul_f32 v[158:159], v[158:159], v[126:127]
 v_exp_f32 v144, v144
 v_exp_f32 v145, v145
 v_exp_f32 v146, v146
 v_exp_f32 v147, v147
 v_exp_f32 v148, v148
 v_exp_f32 v149, v149
 v_exp_f32 v150, v150
 v_exp_f32 v151, v151
 v_exp_f32 v152, v152
 v_exp_f32 v153, v153
 v_exp_f32 v154, v154
 v_exp_f32 v155, v155
 v_exp_f32 v156, v156
 v_exp_f32 v157, v157
 v_exp_f32 v158, v158
 v_exp_f32 v159, v159
 v_pk_add_f32 v[144:145], v[144:145], 1.0 op_sel_hi:[1,0]
 v_pk_add_f32 v[146:147], v[146:147], 1.0 op_sel_hi:[1,0]
 v_pk_add_f32 v[148:149], v[148:149], 1.0 op_sel_hi:[1,0]
 v_pk_add_f32 v[150:151], v[150:151], 1.0 op_sel_hi:[1,0]
 v_pk_add_f32 v[152:153], v[152:153], 1.0 op_sel_hi:[1,0]
 v_pk_add_f32 v[154:155], v[154:155], 1.0 op_sel_hi:[1,0]
 v_pk_add_f32 v[156:157], v[156:157], 1.0 op_sel_hi:[1,0]
 v_pk_add_f32 v[158:159], v[158:159], 1.0 op_sel_hi:[1,0]
 v_rcp_f32 v144, v144
 v_rcp_f32 v145, v145
 v_rcp_f32 v146, v146
 v_rcp_f32 v147, v147
 v_rcp_f32 v148, v148
 v_rcp_f32 v149, v149
 v_rcp_f32 v150, v150
 v_rcp_f32 v151, v151
 v_rcp_f32 v152, v152
 v_rcp_f32 v153, v153
 v_rcp_f32 v154, v154
 v_rcp_f32 v155, v155
 v_rcp_f32 v156, v156
 v_rcp_f32 v157, v157
 v_rcp_f32 v158, v158
 v_rcp_f32 v159, v159
 v_pk_mul_f32 v[112:113], v[112:113], v[144:145]
 v_pk_mul_f32 v[114:115], v[114:115], v[146:147]
 v_pk_mul_f32 v[116:117], v[116:117], v[148:149]
 v_pk_mul_f32 v[118:119], v[118:119], v[150:151]
 v_pk_mul_f32 v[120:121], v[120:121], v[152:153]
 v_pk_mul_f32 v[122:123], v[122:123], v[154:155]
 v_pk_mul_f32 v[124:125], v[124:125], v[156:157]
 v_pk_mul_f32 v[126:127], v[126:127], v[158:159]
 v_cvt_pk_bf16_f32 v112, v112, v113
 v_cvt_pk_bf16_f32 v113, v114, v115
 v_cvt_pk_bf16_f32 v114, v116, v117
 v_cvt_pk_bf16_f32 v115, v118, v119
 v_cvt_pk_bf16_f32 v116, v120, v121
 v_cvt_pk_bf16_f32 v117, v122, v123
 v_cvt_pk_bf16_f32 v118, v124, v125
 v_cvt_pk_bf16_f32 v119, v126, v127
 s_branch L_fz_p4gz1s
L_fz_p4gz1r:
 ds_read_b128 v[128:131], v26 offset:0
 ds_read_b128 v[132:135], v26 offset:1024
 s_waitcnt lgkmcnt(0)
 v_pk_add_f32 v[136:137], v[136:137], v[128:129]
 v_pk_add_f32 v[138:139], v[138:139], v[130:131]
 v_pk_add_f32 v[140:141], v[140:141], v[132:133]
 v_pk_add_f32 v[142:143], v[142:143], v[134:135]
 v_pk_fma_f32 v[136:137], v[30:31], v[60:61], v[136:137] op_sel_hi:[0,1,1] neg_lo:[1,0,0] neg_hi:[1,0,0]
 v_pk_fma_f32 v[138:139], v[30:31], v[62:63], v[138:139] op_sel_hi:[0,1,1] neg_lo:[1,0,0] neg_hi:[1,0,0]
 v_pk_fma_f32 v[140:141], v[30:31], v[60:61], v[140:141] op_sel:[1,0,0] op_sel_hi:[1,1,1] neg_lo:[1,0,0] neg_hi:[1,0,0]
 v_pk_fma_f32 v[142:143], v[30:31], v[62:63], v[142:143] op_sel:[1,0,0] op_sel_hi:[1,1,1] neg_lo:[1,0,0] neg_hi:[1,0,0]
 v_pk_mul_f32 v[144:145], v[136:137], v[136:137]
 v_pk_mul_f32 v[146:147], v[138:139], v[138:139]
 v_pk_mul_f32 v[148:149], v[140:141], v[140:141]
 v_pk_mul_f32 v[150:151], v[142:143], v[142:143]
 v_pk_fma_f32 v[144:145], v[144:145], v[40:41], v[40:41] op_sel:[0,1,0] op_sel_hi:[1,1,0]
 v_pk_fma_f32 v[146:147], v[146:147], v[40:41], v[40:41] op_sel:[0,1,0] op_sel_hi:[1,1,0]
 v_pk_fma_f32 v[148:149], v[148:149], v[42:43], v[42:43] op_sel:[0,1,0] op_sel_hi:[1,1,0]
 v_pk_fma_f32 v[150:151], v[150:151], v[42:43], v[42:43] op_sel:[0,1,0] op_sel_hi:[1,1,0]
 v_pk_mul_f32 v[144:145], v[144:145], v[136:137]
 v_pk_mul_f32 v[146:147], v[146:147], v[138:139]
 v_pk_mul_f32 v[148:149], v[148:149], v[140:141]
 v_pk_mul_f32 v[150:151], v[150:151], v[142:143]
 v_exp_f32 v144, v144
 v_exp_f32 v145, v145
 v_exp_f32 v146, v146
 v_exp_f32 v147, v147
 v_exp_f32 v148, v148
 v_exp_f32 v149, v149
 v_exp_f32 v150, v150
 v_exp_f32 v151, v151
 v_pk_add_f32 v[144:145], v[144:145], 1.0 op_sel_hi:[1,0]
 v_pk_add_f32 v[146:147], v[146:147], 1.0 op_sel_hi:[1,0]
 v_pk_add_f32 v[148:149], v[148:149], 1.0 op_sel_hi:[1,0]
 v_pk_add_f32 v[150:151], v[150:151], 1.0 op_sel_hi:[1,0]
 v_rcp_f32 v144, v144
 v_rcp_f32 v145, v145
 v_rcp_f32 v146, v146
 v_rcp_f32 v147, v147
 v_rcp_f32 v148, v148
 v_rcp_f32 v149, v149
 v_rcp_f32 v150, v150
 v_rcp_f32 v151, v151
 v_pk_mul_f32 v[136:137], v[136:137], v[144:145]
 v_pk_mul_f32 v[138:139], v[138:139], v[146:147]
 v_pk_mul_f32 v[140:141], v[140:141], v[148:149]
 v_pk_mul_f32 v[142:143], v[142:143], v[150:151]
 v_cvt_pk_bf16_f32 v248, v136, v137
 v_cvt_pk_bf16_f32 v249, v138, v139
 v_cvt_pk_bf16_f32 v250, v140, v141
 v_cvt_pk_bf16_f32 v251, v142, v143
 s_mov_b32 s46, 200000
L_fz_p4gs1:
 s_sleep 1
 ds_read_b32 v11, v10
 s_waitcnt lgkmcnt(0)
 v_cmp_ne_u32 vcc, 1, v11
 s_sub_u32 s46, s46, 1
 s_cbranch_vccz L_fz_p4gs1r
 s_cmp_lg_u32 s46, 0
 s_cbranch_scc1 L_fz_p4gs1
L_fz_p4gs1r:
 s_mov_b32 s43, 0
 s_add_u32 m0, s49, 107520
 s_nop 0
 buffer_load_dwordx4 v8, s[16:19], s43 offen sc1 lds
 buffer_load_dwordx4 v8, s[16:19], s43 offen offset:1024 sc1 lds
 s_add_u32 m0, s49, 114688
 s_nop 0
 buffer_load_dwordx4 v8, s[16:19], s43 offen offset:2048 sc1 lds
 buffer_load_dwordx4 v8, s[16:19], s43 offen offset:3072 sc1 lds
 s_movk_i32 s42, 128
 s_mov_b32 s43, 4096
 s_add_u32 m0, s48, 49152
 s_nop 0
 buffer_load_dwordx4 v4, s[12:15], s42 offen lds
 s_add_u32 m0, s48, 50176
 s_nop 0
 buffer_load_dwordx4 v5, s[12:15], s42 offen lds
 s_add_u32 m0, s48, 51200
 s_nop 0
 buffer_load_dwordx4 v6, s[12:15], s42 offen lds
 s_add_u32 m0, s48, 52224
 s_nop 0
 buffer_load_dwordx4 v7, s[12:15], s42 offen lds
 s_add_u32 m0, s49, 125952
 s_nop 0
 buffer_load_dwordx4 v8, s[16:19], s43 offen sc1 lds
 buffer_load_dwordx4 v8, s[16:19], s43 offen offset:1024 sc1 lds
 s_add_u32 m0, s49, 133120
 s_nop 0
 buffer_load_dwordx4 v8, s[16:19], s43 offen offset:2048 sc1 lds
 buffer_load_dwordx4 v8, s[16:19], s43 offen offset:3072 sc1 lds
 s_waitcnt vmcnt(8) lgkmcnt(0)
 s_barrier
 s_movk_i32 s42, 256
 s_mov_b32 s43, 8192
 s_add_u32 m0, s48, 0
 s_nop 0
 buffer_load_dwordx4 v4, s[12:15], s42 offen lds
 s_add_u32 m0, s48, 1024
 s_nop 0
 buffer_load_dwordx4 v5, s[12:15], s42 offen lds
 s_add_u32 m0, s48, 2048
 s_nop 0
 buffer_load_dwordx4 v6, s[12:15], s42 offen lds
 s_add_u32 m0, s48, 3072
 s_nop 0
 buffer_load_dwordx4 v7, s[12:15], s42 offen lds
 s_add_u32 m0, s49, 70656
 s_nop 0
 buffer_load_dwordx4 v8, s[16:19], s43 offen sc1 lds
 buffer_load_dwordx4 v8, s[16:19], s43 offen offset:1024 sc1 lds
 s_add_u32 m0, s49, 77824
 s_nop 0
 buffer_load_dwordx4 v8, s[16:19], s43 offen offset:2048 sc1 lds
 buffer_load_dwordx4 v8, s[16:19], s43 offen offset:3072 sc1 lds
 s_movk_i32 s42, 384
 s_mov_b32 s43, 12288
 s_add_u32 m0, s48, 16384
 s_nop 0
 buffer_load_dwordx4 v4, s[12:15], s42 offen lds
 s_add_u32 m0, s48, 17408
 s_nop 0
 buffer_load_dwordx4 v5, s[12:15], s42 offen lds
 s_add_u32 m0, s48, 18432
 s_nop 0
 buffer_load_dwordx4 v6, s[12:15], s42 offen lds
 s_add_u32 m0, s48, 19456
 s_nop 0
 buffer_load_dwordx4 v7, s[12:15], s42 offen lds
 s_add_u32 m0, s49, 89088
 s_nop 0
 buffer_load_dwordx4 v8, s[16:19], s43 offen sc1 lds
 buffer_load_dwordx4 v8, s[16:19], s43 offen offset:1024 sc1 lds
 s_add_u32 m0, s49, 96256
 s_nop 0
 buffer_load_dwordx4 v8, s[16:19], s43 offen offset:2048 sc1 lds
 buffer_load_dwordx4 v8, s[16:19], s43 offen offset:3072 sc1 lds
 s_movk_i32 s42, 512
 s_mov_b32 s43, 16384
 s_waitcnt vmcnt(16) lgkmcnt(0)
 s_barrier
 s_add_u32 m0, s48, 32768
 s_nop 0
 buffer_load_dwordx4 v4, s[12:15], s42 offen lds
 s_add_u32 m0, s48, 33792
 s_nop 0
 buffer_load_dwordx4 v5, s[12:15], s42 offen lds
 s_add_u32 m0, s48, 34816
 s_nop 0
 buffer_load_dwordx4 v6, s[12:15], s42 offen lds
 s_add_u32 m0, s48, 35840
 s_nop 0
 buffer_load_dwordx4 v7, s[12:15], s42 offen lds
 s_add_u32 m0, s49, 107520
 s_nop 0
 buffer_load_dwordx4 v8, s[16:19], s43 offen sc1 lds
 buffer_load_dwordx4 v8, s[16:19], s43 offen offset:1024 sc1 lds
 s_add_u32 m0, s49, 114688
 s_nop 0
 buffer_load_dwordx4 v8, s[16:19], s43 offen offset:2048 sc1 lds
 buffer_load_dwordx4 v8, s[16:19], s43 offen offset:3072 sc1 lds
 s_add_u32 s42, s42, 128
 s_add_u32 s43, s43, 4096
 s_mov_b32 s20, s78
 s_mov_b32 s21, s79
 s_mov_b32 s22, 2654208
 s_mov_b32 s23, 0x20000
 s_mov_b32 s24, s74
 s_mov_b32 s25, s75
 s_mov_b32 s26, 8388608
 s_mov_b32 s27, 0x20000
 s_lshl_b32 s36, s2, 2
 s_add_u32 s36, s36, s32
 s_lshl_b32 s37, s36, 13
 s_add_u32 s47, s37, 4096
 s_mul_i32 s36, s36, 3072
 v_lshrrev_b32 v12, 3, v0
 v_and_b32 v13, 7, v0
 v_min_u32 v12, 1, v12
 v_lshlrev_b32 v12, 12, v12
 v_lshl_add_u32 v12, v13, 7, v12
 v_min_u32 v13, 23, v0
 v_lshlrev_b32 v13, 7, v13
 s_waitcnt vmcnt(16) lgkmcnt(0)
 s_barrier
 s_add_u32 m0, s48, 49152
 s_nop 0
 buffer_load_dwordx4 v4, s[12:15], s42 offen lds
 s_add_u32 m0, s48, 50176
 s_nop 0
 buffer_load_dwordx4 v5, s[12:15], s42 offen lds
 s_add_u32 m0, s48, 51200
 s_nop 0
 buffer_load_dwordx4 v6, s[12:15], s42 offen lds
 s_add_u32 m0, s48, 52224
 s_nop 0
 buffer_load_dwordx4 v7, s[12:15], s42 offen lds
 s_add_u32 m0, s49, 125952
 s_nop 0
 buffer_load_dwordx4 v8, s[16:19], s43 offen sc1 lds
 buffer_load_dwordx4 v8, s[16:19], s43 offen offset:1024 sc1 lds
 s_add_u32 m0, s49, 133120
 s_nop 0
 buffer_load_dwordx4 v8, s[16:19], s43 offen offset:2048 sc1 lds
 buffer_load_dwordx4 v8, s[16:19], s43 offen offset:3072 sc1 lds
 s_add_u32 s42, s42, 128
 s_add_u32 s43, s43, 4096
 s_waitcnt vmcnt(16) lgkmcnt(0)
 s_barrier
 s_add_u32 m0, s48, 0
 s_nop 0
 buffer_load_dwordx4 v4, s[12:15], s42 offen lds
 s_add_u32 m0, s48, 1024
 s_nop 0
 buffer_load_dwordx4 v5, s[12:15], s42 offen lds
 s_add_u32 m0, s48, 2048
 s_nop 0
 buffer_load_dwordx4 v6, s[12:15], s42 offen lds
 s_add_u32 m0, s48, 3072
 s_nop 0
 buffer_load_dwordx4 v7, s[12:15], s42 offen lds
 s_add_u32 m0, s49, 70656
 s_nop 0
 buffer_load_dwordx4 v8, s[16:19], s43 offen sc1 lds
 buffer_load_dwordx4 v8, s[16:19], s43 offen offset:1024 sc1 lds
 s_add_u32 m0, s49, 77824
 s_nop 0
 buffer_load_dwordx4 v8, s[16:19], s43 offen offset:2048 sc1 lds
 buffer_load_dwordx4 v8, s[16:19], s43 offen offset:3072 sc1 lds
 s_add_u32 s42, s42, 128
 s_add_u32 s43, s43, 4096
 s_waitcnt vmcnt(16) lgkmcnt(0)
 s_barrier
 s_add_u32 m0, s48, 16384
 s_nop 0
 buffer_load_dwordx4 v4, s[12:15], s42 offen lds
 s_add_u32 m0, s48, 17408
 s_nop 0
 buffer_load_dwordx4 v5, s[12:15], s42 offen lds
 s_add_u32 m0, s48, 18432
 s_nop 0
 buffer_load_dwordx4 v6, s[12:15], s42 offen lds
 s_add_u32 m0, s48, 19456
 s_nop 0
 buffer_load_dwordx4 v7, s[12:15], s42 offen lds
 s_add_u32 m0, s49, 89088
 s_nop 0
 buffer_load_dwordx4 v8, s[16:19], s43 offen sc1 lds
 buffer_load_dwordx4 v8, s[16:19], s43 offen offset:1024 sc1 lds
 s_add_u32 m0, s49, 96256
 s_nop 0
 buffer_load_dwordx4 v8, s[16:19], s43 offen offset:2048 sc1 lds
 buffer_load_dwordx4 v8, s[16:19], s43 offen offset:3072 sc1 lds
 s_add_u32 s42, s42, 128
 s_add_u32 s43, s43, 4096
 buffer_load_dword v196, v12, s[24:27], s37 offen offset:3072
 s_waitcnt vmcnt(17) lgkmcnt(0)
 s_barrier
 s_add_u32 m0, s48, 32768
 s_nop 0
 buffer_load_dwordx4 v4, s[12:15], s42 offen lds
 s_add_u32 m0, s48, 33792
 s_nop 0
 buffer_load_dwordx4 v5, s[12:15], s42 offen lds
 s_add_u32 m0, s48, 34816
 s_nop 0
 buffer_load_dwordx4 v6, s[12:15], s42 offen lds
 s_add_u32 m0, s48, 35840
 s_nop 0
 buffer_load_dwordx4 v7, s[12:15], s42 offen lds
 s_add_u32 m0, s49, 107520
 s_nop 0
 buffer_load_dwordx4 v8, s[16:19], s43 offen sc1 lds
 buffer_load_dwordx4 v8, s[16:19], s43 offen offset:1024 sc1 lds
 s_add_u32 m0, s49, 114688
 s_nop 0
 buffer_load_dwordx4 v8, s[16:19], s43 offen offset:2048 sc1 lds
 buffer_load_dwordx4 v8, s[16:19], s43 offen offset:3072 sc1 lds
 s_add_u32 s42, s42, 128
 s_add_u32 s43, s43, 4096
 s_waitcnt vmcnt(17) lgkmcnt(0)
 s_barrier
 s_add_u32 m0, s48, 49152
 s_nop 0
 buffer_load_dwordx4 v4, s[12:15], s42 offen lds
 s_add_u32 m0, s48, 50176
 s_nop 0
 buffer_load_dwordx4 v5, s[12:15], s42 offen lds
 s_add_u32 m0, s48, 51200
 s_nop 0
 buffer_load_dwordx4 v6, s[12:15], s42 offen lds
 s_add_u32 m0, s48, 52224
 s_nop 0
 buffer_load_dwordx4 v7, s[12:15], s42 offen lds
 s_add_u32 m0, s49, 125952
 s_nop 0
 buffer_load_dwordx4 v8, s[16:19], s43 offen sc1 lds
 buffer_load_dwordx4 v8, s[16:19], s43 offen offset:1024 sc1 lds
 s_add_u32 m0, s49, 133120
 s_nop 0
 buffer_load_dwordx4 v8, s[16:19], s43 offen offset:2048 sc1 lds
 buffer_load_dwordx4 v8, s[16:19], s43 offen offset:3072 sc1 lds
 s_add_u32 s42, s42, 128
 s_add_u32 s43, s43, 4096
 s_waitcnt vmcnt(17) lgkmcnt(0)
 s_barrier
 s_add_u32 m0, s48, 0
 s_nop 0
 buffer_load_dwordx4 v4, s[12:15], s42 offen lds
 s_add_u32 m0, s48, 1024
 s_nop 0
 buffer_load_dwordx4 v5, s[12:15], s42 offen lds
 s_add_u32 m0, s48, 2048
 s_nop 0
 buffer_load_dwordx4 v6, s[12:15], s42 offen lds
 s_add_u32 m0, s48, 3072
 s_nop 0
 buffer_load_dwordx4 v7, s[12:15], s42 offen lds
 s_add_u32 m0, s49, 70656
 s_nop 0
 buffer_load_dwordx4 v8, s[16:19], s43 offen sc1 lds
 buffer_load_dwordx4 v8, s[16:19], s43 offen offset:1024 sc1 lds
 s_add_u32 m0, s49, 77824
 s_nop 0
 buffer_load_dwordx4 v8, s[16:19], s43 offen offset:2048 sc1 lds
 buffer_load_dwordx4 v8, s[16:19], s43 offen offset:3072 sc1 lds
 s_add_u32 s42, s42, 128
 s_add_u32 s43, s43, 4096
 s_waitcnt vmcnt(16) lgkmcnt(0)
 s_barrier
 s_add_u32 m0, s48, 16384
 s_nop 0
 buffer_load_dwordx4 v4, s[12:15], s42 offen lds
 s_add_u32 m0, s48, 17408
 s_nop 0
 buffer_load_dwordx4 v5, s[12:15], s42 offen lds
 s_add_u32 m0, s48, 18432
 s_nop 0
 buffer_load_dwordx4 v6, s[12:15], s42 offen lds
 s_add_u32 m0, s48, 19456
 s_nop 0
 buffer_load_dwordx4 v7, s[12:15], s42 offen lds
 s_add_u32 m0, s49, 89088
 s_nop 0
 buffer_load_dwordx4 v8, s[16:19], s43 offen sc1 lds
 buffer_load_dwordx4 v8, s[16:19], s43 offen offset:1024 sc1 lds
 s_add_u32 m0, s49, 96256
 s_nop 0
 buffer_load_dwordx4 v8, s[16:19], s43 offen offset:2048 sc1 lds
 buffer_load_dwordx4 v8, s[16:19], s43 offen offset:3072 sc1 lds
 s_add_u32 s42, s42, 128
 s_add_u32 s43, s43, 4096
 s_waitcnt vmcnt(16) lgkmcnt(0)
 s_barrier
 s_add_u32 m0, s48, 32768
 s_nop 0
 buffer_load_dwordx4 v4, s[12:15], s42 offen lds
 s_add_u32 m0, s48, 33792
 s_nop 0
 buffer_load_dwordx4 v5, s[12:15], s42 offen lds
 s_add_u32 m0, s48, 34816
 s_nop 0
 buffer_load_dwordx4 v6, s[12:15], s42 offen lds
 s_add_u32 m0, s48, 35840
 s_nop 0
 buffer_load_dwordx4 v7, s[12:15], s42 offen lds
 s_add_u32 m0, s49, 107520
 s_nop 0
 buffer_load_dwordx4 v8, s[16:19], s43 offen sc1 lds
 buffer_load_dwordx4 v8, s[16:19], s43 offen offset:1024 sc1 lds
 s_add_u32 m0, s49, 114688
 s_nop 0
 buffer_load_dwordx4 v8, s[16:19], s43 offen offset:2048 sc1 lds
 buffer_load_dwordx4 v8, s[16:19], s43 offen offset:3072 sc1 lds
 s_add_u32 s42, s42, 128
 s_add_u32 s43, s43, 4096
 s_waitcnt vmcnt(16) lgkmcnt(0)
 s_barrier
 s_add_u32 m0, s48, 49152
 s_nop 0
 buffer_load_dwordx4 v4, s[12:15], s42 offen lds
 s_add_u32 m0, s48, 50176
 s_nop 0
 buffer_load_dwordx4 v5, s[12:15], s42 offen lds
 s_add_u32 m0, s48, 51200
 s_nop 0
 buffer_load_dwordx4 v6, s[12:15], s42 offen lds
 s_add_u32 m0, s48, 52224
 s_nop 0
 buffer_load_dwordx4 v7, s[12:15], s42 offen lds
 s_add_u32 m0, s49, 125952
 s_nop 0
 buffer_load_dwordx4 v8, s[16:19], s43 offen sc1 lds
 buffer_load_dwordx4 v8, s[16:19], s43 offen offset:1024 sc1 lds
 s_add_u32 m0, s49, 133120
 s_nop 0
 buffer_load_dwordx4 v8, s[16:19], s43 offen offset:2048 sc1 lds
 buffer_load_dwordx4 v8, s[16:19], s43 offen offset:3072 sc1 lds
 s_add_u32 s42, s42, 128
 s_add_u32 s43, s43, 4096
 s_waitcnt vmcnt(16) lgkmcnt(0)
 s_barrier
 s_add_u32 m0, s48, 0
 s_nop 0
 buffer_load_dwordx4 v4, s[12:15], s42 offen lds
 s_add_u32 m0, s48, 1024
 s_nop 0
 buffer_load_dwordx4 v5, s[12:15], s42 offen lds
 s_add_u32 m0, s48, 2048
 s_nop 0
 buffer_load_dwordx4 v6, s[12:15], s42 offen lds
 s_add_u32 m0, s48, 3072
 s_nop 0
 buffer_load_dwordx4 v7, s[12:15], s42 offen lds
 s_add_u32 m0, s49, 70656
 s_nop 0
 buffer_load_dwordx4 v8, s[16:19], s43 offen sc1 lds
 buffer_load_dwordx4 v8, s[16:19], s43 offen offset:1024 sc1 lds
 s_add_u32 m0, s49, 77824
 s_nop 0
 buffer_load_dwordx4 v8, s[16:19], s43 offen offset:2048 sc1 lds
 buffer_load_dwordx4 v8, s[16:19], s43 offen offset:3072 sc1 lds
 s_add_u32 s42, s42, 128
 s_add_u32 s43, s43, 4096
 s_waitcnt vmcnt(16) lgkmcnt(0)
 s_barrier
 s_add_u32 m0, s48, 16384
 s_nop 0
 buffer_load_dwordx4 v4, s[12:15], s42 offen lds
 s_add_u32 m0, s48, 17408
 s_nop 0
 buffer_load_dwordx4 v5, s[12:15], s42 offen lds
 s_add_u32 m0, s48, 18432
 s_nop 0
 buffer_load_dwordx4 v6, s[12:15], s42 offen lds
 s_add_u32 m0, s48, 19456
 s_nop 0
 buffer_load_dwordx4 v7, s[12:15], s42 offen lds
 s_add_u32 m0, s49, 89088
 s_nop 0
 buffer_load_dwordx4 v8, s[16:19], s43 offen sc1 lds
 buffer_load_dwordx4 v8, s[16:19], s43 offen offset:1024 sc1 lds
 s_add_u32 m0, s49, 96256
 s_nop 0
 buffer_load_dwordx4 v8, s[16:19], s43 offen offset:2048 sc1 lds
 buffer_load_dwordx4 v8, s[16:19], s43 offen offset:3072 sc1 lds
 s_add_u32 s42, s42, 128
 s_add_u32 s43, s43, 4096
 buffer_load_dword v196, v13, s[20:23], s36 offen
 s_waitcnt vmcnt(17) lgkmcnt(0)
 s_barrier
 s_add_u32 m0, s48, 32768
 s_nop 0
 buffer_load_dwordx4 v4, s[12:15], s42 offen lds
 s_add_u32 m0, s48, 33792
 s_nop 0
 buffer_load_dwordx4 v5, s[12:15], s42 offen lds
 s_add_u32 m0, s48, 34816
 s_nop 0
 buffer_load_dwordx4 v6, s[12:15], s42 offen lds
 s_add_u32 m0, s48, 35840
 s_nop 0
 buffer_load_dwordx4 v7, s[12:15], s42 offen lds
 s_add_u32 m0, s49, 107520
 s_nop 0
 buffer_load_dwordx4 v8, s[16:19], s43 offen sc1 lds
 buffer_load_dwordx4 v8, s[16:19], s43 offen offset:1024 sc1 lds
 s_add_u32 m0, s49, 114688
 s_nop 0
 buffer_load_dwordx4 v8, s[16:19], s43 offen offset:2048 sc1 lds
 buffer_load_dwordx4 v8, s[16:19], s43 offen offset:3072 sc1 lds
 s_add_u32 s42, s42, 128
 s_add_u32 s43, s43, 4096
 s_waitcnt vmcnt(17) lgkmcnt(0)
 s_barrier
 s_add_u32 m0, s48, 49152
 s_nop 0
 buffer_load_dwordx4 v4, s[12:15], s42 offen lds
 s_add_u32 m0, s48, 50176
 s_nop 0
 buffer_load_dwordx4 v5, s[12:15], s42 offen lds
 s_add_u32 m0, s48, 51200
 s_nop 0
 buffer_load_dwordx4 v6, s[12:15], s42 offen lds
 s_add_u32 m0, s48, 52224
 s_nop 0
 buffer_load_dwordx4 v7, s[12:15], s42 offen lds
 s_add_u32 m0, s49, 125952
 s_nop 0
 buffer_load_dwordx4 v8, s[16:19], s43 offen sc1 lds
 buffer_load_dwordx4 v8, s[16:19], s43 offen offset:1024 sc1 lds
 s_add_u32 m0, s49, 133120
 s_nop 0
 buffer_load_dwordx4 v8, s[16:19], s43 offen offset:2048 sc1 lds
 buffer_load_dwordx4 v8, s[16:19], s43 offen offset:3072 sc1 lds
 s_add_u32 s42, s42, 128
 s_add_u32 s43, s43, 4096
 s_waitcnt vmcnt(17) lgkmcnt(0)
 s_barrier
 s_add_u32 m0, s48, 0
 s_nop 0
 buffer_load_dwordx4 v4, s[12:15], s42 offen lds
 s_add_u32 m0, s48, 1024
 s_nop 0
 buffer_load_dwordx4 v5, s[12:15], s42 offen lds
 s_add_u32 m0, s48, 2048
 s_nop 0
 buffer_load_dwordx4 v6, s[12:15], s42 offen lds
 s_add_u32 m0, s48, 3072
 s_nop 0
 buffer_load_dwordx4 v7, s[12:15], s42 offen lds
 s_add_u32 m0, s49, 70656
 s_nop 0
 buffer_load_dwordx4 v8, s[16:19], s43 offen sc1 lds
 buffer_load_dwordx4 v8, s[16:19], s43 offen offset:1024 sc1 lds
 s_add_u32 m0, s49, 77824
 s_nop 0
 buffer_load_dwordx4 v8, s[16:19], s43 offen offset:2048 sc1 lds
 buffer_load_dwordx4 v8, s[16:19], s43 offen offset:3072 sc1 lds
 s_add_u32 s42, s42, 128
 s_add_u32 s43, s43, 4096
 s_waitcnt vmcnt(16) lgkmcnt(0)
 s_barrier
 s_add_u32 m0, s48, 16384
 s_nop 0
 buffer_load_dwordx4 v4, s[12:15], s42 offen lds
 s_add_u32 m0, s48, 17408
 s_nop 0
 buffer_load_dwordx4 v5, s[12:15], s42 offen lds
 s_add_u32 m0, s48, 18432
 s_nop 0
 buffer_load_dwordx4 v6, s[12:15], s42 offen lds
 s_add_u32 m0, s48, 19456
 s_nop 0
 buffer_load_dwordx4 v7, s[12:15], s42 offen lds
 s_add_u32 m0, s49, 89088
 s_nop 0
 buffer_load_dwordx4 v8, s[16:19], s43 offen sc1 lds
 buffer_load_dwordx4 v8, s[16:19], s43 offen offset:1024 sc1 lds
 s_add_u32 m0, s49, 96256
 s_nop 0
 buffer_load_dwordx4 v8, s[16:19], s43 offen offset:2048 sc1 lds
 buffer_load_dwordx4 v8, s[16:19], s43 offen offset:3072 sc1 lds
 s_add_u32 s42, s42, 128
 s_add_u32 s43, s43, 4096
 s_waitcnt vmcnt(16) lgkmcnt(0)
 s_barrier
 s_add_u32 m0, s48, 32768
 s_nop 0
 buffer_load_dwordx4 v4, s[12:15], s42 offen lds
 s_add_u32 m0, s48, 33792
 s_nop 0
 buffer_load_dwordx4 v5, s[12:15], s42 offen lds
 s_add_u32 m0, s48, 34816
 s_nop 0
 buffer_load_dwordx4 v6, s[12:15], s42 offen lds
 s_add_u32 m0, s48, 35840
 s_nop 0
 buffer_load_dwordx4 v7, s[12:15], s42 offen lds
 s_add_u32 m0, s49, 107520
 s_nop 0
 buffer_load_dwordx4 v8, s[16:19], s43 offen sc1 lds
 buffer_load_dwordx4 v8, s[16:19], s43 offen offset:1024 sc1 lds
 s_add_u32 m0, s49, 114688
 s_nop 0
 buffer_load_dwordx4 v8, s[16:19], s43 offen offset:2048 sc1 lds
 buffer_load_dwordx4 v8, s[16:19], s43 offen offset:3072 sc1 lds
 s_add_u32 s42, s42, 128
 s_add_u32 s43, s43, 4096
 s_mov_b32 s40, 18
L_fz_p5ll1:
 s_waitcnt vmcnt(16) lgkmcnt(0)
 s_barrier
 s_add_u32 m0, s48, 49152
 s_nop 0
 buffer_load_dwordx4 v4, s[12:15], s42 offen lds
 s_add_u32 m0, s48, 50176
 s_nop 0
 buffer_load_dwordx4 v5, s[12:15], s42 offen lds
 s_add_u32 m0, s48, 51200
 s_nop 0
 buffer_load_dwordx4 v6, s[12:15], s42 offen lds
 s_add_u32 m0, s48, 52224
 s_nop 0
 buffer_load_dwordx4 v7, s[12:15], s42 offen lds
 s_add_u32 m0, s49, 125952
 s_nop 0
 buffer_load_dwordx4 v8, s[16:19], s43 offen sc1 lds
 buffer_load_dwordx4 v8, s[16:19], s43 offen offset:1024 sc1 lds
 s_add_u32 m0, s49, 133120
 s_nop 0
 buffer_load_dwordx4 v8, s[16:19], s43 offen offset:2048 sc1 lds
 buffer_load_dwordx4 v8, s[16:19], s43 offen offset:3072 sc1 lds
 s_add_u32 s42, s42, 128
 s_add_u32 s43, s43, 4096
 s_waitcnt vmcnt(16) lgkmcnt(0)
 s_barrier
 s_add_u32 m0, s48, 0
 s_nop 0
 buffer_load_dwordx4 v4, s[12:15], s42 offen lds
 s_add_u32 m0, s48, 1024
 s_nop 0
 buffer_load_dwordx4 v5, s[12:15], s42 offen lds
 s_add_u32 m0, s48, 2048
 s_nop 0
 buffer_load_dwordx4 v6, s[12:15], s42 offen lds
 s_add_u32 m0, s48, 3072
 s_nop 0
 buffer_load_dwordx4 v7, s[12:15], s42 offen lds
 s_add_u32 m0, s49, 70656
 s_nop 0
 buffer_load_dwordx4 v8, s[16:19], s43 offen sc1 lds
 buffer_load_dwordx4 v8, s[16:19], s43 offen offset:1024 sc1 lds
 s_add_u32 m0, s49, 77824
 s_nop 0
 buffer_load_dwordx4 v8, s[16:19], s43 offen offset:2048 sc1 lds
 buffer_load_dwordx4 v8, s[16:19], s43 offen offset:3072 sc1 lds
 s_add_u32 s42, s42, 128
 s_add_u32 s43, s43, 4096
 s_waitcnt vmcnt(16) lgkmcnt(0)
 s_barrier
 s_add_u32 m0, s48, 16384
 s_nop 0
 buffer_load_dwordx4 v4, s[12:15], s42 offen lds
 s_add_u32 m0, s48, 17408
 s_nop 0
 buffer_load_dwordx4 v5, s[12:15], s42 offen lds
 s_add_u32 m0, s48, 18432
 s_nop 0
 buffer_load_dwordx4 v6, s[12:15], s42 offen lds
 s_add_u32 m0, s48, 19456
 s_nop 0
 buffer_load_dwordx4 v7, s[12:15], s42 offen lds
 s_add_u32 m0, s49, 89088
 s_nop 0
 buffer_load_dwordx4 v8, s[16:19], s43 offen sc1 lds
 buffer_load_dwordx4 v8, s[16:19], s43 offen offset:1024 sc1 lds
 s_add_u32 m0, s49, 96256
 s_nop 0
 buffer_load_dwordx4 v8, s[16:19], s43 offen offset:2048 sc1 lds
 buffer_load_dwordx4 v8, s[16:19], s43 offen offset:3072 sc1 lds
 s_add_u32 s42, s42, 128
 s_add_u32 s43, s43, 4096
 s_waitcnt vmcnt(16) lgkmcnt(0)
 s_barrier
 s_add_u32 m0, s48, 32768
 s_nop 0
 buffer_load_dwordx4 v4, s[12:15], s42 offen lds
 s_add_u32 m0, s48, 33792
 s_nop 0
 buffer_load_dwordx4 v5, s[12:15], s42 offen lds
 s_add_u32 m0, s48, 34816
 s_nop 0
 buffer_load_dwordx4 v6, s[12:15], s42 offen lds
 s_add_u32 m0, s48, 35840
 s_nop 0
 buffer_load_dwordx4 v7, s[12:15], s42 offen lds
 s_add_u32 m0, s49, 107520
 s_nop 0
 buffer_load_dwordx4 v8, s[16:19], s43 offen sc1 lds
 buffer_load_dwordx4 v8, s[16:19], s43 offen offset:1024 sc1 lds
 s_add_u32 m0, s49, 114688
 s_nop 0
 buffer_load_dwordx4 v8, s[16:19], s43 offen offset:2048 sc1 lds
 buffer_load_dwordx4 v8, s[16:19], s43 offen offset:3072 sc1 lds
 s_add_u32 s42, s42, 128
 s_add_u32 s43, s43, 4096
 s_add_u32 s40, s40, 4
 s_cmp_lt_u32 s40, 26
 s_cbranch_scc1 L_fz_p5ll1
 s_waitcnt vmcnt(16) lgkmcnt(0)
 s_barrier
 s_add_u32 m0, s48, 49152
 s_nop 0
 buffer_load_dwordx4 v4, s[12:15], s42 offen lds
 s_add_u32 m0, s48, 50176
 s_nop 0
 buffer_load_dwordx4 v5, s[12:15], s42 offen lds
 s_add_u32 m0, s48, 51200
 s_nop 0
 buffer_load_dwordx4 v6, s[12:15], s42 offen lds
 s_add_u32 m0, s48, 52224
 s_nop 0
 buffer_load_dwordx4 v7, s[12:15], s42 offen lds
 s_add_u32 m0, s49, 125952
 s_nop 0
 buffer_load_dwordx4 v8, s[16:19], s43 offen sc1 lds
 buffer_load_dwordx4 v8, s[16:19], s43 offen offset:1024 sc1 lds
 s_add_u32 m0, s49, 133120
 s_nop 0
 buffer_load_dwordx4 v8, s[16:19], s43 offen offset:2048 sc1 lds
 buffer_load_dwordx4 v8, s[16:19], s43 offen offset:3072 sc1 lds
 s_add_u32 s42, s42, 128
 s_add_u32 s43, s43, 4096
 s_waitcnt vmcnt(16) lgkmcnt(0)
 s_barrier
 s_add_u32 m0, s48, 0
 s_nop 0
 buffer_load_dwordx4 v4, s[12:15], s42 offen lds
 s_add_u32 m0, s48, 1024
 s_nop 0
 buffer_load_dwordx4 v5, s[12:15], s42 offen lds
 s_add_u32 m0, s48, 2048
 s_nop 0
 buffer_load_dwordx4 v6, s[12:15], s42 offen lds
 s_add_u32 m0, s48, 3072
 s_nop 0
 buffer_load_dwordx4 v7, s[12:15], s42 offen lds
 s_add_u32 m0, s49, 70656
 s_nop 0
 buffer_load_dwordx4 v8, s[16:19], s43 offen sc1 lds
 buffer_load_dwordx4 v8, s[16:19], s43 offen offset:1024 sc1 lds
 s_add_u32 m0, s49, 77824
 s_nop 0
 buffer_load_dwordx4 v8, s[16:19], s43 offen offset:2048 sc1 lds
 buffer_load_dwordx4 v8, s[16:19], s43 offen offset:3072 sc1 lds
 s_add_u32 s42, s42, 128
 s_add_u32 s43, s43, 4096
 s_waitcnt vmcnt(16) lgkmcnt(0)
 s_barrier
 s_add_u32 m0, s48, 16384
 s_nop 0
 buffer_load_dwordx4 v4, s[12:15], s42 offen lds
 s_add_u32 m0, s48, 17408
 s_nop 0
 buffer_load_dwordx4 v5, s[12:15], s42 offen lds
 s_add_u32 m0, s48, 18432
 s_nop 0
 buffer_load_dwordx4 v6, s[12:15], s42 offen lds
 s_add_u32 m0, s48, 19456
 s_nop 0
 buffer_load_dwordx4 v7, s[12:15], s42 offen lds
 s_add_u32 m0, s49, 89088
 s_nop 0
 buffer_load_dwordx4 v8, s[16:19], s43 offen sc1 lds
 buffer_load_dwordx4 v8, s[16:19], s43 offen offset:1024 sc1 lds
 s_add_u32 m0, s49, 96256
 s_nop 0
 buffer_load_dwordx4 v8, s[16:19], s43 offen offset:2048 sc1 lds
 buffer_load_dwordx4 v8, s[16:19], s43 offen offset:3072 sc1 lds
 s_add_u32 s42, s42, 128
 s_add_u32 s43, s43, 4096
 s_waitcnt vmcnt(16)
 s_barrier
 s_getpc_b64 s[56:57]
L_fz_cp4:
 s_add_u32 s56, s56, L_fz_p5g0-L_fz_cp4
 s_addc_u32 s57, s57, 0
 s_lshr_b32 s58, s2, 3
 s_lshl_b32 s58, s58, 10
 v_lshlrev_b32 v12, 4, v0
 s_add_u32 s59, s58, 0
 v_add_u32 v12, s59, v12
 v_min_u32 v12, L_fz_last-L_fz_p5g0-16, v12
 global_load_dwordx4 v[196:199], v12, s[56:57]
 s_waitcnt vmcnt(9)
 s_barrier
 ds_write_b128 v27, v[64:67] offset:0
 ds_write_b128 v27, v[68:71] offset:256
 ds_write_b128 v27, v[80:83] offset:4096
 ds_write_b128 v27, v[84:87] offset:4352
 ds_write_b128 v27, v[96:99] offset:1024
 ds_write_b128 v27, v[100:103] offset:1280
 ds_write_b128 v27, v[112:115] offset:5120
 ds_write_b128 v27, v[116:119] offset:5376
 ds_write_b128 v22, v[248:251] offset:8192
 s_waitcnt vmcnt(0) lgkmcnt(0)
 s_barrier
 s_branch L_fz_p5g0
L_fz_p4gb0_10s:
 s_mov_b32 s46, 100000
L_fz_p4gb0_10t:
 ds_read_b128 v[18:21], v24
 s_waitcnt lgkmcnt(0)
 v_min3_u32 v18, v18, v19, v20
 v_min_u32 v18, v18, v21
 v_cmp_gt_u32 vcc, 10, v18
 s_sub_u32 s46, s46, 1
 s_cbranch_vccz L_fz_p4gb0_10r
 s_cmp_lg_u32 s46, 0
 s_cbranch_scc1 L_fz_p4gb0_10t
 s_branch L_fz_p4gb0_10r
L_fz_p4gb0_11s:
 s_mov_b32 s46, 100000
L_fz_p4gb0_11t:
 ds_read_b128 v[18:21], v24
 s_waitcnt lgkmcnt(0)
 v_min3_u32 v18, v18, v19, v20
 v_min_u32 v18, v18, v21
 v_cmp_gt_u32 vcc, 11, v18
 s_sub_u32 s46, s46, 1
 s_cbranch_vccz L_fz_p4gb0_11r
 s_cmp_lg_u32 s46, 0
 s_cbranch_scc1 L_fz_p4gb0_11t
 s_branch L_fz_p4gb0_11r
L_fz_p4gb0_12s:
 s_mov_b32 s46, 100000
L_fz_p4gb0_12t:
 ds_read_b128 v[18:21], v24
 s_waitcnt lgkmcnt(0)
 v_min3_u32 v18, v18, v19, v20
 v_min_u32 v18, v18, v21
 v_cmp_gt_u32 vcc, 12, v18
 s_sub_u32 s46, s46, 1
 s_cbranch_vccz L_fz_p4gb0_12r
 s_cmp_lg_u32 s46, 0
 s_cbranch_scc1 L_fz_p4gb0_12t
 s_branch L_fz_p4gb0_12r
L_fz_p4gb0_13s:
 s_mov_b32 s46, 100000
L_fz_p4gb0_13t:
 ds_read_b128 v[18:21], v24
 s_waitcnt lgkmcnt(0)
 v_min3_u32 v18, v18, v19, v20
 v_min_u32 v18, v18, v21
 v_cmp_gt_u32 vcc, 13, v18
 s_sub_u32 s46, s46, 1
 s_cbranch_vccz L_fz_p4gb0_13r
 s_cmp_lg_u32 s46, 0
 s_cbranch_scc1 L_fz_p4gb0_13t
 s_branch L_fz_p4gb0_13r
L_fz_p4gb0_14s:
 s_mov_b32 s46, 100000
L_fz_p4gb0_14t:
 ds_read_b128 v[18:21], v24
 s_waitcnt lgkmcnt(0)
 v_min3_u32 v18, v18, v19, v20
 v_min_u32 v18, v18, v21
 v_cmp_gt_u32 vcc, 14, v18
 s_sub_u32 s46, s46, 1
 s_cbranch_vccz L_fz_p4gb0_14r
 s_cmp_lg_u32 s46, 0
 s_cbranch_scc1 L_fz_p4gb0_14t
 s_branch L_fz_p4gb0_14r
L_fz_p4gb0_15s:
 s_mov_b32 s46, 100000
L_fz_p4gb0_15t:
 ds_read_b128 v[18:21], v24
 s_waitcnt lgkmcnt(0)
 v_min3_u32 v18, v18, v19, v20
 v_min_u32 v18, v18, v21
 v_cmp_gt_u32 vcc, 15, v18
 s_sub_u32 s46, s46, 1
 s_cbranch_vccz L_fz_p4gb0_15r
 s_cmp_lg_u32 s46, 0
 s_cbranch_scc1 L_fz_p4gb0_15t
 s_branch L_fz_p4gb0_15r
L_fz_p4gb0_16s:
 s_mov_b32 s46, 100000
L_fz_p4gb0_16t:
 ds_read_b128 v[18:21], v24
 s_waitcnt lgkmcnt(0)
 v_min3_u32 v18, v18, v19, v20
 v_min_u32 v18, v18, v21
 v_cmp_gt_u32 vcc, 16, v18
 s_sub_u32 s46, s46, 1
 s_cbranch_vccz L_fz_p4gb0_16r
 s_cmp_lg_u32 s46, 0
 s_cbranch_scc1 L_fz_p4gb0_16t
 s_branch L_fz_p4gb0_16r
L_fz_p4gb0_17s:
 s_mov_b32 s46, 100000
L_fz_p4gb0_17t:
 ds_read_b128 v[18:21], v24
 s_waitcnt lgkmcnt(0)
 v_min3_u32 v18, v18, v19, v20
 v_min_u32 v18, v18, v21
 v_cmp_gt_u32 vcc, 17, v18
 s_sub_u32 s46, s46, 1
 s_cbranch_vccz L_fz_p4gb0_17r
 s_cmp_lg_u32 s46, 0
 s_cbranch_scc1 L_fz_p4gb0_17t
 s_branch L_fz_p4gb0_17r
L_fz_p4gz0s:
 s_mov_b32 s46, 100000
L_fz_p4gz0t:
 ds_read_b128 v[18:21], v24
 s_waitcnt lgkmcnt(0)
 v_min3_u32 v18, v18, v19, v20
 v_min_u32 v18, v18, v21
 v_cmp_gt_u32 vcc, 18, v18
 s_sub_u32 s46, s46, 1
 s_cbranch_vccz L_fz_p4gz0r
 s_cmp_lg_u32 s46, 0
 s_cbranch_scc1 L_fz_p4gz0t
 s_branch L_fz_p4gz0r
L_fz_p4gb1_10s:
 s_mov_b32 s46, 100000
L_fz_p4gb1_10t:
 ds_read_b128 v[18:21], v24
 s_waitcnt lgkmcnt(0)
 v_min3_u32 v18, v18, v19, v20
 v_min_u32 v18, v18, v21
 v_cmp_gt_u32 vcc, 10, v18
 s_sub_u32 s46, s46, 1
 s_cbranch_vccz L_fz_p4gb1_10r
 s_cmp_lg_u32 s46, 0
 s_cbranch_scc1 L_fz_p4gb1_10t
 s_branch L_fz_p4gb1_10r
L_fz_p4gb1_11s:
 s_mov_b32 s46, 100000
L_fz_p4gb1_11t:
 ds_read_b128 v[18:21], v24
 s_waitcnt lgkmcnt(0)
 v_min3_u32 v18, v18, v19, v20
 v_min_u32 v18, v18, v21
 v_cmp_gt_u32 vcc, 11, v18
 s_sub_u32 s46, s46, 1
 s_cbranch_vccz L_fz_p4gb1_11r
 s_cmp_lg_u32 s46, 0
 s_cbranch_scc1 L_fz_p4gb1_11t
 s_branch L_fz_p4gb1_11r
L_fz_p4gb1_12s:
 s_mov_b32 s46, 100000
L_fz_p4gb1_12t:
 ds_read_b128 v[18:21], v24
 s_waitcnt lgkmcnt(0)
 v_min3_u32 v18, v18, v19, v20
 v_min_u32 v18, v18, v21
 v_cmp_gt_u32 vcc, 12, v18
 s_sub_u32 s46, s46, 1
 s_cbranch_vccz L_fz_p4gb1_12r
 s_cmp_lg_u32 s46, 0
 s_cbranch_scc1 L_fz_p4gb1_12t
 s_branch L_fz_p4gb1_12r
L_fz_p4gb1_13s:
 s_mov_b32 s46, 100000
L_fz_p4gb1_13t:
 ds_read_b128 v[18:21], v24
 s_waitcnt lgkmcnt(0)
 v_min3_u32 v18, v18, v19, v20
 v_min_u32 v18, v18, v21
 v_cmp_gt_u32 vcc, 13, v18
 s_sub_u32 s46, s46, 1
 s_cbranch_vccz L_fz_p4gb1_13r
 s_cmp_lg_u32 s46, 0
 s_cbranch_scc1 L_fz_p4gb1_13t
 s_branch L_fz_p4gb1_13r
L_fz_p4gb1_14s:
 s_mov_b32 s46, 100000
L_fz_p4gb1_14t:
 ds_read_b128 v[18:21], v24
 s_waitcnt lgkmcnt(0)
 v_min3_u32 v18, v18, v19, v20
 v_min_u32 v18, v18, v21
 v_cmp_gt_u32 vcc, 14, v18
 s_sub_u32 s46, s46, 1
 s_cbranch_vccz L_fz_p4gb1_14r
 s_cmp_lg_u32 s46, 0
 s_cbranch_scc1 L_fz_p4gb1_14t
 s_branch L_fz_p4gb1_14r
L_fz_p4gb1_15s:
 s_mov_b32 s46, 100000
L_fz_p4gb1_15t:
 ds_read_b128 v[18:21], v24
 s_waitcnt lgkmcnt(0)
 v_min3_u32 v18, v18, v19, v20
 v_min_u32 v18, v18, v21
 v_cmp_gt_u32 vcc, 15, v18
 s_sub_u32 s46, s46, 1
 s_cbranch_vccz L_fz_p4gb1_15r
 s_cmp_lg_u32 s46, 0
 s_cbranch_scc1 L_fz_p4gb1_15t
 s_branch L_fz_p4gb1_15r
L_fz_p4gb1_16s:
 s_mov_b32 s46, 100000
L_fz_p4gb1_16t:
 ds_read_b128 v[18:21], v24
 s_waitcnt lgkmcnt(0)
 v_min3_u32 v18, v18, v19, v20
 v_min_u32 v18, v18, v21
 v_cmp_gt_u32 vcc, 16, v18
 s_sub_u32 s46, s46, 1
 s_cbranch_vccz L_fz_p4gb1_16r
 s_cmp_lg_u32 s46, 0
 s_cbranch_scc1 L_fz_p4gb1_16t
 s_branch L_fz_p4gb1_16r
L_fz_p4gb1_17s:
 s_mov_b32 s46, 100000
L_fz_p4gb1_17t:
 ds_read_b128 v[18:21], v24
 s_waitcnt lgkmcnt(0)
 v_min3_u32 v18, v18, v19, v20
 v_min_u32 v18, v18, v21
 v_cmp_gt_u32 vcc, 17, v18
 s_sub_u32 s46, s46, 1
 s_cbranch_vccz L_fz_p4gb1_17r
 s_cmp_lg_u32 s46, 0
 s_cbranch_scc1 L_fz_p4gb1_17t
 s_branch L_fz_p4gb1_17r
L_fz_p4gz1s:
 s_mov_b32 s46, 100000
L_fz_p4gz1t:
 ds_read_b128 v[18:21], v24
 s_waitcnt lgkmcnt(0)
 v_min3_u32 v18, v18, v19, v20
 v_min_u32 v18, v18, v21
 v_cmp_gt_u32 vcc, 18, v18
 s_sub_u32 s46, s46, 1
 s_cbranch_vccz L_fz_p4gz1r
 s_cmp_lg_u32 s46, 0
 s_cbranch_scc1 L_fz_p4gz1t
 s_branch L_fz_p4gz1r
L_fz_p5g0:
 s_lshl_b32 s55, s33, 4
 s_add_u32 s55, s55, s34
 s_barrier
 s_cmp_ge_u32 s62, 26
 s_cbranch_scc1 L_fz_p6p0
 s_and_b32 s32, s3, 3
 v_bfe_u32 v3, v0, 1, 2
 v_bfe_u32 v4, v0, 4, 2
 v_xor_b32 v3, v3, v4
 v_and_b32 v4, 1, v0
 v_lshlrev_b32 v4, 4, v4
 v_lshl_add_u32 v3, v3, 5, v4
 s_lshl_b32 s36, s63, 7
 v_add_u32 v3, s36, v3
 v_lshrrev_b32 v4, 5, v0
 v_bfe_u32 v5, v0, 3, 2
 v_lshl_add_u32 v4, v4, 3, v5
 v_mul_u32_u24 v4, 1152, v4
 s_mul_i32 s36, s32, 36864
 v_add3_u32 v8, v4, v3, s36
 s_mul_i32 s54, s32, 4096
 s_add_u32 s54, s54, 87040
 v_add_u32 v9, 18432, v8
 v_add_u32 v10, 4608, v8
 v_add_u32 v11, 23040, v8
 s_mov_b32 s12, s78
 s_mov_b32 s13, s79
 s_mov_b32 s14, 2654208
 s_mov_b32 s15, 0x20000
 s_mov_b32 s41, 0
 s_add_u32 m0, s54, 0
 s_nop 0
 buffer_load_dwordx4 v8, s[12:15], s41 offen lds
 s_add_u32 m0, s54, 1024
 s_nop 0
 buffer_load_dwordx4 v9, s[12:15], s41 offen lds
 s_add_u32 m0, s54, 2048
 s_nop 0
 buffer_load_dwordx4 v10, s[12:15], s41 offen lds
 s_add_u32 m0, s54, 3072
 s_nop 0
 buffer_load_dwordx4 v11, s[12:15], s41 offen lds
 s_mov_b32 s41, 147456
 s_add_u32 m0, s54, 16384
 s_nop 0
 buffer_load_dwordx4 v8, s[12:15], s41 offen lds
 s_add_u32 m0, s54, 17408
 s_nop 0
 buffer_load_dwordx4 v9, s[12:15], s41 offen lds
 s_add_u32 m0, s54, 18432
 s_nop 0
 buffer_load_dwordx4 v10, s[12:15], s41 offen lds
 s_add_u32 m0, s54, 19456
 s_nop 0
 buffer_load_dwordx4 v11, s[12:15], s41 offen lds
 s_mul_i32 s46, s62, 5
 s_add_u32 s46, s46, s32
 s_cmp_lt_u32 s46, 128
 s_cselect_b32 s37, 18432, 0
 s_cselect_b32 s38, 73728, 0
 s_mul_i32 s36, s46, 18432
 s_add_u32 s36, s36, 11534336
 v_and_b32 v5, 15, v0
 v_lshrrev_b32 v6, 5, v0
 v_bfe_u32 v7, v0, 4, 1
 v_lshlrev_b32 v27, 4, v5
 v_lshl_add_u32 v27, v6, 8, v27
 v_lshl_add_u32 v27, v7, 3, v27
 s_add_u32 s28, s8, s36
 s_addc_u32 s29, s9, 0
 s_mov_b32 s30, s37
 s_mov_b32 s31, 0x20000
 s_lshl_b32 s36, s63, 11
 buffer_load_dwordx2 v[208:209], v27, s[28:31], s36 offen offset:0 sc1
 buffer_load_dwordx2 v[210:211], v27, s[28:31], s36 offen offset:512 sc1
 buffer_load_dwordx2 v[212:213], v27, s[28:31], s36 offen offset:1024 sc1
 buffer_load_dwordx2 v[214:215], v27, s[28:31], s36 offen offset:1536 sc1
 s_mul_i32 s36, s46, 73728
 s_add_u32 s36, s36, 16777216
 s_add_u32 s16, s8, s36
 s_addc_u32 s17, s9, 0
 s_mov_b32 s18, s38
 s_mov_b32 s19, 0x20000
 v_lshrrev_b32 v3, 2, v0
 v_bfe_u32 v4, v0, 3, 2
 v_lshlrev_b32 v3, 7, v3
 v_lshl_add_u32 v3, v4, 5, v3
 v_and_b32 v4, 3, v0
 v_lshl_add_u32 v21, v4, 3, v3
 v_add_u32 v21, 87040, v21
 v_xor_b32 v22, 32, v21
 v_xor_b32 v23, 64, v21
 v_xor_b32 v24, 96, v21
 v_lshlrev_b32 v16, 4, v0
 s_mul_i32 s36, s32, 2304
 v_mul_u32_u24 v28, 144, v5
 v_lshl_add_u32 v7, v7, 1, v6
 v_lshlrev_b32 v7, 4, v7
 v_add3_u32 v28, v28, v7, s36
 v_lshrrev_b32 v3, 3, v0
 v_and_b32 v4, 7, v0
 v_mul_u32_u24 v29, 144, v3
 v_lshlrev_b32 v4, 4, v4
 v_add3_u32 v29, v29, v4, s36
 v_mul_u32_u24 v30, 1152, v3
 s_mul_i32 s47, s46, 18432
 s_lshl_b32 s36, s63, 7
 s_add_u32 s47, s47, s36
 v_add3_u32 v30, v30, v4, s47
 s_mov_b32 s20, s4
 s_mov_b32 s21, s5
 s_mov_b32 s22, 2359296
 s_mov_b32 s23, 0x20000
 s_mul_i32 s36, s62, 80
 s_lshr_b32 s37, s36, 7
 s_add_u32 s36, s36, 79
 s_lshr_b32 s36, s36, 7
 s_min_u32 s36, s36, 15
 s_sub_u32 s36, s36, s37
 s_add_u32 s36, s36, 1
 s_lshl_b32 s52, s36, 4
 s_lshl_b32 s53, s37, 4
L_fz_p6p0:
L_fz_p5pub:
 s_waitcnt vmcnt(0)
 s_barrier
 s_cmp_lg_u32 s3, 7
 s_cbranch_scc1 L_fz_pub5
 s_add_u32 s56, s8, 16416768
 s_addc_u32 s57, s9, 0
 s_mov_b32 s58, 32768
 s_mov_b32 s59, 0x20000
 s_lshl_b32 s60, s55, 7
 v_mov_b32 v254, 0
 v_mov_b32 v255, s100
 s_mov_b64 exec, 1
 buffer_store_dword v255, v254, s[56:59], s60 offen sc1
 s_mov_b64 exec, -1
L_fz_pub5:
 s_cmp_ge_u32 s62, 26
 s_cbranch_scc1 L_fz_p6end
 s_cmp_lg_u32 s3, 4
 s_cbranch_scc1 L_fz_p6w
 s_add_u32 s56, s8, 16416768
 s_addc_u32 s57, s9, 0
 s_mov_b32 s58, 32768
 s_mov_b32 s59, 0x20000
 s_sub_u32 s60, s52, 1
 v_min_u32 v32, s60, v0
 v_add_lshl_u32 v32, v32, s53, 7
 s_mov_b32 s61, 40000
L_fz_wf5:
 buffer_load_dword v33, v32, s[56:59], 0 offen sc1
 s_waitcnt vmcnt(0)
 v_cmp_ne_u32 vcc, s100, v33
 s_sub_u32 s61, s61, 1
 s_cbranch_vccz L_fz_wd5
 s_cmp_lg_u32 s61, 0
 s_cbranch_scc1 L_fz_wf5
L_fz_wd5:
L_fz_p6w:
 s_cmp_ge_u32 s3, 3
 s_cbranch_scc1 L_fz_p6c
 s_cmp_eq_u32 s3, 2
 s_cbranch_scc0 L_fz_p6l
 s_movk_i32 s40, 18
L_fz_p6i:
 s_barrier
 s_sub_u32 s40, s40, 1
 s_cmp_lg_u32 s40, 0
 s_cbranch_scc1 L_fz_p6i
 s_branch L_fz_p6end
L_fz_p6l:
 s_mov_b32 s41, 294912
 s_add_u32 m0, s54, 32768
 s_nop 0
 buffer_load_dwordx4 v8, s[12:15], s41 offen lds
 s_add_u32 m0, s54, 33792
 s_nop 0
 buffer_load_dwordx4 v9, s[12:15], s41 offen lds
 s_add_u32 m0, s54, 34816
 s_nop 0
 buffer_load_dwordx4 v10, s[12:15], s41 offen lds
 s_add_u32 m0, s54, 35840
 s_nop 0
 buffer_load_dwordx4 v11, s[12:15], s41 offen lds
 s_add_u32 s43, s41, 36864
 s_add_u32 m0, s54, 36864
 s_nop 0
 buffer_load_dwordx4 v8, s[12:15], s43 offen lds
 s_add_u32 m0, s54, 37888
 s_nop 0
 buffer_load_dwordx4 v9, s[12:15], s43 offen lds
 s_add_u32 m0, s54, 38912
 s_nop 0
 buffer_load_dwordx4 v10, s[12:15], s43 offen lds
 s_add_u32 m0, s54, 39936
 s_nop 0
 buffer_load_dwordx4 v11, s[12:15], s43 offen lds
 s_barrier
 s_mov_b32 s41, 442368
 s_add_u32 m0, s54, 49152
 s_nop 0
 buffer_load_dwordx4 v8, s[12:15], s41 offen lds
 s_add_u32 m0, s54, 50176
 s_nop 0
 buffer_load_dwordx4 v9, s[12:15], s41 offen lds
 s_add_u32 m0, s54, 51200
 s_nop 0
 buffer_load_dwordx4 v10, s[12:15], s41 offen lds
 s_add_u32 m0, s54, 52224
 s_nop 0
 buffer_load_dwordx4 v11, s[12:15], s41 offen lds
 s_add_u32 s43, s41, 36864
 s_add_u32 m0, s54, 53248
 s_nop 0
 buffer_load_dwordx4 v8, s[12:15], s43 offen lds
 s_add_u32 m0, s54, 54272
 s_nop 0
 buffer_load_dwordx4 v9, s[12:15], s43 offen lds
 s_add_u32 m0, s54, 55296
 s_nop 0
 buffer_load_dwordx4 v10, s[12:15], s43 offen lds
 s_add_u32 m0, s54, 56320
 s_nop 0
 buffer_load_dwordx4 v11, s[12:15], s43 offen lds
 s_waitcnt vmcnt(16)
 s_barrier
 s_add_u32 s41, s41, 147456
 s_add_u32 m0, s54, 0
 s_nop 0
 buffer_load_dwordx4 v8, s[12:15], s41 offen lds
 s_add_u32 m0, s54, 1024
 s_nop 0
 buffer_load_dwordx4 v9, s[12:15], s41 offen lds
 s_add_u32 m0, s54, 2048
 s_nop 0
 buffer_load_dwordx4 v10, s[12:15], s41 offen lds
 s_add_u32 m0, s54, 3072
 s_nop 0
 buffer_load_dwordx4 v11, s[12:15], s41 offen lds
 s_add_u32 s43, s41, 36864
 s_add_u32 m0, s54, 4096
 s_nop 0
 buffer_load_dwordx4 v8, s[12:15], s43 offen lds
 s_add_u32 m0, s54, 5120
 s_nop 0
 buffer_load_dwordx4 v9, s[12:15], s43 offen lds
 s_add_u32 m0, s54, 6144
 s_nop 0
 buffer_load_dwordx4 v10, s[12:15], s43 offen lds
 s_add_u32 m0, s54, 7168
 s_nop 0
 buffer_load_dwordx4 v11, s[12:15], s43 offen lds
 s_waitcnt vmcnt(16)
 s_barrier
 s_add_u32 s41, s41, 147456
 s_add_u32 m0, s54, 16384
 s_nop 0
 buffer_load_dwordx4 v8, s[12:15], s41 offen lds
 s_add_u32 m0, s54, 17408
 s_nop 0
 buffer_load_dwordx4 v9, s[12:15], s41 offen lds
 s_add_u32 m0, s54, 18432
 s_nop 0
 buffer_load_dwordx4 v10, s[12:15], s41 offen lds
 s_add_u32 m0, s54, 19456
 s_nop 0
 buffer_load_dwordx4 v11, s[12:15], s41 offen lds
 s_add_u32 s43, s41, 36864
 s_add_u32 m0, s54, 20480
 s_nop 0
 buffer_load_dwordx4 v8, s[12:15], s43 offen lds
 s_add_u32 m0, s54, 21504
 s_nop 0
 buffer_load_dwordx4 v9, s[12:15], s43 offen lds
 s_add_u32 m0, s54, 22528
 s_nop 0
 buffer_load_dwordx4 v10, s[12:15], s43 offen lds
 s_add_u32 m0, s54, 23552
 s_nop 0
 buffer_load_dwordx4 v11, s[12:15], s43 offen lds
 s_mov_b32 s40, 3
L_fz_p6ll:
 s_waitcnt vmcnt(16)
 s_barrier
 s_add_u32 s41, s41, 147456
 s_add_u32 m0, s54, 32768
 s_nop 0
 buffer_load_dwordx4 v8, s[12:15], s41 offen lds
 s_add_u32 m0, s54, 33792
 s_nop 0
 buffer_load_dwordx4 v9, s[12:15], s41 offen lds
 s_add_u32 m0, s54, 34816
 s_nop 0
 buffer_load_dwordx4 v10, s[12:15], s41 offen lds
 s_add_u32 m0, s54, 35840
 s_nop 0
 buffer_load_dwordx4 v11, s[12:15], s41 offen lds
 s_add_u32 s43, s41, 36864
 s_add_u32 m0, s54, 36864
 s_nop 0
 buffer_load_dwordx4 v8, s[12:15], s43 offen lds
 s_add_u32 m0, s54, 37888
 s_nop 0
 buffer_load_dwordx4 v9, s[12:15], s43 offen lds
 s_add_u32 m0, s54, 38912
 s_nop 0
 buffer_load_dwordx4 v10, s[12:15], s43 offen lds
 s_add_u32 m0, s54, 39936
 s_nop 0
 buffer_load_dwordx4 v11, s[12:15], s43 offen lds
 s_waitcnt vmcnt(16)
 s_barrier
 s_add_u32 s41, s41, 147456
 s_add_u32 m0, s54, 49152
 s_nop 0
 buffer_load_dwordx4 v8, s[12:15], s41 offen lds
 s_add_u32 m0, s54, 50176
 s_nop 0
 buffer_load_dwordx4 v9, s[12:15], s41 offen lds
 s_add_u32 m0, s54, 51200
 s_nop 0
 buffer_load_dwordx4 v10, s[12:15], s41 offen lds
 s_add_u32 m0, s54, 52224
 s_nop 0
 buffer_load_dwordx4 v11, s[12:15], s41 offen lds
 s_add_u32 s43, s41, 36864
 s_add_u32 m0, s54, 53248
 s_nop 0
 buffer_load_dwordx4 v8, s[12:15], s43 offen lds
 s_add_u32 m0, s54, 54272
 s_nop 0
 buffer_load_dwordx4 v9, s[12:15], s43 offen lds
 s_add_u32 m0, s54, 55296
 s_nop 0
 buffer_load_dwordx4 v10, s[12:15], s43 offen lds
 s_add_u32 m0, s54, 56320
 s_nop 0
 buffer_load_dwordx4 v11, s[12:15], s43 offen lds
 s_waitcnt vmcnt(16)
 s_barrier
 s_add_u32 s41, s41, 147456
 s_add_u32 m0, s54, 0
 s_nop 0
 buffer_load_dwordx4 v8, s[12:15], s41 offen lds
 s_add_u32 m0, s54, 1024
 s_nop 0
 buffer_load_dwordx4 v9, s[12:15], s41 offen lds
 s_add_u32 m0, s54, 2048
 s_nop 0
 buffer_load_dwordx4 v10, s[12:15], s41 offen lds
 s_add_u32 m0, s54, 3072
 s_nop 0
 buffer_load_dwordx4 v11, s[12:15], s41 offen lds
 s_add_u32 s43, s41, 36864
 s_add_u32 m0, s54, 4096
 s_nop 0
 buffer_load_dwordx4 v8, s[12:15], s43 offen lds
 s_add_u32 m0, s54, 5120
 s_nop 0
 buffer_load_dwordx4 v9, s[12:15], s43 offen lds
 s_add_u32 m0, s54, 6144
 s_nop 0
 buffer_load_dwordx4 v10, s[12:15], s43 offen lds
 s_add_u32 m0, s54, 7168
 s_nop 0
 buffer_load_dwordx4 v11, s[12:15], s43 offen lds
 s_waitcnt vmcnt(16)
 s_barrier
 s_add_u32 s41, s41, 147456
 s_add_u32 m0, s54, 16384
 s_nop 0
 buffer_load_dwordx4 v8, s[12:15], s41 offen lds
 s_add_u32 m0, s54, 17408
 s_nop 0
 buffer_load_dwordx4 v9, s[12:15], s41 offen lds
 s_add_u32 m0, s54, 18432
 s_nop 0
 buffer_load_dwordx4 v10, s[12:15], s41 offen lds
 s_add_u32 m0, s54, 19456
 s_nop 0
 buffer_load_dwordx4 v11, s[12:15], s41 offen lds
 s_add_u32 s43, s41, 36864
 s_add_u32 m0, s54, 20480
 s_nop 0
 buffer_load_dwordx4 v8, s[12:15], s43 offen lds
 s_add_u32 m0, s54, 21504
 s_nop 0
 buffer_load_dwordx4 v9, s[12:15], s43 offen lds
 s_add_u32 m0, s54, 22528
 s_nop 0
 buffer_load_dwordx4 v10, s[12:15], s43 offen lds
 s_add_u32 m0, s54, 23552
 s_nop 0
 buffer_load_dwordx4 v11, s[12:15], s43 offen lds
 s_add_u32 s40, s40, 4
 s_cmp_lt_u32 s40, 15
 s_cbranch_scc1 L_fz_p6ll
 s_waitcnt vmcnt(16)
 s_barrier
 s_waitcnt vmcnt(8)
 s_barrier
 s_waitcnt vmcnt(0)
 s_barrier
 s_branch L_fz_p6end
L_fz_p6c:
 s_barrier
 s_mov_b32 s42, 0
 buffer_load_dwordx4 v[96:99], v16, s[16:19], s42 offen offset:0 sc1
 buffer_load_dwordx4 v[100:103], v16, s[16:19], s42 offen offset:1024 sc1
 buffer_load_dwordx4 v[104:107], v16, s[16:19], s42 offen offset:2048 sc1
 buffer_load_dwordx4 v[108:111], v16, s[16:19], s42 offen offset:3072 sc1
 s_add_u32 s42, s42, 4096
 buffer_load_dwordx4 v[112:115], v16, s[16:19], s42 offen offset:0 sc1
 buffer_load_dwordx4 v[116:119], v16, s[16:19], s42 offen offset:1024 sc1
 buffer_load_dwordx4 v[120:123], v16, s[16:19], s42 offen offset:2048 sc1
 buffer_load_dwordx4 v[124:127], v16, s[16:19], s42 offen offset:3072 sc1
 s_add_u32 s42, s42, 4096
 ds_read_b64_tr_b16 v[160:161], v21 offset:0
 ds_read_b64_tr_b16 v[162:163], v21 offset:2048
 ds_read_b64_tr_b16 v[164:165], v22 offset:0
 ds_read_b64_tr_b16 v[166:167], v22 offset:2048
 ds_read_b64_tr_b16 v[168:169], v23 offset:0
 ds_read_b64_tr_b16 v[170:171], v23 offset:2048
 ds_read_b64_tr_b16 v[172:173], v24 offset:0
 ds_read_b64_tr_b16 v[174:175], v24 offset:2048
 buffer_load_dwordx4 v[128:131], v16, s[16:19], s42 offen offset:0 sc1
 s_waitcnt vmcnt(8)
 s_waitcnt lgkmcnt(6)
 v_mfma_f32_16x16x32_bf16 v[192:195], v[160:163], v[96:99], 0
 ds_read_b64_tr_b16 v[176:177], v21 offset:4096
 ds_read_b64_tr_b16 v[178:179], v21 offset:6144
 s_waitcnt lgkmcnt(6)
 v_mfma_f32_16x16x32_bf16 v[196:199], v[164:167], v[96:99], 0
 ds_read_b64_tr_b16 v[180:181], v22 offset:4096
 ds_read_b64_tr_b16 v[182:183], v22 offset:6144
 s_waitcnt lgkmcnt(6)
 v_mfma_f32_16x16x32_bf16 v[200:203], v[168:171], v[96:99], 0
 ds_read_b64_tr_b16 v[184:185], v23 offset:4096
 ds_read_b64_tr_b16 v[186:187], v23 offset:6144
 s_waitcnt lgkmcnt(6)
 v_mfma_f32_16x16x32_bf16 v[204:207], v[172:175], v[96:99], 0
 ds_read_b64_tr_b16 v[188:189], v24 offset:4096
 ds_read_b64_tr_b16 v[190:191], v24 offset:6144
 buffer_load_dwordx4 v[132:135], v16, s[16:19], s42 offen offset:1024 sc1
 s_waitcnt vmcnt(8)
 s_waitcnt lgkmcnt(6)
 v_mfma_f32_16x16x32_bf16 v[192:195], v[176:179], v[100:103], v[192:195]
 ds_read_b64_tr_b16 v[160:161], v21 offset:8192
 ds_read_b64_tr_b16 v[162:163], v21 offset:10240
 s_waitcnt lgkmcnt(6)
 v_mfma_f32_16x16x32_bf16 v[196:199], v[180:183], v[100:103], v[196:199]
 ds_read_b64_tr_b16 v[164:165], v22 offset:8192
 ds_read_b64_tr_b16 v[166:167], v22 offset:10240
 s_waitcnt lgkmcnt(6)
 v_mfma_f32_16x16x32_bf16 v[200:203], v[184:187], v[100:103], v[200:203]
 ds_read_b64_tr_b16 v[168:169], v23 offset:8192
 ds_read_b64_tr_b16 v[170:171], v23 offset:10240
 s_waitcnt lgkmcnt(6)
 v_mfma_f32_16x16x32_bf16 v[204:207], v[188:191], v[100:103], v[204:207]
 ds_read_b64_tr_b16 v[172:173], v24 offset:8192
 ds_read_b64_tr_b16 v[174:175], v24 offset:10240
 buffer_load_dwordx4 v[136:139], v16, s[16:19], s42 offen offset:2048 sc1
 s_waitcnt vmcnt(8)
 s_waitcnt lgkmcnt(6)
 v_mfma_f32_16x16x32_bf16 v[192:195], v[160:163], v[104:107], v[192:195]
 ds_read_b64_tr_b16 v[176:177], v21 offset:12288
 ds_read_b64_tr_b16 v[178:179], v21 offset:14336
 s_waitcnt lgkmcnt(6)
 v_mfma_f32_16x16x32_bf16 v[196:199], v[164:167], v[104:107], v[196:199]
 ds_read_b64_tr_b16 v[180:181], v22 offset:12288
 ds_read_b64_tr_b16 v[182:183], v22 offset:14336
 s_waitcnt lgkmcnt(6)
 v_mfma_f32_16x16x32_bf16 v[200:203], v[168:171], v[104:107], v[200:203]
 ds_read_b64_tr_b16 v[184:185], v23 offset:12288
 ds_read_b64_tr_b16 v[186:187], v23 offset:14336
 s_waitcnt lgkmcnt(6)
 v_mfma_f32_16x16x32_bf16 v[204:207], v[172:175], v[104:107], v[204:207]
 ds_read_b64_tr_b16 v[188:189], v24 offset:12288
 ds_read_b64_tr_b16 v[190:191], v24 offset:14336
 buffer_load_dwordx4 v[140:143], v16, s[16:19], s42 offen offset:3072 sc1
 s_add_u32 s42, s42, 4096
 s_waitcnt vmcnt(8) lgkmcnt(0)
 s_barrier
 v_mfma_f32_16x16x32_bf16 v[192:195], v[176:179], v[108:111], v[192:195]
 ds_read_b64_tr_b16 v[160:161], v21 offset:16384
 ds_read_b64_tr_b16 v[162:163], v21 offset:18432
 v_mfma_f32_16x16x32_bf16 v[196:199], v[180:183], v[108:111], v[196:199]
 ds_read_b64_tr_b16 v[164:165], v22 offset:16384
 ds_read_b64_tr_b16 v[166:167], v22 offset:18432
 v_mfma_f32_16x16x32_bf16 v[200:203], v[184:187], v[108:111], v[200:203]
 ds_read_b64_tr_b16 v[168:169], v23 offset:16384
 ds_read_b64_tr_b16 v[170:171], v23 offset:18432
 v_mfma_f32_16x16x32_bf16 v[204:207], v[188:191], v[108:111], v[204:207]
 ds_read_b64_tr_b16 v[172:173], v24 offset:16384
 ds_read_b64_tr_b16 v[174:175], v24 offset:18432
 buffer_load_dwordx4 v[144:147], v16, s[16:19], s42 offen offset:0 sc1
 s_waitcnt vmcnt(8)
 s_waitcnt lgkmcnt(6)
 v_mfma_f32_16x16x32_bf16 v[192:195], v[160:163], v[112:115], v[192:195]
 ds_read_b64_tr_b16 v[176:177], v21 offset:20480
 ds_read_b64_tr_b16 v[178:179], v21 offset:22528
 s_waitcnt lgkmcnt(6)
 v_mfma_f32_16x16x32_bf16 v[196:199], v[164:167], v[112:115], v[196:199]
 ds_read_b64_tr_b16 v[180:181], v22 offset:20480
 ds_read_b64_tr_b16 v[182:183], v22 offset:22528
 s_waitcnt lgkmcnt(6)
 v_mfma_f32_16x16x32_bf16 v[200:203], v[168:171], v[112:115], v[200:203]
 ds_read_b64_tr_b16 v[184:185], v23 offset:20480
 ds_read_b64_tr_b16 v[186:187], v23 offset:22528
 s_waitcnt lgkmcnt(6)
 v_mfma_f32_16x16x32_bf16 v[204:207], v[172:175], v[112:115], v[204:207]
 ds_read_b64_tr_b16 v[188:189], v24 offset:20480
 ds_read_b64_tr_b16 v[190:191], v24 offset:22528
 buffer_load_dwordx4 v[148:151], v16, s[16:19], s42 offen offset:1024 sc1
 s_waitcnt vmcnt(8)
 s_waitcnt lgkmcnt(6)
 v_mfma_f32_16x16x32_bf16 v[192:195], v[176:179], v[116:119], v[192:195]
 ds_read_b64_tr_b16 v[160:161], v21 offset:24576
 ds_read_b64_tr_b16 v[162:163], v21 offset:26624
 s_waitcnt lgkmcnt(6)
 v_mfma_f32_16x16x32_bf16 v[196:199], v[180:183], v[116:119], v[196:199]
 ds_read_b64_tr_b16 v[164:165], v22 offset:24576
 ds_read_b64_tr_b16 v[166:167], v22 offset:26624
 s_waitcnt lgkmcnt(6)
 v_mfma_f32_16x16x32_bf16 v[200:203], v[184:187], v[116:119], v[200:203]
 ds_read_b64_tr_b16 v[168:169], v23 offset:24576
 ds_read_b64_tr_b16 v[170:171], v23 offset:26624
 s_waitcnt lgkmcnt(6)
 v_mfma_f32_16x16x32_bf16 v[204:207], v[188:191], v[116:119], v[204:207]
 ds_read_b64_tr_b16 v[172:173], v24 offset:24576
 ds_read_b64_tr_b16 v[174:175], v24 offset:26624
 buffer_load_dwordx4 v[152:155], v16, s[16:19], s42 offen offset:2048 sc1
 s_waitcnt vmcnt(8)
 s_waitcnt lgkmcnt(6)
 v_mfma_f32_16x16x32_bf16 v[192:195], v[160:163], v[120:123], v[192:195]
 ds_read_b64_tr_b16 v[176:177], v21 offset:28672
 ds_read_b64_tr_b16 v[178:179], v21 offset:30720
 s_waitcnt lgkmcnt(6)
 v_mfma_f32_16x16x32_bf16 v[196:199], v[164:167], v[120:123], v[196:199]
 ds_read_b64_tr_b16 v[180:181], v22 offset:28672
 ds_read_b64_tr_b16 v[182:183], v22 offset:30720
 s_waitcnt lgkmcnt(6)
 v_mfma_f32_16x16x32_bf16 v[200:203], v[168:171], v[120:123], v[200:203]
 ds_read_b64_tr_b16 v[184:185], v23 offset:28672
 ds_read_b64_tr_b16 v[186:187], v23 offset:30720
 s_waitcnt lgkmcnt(6)
 v_mfma_f32_16x16x32_bf16 v[204:207], v[172:175], v[120:123], v[204:207]
 ds_read_b64_tr_b16 v[188:189], v24 offset:28672
 ds_read_b64_tr_b16 v[190:191], v24 offset:30720
 buffer_load_dwordx4 v[156:159], v16, s[16:19], s42 offen offset:3072 sc1
 s_add_u32 s42, s42, 4096
 s_waitcnt vmcnt(8) lgkmcnt(0)
 s_barrier
 v_mfma_f32_16x16x32_bf16 v[192:195], v[176:179], v[124:127], v[192:195]
 ds_read_b64_tr_b16 v[160:161], v21 offset:32768
 ds_read_b64_tr_b16 v[162:163], v21 offset:34816
 v_mfma_f32_16x16x32_bf16 v[196:199], v[180:183], v[124:127], v[196:199]
 ds_read_b64_tr_b16 v[164:165], v22 offset:32768
 ds_read_b64_tr_b16 v[166:167], v22 offset:34816
 v_mfma_f32_16x16x32_bf16 v[200:203], v[184:187], v[124:127], v[200:203]
 ds_read_b64_tr_b16 v[168:169], v23 offset:32768
 ds_read_b64_tr_b16 v[170:171], v23 offset:34816
 v_mfma_f32_16x16x32_bf16 v[204:207], v[188:191], v[124:127], v[204:207]
 ds_read_b64_tr_b16 v[172:173], v24 offset:32768
 ds_read_b64_tr_b16 v[174:175], v24 offset:34816
 s_mov_b32 s40, 0
L_fz_p6cl:
 buffer_load_dwordx4 v[96:99], v16, s[16:19], s42 offen offset:0 sc1
 s_waitcnt vmcnt(8)
 s_waitcnt lgkmcnt(6)
 v_mfma_f32_16x16x32_bf16 v[192:195], v[160:163], v[128:131], v[192:195]
 ds_read_b64_tr_b16 v[176:177], v21 offset:36864
 ds_read_b64_tr_b16 v[178:179], v21 offset:38912
 s_waitcnt lgkmcnt(6)
 v_mfma_f32_16x16x32_bf16 v[196:199], v[164:167], v[128:131], v[196:199]
 ds_read_b64_tr_b16 v[180:181], v22 offset:36864
 ds_read_b64_tr_b16 v[182:183], v22 offset:38912
 s_waitcnt lgkmcnt(6)
 v_mfma_f32_16x16x32_bf16 v[200:203], v[168:171], v[128:131], v[200:203]
 ds_read_b64_tr_b16 v[184:185], v23 offset:36864
 ds_read_b64_tr_b16 v[186:187], v23 offset:38912
 s_waitcnt lgkmcnt(6)
 v_mfma_f32_16x16x32_bf16 v[204:207], v[172:175], v[128:131], v[204:207]
 ds_read_b64_tr_b16 v[188:189], v24 offset:36864
 ds_read_b64_tr_b16 v[190:191], v24 offset:38912
 buffer_load_dwordx4 v[100:103], v16, s[16:19], s42 offen offset:1024 sc1
 s_waitcnt vmcnt(8)
 s_waitcnt lgkmcnt(6)
 v_mfma_f32_16x16x32_bf16 v[192:195], v[176:179], v[132:135], v[192:195]
 ds_read_b64_tr_b16 v[160:161], v21 offset:40960
 ds_read_b64_tr_b16 v[162:163], v21 offset:43008
 s_waitcnt lgkmcnt(6)
 v_mfma_f32_16x16x32_bf16 v[196:199], v[180:183], v[132:135], v[196:199]
 ds_read_b64_tr_b16 v[164:165], v22 offset:40960
 ds_read_b64_tr_b16 v[166:167], v22 offset:43008
 s_waitcnt lgkmcnt(6)
 v_mfma_f32_16x16x32_bf16 v[200:203], v[184:187], v[132:135], v[200:203]
 ds_read_b64_tr_b16 v[168:169], v23 offset:40960
 ds_read_b64_tr_b16 v[170:171], v23 offset:43008
 s_waitcnt lgkmcnt(6)
 v_mfma_f32_16x16x32_bf16 v[204:207], v[188:191], v[132:135], v[204:207]
 ds_read_b64_tr_b16 v[172:173], v24 offset:40960
 ds_read_b64_tr_b16 v[174:175], v24 offset:43008
 buffer_load_dwordx4 v[104:107], v16, s[16:19], s42 offen offset:2048 sc1
 s_waitcnt vmcnt(8)
 s_waitcnt lgkmcnt(6)
 v_mfma_f32_16x16x32_bf16 v[192:195], v[160:163], v[136:139], v[192:195]
 ds_read_b64_tr_b16 v[176:177], v21 offset:45056
 ds_read_b64_tr_b16 v[178:179], v21 offset:47104
 s_waitcnt lgkmcnt(6)
 v_mfma_f32_16x16x32_bf16 v[196:199], v[164:167], v[136:139], v[196:199]
 ds_read_b64_tr_b16 v[180:181], v22 offset:45056
 ds_read_b64_tr_b16 v[182:183], v22 offset:47104
 s_waitcnt lgkmcnt(6)
 v_mfma_f32_16x16x32_bf16 v[200:203], v[168:171], v[136:139], v[200:203]
 ds_read_b64_tr_b16 v[184:185], v23 offset:45056
 ds_read_b64_tr_b16 v[186:187], v23 offset:47104
 s_waitcnt lgkmcnt(6)
 v_mfma_f32_16x16x32_bf16 v[204:207], v[172:175], v[136:139], v[204:207]
 ds_read_b64_tr_b16 v[188:189], v24 offset:45056
 ds_read_b64_tr_b16 v[190:191], v24 offset:47104
 buffer_load_dwordx4 v[108:111], v16, s[16:19], s42 offen offset:3072 sc1
 s_add_u32 s42, s42, 4096
 s_waitcnt vmcnt(8) lgkmcnt(0)
 s_barrier
 v_mfma_f32_16x16x32_bf16 v[192:195], v[176:179], v[140:143], v[192:195]
 ds_read_b64_tr_b16 v[160:161], v21 offset:49152
 ds_read_b64_tr_b16 v[162:163], v21 offset:51200
 v_mfma_f32_16x16x32_bf16 v[196:199], v[180:183], v[140:143], v[196:199]
 ds_read_b64_tr_b16 v[164:165], v22 offset:49152
 ds_read_b64_tr_b16 v[166:167], v22 offset:51200
 v_mfma_f32_16x16x32_bf16 v[200:203], v[184:187], v[140:143], v[200:203]
 ds_read_b64_tr_b16 v[168:169], v23 offset:49152
 ds_read_b64_tr_b16 v[170:171], v23 offset:51200
 v_mfma_f32_16x16x32_bf16 v[204:207], v[188:191], v[140:143], v[204:207]
 ds_read_b64_tr_b16 v[172:173], v24 offset:49152
 ds_read_b64_tr_b16 v[174:175], v24 offset:51200
 buffer_load_dwordx4 v[112:115], v16, s[16:19], s42 offen offset:0 sc1
 s_waitcnt vmcnt(8)
 s_waitcnt lgkmcnt(6)
 v_mfma_f32_16x16x32_bf16 v[192:195], v[160:163], v[144:147], v[192:195]
 ds_read_b64_tr_b16 v[176:177], v21 offset:53248
 ds_read_b64_tr_b16 v[178:179], v21 offset:55296
 s_waitcnt lgkmcnt(6)
 v_mfma_f32_16x16x32_bf16 v[196:199], v[164:167], v[144:147], v[196:199]
 ds_read_b64_tr_b16 v[180:181], v22 offset:53248
 ds_read_b64_tr_b16 v[182:183], v22 offset:55296
 s_waitcnt lgkmcnt(6)
 v_mfma_f32_16x16x32_bf16 v[200:203], v[168:171], v[144:147], v[200:203]
 ds_read_b64_tr_b16 v[184:185], v23 offset:53248
 ds_read_b64_tr_b16 v[186:187], v23 offset:55296
 s_waitcnt lgkmcnt(6)
 v_mfma_f32_16x16x32_bf16 v[204:207], v[172:175], v[144:147], v[204:207]
 ds_read_b64_tr_b16 v[188:189], v24 offset:53248
 ds_read_b64_tr_b16 v[190:191], v24 offset:55296
 buffer_load_dwordx4 v[116:119], v16, s[16:19], s42 offen offset:1024 sc1
 s_waitcnt vmcnt(8)
 s_waitcnt lgkmcnt(6)
 v_mfma_f32_16x16x32_bf16 v[192:195], v[176:179], v[148:151], v[192:195]
 ds_read_b64_tr_b16 v[160:161], v21 offset:57344
 ds_read_b64_tr_b16 v[162:163], v21 offset:59392
 s_waitcnt lgkmcnt(6)
 v_mfma_f32_16x16x32_bf16 v[196:199], v[180:183], v[148:151], v[196:199]
 ds_read_b64_tr_b16 v[164:165], v22 offset:57344
 ds_read_b64_tr_b16 v[166:167], v22 offset:59392
 s_waitcnt lgkmcnt(6)
 v_mfma_f32_16x16x32_bf16 v[200:203], v[184:187], v[148:151], v[200:203]
 ds_read_b64_tr_b16 v[168:169], v23 offset:57344
 ds_read_b64_tr_b16 v[170:171], v23 offset:59392
 s_waitcnt lgkmcnt(6)
 v_mfma_f32_16x16x32_bf16 v[204:207], v[188:191], v[148:151], v[204:207]
 ds_read_b64_tr_b16 v[172:173], v24 offset:57344
 ds_read_b64_tr_b16 v[174:175], v24 offset:59392
 buffer_load_dwordx4 v[120:123], v16, s[16:19], s42 offen offset:2048 sc1
 s_waitcnt vmcnt(8)
 s_waitcnt lgkmcnt(6)
 v_mfma_f32_16x16x32_bf16 v[192:195], v[160:163], v[152:155], v[192:195]
 ds_read_b64_tr_b16 v[176:177], v21 offset:61440
 ds_read_b64_tr_b16 v[178:179], v21 offset:63488
 s_waitcnt lgkmcnt(6)
 v_mfma_f32_16x16x32_bf16 v[196:199], v[164:167], v[152:155], v[196:199]
 ds_read_b64_tr_b16 v[180:181], v22 offset:61440
 ds_read_b64_tr_b16 v[182:183], v22 offset:63488
 s_waitcnt lgkmcnt(6)
 v_mfma_f32_16x16x32_bf16 v[200:203], v[168:171], v[152:155], v[200:203]
 ds_read_b64_tr_b16 v[184:185], v23 offset:61440
 ds_read_b64_tr_b16 v[186:187], v23 offset:63488
 s_waitcnt lgkmcnt(6)
 v_mfma_f32_16x16x32_bf16 v[204:207], v[172:175], v[152:155], v[204:207]
 ds_read_b64_tr_b16 v[188:189], v24 offset:61440
 ds_read_b64_tr_b16 v[190:191], v24 offset:63488
 buffer_load_dwordx4 v[124:127], v16, s[16:19], s42 offen offset:3072 sc1
 s_add_u32 s42, s42, 4096
 s_waitcnt vmcnt(8) lgkmcnt(0)
 s_barrier
 v_mfma_f32_16x16x32_bf16 v[192:195], v[176:179], v[156:159], v[192:195]
 ds_read_b64_tr_b16 v[160:161], v21 offset:0
 ds_read_b64_tr_b16 v[162:163], v21 offset:2048
 v_mfma_f32_16x16x32_bf16 v[196:199], v[180:183], v[156:159], v[196:199]
 ds_read_b64_tr_b16 v[164:165], v22 offset:0
 ds_read_b64_tr_b16 v[166:167], v22 offset:2048
 v_mfma_f32_16x16x32_bf16 v[200:203], v[184:187], v[156:159], v[200:203]
 ds_read_b64_tr_b16 v[168:169], v23 offset:0
 ds_read_b64_tr_b16 v[170:171], v23 offset:2048
 v_mfma_f32_16x16x32_bf16 v[204:207], v[188:191], v[156:159], v[204:207]
 ds_read_b64_tr_b16 v[172:173], v24 offset:0
 ds_read_b64_tr_b16 v[174:175], v24 offset:2048
 buffer_load_dwordx4 v[128:131], v16, s[16:19], s42 offen offset:0 sc1
 s_waitcnt vmcnt(8)
 s_waitcnt lgkmcnt(6)
 v_mfma_f32_16x16x32_bf16 v[192:195], v[160:163], v[96:99], v[192:195]
 ds_read_b64_tr_b16 v[176:177], v21 offset:4096
 ds_read_b64_tr_b16 v[178:179], v21 offset:6144
 s_waitcnt lgkmcnt(6)
 v_mfma_f32_16x16x32_bf16 v[196:199], v[164:167], v[96:99], v[196:199]
 ds_read_b64_tr_b16 v[180:181], v22 offset:4096
 ds_read_b64_tr_b16 v[182:183], v22 offset:6144
 s_waitcnt lgkmcnt(6)
 v_mfma_f32_16x16x32_bf16 v[200:203], v[168:171], v[96:99], v[200:203]
 ds_read_b64_tr_b16 v[184:185], v23 offset:4096
 ds_read_b64_tr_b16 v[186:187], v23 offset:6144
 s_waitcnt lgkmcnt(6)
 v_mfma_f32_16x16x32_bf16 v[204:207], v[172:175], v[96:99], v[204:207]
 ds_read_b64_tr_b16 v[188:189], v24 offset:4096
 ds_read_b64_tr_b16 v[190:191], v24 offset:6144
 buffer_load_dwordx4 v[132:135], v16, s[16:19], s42 offen offset:1024 sc1
 s_waitcnt vmcnt(8)
 s_waitcnt lgkmcnt(6)
 v_mfma_f32_16x16x32_bf16 v[192:195], v[176:179], v[100:103], v[192:195]
 ds_read_b64_tr_b16 v[160:161], v21 offset:8192
 ds_read_b64_tr_b16 v[162:163], v21 offset:10240
 s_waitcnt lgkmcnt(6)
 v_mfma_f32_16x16x32_bf16 v[196:199], v[180:183], v[100:103], v[196:199]
 ds_read_b64_tr_b16 v[164:165], v22 offset:8192
 ds_read_b64_tr_b16 v[166:167], v22 offset:10240
 s_waitcnt lgkmcnt(6)
 v_mfma_f32_16x16x32_bf16 v[200:203], v[184:187], v[100:103], v[200:203]
 ds_read_b64_tr_b16 v[168:169], v23 offset:8192
 ds_read_b64_tr_b16 v[170:171], v23 offset:10240
 s_waitcnt lgkmcnt(6)
 v_mfma_f32_16x16x32_bf16 v[204:207], v[188:191], v[100:103], v[204:207]
 ds_read_b64_tr_b16 v[172:173], v24 offset:8192
 ds_read_b64_tr_b16 v[174:175], v24 offset:10240
 buffer_load_dwordx4 v[136:139], v16, s[16:19], s42 offen offset:2048 sc1
 s_waitcnt vmcnt(8)
 s_waitcnt lgkmcnt(6)
 v_mfma_f32_16x16x32_bf16 v[192:195], v[160:163], v[104:107], v[192:195]
 ds_read_b64_tr_b16 v[176:177], v21 offset:12288
 ds_read_b64_tr_b16 v[178:179], v21 offset:14336
 s_waitcnt lgkmcnt(6)
 v_mfma_f32_16x16x32_bf16 v[196:199], v[164:167], v[104:107], v[196:199]
 ds_read_b64_tr_b16 v[180:181], v22 offset:12288
 ds_read_b64_tr_b16 v[182:183], v22 offset:14336
 s_waitcnt lgkmcnt(6)
 v_mfma_f32_16x16x32_bf16 v[200:203], v[168:171], v[104:107], v[200:203]
 ds_read_b64_tr_b16 v[184:185], v23 offset:12288
 ds_read_b64_tr_b16 v[186:187], v23 offset:14336
 s_waitcnt lgkmcnt(6)
 v_mfma_f32_16x16x32_bf16 v[204:207], v[172:175], v[104:107], v[204:207]
 ds_read_b64_tr_b16 v[188:189], v24 offset:12288
 ds_read_b64_tr_b16 v[190:191], v24 offset:14336
 buffer_load_dwordx4 v[140:143], v16, s[16:19], s42 offen offset:3072 sc1
 s_add_u32 s42, s42, 4096
 s_waitcnt vmcnt(8) lgkmcnt(0)
 s_barrier
 v_mfma_f32_16x16x32_bf16 v[192:195], v[176:179], v[108:111], v[192:195]
 ds_read_b64_tr_b16 v[160:161], v21 offset:16384
 ds_read_b64_tr_b16 v[162:163], v21 offset:18432
 v_mfma_f32_16x16x32_bf16 v[196:199], v[180:183], v[108:111], v[196:199]
 ds_read_b64_tr_b16 v[164:165], v22 offset:16384
 ds_read_b64_tr_b16 v[166:167], v22 offset:18432
 v_mfma_f32_16x16x32_bf16 v[200:203], v[184:187], v[108:111], v[200:203]
 ds_read_b64_tr_b16 v[168:169], v23 offset:16384
 ds_read_b64_tr_b16 v[170:171], v23 offset:18432
 v_mfma_f32_16x16x32_bf16 v[204:207], v[188:191], v[108:111], v[204:207]
 ds_read_b64_tr_b16 v[172:173], v24 offset:16384
 ds_read_b64_tr_b16 v[174:175], v24 offset:18432
 buffer_load_dwordx4 v[144:147], v16, s[16:19], s42 offen offset:0 sc1
 s_waitcnt vmcnt(8)
 s_waitcnt lgkmcnt(6)
 v_mfma_f32_16x16x32_bf16 v[192:195], v[160:163], v[112:115], v[192:195]
 ds_read_b64_tr_b16 v[176:177], v21 offset:20480
 ds_read_b64_tr_b16 v[178:179], v21 offset:22528
 s_waitcnt lgkmcnt(6)
 v_mfma_f32_16x16x32_bf16 v[196:199], v[164:167], v[112:115], v[196:199]
 ds_read_b64_tr_b16 v[180:181], v22 offset:20480
 ds_read_b64_tr_b16 v[182:183], v22 offset:22528
 s_waitcnt lgkmcnt(6)
 v_mfma_f32_16x16x32_bf16 v[200:203], v[168:171], v[112:115], v[200:203]
 ds_read_b64_tr_b16 v[184:185], v23 offset:20480
 ds_read_b64_tr_b16 v[186:187], v23 offset:22528
 s_waitcnt lgkmcnt(6)
 v_mfma_f32_16x16x32_bf16 v[204:207], v[172:175], v[112:115], v[204:207]
 ds_read_b64_tr_b16 v[188:189], v24 offset:20480
 ds_read_b64_tr_b16 v[190:191], v24 offset:22528
 buffer_load_dwordx4 v[148:151], v16, s[16:19], s42 offen offset:1024 sc1
 s_waitcnt vmcnt(8)
 s_waitcnt lgkmcnt(6)
 v_mfma_f32_16x16x32_bf16 v[192:195], v[176:179], v[116:119], v[192:195]
 ds_read_b64_tr_b16 v[160:161], v21 offset:24576
 ds_read_b64_tr_b16 v[162:163], v21 offset:26624
 s_waitcnt lgkmcnt(6)
 v_mfma_f32_16x16x32_bf16 v[196:199], v[180:183], v[116:119], v[196:199]
 ds_read_b64_tr_b16 v[164:165], v22 offset:24576
 ds_read_b64_tr_b16 v[166:167], v22 offset:26624
 s_waitcnt lgkmcnt(6)
 v_mfma_f32_16x16x32_bf16 v[200:203], v[184:187], v[116:119], v[200:203]
 ds_read_b64_tr_b16 v[168:169], v23 offset:24576
 ds_read_b64_tr_b16 v[170:171], v23 offset:26624
 s_waitcnt lgkmcnt(6)
 v_mfma_f32_16x16x32_bf16 v[204:207], v[188:191], v[116:119], v[204:207]
 ds_read_b64_tr_b16 v[172:173], v24 offset:24576
 ds_read_b64_tr_b16 v[174:175], v24 offset:26624
 buffer_load_dwordx4 v[152:155], v16, s[16:19], s42 offen offset:2048 sc1
 s_waitcnt vmcnt(8)
 s_waitcnt lgkmcnt(6)
 v_mfma_f32_16x16x32_bf16 v[192:195], v[160:163], v[120:123], v[192:195]
 ds_read_b64_tr_b16 v[176:177], v21 offset:28672
 ds_read_b64_tr_b16 v[178:179], v21 offset:30720
 s_waitcnt lgkmcnt(6)
 v_mfma_f32_16x16x32_bf16 v[196:199], v[164:167], v[120:123], v[196:199]
 ds_read_b64_tr_b16 v[180:181], v22 offset:28672
 ds_read_b64_tr_b16 v[182:183], v22 offset:30720
 s_waitcnt lgkmcnt(6)
 v_mfma_f32_16x16x32_bf16 v[200:203], v[168:171], v[120:123], v[200:203]
 ds_read_b64_tr_b16 v[184:185], v23 offset:28672
 ds_read_b64_tr_b16 v[186:187], v23 offset:30720
 s_waitcnt lgkmcnt(6)
 v_mfma_f32_16x16x32_bf16 v[204:207], v[172:175], v[120:123], v[204:207]
 ds_read_b64_tr_b16 v[188:189], v24 offset:28672
 ds_read_b64_tr_b16 v[190:191], v24 offset:30720
 buffer_load_dwordx4 v[156:159], v16, s[16:19], s42 offen offset:3072 sc1
 s_add_u32 s42, s42, 4096
 s_waitcnt vmcnt(8) lgkmcnt(0)
 s_barrier
 v_mfma_f32_16x16x32_bf16 v[192:195], v[176:179], v[124:127], v[192:195]
 ds_read_b64_tr_b16 v[160:161], v21 offset:32768
 ds_read_b64_tr_b16 v[162:163], v21 offset:34816
 v_mfma_f32_16x16x32_bf16 v[196:199], v[180:183], v[124:127], v[196:199]
 ds_read_b64_tr_b16 v[164:165], v22 offset:32768
 ds_read_b64_tr_b16 v[166:167], v22 offset:34816
 v_mfma_f32_16x16x32_bf16 v[200:203], v[184:187], v[124:127], v[200:203]
 ds_read_b64_tr_b16 v[168:169], v23 offset:32768
 ds_read_b64_tr_b16 v[170:171], v23 offset:34816
 v_mfma_f32_16x16x32_bf16 v[204:207], v[188:191], v[124:127], v[204:207]
 ds_read_b64_tr_b16 v[172:173], v24 offset:32768
 ds_read_b64_tr_b16 v[174:175], v24 offset:34816
 s_add_u32 s40, s40, 1
 s_cmp_lt_u32 s40, 3
 s_cbranch_scc1 L_fz_p6cl
 buffer_load_dwordx4 v[96:99], v16, s[16:19], s42 offen offset:0 sc1
 s_waitcnt vmcnt(8)
 s_waitcnt lgkmcnt(6)
 v_mfma_f32_16x16x32_bf16 v[192:195], v[160:163], v[128:131], v[192:195]
 ds_read_b64_tr_b16 v[176:177], v21 offset:36864
 ds_read_b64_tr_b16 v[178:179], v21 offset:38912
 s_waitcnt lgkmcnt(6)
 v_mfma_f32_16x16x32_bf16 v[196:199], v[164:167], v[128:131], v[196:199]
 ds_read_b64_tr_b16 v[180:181], v22 offset:36864
 ds_read_b64_tr_b16 v[182:183], v22 offset:38912
 s_waitcnt lgkmcnt(6)
 v_mfma_f32_16x16x32_bf16 v[200:203], v[168:171], v[128:131], v[200:203]
 ds_read_b64_tr_b16 v[184:185], v23 offset:36864
 ds_read_b64_tr_b16 v[186:187], v23 offset:38912
 s_waitcnt lgkmcnt(6)
 v_mfma_f32_16x16x32_bf16 v[204:207], v[172:175], v[128:131], v[204:207]
 ds_read_b64_tr_b16 v[188:189], v24 offset:36864
 ds_read_b64_tr_b16 v[190:191], v24 offset:38912
 buffer_load_dwordx4 v[100:103], v16, s[16:19], s42 offen offset:1024 sc1
 s_waitcnt vmcnt(8)
 s_waitcnt lgkmcnt(6)
 v_mfma_f32_16x16x32_bf16 v[192:195], v[176:179], v[132:135], v[192:195]
 ds_read_b64_tr_b16 v[160:161], v21 offset:40960
 ds_read_b64_tr_b16 v[162:163], v21 offset:43008
 s_waitcnt lgkmcnt(6)
 v_mfma_f32_16x16x32_bf16 v[196:199], v[180:183], v[132:135], v[196:199]
 ds_read_b64_tr_b16 v[164:165], v22 offset:40960
 ds_read_b64_tr_b16 v[166:167], v22 offset:43008
 s_waitcnt lgkmcnt(6)
 v_mfma_f32_16x16x32_bf16 v[200:203], v[184:187], v[132:135], v[200:203]
 ds_read_b64_tr_b16 v[168:169], v23 offset:40960
 ds_read_b64_tr_b16 v[170:171], v23 offset:43008
 s_waitcnt lgkmcnt(6)
 v_mfma_f32_16x16x32_bf16 v[204:207], v[188:191], v[132:135], v[204:207]
 ds_read_b64_tr_b16 v[172:173], v24 offset:40960
 ds_read_b64_tr_b16 v[174:175], v24 offset:43008
 buffer_load_dwordx4 v[104:107], v16, s[16:19], s42 offen offset:2048 sc1
 s_waitcnt vmcnt(8)
 s_waitcnt lgkmcnt(6)
 v_mfma_f32_16x16x32_bf16 v[192:195], v[160:163], v[136:139], v[192:195]
 ds_read_b64_tr_b16 v[176:177], v21 offset:45056
 ds_read_b64_tr_b16 v[178:179], v21 offset:47104
 s_waitcnt lgkmcnt(6)
 v_mfma_f32_16x16x32_bf16 v[196:199], v[164:167], v[136:139], v[196:199]
 ds_read_b64_tr_b16 v[180:181], v22 offset:45056
 ds_read_b64_tr_b16 v[182:183], v22 offset:47104
 s_waitcnt lgkmcnt(6)
 v_mfma_f32_16x16x32_bf16 v[200:203], v[168:171], v[136:139], v[200:203]
 ds_read_b64_tr_b16 v[184:185], v23 offset:45056
 ds_read_b64_tr_b16 v[186:187], v23 offset:47104
 s_waitcnt lgkmcnt(6)
 v_mfma_f32_16x16x32_bf16 v[204:207], v[172:175], v[136:139], v[204:207]
 ds_read_b64_tr_b16 v[188:189], v24 offset:45056
 ds_read_b64_tr_b16 v[190:191], v24 offset:47104
 buffer_load_dwordx4 v[108:111], v16, s[16:19], s42 offen offset:3072 sc1
 s_add_u32 s42, s42, 4096
 s_waitcnt vmcnt(8) lgkmcnt(0)
 s_barrier
 v_mfma_f32_16x16x32_bf16 v[192:195], v[176:179], v[140:143], v[192:195]
 ds_read_b64_tr_b16 v[160:161], v21 offset:49152
 ds_read_b64_tr_b16 v[162:163], v21 offset:51200
 v_mfma_f32_16x16x32_bf16 v[196:199], v[180:183], v[140:143], v[196:199]
 ds_read_b64_tr_b16 v[164:165], v22 offset:49152
 ds_read_b64_tr_b16 v[166:167], v22 offset:51200
 v_mfma_f32_16x16x32_bf16 v[200:203], v[184:187], v[140:143], v[200:203]
 ds_read_b64_tr_b16 v[168:169], v23 offset:49152
 ds_read_b64_tr_b16 v[170:171], v23 offset:51200
 v_mfma_f32_16x16x32_bf16 v[204:207], v[188:191], v[140:143], v[204:207]
 ds_read_b64_tr_b16 v[172:173], v24 offset:49152
 ds_read_b64_tr_b16 v[174:175], v24 offset:51200
 buffer_load_dwordx4 v[112:115], v16, s[16:19], s42 offen offset:0 sc1
 s_waitcnt vmcnt(8)
 s_waitcnt lgkmcnt(6)
 v_mfma_f32_16x16x32_bf16 v[192:195], v[160:163], v[144:147], v[192:195]
 ds_read_b64_tr_b16 v[176:177], v21 offset:53248
 ds_read_b64_tr_b16 v[178:179], v21 offset:55296
 s_waitcnt lgkmcnt(6)
 v_mfma_f32_16x16x32_bf16 v[196:199], v[164:167], v[144:147], v[196:199]
 ds_read_b64_tr_b16 v[180:181], v22 offset:53248
 ds_read_b64_tr_b16 v[182:183], v22 offset:55296
 s_waitcnt lgkmcnt(6)
 v_mfma_f32_16x16x32_bf16 v[200:203], v[168:171], v[144:147], v[200:203]
 ds_read_b64_tr_b16 v[184:185], v23 offset:53248
 ds_read_b64_tr_b16 v[186:187], v23 offset:55296
 s_waitcnt lgkmcnt(6)
 v_mfma_f32_16x16x32_bf16 v[204:207], v[172:175], v[144:147], v[204:207]
 ds_read_b64_tr_b16 v[188:189], v24 offset:53248
 ds_read_b64_tr_b16 v[190:191], v24 offset:55296
 buffer_load_dwordx4 v[116:119], v16, s[16:19], s42 offen offset:1024 sc1
 s_waitcnt vmcnt(8)
 s_waitcnt lgkmcnt(6)
 v_mfma_f32_16x16x32_bf16 v[192:195], v[176:179], v[148:151], v[192:195]
 ds_read_b64_tr_b16 v[160:161], v21 offset:57344
 ds_read_b64_tr_b16 v[162:163], v21 offset:59392
 s_waitcnt lgkmcnt(6)
 v_mfma_f32_16x16x32_bf16 v[196:199], v[180:183], v[148:151], v[196:199]
 ds_read_b64_tr_b16 v[164:165], v22 offset:57344
 ds_read_b64_tr_b16 v[166:167], v22 offset:59392
 s_waitcnt lgkmcnt(6)
 v_mfma_f32_16x16x32_bf16 v[200:203], v[184:187], v[148:151], v[200:203]
 ds_read_b64_tr_b16 v[168:169], v23 offset:57344
 ds_read_b64_tr_b16 v[170:171], v23 offset:59392
 s_waitcnt lgkmcnt(6)
 v_mfma_f32_16x16x32_bf16 v[204:207], v[188:191], v[148:151], v[204:207]
 ds_read_b64_tr_b16 v[172:173], v24 offset:57344
 ds_read_b64_tr_b16 v[174:175], v24 offset:59392
 buffer_load_dwordx4 v[120:123], v16, s[16:19], s42 offen offset:2048 sc1
 s_waitcnt vmcnt(8)
 s_waitcnt lgkmcnt(6)
 v_mfma_f32_16x16x32_bf16 v[192:195], v[160:163], v[152:155], v[192:195]
 ds_read_b64_tr_b16 v[176:177], v21 offset:61440
 ds_read_b64_tr_b16 v[178:179], v21 offset:63488
 s_waitcnt lgkmcnt(6)
 v_mfma_f32_16x16x32_bf16 v[196:199], v[164:167], v[152:155], v[196:199]
 ds_read_b64_tr_b16 v[180:181], v22 offset:61440
 ds_read_b64_tr_b16 v[182:183], v22 offset:63488
 s_waitcnt lgkmcnt(6)
 v_mfma_f32_16x16x32_bf16 v[200:203], v[168:171], v[152:155], v[200:203]
 ds_read_b64_tr_b16 v[184:185], v23 offset:61440
 ds_read_b64_tr_b16 v[186:187], v23 offset:63488
 s_waitcnt lgkmcnt(6)
 v_mfma_f32_16x16x32_bf16 v[204:207], v[172:175], v[152:155], v[204:207]
 ds_read_b64_tr_b16 v[188:189], v24 offset:61440
 ds_read_b64_tr_b16 v[190:191], v24 offset:63488
 buffer_load_dwordx4 v[124:127], v16, s[16:19], s42 offen offset:3072 sc1
 s_add_u32 s42, s42, 4096
 s_waitcnt vmcnt(8) lgkmcnt(0)
 s_barrier
 v_mfma_f32_16x16x32_bf16 v[192:195], v[176:179], v[156:159], v[192:195]
 ds_read_b64_tr_b16 v[160:161], v21 offset:0
 ds_read_b64_tr_b16 v[162:163], v21 offset:2048
 v_mfma_f32_16x16x32_bf16 v[196:199], v[180:183], v[156:159], v[196:199]
 ds_read_b64_tr_b16 v[164:165], v22 offset:0
 ds_read_b64_tr_b16 v[166:167], v22 offset:2048
 v_mfma_f32_16x16x32_bf16 v[200:203], v[184:187], v[156:159], v[200:203]
 ds_read_b64_tr_b16 v[168:169], v23 offset:0
 ds_read_b64_tr_b16 v[170:171], v23 offset:2048
 v_mfma_f32_16x16x32_bf16 v[204:207], v[188:191], v[156:159], v[204:207]
 ds_read_b64_tr_b16 v[172:173], v24 offset:0
 ds_read_b64_tr_b16 v[174:175], v24 offset:2048
 s_waitcnt vmcnt(7)
 s_waitcnt lgkmcnt(6)
 v_mfma_f32_16x16x32_bf16 v[192:195], v[160:163], v[96:99], v[192:195]
 ds_read_b64_tr_b16 v[176:177], v21 offset:4096
 ds_read_b64_tr_b16 v[178:179], v21 offset:6144
 s_waitcnt lgkmcnt(6)
 v_mfma_f32_16x16x32_bf16 v[196:199], v[164:167], v[96:99], v[196:199]
 ds_read_b64_tr_b16 v[180:181], v22 offset:4096
 ds_read_b64_tr_b16 v[182:183], v22 offset:6144
 s_waitcnt lgkmcnt(6)
 v_mfma_f32_16x16x32_bf16 v[200:203], v[168:171], v[96:99], v[200:203]
 ds_read_b64_tr_b16 v[184:185], v23 offset:4096
 ds_read_b64_tr_b16 v[186:187], v23 offset:6144
 s_waitcnt lgkmcnt(6)
 v_mfma_f32_16x16x32_bf16 v[204:207], v[172:175], v[96:99], v[204:207]
 ds_read_b64_tr_b16 v[188:189], v24 offset:4096
 ds_read_b64_tr_b16 v[190:191], v24 offset:6144
 s_waitcnt vmcnt(6)
 s_waitcnt lgkmcnt(6)
 v_mfma_f32_16x16x32_bf16 v[192:195], v[176:179], v[100:103], v[192:195]
 ds_read_b64_tr_b16 v[160:161], v21 offset:8192
 ds_read_b64_tr_b16 v[162:163], v21 offset:10240
 s_waitcnt lgkmcnt(6)
 v_mfma_f32_16x16x32_bf16 v[196:199], v[180:183], v[100:103], v[196:199]
 ds_read_b64_tr_b16 v[164:165], v22 offset:8192
 ds_read_b64_tr_b16 v[166:167], v22 offset:10240
 s_waitcnt lgkmcnt(6)
 v_mfma_f32_16x16x32_bf16 v[200:203], v[184:187], v[100:103], v[200:203]
 ds_read_b64_tr_b16 v[168:169], v23 offset:8192
 ds_read_b64_tr_b16 v[170:171], v23 offset:10240
 s_waitcnt lgkmcnt(6)
 v_mfma_f32_16x16x32_bf16 v[204:207], v[188:191], v[100:103], v[204:207]
 ds_read_b64_tr_b16 v[172:173], v24 offset:8192
 ds_read_b64_tr_b16 v[174:175], v24 offset:10240
 s_waitcnt vmcnt(5)
 s_waitcnt lgkmcnt(6)
 v_mfma_f32_16x16x32_bf16 v[192:195], v[160:163], v[104:107], v[192:195]
 ds_read_b64_tr_b16 v[176:177], v21 offset:12288
 ds_read_b64_tr_b16 v[178:179], v21 offset:14336
 s_waitcnt lgkmcnt(6)
 v_mfma_f32_16x16x32_bf16 v[196:199], v[164:167], v[104:107], v[196:199]
 ds_read_b64_tr_b16 v[180:181], v22 offset:12288
 ds_read_b64_tr_b16 v[182:183], v22 offset:14336
 s_waitcnt lgkmcnt(6)
 v_mfma_f32_16x16x32_bf16 v[200:203], v[168:171], v[104:107], v[200:203]
 ds_read_b64_tr_b16 v[184:185], v23 offset:12288
 ds_read_b64_tr_b16 v[186:187], v23 offset:14336
 s_waitcnt lgkmcnt(6)
 v_mfma_f32_16x16x32_bf16 v[204:207], v[172:175], v[104:107], v[204:207]
 ds_read_b64_tr_b16 v[188:189], v24 offset:12288
 ds_read_b64_tr_b16 v[190:191], v24 offset:14336
 s_waitcnt vmcnt(4) lgkmcnt(0)
 s_barrier
 v_mfma_f32_16x16x32_bf16 v[192:195], v[176:179], v[108:111], v[192:195]
 ds_read_b64_tr_b16 v[160:161], v21 offset:16384
 ds_read_b64_tr_b16 v[162:163], v21 offset:18432
 v_mfma_f32_16x16x32_bf16 v[196:199], v[180:183], v[108:111], v[196:199]
 ds_read_b64_tr_b16 v[164:165], v22 offset:16384
 ds_read_b64_tr_b16 v[166:167], v22 offset:18432
 v_mfma_f32_16x16x32_bf16 v[200:203], v[184:187], v[108:111], v[200:203]
 ds_read_b64_tr_b16 v[168:169], v23 offset:16384
 ds_read_b64_tr_b16 v[170:171], v23 offset:18432
 v_mfma_f32_16x16x32_bf16 v[204:207], v[188:191], v[108:111], v[204:207]
 ds_read_b64_tr_b16 v[172:173], v24 offset:16384
 ds_read_b64_tr_b16 v[174:175], v24 offset:18432
 s_waitcnt vmcnt(3)
 s_waitcnt lgkmcnt(6)
 v_mfma_f32_16x16x32_bf16 v[192:195], v[160:163], v[112:115], v[192:195]
 ds_read_b64_tr_b16 v[176:177], v21 offset:20480
 ds_read_b64_tr_b16 v[178:179], v21 offset:22528
 s_waitcnt lgkmcnt(6)
 v_mfma_f32_16x16x32_bf16 v[196:199], v[164:167], v[112:115], v[196:199]
 ds_read_b64_tr_b16 v[180:181], v22 offset:20480
 ds_read_b64_tr_b16 v[182:183], v22 offset:22528
 s_waitcnt lgkmcnt(6)
 v_mfma_f32_16x16x32_bf16 v[200:203], v[168:171], v[112:115], v[200:203]
 ds_read_b64_tr_b16 v[184:185], v23 offset:20480
 ds_read_b64_tr_b16 v[186:187], v23 offset:22528
 s_waitcnt lgkmcnt(6)
 v_mfma_f32_16x16x32_bf16 v[204:207], v[172:175], v[112:115], v[204:207]
 ds_read_b64_tr_b16 v[188:189], v24 offset:20480
 ds_read_b64_tr_b16 v[190:191], v24 offset:22528
 s_waitcnt vmcnt(2)
 s_waitcnt lgkmcnt(6)
 v_mfma_f32_16x16x32_bf16 v[192:195], v[176:179], v[116:119], v[192:195]
 ds_read_b64_tr_b16 v[160:161], v21 offset:24576
 ds_read_b64_tr_b16 v[162:163], v21 offset:26624
 s_waitcnt lgkmcnt(6)
 v_mfma_f32_16x16x32_bf16 v[196:199], v[180:183], v[116:119], v[196:199]
 ds_read_b64_tr_b16 v[164:165], v22 offset:24576
 ds_read_b64_tr_b16 v[166:167], v22 offset:26624
 s_waitcnt lgkmcnt(6)
 v_mfma_f32_16x16x32_bf16 v[200:203], v[184:187], v[116:119], v[200:203]
 ds_read_b64_tr_b16 v[168:169], v23 offset:24576
 ds_read_b64_tr_b16 v[170:171], v23 offset:26624
 s_waitcnt lgkmcnt(6)
 v_mfma_f32_16x16x32_bf16 v[204:207], v[188:191], v[116:119], v[204:207]
 ds_read_b64_tr_b16 v[172:173], v24 offset:24576
 ds_read_b64_tr_b16 v[174:175], v24 offset:26624
 s_waitcnt vmcnt(1)
 s_waitcnt lgkmcnt(6)
 v_mfma_f32_16x16x32_bf16 v[192:195], v[160:163], v[120:123], v[192:195]
 ds_read_b64_tr_b16 v[176:177], v21 offset:28672
 ds_read_b64_tr_b16 v[178:179], v21 offset:30720
 s_waitcnt lgkmcnt(6)
 v_mfma_f32_16x16x32_bf16 v[196:199], v[164:167], v[120:123], v[196:199]
 ds_read_b64_tr_b16 v[180:181], v22 offset:28672
 ds_read_b64_tr_b16 v[182:183], v22 offset:30720
 s_waitcnt lgkmcnt(6)
 v_mfma_f32_16x16x32_bf16 v[200:203], v[168:171], v[120:123], v[200:203]
 ds_read_b64_tr_b16 v[184:185], v23 offset:28672
 ds_read_b64_tr_b16 v[186:187], v23 offset:30720
 s_waitcnt lgkmcnt(6)
 v_mfma_f32_16x16x32_bf16 v[204:207], v[172:175], v[120:123], v[204:207]
 ds_read_b64_tr_b16 v[188:189], v24 offset:28672
 ds_read_b64_tr_b16 v[190:191], v24 offset:30720
 s_waitcnt vmcnt(0)
 s_waitcnt lgkmcnt(6)
 v_mfma_f32_16x16x32_bf16 v[192:195], v[176:179], v[124:127], v[192:195]
 s_waitcnt lgkmcnt(4)
 v_mfma_f32_16x16x32_bf16 v[196:199], v[180:183], v[124:127], v[196:199]
 s_waitcnt lgkmcnt(2)
 v_mfma_f32_16x16x32_bf16 v[200:203], v[184:187], v[124:127], v[200:203]
 s_waitcnt lgkmcnt(0)
 v_mfma_f32_16x16x32_bf16 v[204:207], v[188:191], v[124:127], v[204:207]
 v_lshlrev_b32 v96, 16, v208
 v_and_b32 v97, 0xffff0000, v208
 v_lshlrev_b32 v98, 16, v209
 v_and_b32 v99, 0xffff0000, v209
 v_lshlrev_b32 v100, 16, v210
 v_and_b32 v101, 0xffff0000, v210
 v_lshlrev_b32 v102, 16, v211
 v_and_b32 v103, 0xffff0000, v211
 v_lshlrev_b32 v104, 16, v212
 v_and_b32 v105, 0xffff0000, v212
 v_lshlrev_b32 v106, 16, v213
 v_and_b32 v107, 0xffff0000, v213
 v_lshlrev_b32 v108, 16, v214
 v_and_b32 v109, 0xffff0000, v214
 v_lshlrev_b32 v110, 16, v215
 v_and_b32 v111, 0xffff0000, v215
 v_pk_add_f32 v[192:193], v[192:193], v[96:97]
 v_pk_add_f32 v[194:195], v[194:195], v[98:99]
 v_pk_add_f32 v[196:197], v[196:197], v[100:101]
 v_pk_add_f32 v[198:199], v[198:199], v[102:103]
 v_pk_add_f32 v[200:201], v[200:201], v[104:105]
 v_pk_add_f32 v[202:203], v[202:203], v[106:107]
 v_pk_add_f32 v[204:205], v[204:205], v[108:109]
 v_pk_add_f32 v[206:207], v[206:207], v[110:111]
 v_cvt_pk_bf16_f32 v112, v192, v193
 v_cvt_pk_bf16_f32 v114, v196, v197
 v_cvt_pk_bf16_f32 v113, v194, v195
 v_cvt_pk_bf16_f32 v115, v198, v199
 s_nop 0
 v_permlane16_swap_b32 v112, v114
 v_permlane16_swap_b32 v113, v115
 ds_write_b128 v28, v[112:115] offset:0
 v_cvt_pk_bf16_f32 v116, v200, v201
 v_cvt_pk_bf16_f32 v118, v204, v205
 v_cvt_pk_bf16_f32 v117, v202, v203
 v_cvt_pk_bf16_f32 v119, v206, v207
 s_nop 0
 v_permlane16_swap_b32 v116, v118
 v_permlane16_swap_b32 v117, v119
 ds_write_b128 v28, v[116:119] offset:64
 ds_read_b128 v[96:99], v29
 ds_read_b128 v[100:103], v29 offset:1152
 s_movk_i32 s36, 9216
 s_waitcnt lgkmcnt(1)
 buffer_store_dwordx4 v[96:99], v30, s[20:23], 0 offen sc1
 s_waitcnt lgkmcnt(0)
 buffer_store_dwordx4 v[100:103], v30, s[20:23], s36 offen sc1
L_fz_p6end:
L_fz_last:
 s_cmp_lg_u32 s2, 0
 s_cbranch_scc1 L_fz_end
 s_cmp_lg_u32 s3, 0
 s_cbranch_scc1 L_fz_end
 v_mov_b32 v2, 0
 v_mov_b32 v3, s100
 s_mov_b64 exec, 1
 global_store_dword v2, v3, s[10:11] sc1
L_fz_end:
 s_endpgm

.section .rodata,"a"
.p2align 6
.amdhsa_kernel sequential_preLN__sliding_block__mixer_gmlp__prompt_kernel
  .amdhsa_next_free_vgpr 256
  .amdhsa_next_free_sgpr 102
  .amdhsa_accum_offset 256
  .amdhsa_group_segment_fixed_size 0
  .amdhsa_kernarg_size 88
  .amdhsa_user_sgpr_count 2
  .amdhsa_user_sgpr_kernarg_segment_ptr 1
  .amdhsa_system_sgpr_workgroup_id_x 1
  .amdhsa_float_denorm_mode_32 3
.end_amdhsa_kernel
```
